```python
import torch

def _softmax(x, axis=-1):
    return torch.softmax(x, dim=axis)

def _gelu(x):
    return torch.nn.functional.gelu(x, approximate='tanh')

def _silu(x):
    return torch.nn.functional.silu(x)

def _sigmoid(x):
    return torch.sigmoid(x)

def _layernorm(x, axis=-1, eps=1e-05):
    m = x.mean(dim=axis, keepdim=True)
    v = x.var(dim=axis, keepdim=True, unbiased=False)
    return (x - m) / torch.sqrt(v + eps)

def _scatter_add(tgt, idx, src, axis=0):
    return tgt.clone().index_add_(axis, idx, src)

def _segment_sum(src, seg, n):
    out = torch.zeros((n,) + src.shape[1:], dtype=src.dtype)
    return out.index_add_(0, seg, src)

def _pad(x, pw):
    flat = tuple((v for pair in reversed(pw) for v in pair))
    return torch.nn.functional.pad(x, flat)
kernel_name = 'gated_mix__memory_aug_recurrent_mem_tr__glu_gated_swiglu__prompt'

def setup_inputs():

    _w = lambda a: (lambda t: t.to(torch.bfloat16) if t.is_floating_point() else t)(torch.as_tensor(a))

    def _A_setup():
        B, S, Dm = (1, 2048, 512)
        H, Dh = (32, 128)
        M, seg = (8, 32)
        seg = min(seg, S)
        S = S // seg * seg
        return {'x': _w((lambda *s: torch.randn(*s, dtype=torch.bfloat16) * 0.05)(B, S, Dm)), 'mem0': _w((lambda *s: torch.randn(*s, dtype=torch.bfloat16) * 0.4)(B, M, Dm)), 'Wq': _w((lambda *s: torch.randn(*s, dtype=torch.bfloat16) * 6.4)(Dm, H, Dh) * Dm ** (-0.5)), 'Wk': _w((lambda *s: torch.randn(*s, dtype=torch.bfloat16) * 6.4)(Dm, H, Dh) * Dm ** (-0.5)), 'Wv': _w((lambda *s: torch.randn(*s, dtype=torch.bfloat16) * 0.4)(Dm, H, Dh) * Dm ** (-0.5)), 'Wo': _w((lambda *s: torch.randn(*s, dtype=torch.bfloat16) * 0.4)(H, Dh, Dm) * (H * Dh) ** (-0.5)), 'seg_len': seg}
    _A_in = _A_setup()

    def _B_setup():
        B, S, D, F = (1, 2048, 512, 1792)
        return {'x': _w((lambda *s: torch.randn(*s, dtype=torch.bfloat16) * 0.05)(B, S, D)), 'w1': _w((lambda *s: torch.randn(*s, dtype=torch.bfloat16) * 0.8)(D, F) * (2.0 / D) ** 0.5), 'w3': _w((lambda *s: torch.randn(*s, dtype=torch.bfloat16) * 0.8)(D, F) * (2.0 / D) ** 0.5), 'w2': _w((lambda *s: torch.randn(*s, dtype=torch.bfloat16) * 0.8)(F, D) * (2.0 / F) ** 0.5)}
    _B_in = _B_setup()
    return {'A_x': _A_in['x'], 'A_mem0': _A_in['mem0'], 'A_Wq': _A_in['Wq'], 'A_Wk': _A_in['Wk'], 'A_Wv': _A_in['Wv'], 'A_Wo': _A_in['Wo'], 'A_seg_len': _A_in['seg_len'], 'B_x': _B_in['x'], 'B_w1': _B_in['w1'], 'B_w3': _B_in['w3'], 'B_w2': _B_in['w2'], 'gate_w': _w((lambda *s: torch.randn(*s, dtype=torch.bfloat16) * 0.05)(512) * 16.0)}

def reference(A_x, A_mem0, A_Wq, A_Wk, A_Wv, A_Wo, A_seg_len, B_x, B_w1, B_w3, B_w2, gate_w):

    def _A_ref(x, mem0, Wq, Wk, Wv, Wo, seg_len):
        B, S, Dm = x.shape
        H, Dh = (Wq.shape[1], Wq.shape[2])
        M = mem0.shape[1]
        scale = Dh ** (-0.5)
        n_seg = S // seg_len
        L = M + seg_len
        idx = torch.arange(L)
        mask = (idx[:, None] < M) | (idx[:, None] >= idx[None, :])
        mem = mem0
        outs = []
        for s in range(n_seg):
            xs = x[:, s * seg_len:(s + 1) * seg_len, :].clone()
            h = torch.concatenate([mem, xs], axis=1)
            q = torch.einsum('btd,dhe->bhte', h, Wq)
            k = torch.einsum('btd,dhe->bhte', h, Wk)
            v = torch.einsum('btd,dhe->bhte', h, Wv)
            scores = torch.einsum('bhqe,bhke->bhqk', q, k) * scale
            scores = torch.where(mask[None, None], scores, -1000000000.0)
            p = _softmax(scores, axis=-1)
            o = torch.einsum('bhqk,bhke->bhqe', p, v)
            o = torch.einsum('bhte,hed->btd', o, Wo)
            mem = o[:, :M, :].clone()
            outs.append(o[:, M:, :])
        return torch.concatenate(outs, axis=1)

    def _B_ref(x, w1, w3, w2):
        gate = torch.einsum('bsd,df->bsf', x, w1)
        up = torch.einsum('bsd,df->bsf', x, w3)
        h = _silu(gate) * up
        out = torch.einsum('bsf,fd->bsd', h, w2)
        return out
    x = A_x
    g = _sigmoid((x * gate_w).sum(-1, keepdims=True))
    a = _A_ref(x, A_mem0, A_Wq, A_Wk, A_Wv, A_Wo, A_seg_len)
    b = _B_ref(x, B_w1, B_w3, B_w2)
    return g * a + (1 - g) * b
```

```asm
; @launch grid=(256,1,1) block=(256,1,1) lds=163840
.amdgcn_target "amdgcn-amd-amdhsa--gfx950"
.text
.globl gated_mix__memory_aug_recurrent_mem_tr__glu_gated_swiglu__prompt_kernel
.p2align 8
.type gated_mix__memory_aug_recurrent_mem_tr__glu_gated_swiglu__prompt_kernel,@function
gated_mix__memory_aug_recurrent_mem_tr__glu_gated_swiglu__prompt_kernel:

  s_cmp_ge_u32 s2, 256
  s_cbranch_scc1 L_exit
  s_load_dwordx2 s[6:7], s[0:1], 104
  s_load_dwordx2 s[4:5], s[0:1], 112
  s_getreg_b32 s12, hwreg(HW_REG_XCC_ID, 0, 4)
  v_lshrrev_b32 v1, 6, v0
  s_nop 0
  v_readfirstlane_b32 s8, v1
  v_and_b32 v31, 63, v0
  s_waitcnt lgkmcnt(0)
  s_cmp_lg_u32 s8, 0
  s_cbranch_scc0 L_w0
  s_getpc_b64 s[16:17]
L_pc:
  s_sub_u32 s18, s8, 1
  s_mul_i32 s18, s18, 8192
  s_add_u32 s16, s16, s18
  s_addc_u32 s17, s17, 0
  v_lshlrev_b32 v2, 7, v31
  s_mov_b32 s19, (L_code_end - L_pc + 24575) / 24576
L_pfc:
  global_load_dword a255, v2, s[16:17]
  s_add_u32 s16, s16, 24576
  s_addc_u32 s17, s17, 0
  s_sub_u32 s19, s19, 1
  s_cmp_lg_u32 s19, 0
  s_cbranch_scc1 L_pfc
  s_branch L_role
L_w0:
  s_lshl_b32 s13, s12, 2
  s_add_u32 s13, s13, 64
  v_mov_b32 v2, s13
  v_mov_b32 v3, 1
  s_mov_b64 exec, 1
  global_atomic_add v4, v2, v3, s[6:7] sc0
  s_mov_b64 exec, -1
  s_lshl_b32 s13, s2, 12
  s_add_u32 s13, s13, 150999040
  v_lshlrev_b32 v6, 7, v31
  v_add_u32 v6, s13, v6
  v_mov_b32 v7, 0
  s_mov_b64 exec, 0xffffffff
  global_store_dword v6, v7, s[4:5] sc1
  s_mov_b64 exec, -1
  s_lshl_b32 s13, s2, 11
  s_add_u32 s13, s13, 71303168
  v_lshlrev_b32 v6, 4, v31
  v_add_u32 v6, s13, v6
  v_mov_b32 v8, -1
  v_mov_b32 v9, -1
  v_mov_b32 v10, -1
  v_mov_b32 v11, -1
  global_store_dwordx4 v6, v[8:11], s[4:5] sc1
  global_store_dwordx4 v6, v[8:11], s[4:5] offset:1024 sc1
  s_mov_b64 exec, 1
  s_mov_b32 s20, 0
  s_waitcnt vmcnt(3)
  v_readfirstlane_b32 s15, v4
  s_lshl_b32 s14, s12, 5
  s_add_u32 s14, s14, s15
  s_cmp_lt_u32 s15, 32
  s_cbranch_scc0 L_ovf
  s_cmp_lt_u32 s12, 8
  s_cbranch_scc1 L_haverole
L_ovf:
  s_waitcnt vmcnt(0)
  v_mov_b32 v2, 16
  global_atomic_add v2, v3, s[6:7]
  s_mov_b32 s20, 1
  v_mov_b32 v2, 16
  s_mov_b32 s16, 0
L_ovfw:
  global_load_dword v4, v2, s[6:7] sc1
  s_add_u32 s16, s16, 1
  s_mov_b32 s14, 0xffff
  s_cmp_gt_u32 s16, 0x40000
  s_cbranch_scc1 L_haverole
  s_waitcnt vmcnt(0)
  v_readfirstlane_b32 s17, v4
  s_nop 0
  s_cmp_lt_u32 s17, 256
  s_cbranch_scc1 L_ovfw
  v_mov_b32 v2, 24
  global_atomic_add v4, v2, v3, s[6:7] sc0
  s_waitcnt vmcnt(0)
  v_readfirstlane_b32 s16, v4
  s_mov_b32 s17, 0
L_ovfl:
  s_lshl_b32 s13, s17, 2
  s_add_u32 s13, s13, 64
  v_mov_b32 v2, s13
  global_load_dword v4, v2, s[6:7] sc1
  s_waitcnt vmcnt(0)
  v_readfirstlane_b32 s18, v4
  s_nop 0
  s_min_u32 s18, s18, 32
  s_sub_u32 s19, 32, s18
  s_cmp_lt_u32 s16, s19
  s_cbranch_scc1 L_ovfg
  s_sub_u32 s16, s16, s19
  s_add_u32 s17, s17, 1
  s_cmp_lt_u32 s17, 8
  s_cbranch_scc1 L_ovfl
  s_mov_b32 s14, 0xffff
  s_branch L_haverole
L_ovfg:
  s_lshl_b32 s14, s17, 5
  s_add_u32 s14, s14, s18
  s_add_u32 s14, s14, s16
L_haverole:
  v_mov_b32 v4, s14
  v_mov_b32 v5, 161920
  ds_write_b32 v5, v4
  s_waitcnt lgkmcnt(0)
  s_mov_b64 exec, -1
L_role:
  s_barrier
  v_mov_b32 v5, 161920
  ds_read_b32 v4, v5
  s_waitcnt lgkmcnt(0)
  v_readfirstlane_b32 s14, v4
  s_barrier
  s_cmp_lg_u32 s8, 0
  s_cbranch_scc1 L_cnt
  s_cmp_lg_u32 s20, 0
  s_cbranch_scc1 L_cnt
  s_waitcnt vmcnt(0)
  v_mov_b32 v2, 16
  v_mov_b32 v3, 1
  s_mov_b64 exec, 1
  global_atomic_add v2, v3, s[6:7]
  s_mov_b64 exec, -1
L_cnt:
  s_cmp_ge_u32 s14, 256
  s_cbranch_scc1 L_exit
  s_cmp_ge_u32 s14, 32
  s_cbranch_scc1 L_worker
  s_mov_b32 s9, s14
  s_load_dwordx2 s[60:61], s[0:1], 8
  s_load_dwordx2 s[62:63], s[0:1], 16
  s_load_dwordx2 s[64:65], s[0:1], 24
  s_load_dwordx2 s[66:67], s[0:1], 32
  s_load_dwordx2 s[68:69], s[0:1], 40
  s_waitcnt lgkmcnt(0)
  v_lshlrev_b32 v0, 4, v31
  v_and_b32 v20, 15, v31
  v_lshrrev_b32 v21, 4, v31
  v_bfe_u32 v22, v20, 1, 1
  v_mov_b32 v1, 0x44444444
  v_mov_b32 v23, 0xeeeeeeee
  v_cmp_eq_u32 vcc, 1, v22
  s_nop 1
  v_cndmask_b32 v1, v1, v23, vcc
  s_lshl_b32 s12, s8, 11
  v_add_u32 v2, s12, v0
  v_add_u32 v3, 135168, v0
  v_add_u32 v4, 151552, v2
  v_add_u32 v3, 135168, v0
  s_add_u32 s12, s8, 1
  s_and_b32 s12, s12, 3
  s_lshl_b32 s51, s12, 11
  s_add_u32 s12, s8, 2
  s_and_b32 s12, s12, 3
  s_lshl_b32 s52, s12, 11
  s_add_u32 s12, s8, 3
  s_and_b32 s12, s12, 3
  s_lshl_b32 s53, s12, 11
  s_lshl_b32 s50, s8, 11
  v_mov_b32 v6, 0
  v_mov_b32 v7, 0
  v_mov_b32 v5, 0
  v_lshrrev_b32 v24, 2, v20
  s_lshl_b32 s12, s8, 3
  v_add_u32 v24, s12, v24
  v_lshlrev_b32 v24, 13, v24
  v_lshrrev_b32 v25, 1, v21
  v_lshl_add_u32 v24, v25, 12, v24
  v_and_b32 v25, 1, v21
  v_and_b32 v26, 3, v20
  v_lshl_add_u32 v25, v25, 2, v26
  v_lshl_add_u32 v24, v25, 4, v24
  s_lshl_b32 s12, s9, 7
  v_add_u32 v8, s12, v24
  s_lshl_b32 s12, s9, 13
  s_lshl_b32 s13, s8, 12
  s_add_u32 s12, s12, s13
  v_add_u32 v9, s12, v0
  v_bfe_u32 v24, v20, 2, 1
  s_lshl_b32 s12, s8, 1
  v_add_u32 v24, s12, v24
  v_lshlrev_b32 v24, 2, v24
  v_bfe_u32 v25, v20, 1, 1
  v_lshl_add_u32 v24, v25, 1, v24
  v_lshrrev_b32 v25, 1, v21
  v_add_u32 v24, v24, v25
  v_lshlrev_b32 v24, 4, v24
  v_and_b32 v25, 1, v20
  v_and_b32 v26, 1, v21
  v_lshl_add_u32 v25, v25, 1, v26
  v_lshl_add_u32 v24, v25, 2, v24
  s_lshl_b32 s12, s9, 8
  v_add_u32 v10, s12, v24
  v_lshlrev_b32 v24, 1, v20
  v_lshrrev_b32 v25, 1, v21
  v_lshlrev_b32 v25, 3, v25
  v_xor_b32 v24, v24, v25
  v_lshl_add_u32 v24, v21, 5, v24
  v_lshlrev_b32 v24, 2, v24
  s_lshl_b32 s12, s8, 10
  s_add_u32 s12, s12, 131072
  v_add_u32 v11, s12, v24
  v_bfe_u32 v24, v31, 2, 2
  v_and_b32 v25, 3, v31
  v_lshlrev_b32 v24, 1, v24
  v_and_b32 v26, 1, v21
  v_lshl_add_u32 v24, v26, 4, v24
  v_lshrrev_b32 v26, 1, v25
  v_lshlrev_b32 v26, 3, v26
  v_xor_b32 v24, v24, v26
  v_lshl_add_u32 v24, v25, 5, v24
  v_lshrrev_b32 v26, 1, v21
  v_lshl_add_u32 v24, v26, 7, v24
  v_lshlrev_b32 v24, 2, v24
  v_add_u32 v12, 131072, v24
  v_xor_b32 v13, 32, v12
  v_lshrrev_b32 v24, 2, v20
  v_and_b32 v25, 1, v20
  v_lshl_add_u32 v24, v24, 1, v25
  v_mul_u32_u24 v24, 272, v24
  v_lshl_add_u32 v24, v21, 3, v24
  s_lshl_b32 s12, s8, 6
  s_add_u32 s12, s12, 159744
  v_add_u32 v24, s12, v24
  v_lshlrev_b32 v25, 3, v31
  v_add_u32 v25, 131072, v25
  v_and_b32 v26, 2, v20
  v_cmp_eq_u32 vcc, 2, v26
  s_nop 1
  v_cndmask_b32 v14, v25, v24, vcc
  v_lshrrev_b32 v24, 2, v20
  v_and_b32 v25, 1, v20
  v_lshl_add_u32 v24, v24, 1, v25
  v_mul_u32_u24 v24, 272, v24
  v_lshl_add_u32 v24, v21, 5, v24
  v_bfe_u32 v25, v20, 1, 1
  v_lshl_add_u32 v24, v25, 4, v24
  v_add_u32 v15, 159744, v24
  s_lshl_b32 s12, s8, 13
  v_add_u32 v16, s12, v0
  v_add_u32 v17, 65536, v16
  v_mov_b32 v19, 0
  v_mov_b32 v18, 0
  s_lshl_b32 s23, s9, 8
  s_add_u32 s22, s23, 135168
  s_mov_b32 s46, 0
  s_mov_b32 s47, -1
  s_mov_b32 s40, 0x3e0293ee
  s_mov_b32 s41, 0xbe0293ee
  s_add_u32 s26, s4, 69206016
  s_addc_u32 s27, s5, 0
  s_add_u32 s28, s4, 69271552
  s_addc_u32 s29, s5, 0
  s_add_u32 s30, s28, 32768
  s_addc_u32 s31, s29, 0
  v_mov_b32 v32, -1
  v_mov_b32 v33, -1
  v_mov_b32 v34, -1
  v_mov_b32 v35, -1
  s_lshl_b32 s12, s9, 13
  v_add_u32 v24, s12, v2
  global_store_dwordx4 v24, v[32:35], s[28:29] sc1
  global_store_dwordx4 v24, v[32:35], s[28:29] offset:1024 sc1
  v_mov_b32 v96, 0
  v_mov_b32 v97, 0
  v_mov_b32 v98, 0
  s_cmp_lg_u32 s8, 0
  s_cbranch_scc1 L_nomem0_1
  v_lshrrev_b32 v24, 2, v31
  v_and_b32 v25, 3, v31
  v_lshrrev_b32 v26, 2, v24
  v_and_b32 v27, 1, v24
  v_lshl_add_u32 v26, v26, 1, v27
  v_bfe_u32 v27, v24, 1, 1
  v_lshlrev_b32 v27, 3, v27
  v_lshl_add_u32 v27, v25, 1, v27
  s_lshr_b32 s12, s9, 2
  s_lshl_b32 s12, s12, 6
  s_and_b32 s13, s9, 3
  s_lshl_b32 s13, s13, 2
  s_add_u32 s12, s12, s13
  v_and_b32 v28, 3, v27
  v_lshlrev_b32 v28, 4, v28
  v_lshrrev_b32 v29, 2, v27
  v_add_u32 v28, v28, v29
  v_add_u32 v28, s12, v28
  v_lshl_add_u32 v28, v26, 9, v28
  v_lshlrev_b32 v28, 1, v28
  global_load_ushort v96, v28, s[60:61]
  global_load_ushort v97, v28, s[60:61] offset:32
  v_lshlrev_b32 v98, 2, v31
  s_lshl_b32 s12, s9, 8
  v_add_u32 v98, s12, v98
  v_add_u32 v24, 8192, v98
  global_store_dword v24, v32, s[26:27] sc1
  s_mov_b64 exec, 1
  s_getreg_b32 s12, hwreg(HW_REG_XCC_ID, 0, 4)
  s_lshl_b32 s12, 1, s12
  v_mov_b32 v24, 12
  v_mov_b32 v25, s12
  global_atomic_or v24, v25, s[6:7]
  s_mov_b64 exec, -1
L_nomem0_1:
  s_lshr_b32 s54, s9, 1
  s_lshl_b32 s54, s54, 7
  s_add_u32 s58, s4, 150999040
  s_addc_u32 s59, s5, 0
  v_and_b32 v20, 15, v31
  v_lshrrev_b32 v21, 4, v31
  v_lshlrev_b32 v24, 1, v21
  v_xor_b32 v24, v24, v20
  v_lshlrev_b32 v24, 4, v24
  s_lshl_b32 s12, s8, 5
  v_add_u32 v25, s12, v21
  v_lshlrev_b32 v25, 13, v25
  v_mov_b32 v30, v21
  v_add_u32 v22, v25, v24
  v_xor_b32 v23, 128, v22
  s_and_b32 s12, s8, 1
  s_lshl_b32 s12, s12, 7
  v_xor_b32 v24, s12, v0
  v_bfe_u32 v32, v31, 2, 2
  v_and_b32 v33, 3, v31
  v_and_b32 v34, 1, v32
  v_lshrrev_b32 v35, 1, v32
  v_and_b32 v36, 1, v30
  v_lshrrev_b32 v37, 1, v30
  v_lshlrev_b32 v38, 4, v34
  v_lshl_add_u32 v38, v35, 1, v38
  v_lshl_add_u32 v38, v37, 2, v38
  v_add_u32 v38, v38, v36
  v_lshlrev_b32 v39, 2, v34
  v_lshl_add_u32 v39, v35, 1, v39
  v_add_u32 v39, v39, v36
  v_lshlrev_b32 v39, 1, v39
  v_lshrrev_b32 v40, 1, v33
  s_lshl_b32 s12, s8, 2
  v_add_u32 v40, s12, v40
  v_xor_b32 v40, v40, v39
  v_lshlrev_b32 v40, 4, v40
  v_lshl_add_u32 v40, v38, 8, v40
  v_and_b32 v41, 1, v33
  v_lshl_add_u32 v26, v41, 3, v40
  v_xor_b32 v27, 32, v26
  v_lshlrev_b32 v38, 4, v37
  v_lshl_add_u32 v38, v35, 3, v38
  v_lshl_add_u32 v38, v36, 2, v38
  v_add_u32 v38, v38, v34
  v_lshlrev_b32 v39, 3, v35
  v_lshl_add_u32 v39, v36, 2, v39
  v_lshl_add_u32 v39, v34, 1, v39
  v_lshrrev_b32 v40, 1, v33
  s_lshl_b32 s12, s8, 4
  v_add_u32 v40, s12, v40
  v_xor_b32 v40, v40, v39
  v_lshlrev_b32 v40, 4, v40
  v_lshl_add_u32 v40, v38, 10, v40
  v_lshl_add_u32 v28, v41, 3, v40
  s_lshl_b32 s13, s8, 13
  s_cmp_eq_u32 s8, 1
  s_cbranch_scc1 L_wv_4
  s_cmp_eq_u32 s8, 2
  s_cbranch_scc1 L_wv_5
  s_cmp_eq_u32 s8, 3
  s_cbranch_scc1 L_wv_6
L_wv_3:
  s_lshl_b32 s12, s8, 13
  s_add_u32 s12, s12, 131072
  v_add_u32 v21, s12, v0
  v_add_u32 v26, 131072, v26
  v_add_u32 v27, 131072, v27
  s_lshl_b32 s12, s9, 17
  s_add_u32 s44, s68, s12
  s_addc_u32 s45, s69, 0
  s_lshl_b32 s12, s8, 13
  s_add_u32 s12, s12, 0
  s_add_u32 s44, s44, s12
  s_addc_u32 s45, s45, 0
  v_xor_b32 v25, 0, v24
  s_add_u32 m0, s13, 0
  s_nop 0
  global_load_lds_dwordx4 v25, s[44:45] sc1
  s_add_u32 s44, s44, 1024
  s_addc_u32 s45, s45, 0
  v_xor_b32 v25, 32, v24
  s_add_u32 m0, s13, 1024
  s_nop 0
  global_load_lds_dwordx4 v25, s[44:45] sc1
  s_add_u32 s44, s44, 1024
  s_addc_u32 s45, s45, 0
  v_xor_b32 v25, 0, v24
  s_add_u32 m0, s13, 2048
  s_nop 0
  global_load_lds_dwordx4 v25, s[44:45] sc1
  s_add_u32 s44, s44, 1024
  s_addc_u32 s45, s45, 0
  v_xor_b32 v25, 32, v24
  s_add_u32 m0, s13, 3072
  s_nop 0
  global_load_lds_dwordx4 v25, s[44:45] sc1
  s_add_u32 s44, s44, 1024
  s_addc_u32 s45, s45, 0
  v_xor_b32 v25, 64, v24
  s_add_u32 m0, s13, 4096
  s_nop 0
  global_load_lds_dwordx4 v25, s[44:45] sc1
  s_add_u32 s44, s44, 1024
  s_addc_u32 s45, s45, 0
  v_xor_b32 v25, 96, v24
  s_add_u32 m0, s13, 5120
  s_nop 0
  global_load_lds_dwordx4 v25, s[44:45] sc1
  s_add_u32 s44, s44, 1024
  s_addc_u32 s45, s45, 0
  v_xor_b32 v25, 64, v24
  s_add_u32 m0, s13, 6144
  s_nop 0
  global_load_lds_dwordx4 v25, s[44:45] sc1
  s_add_u32 s44, s44, 1024
  s_addc_u32 s45, s45, 0
  v_xor_b32 v25, 96, v24
  s_add_u32 m0, s13, 7168
  s_nop 0
  global_load_lds_dwordx4 v25, s[44:45] sc1
  s_lshl_b32 s12, s9, 17
  s_add_u32 s44, s68, s12
  s_addc_u32 s45, s69, 0
  s_lshl_b32 s12, s8, 13
  s_add_u32 s12, s12, 32768
  s_add_u32 s44, s44, s12
  s_addc_u32 s45, s45, 0
  v_xor_b32 v25, 0, v24
  s_add_u32 m0, s13, 32768
  s_nop 0
  global_load_lds_dwordx4 v25, s[44:45] sc1
  s_add_u32 s44, s44, 1024
  s_addc_u32 s45, s45, 0
  v_xor_b32 v25, 32, v24
  s_add_u32 m0, s13, 33792
  s_nop 0
  global_load_lds_dwordx4 v25, s[44:45] sc1
  s_add_u32 s44, s44, 1024
  s_addc_u32 s45, s45, 0
  v_xor_b32 v25, 0, v24
  s_add_u32 m0, s13, 34816
  s_nop 0
  global_load_lds_dwordx4 v25, s[44:45] sc1
  s_add_u32 s44, s44, 1024
  s_addc_u32 s45, s45, 0
  v_xor_b32 v25, 32, v24
  s_add_u32 m0, s13, 35840
  s_nop 0
  global_load_lds_dwordx4 v25, s[44:45] sc1
  s_add_u32 s44, s44, 1024
  s_addc_u32 s45, s45, 0
  v_xor_b32 v25, 64, v24
  s_add_u32 m0, s13, 36864
  s_nop 0
  global_load_lds_dwordx4 v25, s[44:45] sc1
  s_add_u32 s44, s44, 1024
  s_addc_u32 s45, s45, 0
  v_xor_b32 v25, 96, v24
  s_add_u32 m0, s13, 37888
  s_nop 0
  global_load_lds_dwordx4 v25, s[44:45] sc1
  s_add_u32 s44, s44, 1024
  s_addc_u32 s45, s45, 0
  v_xor_b32 v25, 64, v24
  s_add_u32 m0, s13, 38912
  s_nop 0
  global_load_lds_dwordx4 v25, s[44:45] sc1
  s_add_u32 s44, s44, 1024
  s_addc_u32 s45, s45, 0
  v_xor_b32 v25, 96, v24
  s_add_u32 m0, s13, 39936
  s_nop 0
  global_load_lds_dwordx4 v25, s[44:45] sc1
  s_lshl_b32 s12, s9, 17
  s_add_u32 s44, s68, s12
  s_addc_u32 s45, s69, 0
  s_lshl_b32 s12, s8, 13
  s_add_u32 s12, s12, 65536
  s_add_u32 s44, s44, s12
  s_addc_u32 s45, s45, 0
  v_xor_b32 v25, 0, v24
  s_add_u32 m0, s13, 65536
  s_nop 0
  global_load_lds_dwordx4 v25, s[44:45] sc1
  s_add_u32 s44, s44, 1024
  s_addc_u32 s45, s45, 0
  v_xor_b32 v25, 32, v24
  s_add_u32 m0, s13, 66560
  s_nop 0
  global_load_lds_dwordx4 v25, s[44:45] sc1
  s_add_u32 s44, s44, 1024
  s_addc_u32 s45, s45, 0
  v_xor_b32 v25, 0, v24
  s_add_u32 m0, s13, 67584
  s_nop 0
  global_load_lds_dwordx4 v25, s[44:45] sc1
  s_add_u32 s44, s44, 1024
  s_addc_u32 s45, s45, 0
  v_xor_b32 v25, 32, v24
  s_add_u32 m0, s13, 68608
  s_nop 0
  global_load_lds_dwordx4 v25, s[44:45] sc1
  s_add_u32 s44, s44, 1024
  s_addc_u32 s45, s45, 0
  v_xor_b32 v25, 64, v24
  s_add_u32 m0, s13, 69632
  s_nop 0
  global_load_lds_dwordx4 v25, s[44:45] sc1
  s_add_u32 s44, s44, 1024
  s_addc_u32 s45, s45, 0
  v_xor_b32 v25, 96, v24
  s_add_u32 m0, s13, 70656
  s_nop 0
  global_load_lds_dwordx4 v25, s[44:45] sc1
  s_add_u32 s44, s44, 1024
  s_addc_u32 s45, s45, 0
  v_xor_b32 v25, 64, v24
  s_add_u32 m0, s13, 71680
  s_nop 0
  global_load_lds_dwordx4 v25, s[44:45] sc1
  s_add_u32 s44, s44, 1024
  s_addc_u32 s45, s45, 0
  v_xor_b32 v25, 96, v24
  s_add_u32 m0, s13, 72704
  s_nop 0
  global_load_lds_dwordx4 v25, s[44:45] sc1
  s_lshl_b32 s12, s9, 17
  s_add_u32 s44, s68, s12
  s_addc_u32 s45, s69, 0
  s_lshl_b32 s12, s8, 13
  s_add_u32 s12, s12, 98304
  s_add_u32 s44, s44, s12
  s_addc_u32 s45, s45, 0
  v_xor_b32 v25, 0, v24
  s_add_u32 m0, s13, 98304
  s_nop 0
  global_load_lds_dwordx4 v25, s[44:45] sc1
  s_add_u32 s44, s44, 1024
  s_addc_u32 s45, s45, 0
  v_xor_b32 v25, 32, v24
  s_add_u32 m0, s13, 99328
  s_nop 0
  global_load_lds_dwordx4 v25, s[44:45] sc1
  s_add_u32 s44, s44, 1024
  s_addc_u32 s45, s45, 0
  v_xor_b32 v25, 0, v24
  s_add_u32 m0, s13, 100352
  s_nop 0
  global_load_lds_dwordx4 v25, s[44:45] sc1
  s_add_u32 s44, s44, 1024
  s_addc_u32 s45, s45, 0
  v_xor_b32 v25, 32, v24
  s_add_u32 m0, s13, 101376
  s_nop 0
  global_load_lds_dwordx4 v25, s[44:45] sc1
  s_add_u32 s44, s44, 1024
  s_addc_u32 s45, s45, 0
  v_xor_b32 v25, 64, v24
  s_add_u32 m0, s13, 102400
  s_nop 0
  global_load_lds_dwordx4 v25, s[44:45] sc1
  s_add_u32 s44, s44, 1024
  s_addc_u32 s45, s45, 0
  v_xor_b32 v25, 96, v24
  s_add_u32 m0, s13, 103424
  s_nop 0
  global_load_lds_dwordx4 v25, s[44:45] sc1
  s_add_u32 s44, s44, 1024
  s_addc_u32 s45, s45, 0
  v_xor_b32 v25, 64, v24
  s_add_u32 m0, s13, 104448
  s_nop 0
  global_load_lds_dwordx4 v25, s[44:45] sc1
  s_add_u32 s44, s44, 1024
  s_addc_u32 s45, s45, 0
  v_xor_b32 v25, 96, v24
  s_add_u32 m0, s13, 105472
  s_nop 0
  global_load_lds_dwordx4 v25, s[44:45] sc1
  s_lshl_b32 s12, s9, 8
  s_add_u32 s44, s62, s12
  s_addc_u32 s45, s63, 0
  s_add_u32 s44, s44, 0
  s_addc_u32 s45, s45, 0
  global_load_dwordx4 a[0:3], v22, s[44:45] sc1
  s_add_u32 s44, s44, 32768
  s_addc_u32 s45, s45, 0
  global_load_dwordx4 a[4:7], v22, s[44:45] sc1
  s_add_u32 s44, s44, 32768
  s_addc_u32 s45, s45, 0
  global_load_dwordx4 a[64:67], v22, s[44:45] sc1
  s_add_u32 s44, s44, 32768
  s_addc_u32 s45, s45, 0
  global_load_dwordx4 a[68:71], v22, s[44:45] sc1
  s_add_u32 s44, s44, 32768
  s_addc_u32 s45, s45, 0
  global_load_dwordx4 a[8:11], v23, s[44:45] sc1
  s_add_u32 s44, s44, 32768
  s_addc_u32 s45, s45, 0
  global_load_dwordx4 a[12:15], v23, s[44:45] sc1
  s_add_u32 s44, s44, 32768
  s_addc_u32 s45, s45, 0
  global_load_dwordx4 a[72:75], v23, s[44:45] sc1
  s_add_u32 s44, s44, 32768
  s_addc_u32 s45, s45, 0
  global_load_dwordx4 a[76:79], v23, s[44:45] sc1
  s_lshl_b32 s12, s9, 8
  s_add_u32 s44, s62, s12
  s_addc_u32 s45, s63, 0
  s_add_u32 s44, s44, 1048576
  s_addc_u32 s45, s45, 0
  global_load_dwordx4 a[16:19], v22, s[44:45] sc1
  s_add_u32 s44, s44, 32768
  s_addc_u32 s45, s45, 0
  global_load_dwordx4 a[20:23], v22, s[44:45] sc1
  s_add_u32 s44, s44, 32768
  s_addc_u32 s45, s45, 0
  global_load_dwordx4 a[80:83], v22, s[44:45] sc1
  s_add_u32 s44, s44, 32768
  s_addc_u32 s45, s45, 0
  global_load_dwordx4 a[84:87], v22, s[44:45] sc1
  s_add_u32 s44, s44, 32768
  s_addc_u32 s45, s45, 0
  global_load_dwordx4 a[24:27], v23, s[44:45] sc1
  s_add_u32 s44, s44, 32768
  s_addc_u32 s45, s45, 0
  global_load_dwordx4 a[28:31], v23, s[44:45] sc1
  s_add_u32 s44, s44, 32768
  s_addc_u32 s45, s45, 0
  global_load_dwordx4 a[88:91], v23, s[44:45] sc1
  s_add_u32 s44, s44, 32768
  s_addc_u32 s45, s45, 0
  global_load_dwordx4 a[92:95], v23, s[44:45] sc1
  s_lshl_b32 s12, s9, 8
  s_add_u32 s44, s62, s12
  s_addc_u32 s45, s63, 0
  s_add_u32 s44, s44, 2097152
  s_addc_u32 s45, s45, 0
  global_load_dwordx4 a[32:35], v22, s[44:45] sc1
  s_add_u32 s44, s44, 32768
  s_addc_u32 s45, s45, 0
  global_load_dwordx4 a[36:39], v22, s[44:45] sc1
  s_add_u32 s44, s44, 32768
  s_addc_u32 s45, s45, 0
  global_load_dwordx4 a[96:99], v22, s[44:45] sc1
  s_add_u32 s44, s44, 32768
  s_addc_u32 s45, s45, 0
  global_load_dwordx4 a[100:103], v22, s[44:45] sc1
  s_add_u32 s44, s44, 32768
  s_addc_u32 s45, s45, 0
  global_load_dwordx4 a[40:43], v23, s[44:45] sc1
  s_add_u32 s44, s44, 32768
  s_addc_u32 s45, s45, 0
  global_load_dwordx4 a[44:47], v23, s[44:45] sc1
  s_add_u32 s44, s44, 32768
  s_addc_u32 s45, s45, 0
  global_load_dwordx4 a[104:107], v23, s[44:45] sc1
  s_add_u32 s44, s44, 32768
  s_addc_u32 s45, s45, 0
  global_load_dwordx4 a[108:111], v23, s[44:45] sc1
  v_mov_b32 v99, 16
  global_load_dword v99, v99, s[6:7] sc1
  s_waitcnt vmcnt(49)
  v_lshl_or_b32 v96, v97, 16, v96
  global_store_dword v98, v96, s[26:27] sc1
  s_barrier
  v_add_u32 v29, 0, v28
  v_xor_b32 v30, 0, v29
  ds_read_b64_tr_b16 v[32:33], v30 offset:0
  ds_read_b64_tr_b16 v[34:35], v30 offset:2048
  v_xor_b32 v30, 32, v29
  ds_read_b64_tr_b16 v[36:37], v30 offset:0
  ds_read_b64_tr_b16 v[38:39], v30 offset:2048
  v_xor_b32 v30, 64, v29
  ds_read_b64_tr_b16 v[40:41], v30 offset:0
  ds_read_b64_tr_b16 v[42:43], v30 offset:2048
  v_xor_b32 v30, 96, v29
  ds_read_b64_tr_b16 v[44:45], v30 offset:0
  ds_read_b64_tr_b16 v[46:47], v30 offset:2048
  v_xor_b32 v30, 128, v29
  ds_read_b64_tr_b16 v[48:49], v30 offset:0
  ds_read_b64_tr_b16 v[50:51], v30 offset:2048
  v_xor_b32 v30, 160, v29
  ds_read_b64_tr_b16 v[52:53], v30 offset:0
  ds_read_b64_tr_b16 v[54:55], v30 offset:2048
  v_xor_b32 v30, 192, v29
  ds_read_b64_tr_b16 v[56:57], v30 offset:0
  ds_read_b64_tr_b16 v[58:59], v30 offset:2048
  v_xor_b32 v30, 224, v29
  ds_read_b64_tr_b16 v[60:61], v30 offset:0
  ds_read_b64_tr_b16 v[62:63], v30 offset:2048
  s_lshl_b32 s12, s9, 8
  s_add_u32 s44, s62, s12
  s_addc_u32 s45, s63, 0
  s_add_u32 s44, s44, 3145728
  s_addc_u32 s45, s45, 0
  global_load_dwordx4 a[48:51], v22, s[44:45] sc1
  s_add_u32 s44, s44, 32768
  s_addc_u32 s45, s45, 0
  global_load_dwordx4 a[52:55], v22, s[44:45] sc1
  s_add_u32 s44, s44, 32768
  s_addc_u32 s45, s45, 0
  global_load_dwordx4 a[112:115], v22, s[44:45] sc1
  s_add_u32 s44, s44, 32768
  s_addc_u32 s45, s45, 0
  global_load_dwordx4 a[116:119], v22, s[44:45] sc1
  s_add_u32 s44, s44, 32768
  s_addc_u32 s45, s45, 0
  global_load_dwordx4 a[56:59], v23, s[44:45] sc1
  s_add_u32 s44, s44, 32768
  s_addc_u32 s45, s45, 0
  global_load_dwordx4 a[60:63], v23, s[44:45] sc1
  s_add_u32 s44, s44, 32768
  s_addc_u32 s45, s45, 0
  global_load_dwordx4 a[120:123], v23, s[44:45] sc1
  s_add_u32 s44, s44, 32768
  s_addc_u32 s45, s45, 0
  global_load_dwordx4 a[124:127], v23, s[44:45] sc1
  s_waitcnt lgkmcnt(0)
  s_barrier
  ds_write_b128 v16, v[32:35] offset:0
  ds_write_b128 v16, v[36:39] offset:1024
  ds_write_b128 v16, v[40:43] offset:2048
  ds_write_b128 v16, v[44:47] offset:3072
  ds_write_b128 v16, v[48:51] offset:4096
  ds_write_b128 v16, v[52:55] offset:5120
  ds_write_b128 v16, v[56:59] offset:6144
  ds_write_b128 v16, v[60:63] offset:7168
  s_waitcnt vmcnt(49)
  s_barrier
  v_add_u32 v29, 32768, v28
  v_xor_b32 v30, 0, v29
  ds_read_b64_tr_b16 v[32:33], v30 offset:0
  ds_read_b64_tr_b16 v[34:35], v30 offset:2048
  v_xor_b32 v30, 32, v29
  ds_read_b64_tr_b16 v[36:37], v30 offset:0
  ds_read_b64_tr_b16 v[38:39], v30 offset:2048
  v_xor_b32 v30, 64, v29
  ds_read_b64_tr_b16 v[40:41], v30 offset:0
  ds_read_b64_tr_b16 v[42:43], v30 offset:2048
  v_xor_b32 v30, 96, v29
  ds_read_b64_tr_b16 v[44:45], v30 offset:0
  ds_read_b64_tr_b16 v[46:47], v30 offset:2048
  v_xor_b32 v30, 128, v29
  ds_read_b64_tr_b16 v[48:49], v30 offset:0
  ds_read_b64_tr_b16 v[50:51], v30 offset:2048
  v_xor_b32 v30, 160, v29
  ds_read_b64_tr_b16 v[52:53], v30 offset:0
  ds_read_b64_tr_b16 v[54:55], v30 offset:2048
  v_xor_b32 v30, 192, v29
  ds_read_b64_tr_b16 v[56:57], v30 offset:0
  ds_read_b64_tr_b16 v[58:59], v30 offset:2048
  v_xor_b32 v30, 224, v29
  ds_read_b64_tr_b16 v[60:61], v30 offset:0
  ds_read_b64_tr_b16 v[62:63], v30 offset:2048
  s_lshl_b32 s12, s9, 8
  s_add_u32 s44, s64, s12
  s_addc_u32 s45, s65, 0
  s_add_u32 s44, s44, 0
  s_addc_u32 s45, s45, 0
  global_load_dwordx4 a[128:131], v22, s[44:45] sc1
  s_add_u32 s44, s44, 32768
  s_addc_u32 s45, s45, 0
  global_load_dwordx4 a[132:135], v22, s[44:45] sc1
  s_add_u32 s44, s44, 32768
  s_addc_u32 s45, s45, 0
  global_load_dwordx4 a[192:195], v22, s[44:45] sc1
  s_add_u32 s44, s44, 32768
  s_addc_u32 s45, s45, 0
  global_load_dwordx4 a[196:199], v22, s[44:45] sc1
  s_add_u32 s44, s44, 32768
  s_addc_u32 s45, s45, 0
  global_load_dwordx4 a[136:139], v23, s[44:45] sc1
  s_add_u32 s44, s44, 32768
  s_addc_u32 s45, s45, 0
  global_load_dwordx4 a[140:143], v23, s[44:45] sc1
  s_add_u32 s44, s44, 32768
  s_addc_u32 s45, s45, 0
  global_load_dwordx4 a[200:203], v23, s[44:45] sc1
  s_add_u32 s44, s44, 32768
  s_addc_u32 s45, s45, 0
  global_load_dwordx4 a[204:207], v23, s[44:45] sc1
  s_waitcnt lgkmcnt(0)
  s_barrier
  ds_write_b128 v16, v[32:35] offset:32768
  ds_write_b128 v16, v[36:39] offset:33792
  ds_write_b128 v16, v[40:43] offset:34816
  ds_write_b128 v16, v[44:47] offset:35840
  ds_write_b128 v16, v[48:51] offset:36864
  ds_write_b128 v16, v[52:55] offset:37888
  ds_write_b128 v16, v[56:59] offset:38912
  ds_write_b128 v16, v[60:63] offset:39936
  s_waitcnt vmcnt(49)
  s_barrier
  v_add_u32 v29, 65536, v28
  v_xor_b32 v30, 0, v29
  ds_read_b64_tr_b16 v[32:33], v30 offset:0
  ds_read_b64_tr_b16 v[34:35], v30 offset:2048
  v_xor_b32 v30, 32, v29
  ds_read_b64_tr_b16 v[36:37], v30 offset:0
  ds_read_b64_tr_b16 v[38:39], v30 offset:2048
  v_xor_b32 v30, 64, v29
  ds_read_b64_tr_b16 v[40:41], v30 offset:0
  ds_read_b64_tr_b16 v[42:43], v30 offset:2048
  v_xor_b32 v30, 96, v29
  ds_read_b64_tr_b16 v[44:45], v30 offset:0
  ds_read_b64_tr_b16 v[46:47], v30 offset:2048
  v_xor_b32 v30, 128, v29
  ds_read_b64_tr_b16 v[48:49], v30 offset:0
  ds_read_b64_tr_b16 v[50:51], v30 offset:2048
  v_xor_b32 v30, 160, v29
  ds_read_b64_tr_b16 v[52:53], v30 offset:0
  ds_read_b64_tr_b16 v[54:55], v30 offset:2048
  v_xor_b32 v30, 192, v29
  ds_read_b64_tr_b16 v[56:57], v30 offset:0
  ds_read_b64_tr_b16 v[58:59], v30 offset:2048
  v_xor_b32 v30, 224, v29
  ds_read_b64_tr_b16 v[60:61], v30 offset:0
  ds_read_b64_tr_b16 v[62:63], v30 offset:2048
  s_lshl_b32 s12, s9, 8
  s_add_u32 s44, s64, s12
  s_addc_u32 s45, s65, 0
  s_add_u32 s44, s44, 1048576
  s_addc_u32 s45, s45, 0
  global_load_dwordx4 a[144:147], v22, s[44:45] sc1
  s_add_u32 s44, s44, 32768
  s_addc_u32 s45, s45, 0
  global_load_dwordx4 a[148:151], v22, s[44:45] sc1
  s_add_u32 s44, s44, 32768
  s_addc_u32 s45, s45, 0
  global_load_dwordx4 a[208:211], v22, s[44:45] sc1
  s_add_u32 s44, s44, 32768
  s_addc_u32 s45, s45, 0
  global_load_dwordx4 a[212:215], v22, s[44:45] sc1
  s_add_u32 s44, s44, 32768
  s_addc_u32 s45, s45, 0
  global_load_dwordx4 a[152:155], v23, s[44:45] sc1
  s_add_u32 s44, s44, 32768
  s_addc_u32 s45, s45, 0
  global_load_dwordx4 a[156:159], v23, s[44:45] sc1
  s_add_u32 s44, s44, 32768
  s_addc_u32 s45, s45, 0
  global_load_dwordx4 a[216:219], v23, s[44:45] sc1
  s_add_u32 s44, s44, 32768
  s_addc_u32 s45, s45, 0
  global_load_dwordx4 a[220:223], v23, s[44:45] sc1
  s_waitcnt lgkmcnt(0)
  s_barrier
  ds_write_b128 v17, v[32:35] offset:0
  ds_write_b128 v17, v[36:39] offset:1024
  ds_write_b128 v17, v[40:43] offset:2048
  ds_write_b128 v17, v[44:47] offset:3072
  ds_write_b128 v17, v[48:51] offset:4096
  ds_write_b128 v17, v[52:55] offset:5120
  ds_write_b128 v17, v[56:59] offset:6144
  ds_write_b128 v17, v[60:63] offset:7168
  s_waitcnt vmcnt(49)
  s_barrier
  v_add_u32 v29, 98304, v28
  v_xor_b32 v30, 0, v29
  ds_read_b64_tr_b16 v[32:33], v30 offset:0
  ds_read_b64_tr_b16 v[34:35], v30 offset:2048
  v_xor_b32 v30, 32, v29
  ds_read_b64_tr_b16 v[36:37], v30 offset:0
  ds_read_b64_tr_b16 v[38:39], v30 offset:2048
  v_xor_b32 v30, 64, v29
  ds_read_b64_tr_b16 v[40:41], v30 offset:0
  ds_read_b64_tr_b16 v[42:43], v30 offset:2048
  v_xor_b32 v30, 96, v29
  ds_read_b64_tr_b16 v[44:45], v30 offset:0
  ds_read_b64_tr_b16 v[46:47], v30 offset:2048
  v_xor_b32 v30, 128, v29
  ds_read_b64_tr_b16 v[48:49], v30 offset:0
  ds_read_b64_tr_b16 v[50:51], v30 offset:2048
  v_xor_b32 v30, 160, v29
  ds_read_b64_tr_b16 v[52:53], v30 offset:0
  ds_read_b64_tr_b16 v[54:55], v30 offset:2048
  v_xor_b32 v30, 192, v29
  ds_read_b64_tr_b16 v[56:57], v30 offset:0
  ds_read_b64_tr_b16 v[58:59], v30 offset:2048
  v_xor_b32 v30, 224, v29
  ds_read_b64_tr_b16 v[60:61], v30 offset:0
  ds_read_b64_tr_b16 v[62:63], v30 offset:2048
  s_lshl_b32 s12, s9, 8
  s_add_u32 s44, s64, s12
  s_addc_u32 s45, s65, 0
  s_add_u32 s44, s44, 2097152
  s_addc_u32 s45, s45, 0
  global_load_dwordx4 a[160:163], v22, s[44:45] sc1
  s_add_u32 s44, s44, 32768
  s_addc_u32 s45, s45, 0
  global_load_dwordx4 a[164:167], v22, s[44:45] sc1
  s_add_u32 s44, s44, 32768
  s_addc_u32 s45, s45, 0
  global_load_dwordx4 a[224:227], v22, s[44:45] sc1
  s_add_u32 s44, s44, 32768
  s_addc_u32 s45, s45, 0
  global_load_dwordx4 a[228:231], v22, s[44:45] sc1
  s_add_u32 s44, s44, 32768
  s_addc_u32 s45, s45, 0
  global_load_dwordx4 a[168:171], v23, s[44:45] sc1
  s_add_u32 s44, s44, 32768
  s_addc_u32 s45, s45, 0
  global_load_dwordx4 a[172:175], v23, s[44:45] sc1
  s_add_u32 s44, s44, 32768
  s_addc_u32 s45, s45, 0
  global_load_dwordx4 a[232:235], v23, s[44:45] sc1
  s_add_u32 s44, s44, 32768
  s_addc_u32 s45, s45, 0
  global_load_dwordx4 a[236:239], v23, s[44:45] sc1
  s_waitcnt lgkmcnt(0)
  s_barrier
  ds_write_b128 v17, v[32:35] offset:32768
  ds_write_b128 v17, v[36:39] offset:33792
  ds_write_b128 v17, v[40:43] offset:34816
  ds_write_b128 v17, v[44:47] offset:35840
  ds_write_b128 v17, v[48:51] offset:36864
  ds_write_b128 v17, v[52:55] offset:37888
  ds_write_b128 v17, v[56:59] offset:38912
  ds_write_b128 v17, v[60:63] offset:39936
  s_waitcnt vmcnt(49)
  ds_write_b128 v21, a[0:3] offset:0
  ds_write_b128 v21, a[4:7] offset:1024
  ds_write_b128 v21, a[64:67] offset:2048
  ds_write_b128 v21, a[68:71] offset:3072
  ds_write_b128 v21, a[8:11] offset:4096
  ds_write_b128 v21, a[12:15] offset:5120
  ds_write_b128 v21, a[72:75] offset:6144
  ds_write_b128 v21, a[76:79] offset:7168
  s_waitcnt lgkmcnt(0)
  s_barrier
  ds_read_b64_tr_b16 a[0:1], v26 offset:0
  ds_read_b64_tr_b16 a[2:3], v26 offset:8192
  ds_read_b64_tr_b16 a[4:5], v26 offset:2048
  ds_read_b64_tr_b16 a[6:7], v26 offset:10240
  ds_read_b64_tr_b16 a[64:65], v27 offset:0
  ds_read_b64_tr_b16 a[66:67], v27 offset:8192
  ds_read_b64_tr_b16 a[68:69], v27 offset:2048
  ds_read_b64_tr_b16 a[70:71], v27 offset:10240
  ds_read_b64_tr_b16 a[8:9], v26 offset:16384
  ds_read_b64_tr_b16 a[10:11], v26 offset:24576
  ds_read_b64_tr_b16 a[12:13], v26 offset:18432
  ds_read_b64_tr_b16 a[14:15], v26 offset:26624
  ds_read_b64_tr_b16 a[72:73], v27 offset:16384
  ds_read_b64_tr_b16 a[74:75], v27 offset:24576
  ds_read_b64_tr_b16 a[76:77], v27 offset:18432
  ds_read_b64_tr_b16 a[78:79], v27 offset:26624
  s_lshl_b32 s12, s9, 8
  s_add_u32 s44, s64, s12
  s_addc_u32 s45, s65, 0
  s_add_u32 s44, s44, 3145728
  s_addc_u32 s45, s45, 0
  global_load_dwordx4 a[176:179], v22, s[44:45] sc1
  s_add_u32 s44, s44, 32768
  s_addc_u32 s45, s45, 0
  global_load_dwordx4 a[180:183], v22, s[44:45] sc1
  s_add_u32 s44, s44, 32768
  s_addc_u32 s45, s45, 0
  global_load_dwordx4 a[240:243], v22, s[44:45] sc1
  s_add_u32 s44, s44, 32768
  s_addc_u32 s45, s45, 0
  global_load_dwordx4 a[244:247], v22, s[44:45] sc1
  s_add_u32 s44, s44, 32768
  s_addc_u32 s45, s45, 0
  global_load_dwordx4 a[184:187], v23, s[44:45] sc1
  s_add_u32 s44, s44, 32768
  s_addc_u32 s45, s45, 0
  global_load_dwordx4 a[188:191], v23, s[44:45] sc1
  s_add_u32 s44, s44, 32768
  s_addc_u32 s45, s45, 0
  global_load_dwordx4 a[248:251], v23, s[44:45] sc1
  s_add_u32 s44, s44, 32768
  s_addc_u32 s45, s45, 0
  global_load_dwordx4 a[252:255], v23, s[44:45] sc1
  s_waitcnt lgkmcnt(0)
  s_barrier
  s_waitcnt vmcnt(49)
  ds_write_b128 v21, a[16:19] offset:0
  ds_write_b128 v21, a[20:23] offset:1024
  ds_write_b128 v21, a[80:83] offset:2048
  ds_write_b128 v21, a[84:87] offset:3072
  ds_write_b128 v21, a[24:27] offset:4096
  ds_write_b128 v21, a[28:31] offset:5120
  ds_write_b128 v21, a[88:91] offset:6144
  ds_write_b128 v21, a[92:95] offset:7168
  s_waitcnt lgkmcnt(0)
  s_barrier
  ds_read_b64_tr_b16 a[16:17], v26 offset:0
  ds_read_b64_tr_b16 a[18:19], v26 offset:8192
  ds_read_b64_tr_b16 a[20:21], v26 offset:2048
  ds_read_b64_tr_b16 a[22:23], v26 offset:10240
  ds_read_b64_tr_b16 a[80:81], v27 offset:0
  ds_read_b64_tr_b16 a[82:83], v27 offset:8192
  ds_read_b64_tr_b16 a[84:85], v27 offset:2048
  ds_read_b64_tr_b16 a[86:87], v27 offset:10240
  ds_read_b64_tr_b16 a[24:25], v26 offset:16384
  ds_read_b64_tr_b16 a[26:27], v26 offset:24576
  ds_read_b64_tr_b16 a[28:29], v26 offset:18432
  ds_read_b64_tr_b16 a[30:31], v26 offset:26624
  ds_read_b64_tr_b16 a[88:89], v27 offset:16384
  ds_read_b64_tr_b16 a[90:91], v27 offset:24576
  ds_read_b64_tr_b16 a[92:93], v27 offset:18432
  ds_read_b64_tr_b16 a[94:95], v27 offset:26624
  s_lshl_b32 s12, s9, 8
  s_add_u32 s44, s66, s12
  s_addc_u32 s45, s67, 0
  s_add_u32 s44, s44, 0
  s_addc_u32 s45, s45, 0
  global_load_dwordx4 v[128:131], v22, s[44:45] sc1
  s_add_u32 s44, s44, 32768
  s_addc_u32 s45, s45, 0
  global_load_dwordx4 v[132:135], v22, s[44:45] sc1
  s_add_u32 s44, s44, 32768
  s_addc_u32 s45, s45, 0
  global_load_dwordx4 v[192:195], v22, s[44:45] sc1
  s_add_u32 s44, s44, 32768
  s_addc_u32 s45, s45, 0
  global_load_dwordx4 v[196:199], v22, s[44:45] sc1
  s_add_u32 s44, s44, 32768
  s_addc_u32 s45, s45, 0
  global_load_dwordx4 v[136:139], v23, s[44:45] sc1
  s_add_u32 s44, s44, 32768
  s_addc_u32 s45, s45, 0
  global_load_dwordx4 v[140:143], v23, s[44:45] sc1
  s_add_u32 s44, s44, 32768
  s_addc_u32 s45, s45, 0
  global_load_dwordx4 v[200:203], v23, s[44:45] sc1
  s_add_u32 s44, s44, 32768
  s_addc_u32 s45, s45, 0
  global_load_dwordx4 v[204:207], v23, s[44:45] sc1
  s_waitcnt lgkmcnt(0)
  s_barrier
  s_waitcnt vmcnt(49)
  ds_write_b128 v21, a[32:35] offset:0
  ds_write_b128 v21, a[36:39] offset:1024
  ds_write_b128 v21, a[96:99] offset:2048
  ds_write_b128 v21, a[100:103] offset:3072
  ds_write_b128 v21, a[40:43] offset:4096
  ds_write_b128 v21, a[44:47] offset:5120
  ds_write_b128 v21, a[104:107] offset:6144
  ds_write_b128 v21, a[108:111] offset:7168
  s_waitcnt lgkmcnt(0)
  s_barrier
  ds_read_b64_tr_b16 a[32:33], v26 offset:0
  ds_read_b64_tr_b16 a[34:35], v26 offset:8192
  ds_read_b64_tr_b16 a[36:37], v26 offset:2048
  ds_read_b64_tr_b16 a[38:39], v26 offset:10240
  ds_read_b64_tr_b16 a[96:97], v27 offset:0
  ds_read_b64_tr_b16 a[98:99], v27 offset:8192
  ds_read_b64_tr_b16 a[100:101], v27 offset:2048
  ds_read_b64_tr_b16 a[102:103], v27 offset:10240
  ds_read_b64_tr_b16 a[40:41], v26 offset:16384
  ds_read_b64_tr_b16 a[42:43], v26 offset:24576
  ds_read_b64_tr_b16 a[44:45], v26 offset:18432
  ds_read_b64_tr_b16 a[46:47], v26 offset:26624
  ds_read_b64_tr_b16 a[104:105], v27 offset:16384
  ds_read_b64_tr_b16 a[106:107], v27 offset:24576
  ds_read_b64_tr_b16 a[108:109], v27 offset:18432
  ds_read_b64_tr_b16 a[110:111], v27 offset:26624
  s_lshl_b32 s12, s9, 8
  s_add_u32 s44, s66, s12
  s_addc_u32 s45, s67, 0
  s_add_u32 s44, s44, 1048576
  s_addc_u32 s45, s45, 0
  global_load_dwordx4 v[144:147], v22, s[44:45] sc1
  s_add_u32 s44, s44, 32768
  s_addc_u32 s45, s45, 0
  global_load_dwordx4 v[148:151], v22, s[44:45] sc1
  s_add_u32 s44, s44, 32768
  s_addc_u32 s45, s45, 0
  global_load_dwordx4 v[208:211], v22, s[44:45] sc1
  s_add_u32 s44, s44, 32768
  s_addc_u32 s45, s45, 0
  global_load_dwordx4 v[212:215], v22, s[44:45] sc1
  s_add_u32 s44, s44, 32768
  s_addc_u32 s45, s45, 0
  global_load_dwordx4 v[152:155], v23, s[44:45] sc1
  s_add_u32 s44, s44, 32768
  s_addc_u32 s45, s45, 0
  global_load_dwordx4 v[156:159], v23, s[44:45] sc1
  s_add_u32 s44, s44, 32768
  s_addc_u32 s45, s45, 0
  global_load_dwordx4 v[216:219], v23, s[44:45] sc1
  s_add_u32 s44, s44, 32768
  s_addc_u32 s45, s45, 0
  global_load_dwordx4 v[220:223], v23, s[44:45] sc1
  s_waitcnt lgkmcnt(0)
  s_barrier
  s_waitcnt vmcnt(48)
  ds_write_b128 v21, a[48:51] offset:0
  ds_write_b128 v21, a[52:55] offset:1024
  ds_write_b128 v21, a[112:115] offset:2048
  ds_write_b128 v21, a[116:119] offset:3072
  ds_write_b128 v21, a[56:59] offset:4096
  ds_write_b128 v21, a[60:63] offset:5120
  ds_write_b128 v21, a[120:123] offset:6144
  ds_write_b128 v21, a[124:127] offset:7168
  s_waitcnt lgkmcnt(0)
  s_barrier
  ds_read_b64_tr_b16 a[48:49], v26 offset:0
  ds_read_b64_tr_b16 a[50:51], v26 offset:8192
  ds_read_b64_tr_b16 a[52:53], v26 offset:2048
  ds_read_b64_tr_b16 a[54:55], v26 offset:10240
  ds_read_b64_tr_b16 a[112:113], v27 offset:0
  ds_read_b64_tr_b16 a[114:115], v27 offset:8192
  ds_read_b64_tr_b16 a[116:117], v27 offset:2048
  ds_read_b64_tr_b16 a[118:119], v27 offset:10240
  ds_read_b64_tr_b16 a[56:57], v26 offset:16384
  ds_read_b64_tr_b16 a[58:59], v26 offset:24576
  ds_read_b64_tr_b16 a[60:61], v26 offset:18432
  ds_read_b64_tr_b16 a[62:63], v26 offset:26624
  ds_read_b64_tr_b16 a[120:121], v27 offset:16384
  ds_read_b64_tr_b16 a[122:123], v27 offset:24576
  ds_read_b64_tr_b16 a[124:125], v27 offset:18432
  ds_read_b64_tr_b16 a[126:127], v27 offset:26624
  s_lshl_b32 s12, s9, 8
  s_add_u32 s44, s66, s12
  s_addc_u32 s45, s67, 0
  s_add_u32 s44, s44, 2097152
  s_addc_u32 s45, s45, 0
  global_load_dwordx4 v[160:163], v22, s[44:45] sc1
  s_add_u32 s44, s44, 32768
  s_addc_u32 s45, s45, 0
  global_load_dwordx4 v[164:167], v22, s[44:45] sc1
  s_add_u32 s44, s44, 32768
  s_addc_u32 s45, s45, 0
  global_load_dwordx4 v[224:227], v22, s[44:45] sc1
  s_add_u32 s44, s44, 32768
  s_addc_u32 s45, s45, 0
  global_load_dwordx4 v[228:231], v22, s[44:45] sc1
  s_add_u32 s44, s44, 32768
  s_addc_u32 s45, s45, 0
  global_load_dwordx4 v[168:171], v23, s[44:45] sc1
  s_add_u32 s44, s44, 32768
  s_addc_u32 s45, s45, 0
  global_load_dwordx4 v[172:175], v23, s[44:45] sc1
  s_add_u32 s44, s44, 32768
  s_addc_u32 s45, s45, 0
  global_load_dwordx4 v[232:235], v23, s[44:45] sc1
  s_add_u32 s44, s44, 32768
  s_addc_u32 s45, s45, 0
  global_load_dwordx4 v[236:239], v23, s[44:45] sc1
  s_waitcnt lgkmcnt(0)
  s_barrier
  v_mov_b32 v96, 4
  v_mov_b32 v97, 1
  s_mov_b64 exec, 1
  global_atomic_add v96, v97, s[6:7]
  s_mov_b64 exec, -1
  s_waitcnt vmcnt(48)
  ds_write_b128 v21, a[128:131] offset:0
  ds_write_b128 v21, a[132:135] offset:1024
  ds_write_b128 v21, a[192:195] offset:2048
  ds_write_b128 v21, a[196:199] offset:3072
  ds_write_b128 v21, a[136:139] offset:4096
  ds_write_b128 v21, a[140:143] offset:5120
  ds_write_b128 v21, a[200:203] offset:6144
  ds_write_b128 v21, a[204:207] offset:7168
  s_waitcnt lgkmcnt(0)
  s_barrier
  ds_read_b64_tr_b16 a[128:129], v26 offset:0
  ds_read_b64_tr_b16 a[130:131], v26 offset:8192
  ds_read_b64_tr_b16 a[132:133], v26 offset:2048
  ds_read_b64_tr_b16 a[134:135], v26 offset:10240
  ds_read_b64_tr_b16 a[192:193], v27 offset:0
  ds_read_b64_tr_b16 a[194:195], v27 offset:8192
  ds_read_b64_tr_b16 a[196:197], v27 offset:2048
  ds_read_b64_tr_b16 a[198:199], v27 offset:10240
  ds_read_b64_tr_b16 a[136:137], v26 offset:16384
  ds_read_b64_tr_b16 a[138:139], v26 offset:24576
  ds_read_b64_tr_b16 a[140:141], v26 offset:18432
  ds_read_b64_tr_b16 a[142:143], v26 offset:26624
  ds_read_b64_tr_b16 a[200:201], v27 offset:16384
  ds_read_b64_tr_b16 a[202:203], v27 offset:24576
  ds_read_b64_tr_b16 a[204:205], v27 offset:18432
  ds_read_b64_tr_b16 a[206:207], v27 offset:26624
  s_lshl_b32 s12, s9, 8
  s_add_u32 s44, s66, s12
  s_addc_u32 s45, s67, 0
  s_add_u32 s44, s44, 3145728
  s_addc_u32 s45, s45, 0
  global_load_dwordx4 v[176:179], v22, s[44:45] sc1
  s_add_u32 s44, s44, 32768
  s_addc_u32 s45, s45, 0
  global_load_dwordx4 v[180:183], v22, s[44:45] sc1
  s_add_u32 s44, s44, 32768
  s_addc_u32 s45, s45, 0
  global_load_dwordx4 v[240:243], v22, s[44:45] sc1
  s_add_u32 s44, s44, 32768
  s_addc_u32 s45, s45, 0
  global_load_dwordx4 v[244:247], v22, s[44:45] sc1
  s_add_u32 s44, s44, 32768
  s_addc_u32 s45, s45, 0
  global_load_dwordx4 v[184:187], v23, s[44:45] sc1
  s_add_u32 s44, s44, 32768
  s_addc_u32 s45, s45, 0
  global_load_dwordx4 v[188:191], v23, s[44:45] sc1
  s_add_u32 s44, s44, 32768
  s_addc_u32 s45, s45, 0
  global_load_dwordx4 v[248:251], v23, s[44:45] sc1
  s_add_u32 s44, s44, 32768
  s_addc_u32 s45, s45, 0
  global_load_dwordx4 v[252:255], v23, s[44:45] sc1
  s_waitcnt lgkmcnt(0)
  s_barrier
  s_waitcnt vmcnt(48)
  ds_write_b128 v21, a[144:147] offset:0
  ds_write_b128 v21, a[148:151] offset:1024
  ds_write_b128 v21, a[208:211] offset:2048
  ds_write_b128 v21, a[212:215] offset:3072
  ds_write_b128 v21, a[152:155] offset:4096
  ds_write_b128 v21, a[156:159] offset:5120
  ds_write_b128 v21, a[216:219] offset:6144
  ds_write_b128 v21, a[220:223] offset:7168
  s_waitcnt lgkmcnt(0)
  s_barrier
  ds_read_b64_tr_b16 a[144:145], v26 offset:0
  ds_read_b64_tr_b16 a[146:147], v26 offset:8192
  ds_read_b64_tr_b16 a[148:149], v26 offset:2048
  ds_read_b64_tr_b16 a[150:151], v26 offset:10240
  ds_read_b64_tr_b16 a[208:209], v27 offset:0
  ds_read_b64_tr_b16 a[210:211], v27 offset:8192
  ds_read_b64_tr_b16 a[212:213], v27 offset:2048
  ds_read_b64_tr_b16 a[214:215], v27 offset:10240
  ds_read_b64_tr_b16 a[152:153], v26 offset:16384
  ds_read_b64_tr_b16 a[154:155], v26 offset:24576
  ds_read_b64_tr_b16 a[156:157], v26 offset:18432
  ds_read_b64_tr_b16 a[158:159], v26 offset:26624
  ds_read_b64_tr_b16 a[216:217], v27 offset:16384
  ds_read_b64_tr_b16 a[218:219], v27 offset:24576
  ds_read_b64_tr_b16 a[220:221], v27 offset:18432
  ds_read_b64_tr_b16 a[222:223], v27 offset:26624
  s_waitcnt lgkmcnt(0)
  s_barrier
  s_waitcnt vmcnt(40)
  ds_write_b128 v21, a[160:163] offset:0
  ds_write_b128 v21, a[164:167] offset:1024
  ds_write_b128 v21, a[224:227] offset:2048
  ds_write_b128 v21, a[228:231] offset:3072
  ds_write_b128 v21, a[168:171] offset:4096
  ds_write_b128 v21, a[172:175] offset:5120
  ds_write_b128 v21, a[232:235] offset:6144
  ds_write_b128 v21, a[236:239] offset:7168
  s_waitcnt lgkmcnt(0)
  s_barrier
  ds_read_b64_tr_b16 a[160:161], v26 offset:0
  ds_read_b64_tr_b16 a[162:163], v26 offset:8192
  ds_read_b64_tr_b16 a[164:165], v26 offset:2048
  ds_read_b64_tr_b16 a[166:167], v26 offset:10240
  ds_read_b64_tr_b16 a[224:225], v27 offset:0
  ds_read_b64_tr_b16 a[226:227], v27 offset:8192
  ds_read_b64_tr_b16 a[228:229], v27 offset:2048
  ds_read_b64_tr_b16 a[230:231], v27 offset:10240
  ds_read_b64_tr_b16 a[168:169], v26 offset:16384
  ds_read_b64_tr_b16 a[170:171], v26 offset:24576
  ds_read_b64_tr_b16 a[172:173], v26 offset:18432
  ds_read_b64_tr_b16 a[174:175], v26 offset:26624
  ds_read_b64_tr_b16 a[232:233], v27 offset:16384
  ds_read_b64_tr_b16 a[234:235], v27 offset:24576
  ds_read_b64_tr_b16 a[236:237], v27 offset:18432
  ds_read_b64_tr_b16 a[238:239], v27 offset:26624
  s_waitcnt lgkmcnt(0)
  s_barrier
  s_waitcnt vmcnt(32)
  ds_write_b128 v21, a[176:179] offset:0
  ds_write_b128 v21, a[180:183] offset:1024
  ds_write_b128 v21, a[240:243] offset:2048
  ds_write_b128 v21, a[244:247] offset:3072
  ds_write_b128 v21, a[184:187] offset:4096
  ds_write_b128 v21, a[188:191] offset:5120
  ds_write_b128 v21, a[248:251] offset:6144
  ds_write_b128 v21, a[252:255] offset:7168
  s_waitcnt lgkmcnt(0)
  s_barrier
  ds_read_b64_tr_b16 a[176:177], v26 offset:0
  ds_read_b64_tr_b16 a[178:179], v26 offset:8192
  ds_read_b64_tr_b16 a[180:181], v26 offset:2048
  ds_read_b64_tr_b16 a[182:183], v26 offset:10240
  ds_read_b64_tr_b16 a[240:241], v27 offset:0
  ds_read_b64_tr_b16 a[242:243], v27 offset:8192
  ds_read_b64_tr_b16 a[244:245], v27 offset:2048
  ds_read_b64_tr_b16 a[246:247], v27 offset:10240
  ds_read_b64_tr_b16 a[184:185], v26 offset:16384
  ds_read_b64_tr_b16 a[186:187], v26 offset:24576
  ds_read_b64_tr_b16 a[188:189], v26 offset:18432
  ds_read_b64_tr_b16 a[190:191], v26 offset:26624
  ds_read_b64_tr_b16 a[248:249], v27 offset:16384
  ds_read_b64_tr_b16 a[250:251], v27 offset:24576
  ds_read_b64_tr_b16 a[252:253], v27 offset:18432
  ds_read_b64_tr_b16 a[254:255], v27 offset:26624
  s_waitcnt lgkmcnt(0)
  s_barrier
  s_waitcnt vmcnt(24)
  ds_write_b128 v21, v[128:131] offset:0
  ds_write_b128 v21, v[132:135] offset:1024
  ds_write_b128 v21, v[192:195] offset:2048
  ds_write_b128 v21, v[196:199] offset:3072
  ds_write_b128 v21, v[136:139] offset:4096
  ds_write_b128 v21, v[140:143] offset:5120
  ds_write_b128 v21, v[200:203] offset:6144
  ds_write_b128 v21, v[204:207] offset:7168
  s_waitcnt lgkmcnt(0)
  s_barrier
  ds_read_b64_tr_b16 v[128:129], v26 offset:0
  ds_read_b64_tr_b16 v[130:131], v26 offset:8192
  ds_read_b64_tr_b16 v[132:133], v26 offset:2048
  ds_read_b64_tr_b16 v[134:135], v26 offset:10240
  ds_read_b64_tr_b16 v[192:193], v27 offset:0
  ds_read_b64_tr_b16 v[194:195], v27 offset:8192
  ds_read_b64_tr_b16 v[196:197], v27 offset:2048
  ds_read_b64_tr_b16 v[198:199], v27 offset:10240
  ds_read_b64_tr_b16 v[136:137], v26 offset:16384
  ds_read_b64_tr_b16 v[138:139], v26 offset:24576
  ds_read_b64_tr_b16 v[140:141], v26 offset:18432
  ds_read_b64_tr_b16 v[142:143], v26 offset:26624
  ds_read_b64_tr_b16 v[200:201], v27 offset:16384
  ds_read_b64_tr_b16 v[202:203], v27 offset:24576
  ds_read_b64_tr_b16 v[204:205], v27 offset:18432
  ds_read_b64_tr_b16 v[206:207], v27 offset:26624
  s_waitcnt lgkmcnt(0)
  s_barrier
  s_waitcnt vmcnt(16)
  ds_write_b128 v21, v[144:147] offset:0
  ds_write_b128 v21, v[148:151] offset:1024
  ds_write_b128 v21, v[208:211] offset:2048
  ds_write_b128 v21, v[212:215] offset:3072
  ds_write_b128 v21, v[152:155] offset:4096
  ds_write_b128 v21, v[156:159] offset:5120
  ds_write_b128 v21, v[216:219] offset:6144
  ds_write_b128 v21, v[220:223] offset:7168
  s_waitcnt lgkmcnt(0)
  s_barrier
  ds_read_b64_tr_b16 v[144:145], v26 offset:0
  ds_read_b64_tr_b16 v[146:147], v26 offset:8192
  ds_read_b64_tr_b16 v[148:149], v26 offset:2048
  ds_read_b64_tr_b16 v[150:151], v26 offset:10240
  ds_read_b64_tr_b16 v[208:209], v27 offset:0
  ds_read_b64_tr_b16 v[210:211], v27 offset:8192
  ds_read_b64_tr_b16 v[212:213], v27 offset:2048
  ds_read_b64_tr_b16 v[214:215], v27 offset:10240
  ds_read_b64_tr_b16 v[152:153], v26 offset:16384
  ds_read_b64_tr_b16 v[154:155], v26 offset:24576
  ds_read_b64_tr_b16 v[156:157], v26 offset:18432
  ds_read_b64_tr_b16 v[158:159], v26 offset:26624
  ds_read_b64_tr_b16 v[216:217], v27 offset:16384
  ds_read_b64_tr_b16 v[218:219], v27 offset:24576
  ds_read_b64_tr_b16 v[220:221], v27 offset:18432
  ds_read_b64_tr_b16 v[222:223], v27 offset:26624
  s_waitcnt lgkmcnt(0)
  s_barrier
  v_lshrrev_b32 v104, 2, v0
  v_and_b32 v104, 0x1c, v104
  v_bfe_u32 v103, v0, 4, 1
  v_lshl_add_u32 v103, v103, 11, s54
  v_add_u32 v105, 16384, v103
  v_add_u32 v106, 32768, v103
  global_load_dword v100, v104, s[6:7] sc1
  global_load_dword v101, v103, s[58:59] sc1
  global_load_dword v102, v105, s[58:59] sc1
  global_load_dword v5, v106, s[58:59] sc1
  s_waitcnt vmcnt(12)
  ds_write_b128 v21, v[160:163] offset:0
  ds_write_b128 v21, v[164:167] offset:1024
  ds_write_b128 v21, v[224:227] offset:2048
  ds_write_b128 v21, v[228:231] offset:3072
  ds_write_b128 v21, v[168:171] offset:4096
  ds_write_b128 v21, v[172:175] offset:5120
  ds_write_b128 v21, v[232:235] offset:6144
  ds_write_b128 v21, v[236:239] offset:7168
  s_waitcnt lgkmcnt(0)
  s_barrier
  ds_read_b64_tr_b16 v[160:161], v26 offset:0
  ds_read_b64_tr_b16 v[162:163], v26 offset:8192
  ds_read_b64_tr_b16 v[164:165], v26 offset:2048
  ds_read_b64_tr_b16 v[166:167], v26 offset:10240
  ds_read_b64_tr_b16 v[224:225], v27 offset:0
  ds_read_b64_tr_b16 v[226:227], v27 offset:8192
  ds_read_b64_tr_b16 v[228:229], v27 offset:2048
  ds_read_b64_tr_b16 v[230:231], v27 offset:10240
  ds_read_b64_tr_b16 v[168:169], v26 offset:16384
  ds_read_b64_tr_b16 v[170:171], v26 offset:24576
  ds_read_b64_tr_b16 v[172:173], v26 offset:18432
  ds_read_b64_tr_b16 v[174:175], v26 offset:26624
  ds_read_b64_tr_b16 v[232:233], v27 offset:16384
  ds_read_b64_tr_b16 v[234:235], v27 offset:24576
  ds_read_b64_tr_b16 v[236:237], v27 offset:18432
  ds_read_b64_tr_b16 v[238:239], v27 offset:26624
  s_waitcnt lgkmcnt(0)
  s_barrier
  s_waitcnt vmcnt(4)
  ds_write_b128 v21, v[176:179] offset:0
  ds_write_b128 v21, v[180:183] offset:1024
  ds_write_b128 v21, v[240:243] offset:2048
  ds_write_b128 v21, v[244:247] offset:3072
  ds_write_b128 v21, v[184:187] offset:4096
  ds_write_b128 v21, v[188:191] offset:5120
  ds_write_b128 v21, v[248:251] offset:6144
  ds_write_b128 v21, v[252:255] offset:7168
  s_waitcnt lgkmcnt(0)
  s_barrier
  ds_read_b64_tr_b16 v[176:177], v26 offset:0
  ds_read_b64_tr_b16 v[178:179], v26 offset:8192
  ds_read_b64_tr_b16 v[180:181], v26 offset:2048
  ds_read_b64_tr_b16 v[182:183], v26 offset:10240
  ds_read_b64_tr_b16 v[240:241], v27 offset:0
  ds_read_b64_tr_b16 v[242:243], v27 offset:8192
  ds_read_b64_tr_b16 v[244:245], v27 offset:2048
  ds_read_b64_tr_b16 v[246:247], v27 offset:10240
  ds_read_b64_tr_b16 v[184:185], v26 offset:16384
  ds_read_b64_tr_b16 v[186:187], v26 offset:24576
  ds_read_b64_tr_b16 v[188:189], v26 offset:18432
  ds_read_b64_tr_b16 v[190:191], v26 offset:26624
  ds_read_b64_tr_b16 v[248:249], v27 offset:16384
  ds_read_b64_tr_b16 v[250:251], v27 offset:24576
  ds_read_b64_tr_b16 v[252:253], v27 offset:18432
  ds_read_b64_tr_b16 v[254:255], v27 offset:26624
  s_waitcnt lgkmcnt(0)
  s_barrier
  s_waitcnt lgkmcnt(0)
  s_barrier
  s_branch L_wdone_2
L_wv_4:
  s_lshl_b32 s12, s8, 13
  s_add_u32 s12, s12, 131072
  v_add_u32 v21, s12, v0
  v_add_u32 v26, 131072, v26
  v_add_u32 v27, 131072, v27
  s_lshl_b32 s12, s9, 17
  s_add_u32 s44, s68, s12
  s_addc_u32 s45, s69, 0
  s_lshl_b32 s12, s8, 13
  s_add_u32 s12, s12, 0
  s_add_u32 s44, s44, s12
  s_addc_u32 s45, s45, 0
  v_xor_b32 v25, 0, v24
  s_add_u32 m0, s13, 0
  s_nop 0
  global_load_lds_dwordx4 v25, s[44:45] sc1
  s_add_u32 s44, s44, 1024
  s_addc_u32 s45, s45, 0
  v_xor_b32 v25, 32, v24
  s_add_u32 m0, s13, 1024
  s_nop 0
  global_load_lds_dwordx4 v25, s[44:45] sc1
  s_add_u32 s44, s44, 1024
  s_addc_u32 s45, s45, 0
  v_xor_b32 v25, 0, v24
  s_add_u32 m0, s13, 2048
  s_nop 0
  global_load_lds_dwordx4 v25, s[44:45] sc1
  s_add_u32 s44, s44, 1024
  s_addc_u32 s45, s45, 0
  v_xor_b32 v25, 32, v24
  s_add_u32 m0, s13, 3072
  s_nop 0
  global_load_lds_dwordx4 v25, s[44:45] sc1
  s_add_u32 s44, s44, 1024
  s_addc_u32 s45, s45, 0
  v_xor_b32 v25, 64, v24
  s_add_u32 m0, s13, 4096
  s_nop 0
  global_load_lds_dwordx4 v25, s[44:45] sc1
  s_add_u32 s44, s44, 1024
  s_addc_u32 s45, s45, 0
  v_xor_b32 v25, 96, v24
  s_add_u32 m0, s13, 5120
  s_nop 0
  global_load_lds_dwordx4 v25, s[44:45] sc1
  s_add_u32 s44, s44, 1024
  s_addc_u32 s45, s45, 0
  v_xor_b32 v25, 64, v24
  s_add_u32 m0, s13, 6144
  s_nop 0
  global_load_lds_dwordx4 v25, s[44:45] sc1
  s_add_u32 s44, s44, 1024
  s_addc_u32 s45, s45, 0
  v_xor_b32 v25, 96, v24
  s_add_u32 m0, s13, 7168
  s_nop 0
  global_load_lds_dwordx4 v25, s[44:45] sc1
  s_lshl_b32 s12, s9, 17
  s_add_u32 s44, s68, s12
  s_addc_u32 s45, s69, 0
  s_lshl_b32 s12, s8, 13
  s_add_u32 s12, s12, 32768
  s_add_u32 s44, s44, s12
  s_addc_u32 s45, s45, 0
  v_xor_b32 v25, 0, v24
  s_add_u32 m0, s13, 32768
  s_nop 0
  global_load_lds_dwordx4 v25, s[44:45] sc1
  s_add_u32 s44, s44, 1024
  s_addc_u32 s45, s45, 0
  v_xor_b32 v25, 32, v24
  s_add_u32 m0, s13, 33792
  s_nop 0
  global_load_lds_dwordx4 v25, s[44:45] sc1
  s_add_u32 s44, s44, 1024
  s_addc_u32 s45, s45, 0
  v_xor_b32 v25, 0, v24
  s_add_u32 m0, s13, 34816
  s_nop 0
  global_load_lds_dwordx4 v25, s[44:45] sc1
  s_add_u32 s44, s44, 1024
  s_addc_u32 s45, s45, 0
  v_xor_b32 v25, 32, v24
  s_add_u32 m0, s13, 35840
  s_nop 0
  global_load_lds_dwordx4 v25, s[44:45] sc1
  s_add_u32 s44, s44, 1024
  s_addc_u32 s45, s45, 0
  v_xor_b32 v25, 64, v24
  s_add_u32 m0, s13, 36864
  s_nop 0
  global_load_lds_dwordx4 v25, s[44:45] sc1
  s_add_u32 s44, s44, 1024
  s_addc_u32 s45, s45, 0
  v_xor_b32 v25, 96, v24
  s_add_u32 m0, s13, 37888
  s_nop 0
  global_load_lds_dwordx4 v25, s[44:45] sc1
  s_add_u32 s44, s44, 1024
  s_addc_u32 s45, s45, 0
  v_xor_b32 v25, 64, v24
  s_add_u32 m0, s13, 38912
  s_nop 0
  global_load_lds_dwordx4 v25, s[44:45] sc1
  s_add_u32 s44, s44, 1024
  s_addc_u32 s45, s45, 0
  v_xor_b32 v25, 96, v24
  s_add_u32 m0, s13, 39936
  s_nop 0
  global_load_lds_dwordx4 v25, s[44:45] sc1
  s_lshl_b32 s12, s9, 17
  s_add_u32 s44, s68, s12
  s_addc_u32 s45, s69, 0
  s_lshl_b32 s12, s8, 13
  s_add_u32 s12, s12, 65536
  s_add_u32 s44, s44, s12
  s_addc_u32 s45, s45, 0
  v_xor_b32 v25, 0, v24
  s_add_u32 m0, s13, 65536
  s_nop 0
  global_load_lds_dwordx4 v25, s[44:45] sc1
  s_add_u32 s44, s44, 1024
  s_addc_u32 s45, s45, 0
  v_xor_b32 v25, 32, v24
  s_add_u32 m0, s13, 66560
  s_nop 0
  global_load_lds_dwordx4 v25, s[44:45] sc1
  s_add_u32 s44, s44, 1024
  s_addc_u32 s45, s45, 0
  v_xor_b32 v25, 0, v24
  s_add_u32 m0, s13, 67584
  s_nop 0
  global_load_lds_dwordx4 v25, s[44:45] sc1
  s_add_u32 s44, s44, 1024
  s_addc_u32 s45, s45, 0
  v_xor_b32 v25, 32, v24
  s_add_u32 m0, s13, 68608
  s_nop 0
  global_load_lds_dwordx4 v25, s[44:45] sc1
  s_add_u32 s44, s44, 1024
  s_addc_u32 s45, s45, 0
  v_xor_b32 v25, 64, v24
  s_add_u32 m0, s13, 69632
  s_nop 0
  global_load_lds_dwordx4 v25, s[44:45] sc1
  s_add_u32 s44, s44, 1024
  s_addc_u32 s45, s45, 0
  v_xor_b32 v25, 96, v24
  s_add_u32 m0, s13, 70656
  s_nop 0
  global_load_lds_dwordx4 v25, s[44:45] sc1
  s_add_u32 s44, s44, 1024
  s_addc_u32 s45, s45, 0
  v_xor_b32 v25, 64, v24
  s_add_u32 m0, s13, 71680
  s_nop 0
  global_load_lds_dwordx4 v25, s[44:45] sc1
  s_add_u32 s44, s44, 1024
  s_addc_u32 s45, s45, 0
  v_xor_b32 v25, 96, v24
  s_add_u32 m0, s13, 72704
  s_nop 0
  global_load_lds_dwordx4 v25, s[44:45] sc1
  s_lshl_b32 s12, s9, 17
  s_add_u32 s44, s68, s12
  s_addc_u32 s45, s69, 0
  s_lshl_b32 s12, s8, 13
  s_add_u32 s12, s12, 98304
  s_add_u32 s44, s44, s12
  s_addc_u32 s45, s45, 0
  v_xor_b32 v25, 0, v24
  s_add_u32 m0, s13, 98304
  s_nop 0
  global_load_lds_dwordx4 v25, s[44:45] sc1
  s_add_u32 s44, s44, 1024
  s_addc_u32 s45, s45, 0
  v_xor_b32 v25, 32, v24
  s_add_u32 m0, s13, 99328
  s_nop 0
  global_load_lds_dwordx4 v25, s[44:45] sc1
  s_add_u32 s44, s44, 1024
  s_addc_u32 s45, s45, 0
  v_xor_b32 v25, 0, v24
  s_add_u32 m0, s13, 100352
  s_nop 0
  global_load_lds_dwordx4 v25, s[44:45] sc1
  s_add_u32 s44, s44, 1024
  s_addc_u32 s45, s45, 0
  v_xor_b32 v25, 32, v24
  s_add_u32 m0, s13, 101376
  s_nop 0
  global_load_lds_dwordx4 v25, s[44:45] sc1
  s_add_u32 s44, s44, 1024
  s_addc_u32 s45, s45, 0
  v_xor_b32 v25, 64, v24
  s_add_u32 m0, s13, 102400
  s_nop 0
  global_load_lds_dwordx4 v25, s[44:45] sc1
  s_add_u32 s44, s44, 1024
  s_addc_u32 s45, s45, 0
  v_xor_b32 v25, 96, v24
  s_add_u32 m0, s13, 103424
  s_nop 0
  global_load_lds_dwordx4 v25, s[44:45] sc1
  s_add_u32 s44, s44, 1024
  s_addc_u32 s45, s45, 0
  v_xor_b32 v25, 64, v24
  s_add_u32 m0, s13, 104448
  s_nop 0
  global_load_lds_dwordx4 v25, s[44:45] sc1
  s_add_u32 s44, s44, 1024
  s_addc_u32 s45, s45, 0
  v_xor_b32 v25, 96, v24
  s_add_u32 m0, s13, 105472
  s_nop 0
  global_load_lds_dwordx4 v25, s[44:45] sc1
  s_lshl_b32 s12, s9, 8
  s_add_u32 s44, s62, s12
  s_addc_u32 s45, s63, 0
  s_add_u32 s44, s44, 0
  s_addc_u32 s45, s45, 0
  global_load_dwordx4 a[48:51], v22, s[44:45] sc1
  s_add_u32 s44, s44, 32768
  s_addc_u32 s45, s45, 0
  global_load_dwordx4 a[52:55], v22, s[44:45] sc1
  s_add_u32 s44, s44, 32768
  s_addc_u32 s45, s45, 0
  global_load_dwordx4 a[112:115], v22, s[44:45] sc1
  s_add_u32 s44, s44, 32768
  s_addc_u32 s45, s45, 0
  global_load_dwordx4 a[116:119], v22, s[44:45] sc1
  s_add_u32 s44, s44, 32768
  s_addc_u32 s45, s45, 0
  global_load_dwordx4 a[56:59], v23, s[44:45] sc1
  s_add_u32 s44, s44, 32768
  s_addc_u32 s45, s45, 0
  global_load_dwordx4 a[60:63], v23, s[44:45] sc1
  s_add_u32 s44, s44, 32768
  s_addc_u32 s45, s45, 0
  global_load_dwordx4 a[120:123], v23, s[44:45] sc1
  s_add_u32 s44, s44, 32768
  s_addc_u32 s45, s45, 0
  global_load_dwordx4 a[124:127], v23, s[44:45] sc1
  s_lshl_b32 s12, s9, 8
  s_add_u32 s44, s62, s12
  s_addc_u32 s45, s63, 0
  s_add_u32 s44, s44, 1048576
  s_addc_u32 s45, s45, 0
  global_load_dwordx4 a[0:3], v22, s[44:45] sc1
  s_add_u32 s44, s44, 32768
  s_addc_u32 s45, s45, 0
  global_load_dwordx4 a[4:7], v22, s[44:45] sc1
  s_add_u32 s44, s44, 32768
  s_addc_u32 s45, s45, 0
  global_load_dwordx4 a[64:67], v22, s[44:45] sc1
  s_add_u32 s44, s44, 32768
  s_addc_u32 s45, s45, 0
  global_load_dwordx4 a[68:71], v22, s[44:45] sc1
  s_add_u32 s44, s44, 32768
  s_addc_u32 s45, s45, 0
  global_load_dwordx4 a[8:11], v23, s[44:45] sc1
  s_add_u32 s44, s44, 32768
  s_addc_u32 s45, s45, 0
  global_load_dwordx4 a[12:15], v23, s[44:45] sc1
  s_add_u32 s44, s44, 32768
  s_addc_u32 s45, s45, 0
  global_load_dwordx4 a[72:75], v23, s[44:45] sc1
  s_add_u32 s44, s44, 32768
  s_addc_u32 s45, s45, 0
  global_load_dwordx4 a[76:79], v23, s[44:45] sc1
  s_lshl_b32 s12, s9, 8
  s_add_u32 s44, s62, s12
  s_addc_u32 s45, s63, 0
  s_add_u32 s44, s44, 2097152
  s_addc_u32 s45, s45, 0
  global_load_dwordx4 a[16:19], v22, s[44:45] sc1
  s_add_u32 s44, s44, 32768
  s_addc_u32 s45, s45, 0
  global_load_dwordx4 a[20:23], v22, s[44:45] sc1
  s_add_u32 s44, s44, 32768
  s_addc_u32 s45, s45, 0
  global_load_dwordx4 a[80:83], v22, s[44:45] sc1
  s_add_u32 s44, s44, 32768
  s_addc_u32 s45, s45, 0
  global_load_dwordx4 a[84:87], v22, s[44:45] sc1
  s_add_u32 s44, s44, 32768
  s_addc_u32 s45, s45, 0
  global_load_dwordx4 a[24:27], v23, s[44:45] sc1
  s_add_u32 s44, s44, 32768
  s_addc_u32 s45, s45, 0
  global_load_dwordx4 a[28:31], v23, s[44:45] sc1
  s_add_u32 s44, s44, 32768
  s_addc_u32 s45, s45, 0
  global_load_dwordx4 a[88:91], v23, s[44:45] sc1
  s_add_u32 s44, s44, 32768
  s_addc_u32 s45, s45, 0
  global_load_dwordx4 a[92:95], v23, s[44:45] sc1
  v_mov_b32 v99, 16
  global_load_dword v99, v99, s[6:7] sc1
  s_waitcnt vmcnt(49)
  s_barrier
  v_add_u32 v29, 0, v28
  v_xor_b32 v30, 0, v29
  ds_read_b64_tr_b16 v[32:33], v30 offset:0
  ds_read_b64_tr_b16 v[34:35], v30 offset:2048
  v_xor_b32 v30, 32, v29
  ds_read_b64_tr_b16 v[36:37], v30 offset:0
  ds_read_b64_tr_b16 v[38:39], v30 offset:2048
  v_xor_b32 v30, 64, v29
  ds_read_b64_tr_b16 v[40:41], v30 offset:0
  ds_read_b64_tr_b16 v[42:43], v30 offset:2048
  v_xor_b32 v30, 96, v29
  ds_read_b64_tr_b16 v[44:45], v30 offset:0
  ds_read_b64_tr_b16 v[46:47], v30 offset:2048
  v_xor_b32 v30, 128, v29
  ds_read_b64_tr_b16 v[48:49], v30 offset:0
  ds_read_b64_tr_b16 v[50:51], v30 offset:2048
  v_xor_b32 v30, 160, v29
  ds_read_b64_tr_b16 v[52:53], v30 offset:0
  ds_read_b64_tr_b16 v[54:55], v30 offset:2048
  v_xor_b32 v30, 192, v29
  ds_read_b64_tr_b16 v[56:57], v30 offset:0
  ds_read_b64_tr_b16 v[58:59], v30 offset:2048
  v_xor_b32 v30, 224, v29
  ds_read_b64_tr_b16 v[60:61], v30 offset:0
  ds_read_b64_tr_b16 v[62:63], v30 offset:2048
  s_lshl_b32 s12, s9, 8
  s_add_u32 s44, s62, s12
  s_addc_u32 s45, s63, 0
  s_add_u32 s44, s44, 3145728
  s_addc_u32 s45, s45, 0
  global_load_dwordx4 a[32:35], v22, s[44:45] sc1
  s_add_u32 s44, s44, 32768
  s_addc_u32 s45, s45, 0
  global_load_dwordx4 a[36:39], v22, s[44:45] sc1
  s_add_u32 s44, s44, 32768
  s_addc_u32 s45, s45, 0
  global_load_dwordx4 a[96:99], v22, s[44:45] sc1
  s_add_u32 s44, s44, 32768
  s_addc_u32 s45, s45, 0
  global_load_dwordx4 a[100:103], v22, s[44:45] sc1
  s_add_u32 s44, s44, 32768
  s_addc_u32 s45, s45, 0
  global_load_dwordx4 a[40:43], v23, s[44:45] sc1
  s_add_u32 s44, s44, 32768
  s_addc_u32 s45, s45, 0
  global_load_dwordx4 a[44:47], v23, s[44:45] sc1
  s_add_u32 s44, s44, 32768
  s_addc_u32 s45, s45, 0
  global_load_dwordx4 a[104:107], v23, s[44:45] sc1
  s_add_u32 s44, s44, 32768
  s_addc_u32 s45, s45, 0
  global_load_dwordx4 a[108:111], v23, s[44:45] sc1
  s_waitcnt lgkmcnt(0)
  s_barrier
  ds_write_b128 v16, v[32:35] offset:0
  ds_write_b128 v16, v[36:39] offset:1024
  ds_write_b128 v16, v[40:43] offset:2048
  ds_write_b128 v16, v[44:47] offset:3072
  ds_write_b128 v16, v[48:51] offset:4096
  ds_write_b128 v16, v[52:55] offset:5120
  ds_write_b128 v16, v[56:59] offset:6144
  ds_write_b128 v16, v[60:63] offset:7168
  s_waitcnt vmcnt(49)
  s_barrier
  v_add_u32 v29, 32768, v28
  v_xor_b32 v30, 0, v29
  ds_read_b64_tr_b16 v[32:33], v30 offset:0
  ds_read_b64_tr_b16 v[34:35], v30 offset:2048
  v_xor_b32 v30, 32, v29
  ds_read_b64_tr_b16 v[36:37], v30 offset:0
  ds_read_b64_tr_b16 v[38:39], v30 offset:2048
  v_xor_b32 v30, 64, v29
  ds_read_b64_tr_b16 v[40:41], v30 offset:0
  ds_read_b64_tr_b16 v[42:43], v30 offset:2048
  v_xor_b32 v30, 96, v29
  ds_read_b64_tr_b16 v[44:45], v30 offset:0
  ds_read_b64_tr_b16 v[46:47], v30 offset:2048
  v_xor_b32 v30, 128, v29
  ds_read_b64_tr_b16 v[48:49], v30 offset:0
  ds_read_b64_tr_b16 v[50:51], v30 offset:2048
  v_xor_b32 v30, 160, v29
  ds_read_b64_tr_b16 v[52:53], v30 offset:0
  ds_read_b64_tr_b16 v[54:55], v30 offset:2048
  v_xor_b32 v30, 192, v29
  ds_read_b64_tr_b16 v[56:57], v30 offset:0
  ds_read_b64_tr_b16 v[58:59], v30 offset:2048
  v_xor_b32 v30, 224, v29
  ds_read_b64_tr_b16 v[60:61], v30 offset:0
  ds_read_b64_tr_b16 v[62:63], v30 offset:2048
  s_lshl_b32 s12, s9, 8
  s_add_u32 s44, s64, s12
  s_addc_u32 s45, s65, 0
  s_add_u32 s44, s44, 0
  s_addc_u32 s45, s45, 0
  global_load_dwordx4 a[176:179], v22, s[44:45] sc1
  s_add_u32 s44, s44, 32768
  s_addc_u32 s45, s45, 0
  global_load_dwordx4 a[180:183], v22, s[44:45] sc1
  s_add_u32 s44, s44, 32768
  s_addc_u32 s45, s45, 0
  global_load_dwordx4 a[240:243], v22, s[44:45] sc1
  s_add_u32 s44, s44, 32768
  s_addc_u32 s45, s45, 0
  global_load_dwordx4 a[244:247], v22, s[44:45] sc1
  s_add_u32 s44, s44, 32768
  s_addc_u32 s45, s45, 0
  global_load_dwordx4 a[184:187], v23, s[44:45] sc1
  s_add_u32 s44, s44, 32768
  s_addc_u32 s45, s45, 0
  global_load_dwordx4 a[188:191], v23, s[44:45] sc1
  s_add_u32 s44, s44, 32768
  s_addc_u32 s45, s45, 0
  global_load_dwordx4 a[248:251], v23, s[44:45] sc1
  s_add_u32 s44, s44, 32768
  s_addc_u32 s45, s45, 0
  global_load_dwordx4 a[252:255], v23, s[44:45] sc1
  s_waitcnt lgkmcnt(0)
  s_barrier
  ds_write_b128 v16, v[32:35] offset:32768
  ds_write_b128 v16, v[36:39] offset:33792
  ds_write_b128 v16, v[40:43] offset:34816
  ds_write_b128 v16, v[44:47] offset:35840
  ds_write_b128 v16, v[48:51] offset:36864
  ds_write_b128 v16, v[52:55] offset:37888
  ds_write_b128 v16, v[56:59] offset:38912
  ds_write_b128 v16, v[60:63] offset:39936
  s_waitcnt vmcnt(49)
  s_barrier
  v_add_u32 v29, 65536, v28
  v_xor_b32 v30, 0, v29
  ds_read_b64_tr_b16 v[32:33], v30 offset:0
  ds_read_b64_tr_b16 v[34:35], v30 offset:2048
  v_xor_b32 v30, 32, v29
  ds_read_b64_tr_b16 v[36:37], v30 offset:0
  ds_read_b64_tr_b16 v[38:39], v30 offset:2048
  v_xor_b32 v30, 64, v29
  ds_read_b64_tr_b16 v[40:41], v30 offset:0
  ds_read_b64_tr_b16 v[42:43], v30 offset:2048
  v_xor_b32 v30, 96, v29
  ds_read_b64_tr_b16 v[44:45], v30 offset:0
  ds_read_b64_tr_b16 v[46:47], v30 offset:2048
  v_xor_b32 v30, 128, v29
  ds_read_b64_tr_b16 v[48:49], v30 offset:0
  ds_read_b64_tr_b16 v[50:51], v30 offset:2048
  v_xor_b32 v30, 160, v29
  ds_read_b64_tr_b16 v[52:53], v30 offset:0
  ds_read_b64_tr_b16 v[54:55], v30 offset:2048
  v_xor_b32 v30, 192, v29
  ds_read_b64_tr_b16 v[56:57], v30 offset:0
  ds_read_b64_tr_b16 v[58:59], v30 offset:2048
  v_xor_b32 v30, 224, v29
  ds_read_b64_tr_b16 v[60:61], v30 offset:0
  ds_read_b64_tr_b16 v[62:63], v30 offset:2048
  s_lshl_b32 s12, s9, 8
  s_add_u32 s44, s64, s12
  s_addc_u32 s45, s65, 0
  s_add_u32 s44, s44, 1048576
  s_addc_u32 s45, s45, 0
  global_load_dwordx4 a[128:131], v22, s[44:45] sc1
  s_add_u32 s44, s44, 32768
  s_addc_u32 s45, s45, 0
  global_load_dwordx4 a[132:135], v22, s[44:45] sc1
  s_add_u32 s44, s44, 32768
  s_addc_u32 s45, s45, 0
  global_load_dwordx4 a[192:195], v22, s[44:45] sc1
  s_add_u32 s44, s44, 32768
  s_addc_u32 s45, s45, 0
  global_load_dwordx4 a[196:199], v22, s[44:45] sc1
  s_add_u32 s44, s44, 32768
  s_addc_u32 s45, s45, 0
  global_load_dwordx4 a[136:139], v23, s[44:45] sc1
  s_add_u32 s44, s44, 32768
  s_addc_u32 s45, s45, 0
  global_load_dwordx4 a[140:143], v23, s[44:45] sc1
  s_add_u32 s44, s44, 32768
  s_addc_u32 s45, s45, 0
  global_load_dwordx4 a[200:203], v23, s[44:45] sc1
  s_add_u32 s44, s44, 32768
  s_addc_u32 s45, s45, 0
  global_load_dwordx4 a[204:207], v23, s[44:45] sc1
  s_waitcnt lgkmcnt(0)
  s_barrier
  ds_write_b128 v17, v[32:35] offset:0
  ds_write_b128 v17, v[36:39] offset:1024
  ds_write_b128 v17, v[40:43] offset:2048
  ds_write_b128 v17, v[44:47] offset:3072
  ds_write_b128 v17, v[48:51] offset:4096
  ds_write_b128 v17, v[52:55] offset:5120
  ds_write_b128 v17, v[56:59] offset:6144
  ds_write_b128 v17, v[60:63] offset:7168
  s_waitcnt vmcnt(49)
  s_barrier
  v_add_u32 v29, 98304, v28
  v_xor_b32 v30, 0, v29
  ds_read_b64_tr_b16 v[32:33], v30 offset:0
  ds_read_b64_tr_b16 v[34:35], v30 offset:2048
  v_xor_b32 v30, 32, v29
  ds_read_b64_tr_b16 v[36:37], v30 offset:0
  ds_read_b64_tr_b16 v[38:39], v30 offset:2048
  v_xor_b32 v30, 64, v29
  ds_read_b64_tr_b16 v[40:41], v30 offset:0
  ds_read_b64_tr_b16 v[42:43], v30 offset:2048
  v_xor_b32 v30, 96, v29
  ds_read_b64_tr_b16 v[44:45], v30 offset:0
  ds_read_b64_tr_b16 v[46:47], v30 offset:2048
  v_xor_b32 v30, 128, v29
  ds_read_b64_tr_b16 v[48:49], v30 offset:0
  ds_read_b64_tr_b16 v[50:51], v30 offset:2048
  v_xor_b32 v30, 160, v29
  ds_read_b64_tr_b16 v[52:53], v30 offset:0
  ds_read_b64_tr_b16 v[54:55], v30 offset:2048
  v_xor_b32 v30, 192, v29
  ds_read_b64_tr_b16 v[56:57], v30 offset:0
  ds_read_b64_tr_b16 v[58:59], v30 offset:2048
  v_xor_b32 v30, 224, v29
  ds_read_b64_tr_b16 v[60:61], v30 offset:0
  ds_read_b64_tr_b16 v[62:63], v30 offset:2048
  s_lshl_b32 s12, s9, 8
  s_add_u32 s44, s64, s12
  s_addc_u32 s45, s65, 0
  s_add_u32 s44, s44, 2097152
  s_addc_u32 s45, s45, 0
  global_load_dwordx4 a[144:147], v22, s[44:45] sc1
  s_add_u32 s44, s44, 32768
  s_addc_u32 s45, s45, 0
  global_load_dwordx4 a[148:151], v22, s[44:45] sc1
  s_add_u32 s44, s44, 32768
  s_addc_u32 s45, s45, 0
  global_load_dwordx4 a[208:211], v22, s[44:45] sc1
  s_add_u32 s44, s44, 32768
  s_addc_u32 s45, s45, 0
  global_load_dwordx4 a[212:215], v22, s[44:45] sc1
  s_add_u32 s44, s44, 32768
  s_addc_u32 s45, s45, 0
  global_load_dwordx4 a[152:155], v23, s[44:45] sc1
  s_add_u32 s44, s44, 32768
  s_addc_u32 s45, s45, 0
  global_load_dwordx4 a[156:159], v23, s[44:45] sc1
  s_add_u32 s44, s44, 32768
  s_addc_u32 s45, s45, 0
  global_load_dwordx4 a[216:219], v23, s[44:45] sc1
  s_add_u32 s44, s44, 32768
  s_addc_u32 s45, s45, 0
  global_load_dwordx4 a[220:223], v23, s[44:45] sc1
  s_waitcnt lgkmcnt(0)
  s_barrier
  ds_write_b128 v17, v[32:35] offset:32768
  ds_write_b128 v17, v[36:39] offset:33792
  ds_write_b128 v17, v[40:43] offset:34816
  ds_write_b128 v17, v[44:47] offset:35840
  ds_write_b128 v17, v[48:51] offset:36864
  ds_write_b128 v17, v[52:55] offset:37888
  ds_write_b128 v17, v[56:59] offset:38912
  ds_write_b128 v17, v[60:63] offset:39936
  s_waitcnt vmcnt(49)
  ds_write_b128 v21, a[48:51] offset:0
  ds_write_b128 v21, a[52:55] offset:1024
  ds_write_b128 v21, a[112:115] offset:2048
  ds_write_b128 v21, a[116:119] offset:3072
  ds_write_b128 v21, a[56:59] offset:4096
  ds_write_b128 v21, a[60:63] offset:5120
  ds_write_b128 v21, a[120:123] offset:6144
  ds_write_b128 v21, a[124:127] offset:7168
  s_waitcnt lgkmcnt(0)
  s_barrier
  ds_read_b64_tr_b16 a[48:49], v26 offset:0
  ds_read_b64_tr_b16 a[50:51], v26 offset:8192
  ds_read_b64_tr_b16 a[52:53], v26 offset:2048
  ds_read_b64_tr_b16 a[54:55], v26 offset:10240
  ds_read_b64_tr_b16 a[112:113], v27 offset:0
  ds_read_b64_tr_b16 a[114:115], v27 offset:8192
  ds_read_b64_tr_b16 a[116:117], v27 offset:2048
  ds_read_b64_tr_b16 a[118:119], v27 offset:10240
  ds_read_b64_tr_b16 a[56:57], v26 offset:16384
  ds_read_b64_tr_b16 a[58:59], v26 offset:24576
  ds_read_b64_tr_b16 a[60:61], v26 offset:18432
  ds_read_b64_tr_b16 a[62:63], v26 offset:26624
  ds_read_b64_tr_b16 a[120:121], v27 offset:16384
  ds_read_b64_tr_b16 a[122:123], v27 offset:24576
  ds_read_b64_tr_b16 a[124:125], v27 offset:18432
  ds_read_b64_tr_b16 a[126:127], v27 offset:26624
  s_lshl_b32 s12, s9, 8
  s_add_u32 s44, s64, s12
  s_addc_u32 s45, s65, 0
  s_add_u32 s44, s44, 3145728
  s_addc_u32 s45, s45, 0
  global_load_dwordx4 a[160:163], v22, s[44:45] sc1
  s_add_u32 s44, s44, 32768
  s_addc_u32 s45, s45, 0
  global_load_dwordx4 a[164:167], v22, s[44:45] sc1
  s_add_u32 s44, s44, 32768
  s_addc_u32 s45, s45, 0
  global_load_dwordx4 a[224:227], v22, s[44:45] sc1
  s_add_u32 s44, s44, 32768
  s_addc_u32 s45, s45, 0
  global_load_dwordx4 a[228:231], v22, s[44:45] sc1
  s_add_u32 s44, s44, 32768
  s_addc_u32 s45, s45, 0
  global_load_dwordx4 a[168:171], v23, s[44:45] sc1
  s_add_u32 s44, s44, 32768
  s_addc_u32 s45, s45, 0
  global_load_dwordx4 a[172:175], v23, s[44:45] sc1
  s_add_u32 s44, s44, 32768
  s_addc_u32 s45, s45, 0
  global_load_dwordx4 a[232:235], v23, s[44:45] sc1
  s_add_u32 s44, s44, 32768
  s_addc_u32 s45, s45, 0
  global_load_dwordx4 a[236:239], v23, s[44:45] sc1
  s_waitcnt lgkmcnt(0)
  s_barrier
  s_waitcnt vmcnt(49)
  ds_write_b128 v21, a[0:3] offset:0
  ds_write_b128 v21, a[4:7] offset:1024
  ds_write_b128 v21, a[64:67] offset:2048
  ds_write_b128 v21, a[68:71] offset:3072
  ds_write_b128 v21, a[8:11] offset:4096
  ds_write_b128 v21, a[12:15] offset:5120
  ds_write_b128 v21, a[72:75] offset:6144
  ds_write_b128 v21, a[76:79] offset:7168
  s_waitcnt lgkmcnt(0)
  s_barrier
  ds_read_b64_tr_b16 a[0:1], v26 offset:0
  ds_read_b64_tr_b16 a[2:3], v26 offset:8192
  ds_read_b64_tr_b16 a[4:5], v26 offset:2048
  ds_read_b64_tr_b16 a[6:7], v26 offset:10240
  ds_read_b64_tr_b16 a[64:65], v27 offset:0
  ds_read_b64_tr_b16 a[66:67], v27 offset:8192
  ds_read_b64_tr_b16 a[68:69], v27 offset:2048
  ds_read_b64_tr_b16 a[70:71], v27 offset:10240
  ds_read_b64_tr_b16 a[8:9], v26 offset:16384
  ds_read_b64_tr_b16 a[10:11], v26 offset:24576
  ds_read_b64_tr_b16 a[12:13], v26 offset:18432
  ds_read_b64_tr_b16 a[14:15], v26 offset:26624
  ds_read_b64_tr_b16 a[72:73], v27 offset:16384
  ds_read_b64_tr_b16 a[74:75], v27 offset:24576
  ds_read_b64_tr_b16 a[76:77], v27 offset:18432
  ds_read_b64_tr_b16 a[78:79], v27 offset:26624
  s_lshl_b32 s12, s9, 8
  s_add_u32 s44, s66, s12
  s_addc_u32 s45, s67, 0
  s_add_u32 s44, s44, 0
  s_addc_u32 s45, s45, 0
  global_load_dwordx4 v[176:179], v22, s[44:45] sc1
  s_add_u32 s44, s44, 32768
  s_addc_u32 s45, s45, 0
  global_load_dwordx4 v[180:183], v22, s[44:45] sc1
  s_add_u32 s44, s44, 32768
  s_addc_u32 s45, s45, 0
  global_load_dwordx4 v[240:243], v22, s[44:45] sc1
  s_add_u32 s44, s44, 32768
  s_addc_u32 s45, s45, 0
  global_load_dwordx4 v[244:247], v22, s[44:45] sc1
  s_add_u32 s44, s44, 32768
  s_addc_u32 s45, s45, 0
  global_load_dwordx4 v[184:187], v23, s[44:45] sc1
  s_add_u32 s44, s44, 32768
  s_addc_u32 s45, s45, 0
  global_load_dwordx4 v[188:191], v23, s[44:45] sc1
  s_add_u32 s44, s44, 32768
  s_addc_u32 s45, s45, 0
  global_load_dwordx4 v[248:251], v23, s[44:45] sc1
  s_add_u32 s44, s44, 32768
  s_addc_u32 s45, s45, 0
  global_load_dwordx4 v[252:255], v23, s[44:45] sc1
  s_waitcnt lgkmcnt(0)
  s_barrier
  s_waitcnt vmcnt(49)
  ds_write_b128 v21, a[16:19] offset:0
  ds_write_b128 v21, a[20:23] offset:1024
  ds_write_b128 v21, a[80:83] offset:2048
  ds_write_b128 v21, a[84:87] offset:3072
  ds_write_b128 v21, a[24:27] offset:4096
  ds_write_b128 v21, a[28:31] offset:5120
  ds_write_b128 v21, a[88:91] offset:6144
  ds_write_b128 v21, a[92:95] offset:7168
  s_waitcnt lgkmcnt(0)
  s_barrier
  ds_read_b64_tr_b16 a[16:17], v26 offset:0
  ds_read_b64_tr_b16 a[18:19], v26 offset:8192
  ds_read_b64_tr_b16 a[20:21], v26 offset:2048
  ds_read_b64_tr_b16 a[22:23], v26 offset:10240
  ds_read_b64_tr_b16 a[80:81], v27 offset:0
  ds_read_b64_tr_b16 a[82:83], v27 offset:8192
  ds_read_b64_tr_b16 a[84:85], v27 offset:2048
  ds_read_b64_tr_b16 a[86:87], v27 offset:10240
  ds_read_b64_tr_b16 a[24:25], v26 offset:16384
  ds_read_b64_tr_b16 a[26:27], v26 offset:24576
  ds_read_b64_tr_b16 a[28:29], v26 offset:18432
  ds_read_b64_tr_b16 a[30:31], v26 offset:26624
  ds_read_b64_tr_b16 a[88:89], v27 offset:16384
  ds_read_b64_tr_b16 a[90:91], v27 offset:24576
  ds_read_b64_tr_b16 a[92:93], v27 offset:18432
  ds_read_b64_tr_b16 a[94:95], v27 offset:26624
  s_lshl_b32 s12, s9, 8
  s_add_u32 s44, s66, s12
  s_addc_u32 s45, s67, 0
  s_add_u32 s44, s44, 1048576
  s_addc_u32 s45, s45, 0
  global_load_dwordx4 v[128:131], v22, s[44:45] sc1
  s_add_u32 s44, s44, 32768
  s_addc_u32 s45, s45, 0
  global_load_dwordx4 v[132:135], v22, s[44:45] sc1
  s_add_u32 s44, s44, 32768
  s_addc_u32 s45, s45, 0
  global_load_dwordx4 v[192:195], v22, s[44:45] sc1
  s_add_u32 s44, s44, 32768
  s_addc_u32 s45, s45, 0
  global_load_dwordx4 v[196:199], v22, s[44:45] sc1
  s_add_u32 s44, s44, 32768
  s_addc_u32 s45, s45, 0
  global_load_dwordx4 v[136:139], v23, s[44:45] sc1
  s_add_u32 s44, s44, 32768
  s_addc_u32 s45, s45, 0
  global_load_dwordx4 v[140:143], v23, s[44:45] sc1
  s_add_u32 s44, s44, 32768
  s_addc_u32 s45, s45, 0
  global_load_dwordx4 v[200:203], v23, s[44:45] sc1
  s_add_u32 s44, s44, 32768
  s_addc_u32 s45, s45, 0
  global_load_dwordx4 v[204:207], v23, s[44:45] sc1
  s_waitcnt lgkmcnt(0)
  s_barrier
  s_waitcnt vmcnt(48)
  ds_write_b128 v21, a[32:35] offset:0
  ds_write_b128 v21, a[36:39] offset:1024
  ds_write_b128 v21, a[96:99] offset:2048
  ds_write_b128 v21, a[100:103] offset:3072
  ds_write_b128 v21, a[40:43] offset:4096
  ds_write_b128 v21, a[44:47] offset:5120
  ds_write_b128 v21, a[104:107] offset:6144
  ds_write_b128 v21, a[108:111] offset:7168
  s_waitcnt lgkmcnt(0)
  s_barrier
  ds_read_b64_tr_b16 a[32:33], v26 offset:0
  ds_read_b64_tr_b16 a[34:35], v26 offset:8192
  ds_read_b64_tr_b16 a[36:37], v26 offset:2048
  ds_read_b64_tr_b16 a[38:39], v26 offset:10240
  ds_read_b64_tr_b16 a[96:97], v27 offset:0
  ds_read_b64_tr_b16 a[98:99], v27 offset:8192
  ds_read_b64_tr_b16 a[100:101], v27 offset:2048
  ds_read_b64_tr_b16 a[102:103], v27 offset:10240
  ds_read_b64_tr_b16 a[40:41], v26 offset:16384
  ds_read_b64_tr_b16 a[42:43], v26 offset:24576
  ds_read_b64_tr_b16 a[44:45], v26 offset:18432
  ds_read_b64_tr_b16 a[46:47], v26 offset:26624
  ds_read_b64_tr_b16 a[104:105], v27 offset:16384
  ds_read_b64_tr_b16 a[106:107], v27 offset:24576
  ds_read_b64_tr_b16 a[108:109], v27 offset:18432
  ds_read_b64_tr_b16 a[110:111], v27 offset:26624
  s_lshl_b32 s12, s9, 8
  s_add_u32 s44, s66, s12
  s_addc_u32 s45, s67, 0
  s_add_u32 s44, s44, 2097152
  s_addc_u32 s45, s45, 0
  global_load_dwordx4 v[144:147], v22, s[44:45] sc1
  s_add_u32 s44, s44, 32768
  s_addc_u32 s45, s45, 0
  global_load_dwordx4 v[148:151], v22, s[44:45] sc1
  s_add_u32 s44, s44, 32768
  s_addc_u32 s45, s45, 0
  global_load_dwordx4 v[208:211], v22, s[44:45] sc1
  s_add_u32 s44, s44, 32768
  s_addc_u32 s45, s45, 0
  global_load_dwordx4 v[212:215], v22, s[44:45] sc1
  s_add_u32 s44, s44, 32768
  s_addc_u32 s45, s45, 0
  global_load_dwordx4 v[152:155], v23, s[44:45] sc1
  s_add_u32 s44, s44, 32768
  s_addc_u32 s45, s45, 0
  global_load_dwordx4 v[156:159], v23, s[44:45] sc1
  s_add_u32 s44, s44, 32768
  s_addc_u32 s45, s45, 0
  global_load_dwordx4 v[216:219], v23, s[44:45] sc1
  s_add_u32 s44, s44, 32768
  s_addc_u32 s45, s45, 0
  global_load_dwordx4 v[220:223], v23, s[44:45] sc1
  s_waitcnt lgkmcnt(0)
  s_barrier
  s_waitcnt vmcnt(48)
  ds_write_b128 v21, a[176:179] offset:0
  ds_write_b128 v21, a[180:183] offset:1024
  ds_write_b128 v21, a[240:243] offset:2048
  ds_write_b128 v21, a[244:247] offset:3072
  ds_write_b128 v21, a[184:187] offset:4096
  ds_write_b128 v21, a[188:191] offset:5120
  ds_write_b128 v21, a[248:251] offset:6144
  ds_write_b128 v21, a[252:255] offset:7168
  s_waitcnt lgkmcnt(0)
  s_barrier
  ds_read_b64_tr_b16 a[176:177], v26 offset:0
  ds_read_b64_tr_b16 a[178:179], v26 offset:8192
  ds_read_b64_tr_b16 a[180:181], v26 offset:2048
  ds_read_b64_tr_b16 a[182:183], v26 offset:10240
  ds_read_b64_tr_b16 a[240:241], v27 offset:0
  ds_read_b64_tr_b16 a[242:243], v27 offset:8192
  ds_read_b64_tr_b16 a[244:245], v27 offset:2048
  ds_read_b64_tr_b16 a[246:247], v27 offset:10240
  ds_read_b64_tr_b16 a[184:185], v26 offset:16384
  ds_read_b64_tr_b16 a[186:187], v26 offset:24576
  ds_read_b64_tr_b16 a[188:189], v26 offset:18432
  ds_read_b64_tr_b16 a[190:191], v26 offset:26624
  ds_read_b64_tr_b16 a[248:249], v27 offset:16384
  ds_read_b64_tr_b16 a[250:251], v27 offset:24576
  ds_read_b64_tr_b16 a[252:253], v27 offset:18432
  ds_read_b64_tr_b16 a[254:255], v27 offset:26624
  s_lshl_b32 s12, s9, 8
  s_add_u32 s44, s66, s12
  s_addc_u32 s45, s67, 0
  s_add_u32 s44, s44, 3145728
  s_addc_u32 s45, s45, 0
  global_load_dwordx4 v[160:163], v22, s[44:45] sc1
  s_add_u32 s44, s44, 32768
  s_addc_u32 s45, s45, 0
  global_load_dwordx4 v[164:167], v22, s[44:45] sc1
  s_add_u32 s44, s44, 32768
  s_addc_u32 s45, s45, 0
  global_load_dwordx4 v[224:227], v22, s[44:45] sc1
  s_add_u32 s44, s44, 32768
  s_addc_u32 s45, s45, 0
  global_load_dwordx4 v[228:231], v22, s[44:45] sc1
  s_add_u32 s44, s44, 32768
  s_addc_u32 s45, s45, 0
  global_load_dwordx4 v[168:171], v23, s[44:45] sc1
  s_add_u32 s44, s44, 32768
  s_addc_u32 s45, s45, 0
  global_load_dwordx4 v[172:175], v23, s[44:45] sc1
  s_add_u32 s44, s44, 32768
  s_addc_u32 s45, s45, 0
  global_load_dwordx4 v[232:235], v23, s[44:45] sc1
  s_add_u32 s44, s44, 32768
  s_addc_u32 s45, s45, 0
  global_load_dwordx4 v[236:239], v23, s[44:45] sc1
  s_waitcnt lgkmcnt(0)
  s_barrier
  s_waitcnt vmcnt(48)
  ds_write_b128 v21, a[128:131] offset:0
  ds_write_b128 v21, a[132:135] offset:1024
  ds_write_b128 v21, a[192:195] offset:2048
  ds_write_b128 v21, a[196:199] offset:3072
  ds_write_b128 v21, a[136:139] offset:4096
  ds_write_b128 v21, a[140:143] offset:5120
  ds_write_b128 v21, a[200:203] offset:6144
  ds_write_b128 v21, a[204:207] offset:7168
  s_waitcnt lgkmcnt(0)
  s_barrier
  ds_read_b64_tr_b16 a[128:129], v26 offset:0
  ds_read_b64_tr_b16 a[130:131], v26 offset:8192
  ds_read_b64_tr_b16 a[132:133], v26 offset:2048
  ds_read_b64_tr_b16 a[134:135], v26 offset:10240
  ds_read_b64_tr_b16 a[192:193], v27 offset:0
  ds_read_b64_tr_b16 a[194:195], v27 offset:8192
  ds_read_b64_tr_b16 a[196:197], v27 offset:2048
  ds_read_b64_tr_b16 a[198:199], v27 offset:10240
  ds_read_b64_tr_b16 a[136:137], v26 offset:16384
  ds_read_b64_tr_b16 a[138:139], v26 offset:24576
  ds_read_b64_tr_b16 a[140:141], v26 offset:18432
  ds_read_b64_tr_b16 a[142:143], v26 offset:26624
  ds_read_b64_tr_b16 a[200:201], v27 offset:16384
  ds_read_b64_tr_b16 a[202:203], v27 offset:24576
  ds_read_b64_tr_b16 a[204:205], v27 offset:18432
  ds_read_b64_tr_b16 a[206:207], v27 offset:26624
  s_waitcnt lgkmcnt(0)
  s_barrier
  s_waitcnt vmcnt(40)
  ds_write_b128 v21, a[144:147] offset:0
  ds_write_b128 v21, a[148:151] offset:1024
  ds_write_b128 v21, a[208:211] offset:2048
  ds_write_b128 v21, a[212:215] offset:3072
  ds_write_b128 v21, a[152:155] offset:4096
  ds_write_b128 v21, a[156:159] offset:5120
  ds_write_b128 v21, a[216:219] offset:6144
  ds_write_b128 v21, a[220:223] offset:7168
  s_waitcnt lgkmcnt(0)
  s_barrier
  ds_read_b64_tr_b16 a[144:145], v26 offset:0
  ds_read_b64_tr_b16 a[146:147], v26 offset:8192
  ds_read_b64_tr_b16 a[148:149], v26 offset:2048
  ds_read_b64_tr_b16 a[150:151], v26 offset:10240
  ds_read_b64_tr_b16 a[208:209], v27 offset:0
  ds_read_b64_tr_b16 a[210:211], v27 offset:8192
  ds_read_b64_tr_b16 a[212:213], v27 offset:2048
  ds_read_b64_tr_b16 a[214:215], v27 offset:10240
  ds_read_b64_tr_b16 a[152:153], v26 offset:16384
  ds_read_b64_tr_b16 a[154:155], v26 offset:24576
  ds_read_b64_tr_b16 a[156:157], v26 offset:18432
  ds_read_b64_tr_b16 a[158:159], v26 offset:26624
  ds_read_b64_tr_b16 a[216:217], v27 offset:16384
  ds_read_b64_tr_b16 a[218:219], v27 offset:24576
  ds_read_b64_tr_b16 a[220:221], v27 offset:18432
  ds_read_b64_tr_b16 a[222:223], v27 offset:26624
  s_waitcnt lgkmcnt(0)
  s_barrier
  s_waitcnt vmcnt(32)
  ds_write_b128 v21, a[160:163] offset:0
  ds_write_b128 v21, a[164:167] offset:1024
  ds_write_b128 v21, a[224:227] offset:2048
  ds_write_b128 v21, a[228:231] offset:3072
  ds_write_b128 v21, a[168:171] offset:4096
  ds_write_b128 v21, a[172:175] offset:5120
  ds_write_b128 v21, a[232:235] offset:6144
  ds_write_b128 v21, a[236:239] offset:7168
  s_waitcnt lgkmcnt(0)
  s_barrier
  ds_read_b64_tr_b16 a[160:161], v26 offset:0
  ds_read_b64_tr_b16 a[162:163], v26 offset:8192
  ds_read_b64_tr_b16 a[164:165], v26 offset:2048
  ds_read_b64_tr_b16 a[166:167], v26 offset:10240
  ds_read_b64_tr_b16 a[224:225], v27 offset:0
  ds_read_b64_tr_b16 a[226:227], v27 offset:8192
  ds_read_b64_tr_b16 a[228:229], v27 offset:2048
  ds_read_b64_tr_b16 a[230:231], v27 offset:10240
  ds_read_b64_tr_b16 a[168:169], v26 offset:16384
  ds_read_b64_tr_b16 a[170:171], v26 offset:24576
  ds_read_b64_tr_b16 a[172:173], v26 offset:18432
  ds_read_b64_tr_b16 a[174:175], v26 offset:26624
  ds_read_b64_tr_b16 a[232:233], v27 offset:16384
  ds_read_b64_tr_b16 a[234:235], v27 offset:24576
  ds_read_b64_tr_b16 a[236:237], v27 offset:18432
  ds_read_b64_tr_b16 a[238:239], v27 offset:26624
  s_waitcnt lgkmcnt(0)
  s_barrier
  s_waitcnt vmcnt(24)
  ds_write_b128 v21, v[176:179] offset:0
  ds_write_b128 v21, v[180:183] offset:1024
  ds_write_b128 v21, v[240:243] offset:2048
  ds_write_b128 v21, v[244:247] offset:3072
  ds_write_b128 v21, v[184:187] offset:4096
  ds_write_b128 v21, v[188:191] offset:5120
  ds_write_b128 v21, v[248:251] offset:6144
  ds_write_b128 v21, v[252:255] offset:7168
  s_waitcnt lgkmcnt(0)
  s_barrier
  ds_read_b64_tr_b16 v[176:177], v26 offset:0
  ds_read_b64_tr_b16 v[178:179], v26 offset:8192
  ds_read_b64_tr_b16 v[180:181], v26 offset:2048
  ds_read_b64_tr_b16 v[182:183], v26 offset:10240
  ds_read_b64_tr_b16 v[240:241], v27 offset:0
  ds_read_b64_tr_b16 v[242:243], v27 offset:8192
  ds_read_b64_tr_b16 v[244:245], v27 offset:2048
  ds_read_b64_tr_b16 v[246:247], v27 offset:10240
  ds_read_b64_tr_b16 v[184:185], v26 offset:16384
  ds_read_b64_tr_b16 v[186:187], v26 offset:24576
  ds_read_b64_tr_b16 v[188:189], v26 offset:18432
  ds_read_b64_tr_b16 v[190:191], v26 offset:26624
  ds_read_b64_tr_b16 v[248:249], v27 offset:16384
  ds_read_b64_tr_b16 v[250:251], v27 offset:24576
  ds_read_b64_tr_b16 v[252:253], v27 offset:18432
  ds_read_b64_tr_b16 v[254:255], v27 offset:26624
  s_waitcnt lgkmcnt(0)
  s_barrier
  s_waitcnt vmcnt(16)
  ds_write_b128 v21, v[128:131] offset:0
  ds_write_b128 v21, v[132:135] offset:1024
  ds_write_b128 v21, v[192:195] offset:2048
  ds_write_b128 v21, v[196:199] offset:3072
  ds_write_b128 v21, v[136:139] offset:4096
  ds_write_b128 v21, v[140:143] offset:5120
  ds_write_b128 v21, v[200:203] offset:6144
  ds_write_b128 v21, v[204:207] offset:7168
  s_waitcnt lgkmcnt(0)
  s_barrier
  ds_read_b64_tr_b16 v[128:129], v26 offset:0
  ds_read_b64_tr_b16 v[130:131], v26 offset:8192
  ds_read_b64_tr_b16 v[132:133], v26 offset:2048
  ds_read_b64_tr_b16 v[134:135], v26 offset:10240
  ds_read_b64_tr_b16 v[192:193], v27 offset:0
  ds_read_b64_tr_b16 v[194:195], v27 offset:8192
  ds_read_b64_tr_b16 v[196:197], v27 offset:2048
  ds_read_b64_tr_b16 v[198:199], v27 offset:10240
  ds_read_b64_tr_b16 v[136:137], v26 offset:16384
  ds_read_b64_tr_b16 v[138:139], v26 offset:24576
  ds_read_b64_tr_b16 v[140:141], v26 offset:18432
  ds_read_b64_tr_b16 v[142:143], v26 offset:26624
  ds_read_b64_tr_b16 v[200:201], v27 offset:16384
  ds_read_b64_tr_b16 v[202:203], v27 offset:24576
  ds_read_b64_tr_b16 v[204:205], v27 offset:18432
  ds_read_b64_tr_b16 v[206:207], v27 offset:26624
  s_waitcnt lgkmcnt(0)
  s_barrier
  v_lshrrev_b32 v104, 2, v0
  v_and_b32 v104, 0x1c, v104
  v_bfe_u32 v103, v0, 4, 1
  v_lshl_add_u32 v103, v103, 11, s54
  v_add_u32 v105, 16384, v103
  v_add_u32 v106, 32768, v103
  global_load_dword v100, v104, s[6:7] sc1
  global_load_dword v101, v103, s[58:59] sc1
  global_load_dword v102, v105, s[58:59] sc1
  global_load_dword v5, v106, s[58:59] sc1
  s_waitcnt vmcnt(12)
  ds_write_b128 v21, v[144:147] offset:0
  ds_write_b128 v21, v[148:151] offset:1024
  ds_write_b128 v21, v[208:211] offset:2048
  ds_write_b128 v21, v[212:215] offset:3072
  ds_write_b128 v21, v[152:155] offset:4096
  ds_write_b128 v21, v[156:159] offset:5120
  ds_write_b128 v21, v[216:219] offset:6144
  ds_write_b128 v21, v[220:223] offset:7168
  s_waitcnt lgkmcnt(0)
  s_barrier
  ds_read_b64_tr_b16 v[144:145], v26 offset:0
  ds_read_b64_tr_b16 v[146:147], v26 offset:8192
  ds_read_b64_tr_b16 v[148:149], v26 offset:2048
  ds_read_b64_tr_b16 v[150:151], v26 offset:10240
  ds_read_b64_tr_b16 v[208:209], v27 offset:0
  ds_read_b64_tr_b16 v[210:211], v27 offset:8192
  ds_read_b64_tr_b16 v[212:213], v27 offset:2048
  ds_read_b64_tr_b16 v[214:215], v27 offset:10240
  ds_read_b64_tr_b16 v[152:153], v26 offset:16384
  ds_read_b64_tr_b16 v[154:155], v26 offset:24576
  ds_read_b64_tr_b16 v[156:157], v26 offset:18432
  ds_read_b64_tr_b16 v[158:159], v26 offset:26624
  ds_read_b64_tr_b16 v[216:217], v27 offset:16384
  ds_read_b64_tr_b16 v[218:219], v27 offset:24576
  ds_read_b64_tr_b16 v[220:221], v27 offset:18432
  ds_read_b64_tr_b16 v[222:223], v27 offset:26624
  s_waitcnt lgkmcnt(0)
  s_barrier
  s_waitcnt vmcnt(4)
  ds_write_b128 v21, v[160:163] offset:0
  ds_write_b128 v21, v[164:167] offset:1024
  ds_write_b128 v21, v[224:227] offset:2048
  ds_write_b128 v21, v[228:231] offset:3072
  ds_write_b128 v21, v[168:171] offset:4096
  ds_write_b128 v21, v[172:175] offset:5120
  ds_write_b128 v21, v[232:235] offset:6144
  ds_write_b128 v21, v[236:239] offset:7168
  s_waitcnt lgkmcnt(0)
  s_barrier
  ds_read_b64_tr_b16 v[160:161], v26 offset:0
  ds_read_b64_tr_b16 v[162:163], v26 offset:8192
  ds_read_b64_tr_b16 v[164:165], v26 offset:2048
  ds_read_b64_tr_b16 v[166:167], v26 offset:10240
  ds_read_b64_tr_b16 v[224:225], v27 offset:0
  ds_read_b64_tr_b16 v[226:227], v27 offset:8192
  ds_read_b64_tr_b16 v[228:229], v27 offset:2048
  ds_read_b64_tr_b16 v[230:231], v27 offset:10240
  ds_read_b64_tr_b16 v[168:169], v26 offset:16384
  ds_read_b64_tr_b16 v[170:171], v26 offset:24576
  ds_read_b64_tr_b16 v[172:173], v26 offset:18432
  ds_read_b64_tr_b16 v[174:175], v26 offset:26624
  ds_read_b64_tr_b16 v[232:233], v27 offset:16384
  ds_read_b64_tr_b16 v[234:235], v27 offset:24576
  ds_read_b64_tr_b16 v[236:237], v27 offset:18432
  ds_read_b64_tr_b16 v[238:239], v27 offset:26624
  s_waitcnt lgkmcnt(0)
  s_barrier
  s_waitcnt lgkmcnt(0)
  s_barrier
  s_branch L_wdone_2
L_wv_5:
  s_lshl_b32 s12, s8, 13
  s_add_u32 s12, s12, 131072
  v_add_u32 v21, s12, v0
  v_add_u32 v26, 131072, v26
  v_add_u32 v27, 131072, v27
  s_lshl_b32 s12, s9, 17
  s_add_u32 s44, s68, s12
  s_addc_u32 s45, s69, 0
  s_lshl_b32 s12, s8, 13
  s_add_u32 s12, s12, 0
  s_add_u32 s44, s44, s12
  s_addc_u32 s45, s45, 0
  v_xor_b32 v25, 0, v24
  s_add_u32 m0, s13, 0
  s_nop 0
  global_load_lds_dwordx4 v25, s[44:45] sc1
  s_add_u32 s44, s44, 1024
  s_addc_u32 s45, s45, 0
  v_xor_b32 v25, 32, v24
  s_add_u32 m0, s13, 1024
  s_nop 0
  global_load_lds_dwordx4 v25, s[44:45] sc1
  s_add_u32 s44, s44, 1024
  s_addc_u32 s45, s45, 0
  v_xor_b32 v25, 0, v24
  s_add_u32 m0, s13, 2048
  s_nop 0
  global_load_lds_dwordx4 v25, s[44:45] sc1
  s_add_u32 s44, s44, 1024
  s_addc_u32 s45, s45, 0
  v_xor_b32 v25, 32, v24
  s_add_u32 m0, s13, 3072
  s_nop 0
  global_load_lds_dwordx4 v25, s[44:45] sc1
  s_add_u32 s44, s44, 1024
  s_addc_u32 s45, s45, 0
  v_xor_b32 v25, 64, v24
  s_add_u32 m0, s13, 4096
  s_nop 0
  global_load_lds_dwordx4 v25, s[44:45] sc1
  s_add_u32 s44, s44, 1024
  s_addc_u32 s45, s45, 0
  v_xor_b32 v25, 96, v24
  s_add_u32 m0, s13, 5120
  s_nop 0
  global_load_lds_dwordx4 v25, s[44:45] sc1
  s_add_u32 s44, s44, 1024
  s_addc_u32 s45, s45, 0
  v_xor_b32 v25, 64, v24
  s_add_u32 m0, s13, 6144
  s_nop 0
  global_load_lds_dwordx4 v25, s[44:45] sc1
  s_add_u32 s44, s44, 1024
  s_addc_u32 s45, s45, 0
  v_xor_b32 v25, 96, v24
  s_add_u32 m0, s13, 7168
  s_nop 0
  global_load_lds_dwordx4 v25, s[44:45] sc1
  s_lshl_b32 s12, s9, 17
  s_add_u32 s44, s68, s12
  s_addc_u32 s45, s69, 0
  s_lshl_b32 s12, s8, 13
  s_add_u32 s12, s12, 32768
  s_add_u32 s44, s44, s12
  s_addc_u32 s45, s45, 0
  v_xor_b32 v25, 0, v24
  s_add_u32 m0, s13, 32768
  s_nop 0
  global_load_lds_dwordx4 v25, s[44:45] sc1
  s_add_u32 s44, s44, 1024
  s_addc_u32 s45, s45, 0
  v_xor_b32 v25, 32, v24
  s_add_u32 m0, s13, 33792
  s_nop 0
  global_load_lds_dwordx4 v25, s[44:45] sc1
  s_add_u32 s44, s44, 1024
  s_addc_u32 s45, s45, 0
  v_xor_b32 v25, 0, v24
  s_add_u32 m0, s13, 34816
  s_nop 0
  global_load_lds_dwordx4 v25, s[44:45] sc1
  s_add_u32 s44, s44, 1024
  s_addc_u32 s45, s45, 0
  v_xor_b32 v25, 32, v24
  s_add_u32 m0, s13, 35840
  s_nop 0
  global_load_lds_dwordx4 v25, s[44:45] sc1
  s_add_u32 s44, s44, 1024
  s_addc_u32 s45, s45, 0
  v_xor_b32 v25, 64, v24
  s_add_u32 m0, s13, 36864
  s_nop 0
  global_load_lds_dwordx4 v25, s[44:45] sc1
  s_add_u32 s44, s44, 1024
  s_addc_u32 s45, s45, 0
  v_xor_b32 v25, 96, v24
  s_add_u32 m0, s13, 37888
  s_nop 0
  global_load_lds_dwordx4 v25, s[44:45] sc1
  s_add_u32 s44, s44, 1024
  s_addc_u32 s45, s45, 0
  v_xor_b32 v25, 64, v24
  s_add_u32 m0, s13, 38912
  s_nop 0
  global_load_lds_dwordx4 v25, s[44:45] sc1
  s_add_u32 s44, s44, 1024
  s_addc_u32 s45, s45, 0
  v_xor_b32 v25, 96, v24
  s_add_u32 m0, s13, 39936
  s_nop 0
  global_load_lds_dwordx4 v25, s[44:45] sc1
  s_lshl_b32 s12, s9, 17
  s_add_u32 s44, s68, s12
  s_addc_u32 s45, s69, 0
  s_lshl_b32 s12, s8, 13
  s_add_u32 s12, s12, 65536
  s_add_u32 s44, s44, s12
  s_addc_u32 s45, s45, 0
  v_xor_b32 v25, 0, v24
  s_add_u32 m0, s13, 65536
  s_nop 0
  global_load_lds_dwordx4 v25, s[44:45] sc1
  s_add_u32 s44, s44, 1024
  s_addc_u32 s45, s45, 0
  v_xor_b32 v25, 32, v24
  s_add_u32 m0, s13, 66560
  s_nop 0
  global_load_lds_dwordx4 v25, s[44:45] sc1
  s_add_u32 s44, s44, 1024
  s_addc_u32 s45, s45, 0
  v_xor_b32 v25, 0, v24
  s_add_u32 m0, s13, 67584
  s_nop 0
  global_load_lds_dwordx4 v25, s[44:45] sc1
  s_add_u32 s44, s44, 1024
  s_addc_u32 s45, s45, 0
  v_xor_b32 v25, 32, v24
  s_add_u32 m0, s13, 68608
  s_nop 0
  global_load_lds_dwordx4 v25, s[44:45] sc1
  s_add_u32 s44, s44, 1024
  s_addc_u32 s45, s45, 0
  v_xor_b32 v25, 64, v24
  s_add_u32 m0, s13, 69632
  s_nop 0
  global_load_lds_dwordx4 v25, s[44:45] sc1
  s_add_u32 s44, s44, 1024
  s_addc_u32 s45, s45, 0
  v_xor_b32 v25, 96, v24
  s_add_u32 m0, s13, 70656
  s_nop 0
  global_load_lds_dwordx4 v25, s[44:45] sc1
  s_add_u32 s44, s44, 1024
  s_addc_u32 s45, s45, 0
  v_xor_b32 v25, 64, v24
  s_add_u32 m0, s13, 71680
  s_nop 0
  global_load_lds_dwordx4 v25, s[44:45] sc1
  s_add_u32 s44, s44, 1024
  s_addc_u32 s45, s45, 0
  v_xor_b32 v25, 96, v24
  s_add_u32 m0, s13, 72704
  s_nop 0
  global_load_lds_dwordx4 v25, s[44:45] sc1
  s_lshl_b32 s12, s9, 17
  s_add_u32 s44, s68, s12
  s_addc_u32 s45, s69, 0
  s_lshl_b32 s12, s8, 13
  s_add_u32 s12, s12, 98304
  s_add_u32 s44, s44, s12
  s_addc_u32 s45, s45, 0
  v_xor_b32 v25, 0, v24
  s_add_u32 m0, s13, 98304
  s_nop 0
  global_load_lds_dwordx4 v25, s[44:45] sc1
  s_add_u32 s44, s44, 1024
  s_addc_u32 s45, s45, 0
  v_xor_b32 v25, 32, v24
  s_add_u32 m0, s13, 99328
  s_nop 0
  global_load_lds_dwordx4 v25, s[44:45] sc1
  s_add_u32 s44, s44, 1024
  s_addc_u32 s45, s45, 0
  v_xor_b32 v25, 0, v24
  s_add_u32 m0, s13, 100352
  s_nop 0
  global_load_lds_dwordx4 v25, s[44:45] sc1
  s_add_u32 s44, s44, 1024
  s_addc_u32 s45, s45, 0
  v_xor_b32 v25, 32, v24
  s_add_u32 m0, s13, 101376
  s_nop 0
  global_load_lds_dwordx4 v25, s[44:45] sc1
  s_add_u32 s44, s44, 1024
  s_addc_u32 s45, s45, 0
  v_xor_b32 v25, 64, v24
  s_add_u32 m0, s13, 102400
  s_nop 0
  global_load_lds_dwordx4 v25, s[44:45] sc1
  s_add_u32 s44, s44, 1024
  s_addc_u32 s45, s45, 0
  v_xor_b32 v25, 96, v24
  s_add_u32 m0, s13, 103424
  s_nop 0
  global_load_lds_dwordx4 v25, s[44:45] sc1
  s_add_u32 s44, s44, 1024
  s_addc_u32 s45, s45, 0
  v_xor_b32 v25, 64, v24
  s_add_u32 m0, s13, 104448
  s_nop 0
  global_load_lds_dwordx4 v25, s[44:45] sc1
  s_add_u32 s44, s44, 1024
  s_addc_u32 s45, s45, 0
  v_xor_b32 v25, 96, v24
  s_add_u32 m0, s13, 105472
  s_nop 0
  global_load_lds_dwordx4 v25, s[44:45] sc1
  s_lshl_b32 s12, s9, 8
  s_add_u32 s44, s62, s12
  s_addc_u32 s45, s63, 0
  s_add_u32 s44, s44, 0
  s_addc_u32 s45, s45, 0
  global_load_dwordx4 a[32:35], v22, s[44:45] sc1
  s_add_u32 s44, s44, 32768
  s_addc_u32 s45, s45, 0
  global_load_dwordx4 a[36:39], v22, s[44:45] sc1
  s_add_u32 s44, s44, 32768
  s_addc_u32 s45, s45, 0
  global_load_dwordx4 a[96:99], v22, s[44:45] sc1
  s_add_u32 s44, s44, 32768
  s_addc_u32 s45, s45, 0
  global_load_dwordx4 a[100:103], v22, s[44:45] sc1
  s_add_u32 s44, s44, 32768
  s_addc_u32 s45, s45, 0
  global_load_dwordx4 a[40:43], v23, s[44:45] sc1
  s_add_u32 s44, s44, 32768
  s_addc_u32 s45, s45, 0
  global_load_dwordx4 a[44:47], v23, s[44:45] sc1
  s_add_u32 s44, s44, 32768
  s_addc_u32 s45, s45, 0
  global_load_dwordx4 a[104:107], v23, s[44:45] sc1
  s_add_u32 s44, s44, 32768
  s_addc_u32 s45, s45, 0
  global_load_dwordx4 a[108:111], v23, s[44:45] sc1
  s_lshl_b32 s12, s9, 8
  s_add_u32 s44, s62, s12
  s_addc_u32 s45, s63, 0
  s_add_u32 s44, s44, 1048576
  s_addc_u32 s45, s45, 0
  global_load_dwordx4 a[48:51], v22, s[44:45] sc1
  s_add_u32 s44, s44, 32768
  s_addc_u32 s45, s45, 0
  global_load_dwordx4 a[52:55], v22, s[44:45] sc1
  s_add_u32 s44, s44, 32768
  s_addc_u32 s45, s45, 0
  global_load_dwordx4 a[112:115], v22, s[44:45] sc1
  s_add_u32 s44, s44, 32768
  s_addc_u32 s45, s45, 0
  global_load_dwordx4 a[116:119], v22, s[44:45] sc1
  s_add_u32 s44, s44, 32768
  s_addc_u32 s45, s45, 0
  global_load_dwordx4 a[56:59], v23, s[44:45] sc1
  s_add_u32 s44, s44, 32768
  s_addc_u32 s45, s45, 0
  global_load_dwordx4 a[60:63], v23, s[44:45] sc1
  s_add_u32 s44, s44, 32768
  s_addc_u32 s45, s45, 0
  global_load_dwordx4 a[120:123], v23, s[44:45] sc1
  s_add_u32 s44, s44, 32768
  s_addc_u32 s45, s45, 0
  global_load_dwordx4 a[124:127], v23, s[44:45] sc1
  s_lshl_b32 s12, s9, 8
  s_add_u32 s44, s62, s12
  s_addc_u32 s45, s63, 0
  s_add_u32 s44, s44, 2097152
  s_addc_u32 s45, s45, 0
  global_load_dwordx4 a[0:3], v22, s[44:45] sc1
  s_add_u32 s44, s44, 32768
  s_addc_u32 s45, s45, 0
  global_load_dwordx4 a[4:7], v22, s[44:45] sc1
  s_add_u32 s44, s44, 32768
  s_addc_u32 s45, s45, 0
  global_load_dwordx4 a[64:67], v22, s[44:45] sc1
  s_add_u32 s44, s44, 32768
  s_addc_u32 s45, s45, 0
  global_load_dwordx4 a[68:71], v22, s[44:45] sc1
  s_add_u32 s44, s44, 32768
  s_addc_u32 s45, s45, 0
  global_load_dwordx4 a[8:11], v23, s[44:45] sc1
  s_add_u32 s44, s44, 32768
  s_addc_u32 s45, s45, 0
  global_load_dwordx4 a[12:15], v23, s[44:45] sc1
  s_add_u32 s44, s44, 32768
  s_addc_u32 s45, s45, 0
  global_load_dwordx4 a[72:75], v23, s[44:45] sc1
  s_add_u32 s44, s44, 32768
  s_addc_u32 s45, s45, 0
  global_load_dwordx4 a[76:79], v23, s[44:45] sc1
  v_mov_b32 v99, 16
  global_load_dword v99, v99, s[6:7] sc1
  s_waitcnt vmcnt(49)
  s_barrier
  v_add_u32 v29, 0, v28
  v_xor_b32 v30, 0, v29
  ds_read_b64_tr_b16 v[32:33], v30 offset:0
  ds_read_b64_tr_b16 v[34:35], v30 offset:2048
  v_xor_b32 v30, 32, v29
  ds_read_b64_tr_b16 v[36:37], v30 offset:0
  ds_read_b64_tr_b16 v[38:39], v30 offset:2048
  v_xor_b32 v30, 64, v29
  ds_read_b64_tr_b16 v[40:41], v30 offset:0
  ds_read_b64_tr_b16 v[42:43], v30 offset:2048
  v_xor_b32 v30, 96, v29
  ds_read_b64_tr_b16 v[44:45], v30 offset:0
  ds_read_b64_tr_b16 v[46:47], v30 offset:2048
  v_xor_b32 v30, 128, v29
  ds_read_b64_tr_b16 v[48:49], v30 offset:0
  ds_read_b64_tr_b16 v[50:51], v30 offset:2048
  v_xor_b32 v30, 160, v29
  ds_read_b64_tr_b16 v[52:53], v30 offset:0
  ds_read_b64_tr_b16 v[54:55], v30 offset:2048
  v_xor_b32 v30, 192, v29
  ds_read_b64_tr_b16 v[56:57], v30 offset:0
  ds_read_b64_tr_b16 v[58:59], v30 offset:2048
  v_xor_b32 v30, 224, v29
  ds_read_b64_tr_b16 v[60:61], v30 offset:0
  ds_read_b64_tr_b16 v[62:63], v30 offset:2048
  s_lshl_b32 s12, s9, 8
  s_add_u32 s44, s62, s12
  s_addc_u32 s45, s63, 0
  s_add_u32 s44, s44, 3145728
  s_addc_u32 s45, s45, 0
  global_load_dwordx4 a[16:19], v22, s[44:45] sc1
  s_add_u32 s44, s44, 32768
  s_addc_u32 s45, s45, 0
  global_load_dwordx4 a[20:23], v22, s[44:45] sc1
  s_add_u32 s44, s44, 32768
  s_addc_u32 s45, s45, 0
  global_load_dwordx4 a[80:83], v22, s[44:45] sc1
  s_add_u32 s44, s44, 32768
  s_addc_u32 s45, s45, 0
  global_load_dwordx4 a[84:87], v22, s[44:45] sc1
  s_add_u32 s44, s44, 32768
  s_addc_u32 s45, s45, 0
  global_load_dwordx4 a[24:27], v23, s[44:45] sc1
  s_add_u32 s44, s44, 32768
  s_addc_u32 s45, s45, 0
  global_load_dwordx4 a[28:31], v23, s[44:45] sc1
  s_add_u32 s44, s44, 32768
  s_addc_u32 s45, s45, 0
  global_load_dwordx4 a[88:91], v23, s[44:45] sc1
  s_add_u32 s44, s44, 32768
  s_addc_u32 s45, s45, 0
  global_load_dwordx4 a[92:95], v23, s[44:45] sc1
  s_waitcnt lgkmcnt(0)
  s_barrier
  ds_write_b128 v16, v[32:35] offset:0
  ds_write_b128 v16, v[36:39] offset:1024
  ds_write_b128 v16, v[40:43] offset:2048
  ds_write_b128 v16, v[44:47] offset:3072
  ds_write_b128 v16, v[48:51] offset:4096
  ds_write_b128 v16, v[52:55] offset:5120
  ds_write_b128 v16, v[56:59] offset:6144
  ds_write_b128 v16, v[60:63] offset:7168
  s_waitcnt vmcnt(49)
  s_barrier
  v_add_u32 v29, 32768, v28
  v_xor_b32 v30, 0, v29
  ds_read_b64_tr_b16 v[32:33], v30 offset:0
  ds_read_b64_tr_b16 v[34:35], v30 offset:2048
  v_xor_b32 v30, 32, v29
  ds_read_b64_tr_b16 v[36:37], v30 offset:0
  ds_read_b64_tr_b16 v[38:39], v30 offset:2048
  v_xor_b32 v30, 64, v29
  ds_read_b64_tr_b16 v[40:41], v30 offset:0
  ds_read_b64_tr_b16 v[42:43], v30 offset:2048
  v_xor_b32 v30, 96, v29
  ds_read_b64_tr_b16 v[44:45], v30 offset:0
  ds_read_b64_tr_b16 v[46:47], v30 offset:2048
  v_xor_b32 v30, 128, v29
  ds_read_b64_tr_b16 v[48:49], v30 offset:0
  ds_read_b64_tr_b16 v[50:51], v30 offset:2048
  v_xor_b32 v30, 160, v29
  ds_read_b64_tr_b16 v[52:53], v30 offset:0
  ds_read_b64_tr_b16 v[54:55], v30 offset:2048
  v_xor_b32 v30, 192, v29
  ds_read_b64_tr_b16 v[56:57], v30 offset:0
  ds_read_b64_tr_b16 v[58:59], v30 offset:2048
  v_xor_b32 v30, 224, v29
  ds_read_b64_tr_b16 v[60:61], v30 offset:0
  ds_read_b64_tr_b16 v[62:63], v30 offset:2048
  s_lshl_b32 s12, s9, 8
  s_add_u32 s44, s64, s12
  s_addc_u32 s45, s65, 0
  s_add_u32 s44, s44, 0
  s_addc_u32 s45, s45, 0
  global_load_dwordx4 a[160:163], v22, s[44:45] sc1
  s_add_u32 s44, s44, 32768
  s_addc_u32 s45, s45, 0
  global_load_dwordx4 a[164:167], v22, s[44:45] sc1
  s_add_u32 s44, s44, 32768
  s_addc_u32 s45, s45, 0
  global_load_dwordx4 a[224:227], v22, s[44:45] sc1
  s_add_u32 s44, s44, 32768
  s_addc_u32 s45, s45, 0
  global_load_dwordx4 a[228:231], v22, s[44:45] sc1
  s_add_u32 s44, s44, 32768
  s_addc_u32 s45, s45, 0
  global_load_dwordx4 a[168:171], v23, s[44:45] sc1
  s_add_u32 s44, s44, 32768
  s_addc_u32 s45, s45, 0
  global_load_dwordx4 a[172:175], v23, s[44:45] sc1
  s_add_u32 s44, s44, 32768
  s_addc_u32 s45, s45, 0
  global_load_dwordx4 a[232:235], v23, s[44:45] sc1
  s_add_u32 s44, s44, 32768
  s_addc_u32 s45, s45, 0
  global_load_dwordx4 a[236:239], v23, s[44:45] sc1
  s_waitcnt lgkmcnt(0)
  s_barrier
  ds_write_b128 v16, v[32:35] offset:32768
  ds_write_b128 v16, v[36:39] offset:33792
  ds_write_b128 v16, v[40:43] offset:34816
  ds_write_b128 v16, v[44:47] offset:35840
  ds_write_b128 v16, v[48:51] offset:36864
  ds_write_b128 v16, v[52:55] offset:37888
  ds_write_b128 v16, v[56:59] offset:38912
  ds_write_b128 v16, v[60:63] offset:39936
  s_waitcnt vmcnt(49)
  s_barrier
  v_add_u32 v29, 65536, v28
  v_xor_b32 v30, 0, v29
  ds_read_b64_tr_b16 v[32:33], v30 offset:0
  ds_read_b64_tr_b16 v[34:35], v30 offset:2048
  v_xor_b32 v30, 32, v29
  ds_read_b64_tr_b16 v[36:37], v30 offset:0
  ds_read_b64_tr_b16 v[38:39], v30 offset:2048
  v_xor_b32 v30, 64, v29
  ds_read_b64_tr_b16 v[40:41], v30 offset:0
  ds_read_b64_tr_b16 v[42:43], v30 offset:2048
  v_xor_b32 v30, 96, v29
  ds_read_b64_tr_b16 v[44:45], v30 offset:0
  ds_read_b64_tr_b16 v[46:47], v30 offset:2048
  v_xor_b32 v30, 128, v29
  ds_read_b64_tr_b16 v[48:49], v30 offset:0
  ds_read_b64_tr_b16 v[50:51], v30 offset:2048
  v_xor_b32 v30, 160, v29
  ds_read_b64_tr_b16 v[52:53], v30 offset:0
  ds_read_b64_tr_b16 v[54:55], v30 offset:2048
  v_xor_b32 v30, 192, v29
  ds_read_b64_tr_b16 v[56:57], v30 offset:0
  ds_read_b64_tr_b16 v[58:59], v30 offset:2048
  v_xor_b32 v30, 224, v29
  ds_read_b64_tr_b16 v[60:61], v30 offset:0
  ds_read_b64_tr_b16 v[62:63], v30 offset:2048
  s_lshl_b32 s12, s9, 8
  s_add_u32 s44, s64, s12
  s_addc_u32 s45, s65, 0
  s_add_u32 s44, s44, 1048576
  s_addc_u32 s45, s45, 0
  global_load_dwordx4 a[176:179], v22, s[44:45] sc1
  s_add_u32 s44, s44, 32768
  s_addc_u32 s45, s45, 0
  global_load_dwordx4 a[180:183], v22, s[44:45] sc1
  s_add_u32 s44, s44, 32768
  s_addc_u32 s45, s45, 0
  global_load_dwordx4 a[240:243], v22, s[44:45] sc1
  s_add_u32 s44, s44, 32768
  s_addc_u32 s45, s45, 0
  global_load_dwordx4 a[244:247], v22, s[44:45] sc1
  s_add_u32 s44, s44, 32768
  s_addc_u32 s45, s45, 0
  global_load_dwordx4 a[184:187], v23, s[44:45] sc1
  s_add_u32 s44, s44, 32768
  s_addc_u32 s45, s45, 0
  global_load_dwordx4 a[188:191], v23, s[44:45] sc1
  s_add_u32 s44, s44, 32768
  s_addc_u32 s45, s45, 0
  global_load_dwordx4 a[248:251], v23, s[44:45] sc1
  s_add_u32 s44, s44, 32768
  s_addc_u32 s45, s45, 0
  global_load_dwordx4 a[252:255], v23, s[44:45] sc1
  s_waitcnt lgkmcnt(0)
  s_barrier
  ds_write_b128 v17, v[32:35] offset:0
  ds_write_b128 v17, v[36:39] offset:1024
  ds_write_b128 v17, v[40:43] offset:2048
  ds_write_b128 v17, v[44:47] offset:3072
  ds_write_b128 v17, v[48:51] offset:4096
  ds_write_b128 v17, v[52:55] offset:5120
  ds_write_b128 v17, v[56:59] offset:6144
  ds_write_b128 v17, v[60:63] offset:7168
  s_waitcnt vmcnt(49)
  s_barrier
  v_add_u32 v29, 98304, v28
  v_xor_b32 v30, 0, v29
  ds_read_b64_tr_b16 v[32:33], v30 offset:0
  ds_read_b64_tr_b16 v[34:35], v30 offset:2048
  v_xor_b32 v30, 32, v29
  ds_read_b64_tr_b16 v[36:37], v30 offset:0
  ds_read_b64_tr_b16 v[38:39], v30 offset:2048
  v_xor_b32 v30, 64, v29
  ds_read_b64_tr_b16 v[40:41], v30 offset:0
  ds_read_b64_tr_b16 v[42:43], v30 offset:2048
  v_xor_b32 v30, 96, v29
  ds_read_b64_tr_b16 v[44:45], v30 offset:0
  ds_read_b64_tr_b16 v[46:47], v30 offset:2048
  v_xor_b32 v30, 128, v29
  ds_read_b64_tr_b16 v[48:49], v30 offset:0
  ds_read_b64_tr_b16 v[50:51], v30 offset:2048
  v_xor_b32 v30, 160, v29
  ds_read_b64_tr_b16 v[52:53], v30 offset:0
  ds_read_b64_tr_b16 v[54:55], v30 offset:2048
  v_xor_b32 v30, 192, v29
  ds_read_b64_tr_b16 v[56:57], v30 offset:0
  ds_read_b64_tr_b16 v[58:59], v30 offset:2048
  v_xor_b32 v30, 224, v29
  ds_read_b64_tr_b16 v[60:61], v30 offset:0
  ds_read_b64_tr_b16 v[62:63], v30 offset:2048
  s_lshl_b32 s12, s9, 8
  s_add_u32 s44, s64, s12
  s_addc_u32 s45, s65, 0
  s_add_u32 s44, s44, 2097152
  s_addc_u32 s45, s45, 0
  global_load_dwordx4 a[128:131], v22, s[44:45] sc1
  s_add_u32 s44, s44, 32768
  s_addc_u32 s45, s45, 0
  global_load_dwordx4 a[132:135], v22, s[44:45] sc1
  s_add_u32 s44, s44, 32768
  s_addc_u32 s45, s45, 0
  global_load_dwordx4 a[192:195], v22, s[44:45] sc1
  s_add_u32 s44, s44, 32768
  s_addc_u32 s45, s45, 0
  global_load_dwordx4 a[196:199], v22, s[44:45] sc1
  s_add_u32 s44, s44, 32768
  s_addc_u32 s45, s45, 0
  global_load_dwordx4 a[136:139], v23, s[44:45] sc1
  s_add_u32 s44, s44, 32768
  s_addc_u32 s45, s45, 0
  global_load_dwordx4 a[140:143], v23, s[44:45] sc1
  s_add_u32 s44, s44, 32768
  s_addc_u32 s45, s45, 0
  global_load_dwordx4 a[200:203], v23, s[44:45] sc1
  s_add_u32 s44, s44, 32768
  s_addc_u32 s45, s45, 0
  global_load_dwordx4 a[204:207], v23, s[44:45] sc1
  s_waitcnt lgkmcnt(0)
  s_barrier
  ds_write_b128 v17, v[32:35] offset:32768
  ds_write_b128 v17, v[36:39] offset:33792
  ds_write_b128 v17, v[40:43] offset:34816
  ds_write_b128 v17, v[44:47] offset:35840
  ds_write_b128 v17, v[48:51] offset:36864
  ds_write_b128 v17, v[52:55] offset:37888
  ds_write_b128 v17, v[56:59] offset:38912
  ds_write_b128 v17, v[60:63] offset:39936
  s_waitcnt vmcnt(49)
  ds_write_b128 v21, a[32:35] offset:0
  ds_write_b128 v21, a[36:39] offset:1024
  ds_write_b128 v21, a[96:99] offset:2048
  ds_write_b128 v21, a[100:103] offset:3072
  ds_write_b128 v21, a[40:43] offset:4096
  ds_write_b128 v21, a[44:47] offset:5120
  ds_write_b128 v21, a[104:107] offset:6144
  ds_write_b128 v21, a[108:111] offset:7168
  s_waitcnt lgkmcnt(0)
  s_barrier
  ds_read_b64_tr_b16 a[32:33], v26 offset:0
  ds_read_b64_tr_b16 a[34:35], v26 offset:8192
  ds_read_b64_tr_b16 a[36:37], v26 offset:2048
  ds_read_b64_tr_b16 a[38:39], v26 offset:10240
  ds_read_b64_tr_b16 a[96:97], v27 offset:0
  ds_read_b64_tr_b16 a[98:99], v27 offset:8192
  ds_read_b64_tr_b16 a[100:101], v27 offset:2048
  ds_read_b64_tr_b16 a[102:103], v27 offset:10240
  ds_read_b64_tr_b16 a[40:41], v26 offset:16384
  ds_read_b64_tr_b16 a[42:43], v26 offset:24576
  ds_read_b64_tr_b16 a[44:45], v26 offset:18432
  ds_read_b64_tr_b16 a[46:47], v26 offset:26624
  ds_read_b64_tr_b16 a[104:105], v27 offset:16384
  ds_read_b64_tr_b16 a[106:107], v27 offset:24576
  ds_read_b64_tr_b16 a[108:109], v27 offset:18432
  ds_read_b64_tr_b16 a[110:111], v27 offset:26624
  s_lshl_b32 s12, s9, 8
  s_add_u32 s44, s64, s12
  s_addc_u32 s45, s65, 0
  s_add_u32 s44, s44, 3145728
  s_addc_u32 s45, s45, 0
  global_load_dwordx4 a[144:147], v22, s[44:45] sc1
  s_add_u32 s44, s44, 32768
  s_addc_u32 s45, s45, 0
  global_load_dwordx4 a[148:151], v22, s[44:45] sc1
  s_add_u32 s44, s44, 32768
  s_addc_u32 s45, s45, 0
  global_load_dwordx4 a[208:211], v22, s[44:45] sc1
  s_add_u32 s44, s44, 32768
  s_addc_u32 s45, s45, 0
  global_load_dwordx4 a[212:215], v22, s[44:45] sc1
  s_add_u32 s44, s44, 32768
  s_addc_u32 s45, s45, 0
  global_load_dwordx4 a[152:155], v23, s[44:45] sc1
  s_add_u32 s44, s44, 32768
  s_addc_u32 s45, s45, 0
  global_load_dwordx4 a[156:159], v23, s[44:45] sc1
  s_add_u32 s44, s44, 32768
  s_addc_u32 s45, s45, 0
  global_load_dwordx4 a[216:219], v23, s[44:45] sc1
  s_add_u32 s44, s44, 32768
  s_addc_u32 s45, s45, 0
  global_load_dwordx4 a[220:223], v23, s[44:45] sc1
  s_waitcnt lgkmcnt(0)
  s_barrier
  s_waitcnt vmcnt(49)
  ds_write_b128 v21, a[48:51] offset:0
  ds_write_b128 v21, a[52:55] offset:1024
  ds_write_b128 v21, a[112:115] offset:2048
  ds_write_b128 v21, a[116:119] offset:3072
  ds_write_b128 v21, a[56:59] offset:4096
  ds_write_b128 v21, a[60:63] offset:5120
  ds_write_b128 v21, a[120:123] offset:6144
  ds_write_b128 v21, a[124:127] offset:7168
  s_waitcnt lgkmcnt(0)
  s_barrier
  ds_read_b64_tr_b16 a[48:49], v26 offset:0
  ds_read_b64_tr_b16 a[50:51], v26 offset:8192
  ds_read_b64_tr_b16 a[52:53], v26 offset:2048
  ds_read_b64_tr_b16 a[54:55], v26 offset:10240
  ds_read_b64_tr_b16 a[112:113], v27 offset:0
  ds_read_b64_tr_b16 a[114:115], v27 offset:8192
  ds_read_b64_tr_b16 a[116:117], v27 offset:2048
  ds_read_b64_tr_b16 a[118:119], v27 offset:10240
  ds_read_b64_tr_b16 a[56:57], v26 offset:16384
  ds_read_b64_tr_b16 a[58:59], v26 offset:24576
  ds_read_b64_tr_b16 a[60:61], v26 offset:18432
  ds_read_b64_tr_b16 a[62:63], v26 offset:26624
  ds_read_b64_tr_b16 a[120:121], v27 offset:16384
  ds_read_b64_tr_b16 a[122:123], v27 offset:24576
  ds_read_b64_tr_b16 a[124:125], v27 offset:18432
  ds_read_b64_tr_b16 a[126:127], v27 offset:26624
  s_lshl_b32 s12, s9, 8
  s_add_u32 s44, s66, s12
  s_addc_u32 s45, s67, 0
  s_add_u32 s44, s44, 0
  s_addc_u32 s45, s45, 0
  global_load_dwordx4 v[160:163], v22, s[44:45] sc1
  s_add_u32 s44, s44, 32768
  s_addc_u32 s45, s45, 0
  global_load_dwordx4 v[164:167], v22, s[44:45] sc1
  s_add_u32 s44, s44, 32768
  s_addc_u32 s45, s45, 0
  global_load_dwordx4 v[224:227], v22, s[44:45] sc1
  s_add_u32 s44, s44, 32768
  s_addc_u32 s45, s45, 0
  global_load_dwordx4 v[228:231], v22, s[44:45] sc1
  s_add_u32 s44, s44, 32768
  s_addc_u32 s45, s45, 0
  global_load_dwordx4 v[168:171], v23, s[44:45] sc1
  s_add_u32 s44, s44, 32768
  s_addc_u32 s45, s45, 0
  global_load_dwordx4 v[172:175], v23, s[44:45] sc1
  s_add_u32 s44, s44, 32768
  s_addc_u32 s45, s45, 0
  global_load_dwordx4 v[232:235], v23, s[44:45] sc1
  s_add_u32 s44, s44, 32768
  s_addc_u32 s45, s45, 0
  global_load_dwordx4 v[236:239], v23, s[44:45] sc1
  s_waitcnt lgkmcnt(0)
  s_barrier
  s_waitcnt vmcnt(49)
  ds_write_b128 v21, a[0:3] offset:0
  ds_write_b128 v21, a[4:7] offset:1024
  ds_write_b128 v21, a[64:67] offset:2048
  ds_write_b128 v21, a[68:71] offset:3072
  ds_write_b128 v21, a[8:11] offset:4096
  ds_write_b128 v21, a[12:15] offset:5120
  ds_write_b128 v21, a[72:75] offset:6144
  ds_write_b128 v21, a[76:79] offset:7168
  s_waitcnt lgkmcnt(0)
  s_barrier
  ds_read_b64_tr_b16 a[0:1], v26 offset:0
  ds_read_b64_tr_b16 a[2:3], v26 offset:8192
  ds_read_b64_tr_b16 a[4:5], v26 offset:2048
  ds_read_b64_tr_b16 a[6:7], v26 offset:10240
  ds_read_b64_tr_b16 a[64:65], v27 offset:0
  ds_read_b64_tr_b16 a[66:67], v27 offset:8192
  ds_read_b64_tr_b16 a[68:69], v27 offset:2048
  ds_read_b64_tr_b16 a[70:71], v27 offset:10240
  ds_read_b64_tr_b16 a[8:9], v26 offset:16384
  ds_read_b64_tr_b16 a[10:11], v26 offset:24576
  ds_read_b64_tr_b16 a[12:13], v26 offset:18432
  ds_read_b64_tr_b16 a[14:15], v26 offset:26624
  ds_read_b64_tr_b16 a[72:73], v27 offset:16384
  ds_read_b64_tr_b16 a[74:75], v27 offset:24576
  ds_read_b64_tr_b16 a[76:77], v27 offset:18432
  ds_read_b64_tr_b16 a[78:79], v27 offset:26624
  s_lshl_b32 s12, s9, 8
  s_add_u32 s44, s66, s12
  s_addc_u32 s45, s67, 0
  s_add_u32 s44, s44, 1048576
  s_addc_u32 s45, s45, 0
  global_load_dwordx4 v[176:179], v22, s[44:45] sc1
  s_add_u32 s44, s44, 32768
  s_addc_u32 s45, s45, 0
  global_load_dwordx4 v[180:183], v22, s[44:45] sc1
  s_add_u32 s44, s44, 32768
  s_addc_u32 s45, s45, 0
  global_load_dwordx4 v[240:243], v22, s[44:45] sc1
  s_add_u32 s44, s44, 32768
  s_addc_u32 s45, s45, 0
  global_load_dwordx4 v[244:247], v22, s[44:45] sc1
  s_add_u32 s44, s44, 32768
  s_addc_u32 s45, s45, 0
  global_load_dwordx4 v[184:187], v23, s[44:45] sc1
  s_add_u32 s44, s44, 32768
  s_addc_u32 s45, s45, 0
  global_load_dwordx4 v[188:191], v23, s[44:45] sc1
  s_add_u32 s44, s44, 32768
  s_addc_u32 s45, s45, 0
  global_load_dwordx4 v[248:251], v23, s[44:45] sc1
  s_add_u32 s44, s44, 32768
  s_addc_u32 s45, s45, 0
  global_load_dwordx4 v[252:255], v23, s[44:45] sc1
  s_waitcnt lgkmcnt(0)
  s_barrier
  s_waitcnt vmcnt(48)
  ds_write_b128 v21, a[16:19] offset:0
  ds_write_b128 v21, a[20:23] offset:1024
  ds_write_b128 v21, a[80:83] offset:2048
  ds_write_b128 v21, a[84:87] offset:3072
  ds_write_b128 v21, a[24:27] offset:4096
  ds_write_b128 v21, a[28:31] offset:5120
  ds_write_b128 v21, a[88:91] offset:6144
  ds_write_b128 v21, a[92:95] offset:7168
  s_waitcnt lgkmcnt(0)
  s_barrier
  ds_read_b64_tr_b16 a[16:17], v26 offset:0
  ds_read_b64_tr_b16 a[18:19], v26 offset:8192
  ds_read_b64_tr_b16 a[20:21], v26 offset:2048
  ds_read_b64_tr_b16 a[22:23], v26 offset:10240
  ds_read_b64_tr_b16 a[80:81], v27 offset:0
  ds_read_b64_tr_b16 a[82:83], v27 offset:8192
  ds_read_b64_tr_b16 a[84:85], v27 offset:2048
  ds_read_b64_tr_b16 a[86:87], v27 offset:10240
  ds_read_b64_tr_b16 a[24:25], v26 offset:16384
  ds_read_b64_tr_b16 a[26:27], v26 offset:24576
  ds_read_b64_tr_b16 a[28:29], v26 offset:18432
  ds_read_b64_tr_b16 a[30:31], v26 offset:26624
  ds_read_b64_tr_b16 a[88:89], v27 offset:16384
  ds_read_b64_tr_b16 a[90:91], v27 offset:24576
  ds_read_b64_tr_b16 a[92:93], v27 offset:18432
  ds_read_b64_tr_b16 a[94:95], v27 offset:26624
  s_lshl_b32 s12, s9, 8
  s_add_u32 s44, s66, s12
  s_addc_u32 s45, s67, 0
  s_add_u32 s44, s44, 2097152
  s_addc_u32 s45, s45, 0
  global_load_dwordx4 v[128:131], v22, s[44:45] sc1
  s_add_u32 s44, s44, 32768
  s_addc_u32 s45, s45, 0
  global_load_dwordx4 v[132:135], v22, s[44:45] sc1
  s_add_u32 s44, s44, 32768
  s_addc_u32 s45, s45, 0
  global_load_dwordx4 v[192:195], v22, s[44:45] sc1
  s_add_u32 s44, s44, 32768
  s_addc_u32 s45, s45, 0
  global_load_dwordx4 v[196:199], v22, s[44:45] sc1
  s_add_u32 s44, s44, 32768
  s_addc_u32 s45, s45, 0
  global_load_dwordx4 v[136:139], v23, s[44:45] sc1
  s_add_u32 s44, s44, 32768
  s_addc_u32 s45, s45, 0
  global_load_dwordx4 v[140:143], v23, s[44:45] sc1
  s_add_u32 s44, s44, 32768
  s_addc_u32 s45, s45, 0
  global_load_dwordx4 v[200:203], v23, s[44:45] sc1
  s_add_u32 s44, s44, 32768
  s_addc_u32 s45, s45, 0
  global_load_dwordx4 v[204:207], v23, s[44:45] sc1
  s_waitcnt lgkmcnt(0)
  s_barrier
  s_waitcnt vmcnt(48)
  ds_write_b128 v21, a[160:163] offset:0
  ds_write_b128 v21, a[164:167] offset:1024
  ds_write_b128 v21, a[224:227] offset:2048
  ds_write_b128 v21, a[228:231] offset:3072
  ds_write_b128 v21, a[168:171] offset:4096
  ds_write_b128 v21, a[172:175] offset:5120
  ds_write_b128 v21, a[232:235] offset:6144
  ds_write_b128 v21, a[236:239] offset:7168
  s_waitcnt lgkmcnt(0)
  s_barrier
  ds_read_b64_tr_b16 a[160:161], v26 offset:0
  ds_read_b64_tr_b16 a[162:163], v26 offset:8192
  ds_read_b64_tr_b16 a[164:165], v26 offset:2048
  ds_read_b64_tr_b16 a[166:167], v26 offset:10240
  ds_read_b64_tr_b16 a[224:225], v27 offset:0
  ds_read_b64_tr_b16 a[226:227], v27 offset:8192
  ds_read_b64_tr_b16 a[228:229], v27 offset:2048
  ds_read_b64_tr_b16 a[230:231], v27 offset:10240
  ds_read_b64_tr_b16 a[168:169], v26 offset:16384
  ds_read_b64_tr_b16 a[170:171], v26 offset:24576
  ds_read_b64_tr_b16 a[172:173], v26 offset:18432
  ds_read_b64_tr_b16 a[174:175], v26 offset:26624
  ds_read_b64_tr_b16 a[232:233], v27 offset:16384
  ds_read_b64_tr_b16 a[234:235], v27 offset:24576
  ds_read_b64_tr_b16 a[236:237], v27 offset:18432
  ds_read_b64_tr_b16 a[238:239], v27 offset:26624
  s_lshl_b32 s12, s9, 8
  s_add_u32 s44, s66, s12
  s_addc_u32 s45, s67, 0
  s_add_u32 s44, s44, 3145728
  s_addc_u32 s45, s45, 0
  global_load_dwordx4 v[144:147], v22, s[44:45] sc1
  s_add_u32 s44, s44, 32768
  s_addc_u32 s45, s45, 0
  global_load_dwordx4 v[148:151], v22, s[44:45] sc1
  s_add_u32 s44, s44, 32768
  s_addc_u32 s45, s45, 0
  global_load_dwordx4 v[208:211], v22, s[44:45] sc1
  s_add_u32 s44, s44, 32768
  s_addc_u32 s45, s45, 0
  global_load_dwordx4 v[212:215], v22, s[44:45] sc1
  s_add_u32 s44, s44, 32768
  s_addc_u32 s45, s45, 0
  global_load_dwordx4 v[152:155], v23, s[44:45] sc1
  s_add_u32 s44, s44, 32768
  s_addc_u32 s45, s45, 0
  global_load_dwordx4 v[156:159], v23, s[44:45] sc1
  s_add_u32 s44, s44, 32768
  s_addc_u32 s45, s45, 0
  global_load_dwordx4 v[216:219], v23, s[44:45] sc1
  s_add_u32 s44, s44, 32768
  s_addc_u32 s45, s45, 0
  global_load_dwordx4 v[220:223], v23, s[44:45] sc1
  s_waitcnt lgkmcnt(0)
  s_barrier
  s_waitcnt vmcnt(48)
  ds_write_b128 v21, a[176:179] offset:0
  ds_write_b128 v21, a[180:183] offset:1024
  ds_write_b128 v21, a[240:243] offset:2048
  ds_write_b128 v21, a[244:247] offset:3072
  ds_write_b128 v21, a[184:187] offset:4096
  ds_write_b128 v21, a[188:191] offset:5120
  ds_write_b128 v21, a[248:251] offset:6144
  ds_write_b128 v21, a[252:255] offset:7168
  s_waitcnt lgkmcnt(0)
  s_barrier
  ds_read_b64_tr_b16 a[176:177], v26 offset:0
  ds_read_b64_tr_b16 a[178:179], v26 offset:8192
  ds_read_b64_tr_b16 a[180:181], v26 offset:2048
  ds_read_b64_tr_b16 a[182:183], v26 offset:10240
  ds_read_b64_tr_b16 a[240:241], v27 offset:0
  ds_read_b64_tr_b16 a[242:243], v27 offset:8192
  ds_read_b64_tr_b16 a[244:245], v27 offset:2048
  ds_read_b64_tr_b16 a[246:247], v27 offset:10240
  ds_read_b64_tr_b16 a[184:185], v26 offset:16384
  ds_read_b64_tr_b16 a[186:187], v26 offset:24576
  ds_read_b64_tr_b16 a[188:189], v26 offset:18432
  ds_read_b64_tr_b16 a[190:191], v26 offset:26624
  ds_read_b64_tr_b16 a[248:249], v27 offset:16384
  ds_read_b64_tr_b16 a[250:251], v27 offset:24576
  ds_read_b64_tr_b16 a[252:253], v27 offset:18432
  ds_read_b64_tr_b16 a[254:255], v27 offset:26624
  s_waitcnt lgkmcnt(0)
  s_barrier
  s_waitcnt vmcnt(40)
  ds_write_b128 v21, a[128:131] offset:0
  ds_write_b128 v21, a[132:135] offset:1024
  ds_write_b128 v21, a[192:195] offset:2048
  ds_write_b128 v21, a[196:199] offset:3072
  ds_write_b128 v21, a[136:139] offset:4096
  ds_write_b128 v21, a[140:143] offset:5120
  ds_write_b128 v21, a[200:203] offset:6144
  ds_write_b128 v21, a[204:207] offset:7168
  s_waitcnt lgkmcnt(0)
  s_barrier
  ds_read_b64_tr_b16 a[128:129], v26 offset:0
  ds_read_b64_tr_b16 a[130:131], v26 offset:8192
  ds_read_b64_tr_b16 a[132:133], v26 offset:2048
  ds_read_b64_tr_b16 a[134:135], v26 offset:10240
  ds_read_b64_tr_b16 a[192:193], v27 offset:0
  ds_read_b64_tr_b16 a[194:195], v27 offset:8192
  ds_read_b64_tr_b16 a[196:197], v27 offset:2048
  ds_read_b64_tr_b16 a[198:199], v27 offset:10240
  ds_read_b64_tr_b16 a[136:137], v26 offset:16384
  ds_read_b64_tr_b16 a[138:139], v26 offset:24576
  ds_read_b64_tr_b16 a[140:141], v26 offset:18432
  ds_read_b64_tr_b16 a[142:143], v26 offset:26624
  ds_read_b64_tr_b16 a[200:201], v27 offset:16384
  ds_read_b64_tr_b16 a[202:203], v27 offset:24576
  ds_read_b64_tr_b16 a[204:205], v27 offset:18432
  ds_read_b64_tr_b16 a[206:207], v27 offset:26624
  s_waitcnt lgkmcnt(0)
  s_barrier
  s_waitcnt vmcnt(32)
  ds_write_b128 v21, a[144:147] offset:0
  ds_write_b128 v21, a[148:151] offset:1024
  ds_write_b128 v21, a[208:211] offset:2048
  ds_write_b128 v21, a[212:215] offset:3072
  ds_write_b128 v21, a[152:155] offset:4096
  ds_write_b128 v21, a[156:159] offset:5120
  ds_write_b128 v21, a[216:219] offset:6144
  ds_write_b128 v21, a[220:223] offset:7168
  s_waitcnt lgkmcnt(0)
  s_barrier
  ds_read_b64_tr_b16 a[144:145], v26 offset:0
  ds_read_b64_tr_b16 a[146:147], v26 offset:8192
  ds_read_b64_tr_b16 a[148:149], v26 offset:2048
  ds_read_b64_tr_b16 a[150:151], v26 offset:10240
  ds_read_b64_tr_b16 a[208:209], v27 offset:0
  ds_read_b64_tr_b16 a[210:211], v27 offset:8192
  ds_read_b64_tr_b16 a[212:213], v27 offset:2048
  ds_read_b64_tr_b16 a[214:215], v27 offset:10240
  ds_read_b64_tr_b16 a[152:153], v26 offset:16384
  ds_read_b64_tr_b16 a[154:155], v26 offset:24576
  ds_read_b64_tr_b16 a[156:157], v26 offset:18432
  ds_read_b64_tr_b16 a[158:159], v26 offset:26624
  ds_read_b64_tr_b16 a[216:217], v27 offset:16384
  ds_read_b64_tr_b16 a[218:219], v27 offset:24576
  ds_read_b64_tr_b16 a[220:221], v27 offset:18432
  ds_read_b64_tr_b16 a[222:223], v27 offset:26624
  s_waitcnt lgkmcnt(0)
  s_barrier
  s_waitcnt vmcnt(24)
  ds_write_b128 v21, v[160:163] offset:0
  ds_write_b128 v21, v[164:167] offset:1024
  ds_write_b128 v21, v[224:227] offset:2048
  ds_write_b128 v21, v[228:231] offset:3072
  ds_write_b128 v21, v[168:171] offset:4096
  ds_write_b128 v21, v[172:175] offset:5120
  ds_write_b128 v21, v[232:235] offset:6144
  ds_write_b128 v21, v[236:239] offset:7168
  s_waitcnt lgkmcnt(0)
  s_barrier
  ds_read_b64_tr_b16 v[160:161], v26 offset:0
  ds_read_b64_tr_b16 v[162:163], v26 offset:8192
  ds_read_b64_tr_b16 v[164:165], v26 offset:2048
  ds_read_b64_tr_b16 v[166:167], v26 offset:10240
  ds_read_b64_tr_b16 v[224:225], v27 offset:0
  ds_read_b64_tr_b16 v[226:227], v27 offset:8192
  ds_read_b64_tr_b16 v[228:229], v27 offset:2048
  ds_read_b64_tr_b16 v[230:231], v27 offset:10240
  ds_read_b64_tr_b16 v[168:169], v26 offset:16384
  ds_read_b64_tr_b16 v[170:171], v26 offset:24576
  ds_read_b64_tr_b16 v[172:173], v26 offset:18432
  ds_read_b64_tr_b16 v[174:175], v26 offset:26624
  ds_read_b64_tr_b16 v[232:233], v27 offset:16384
  ds_read_b64_tr_b16 v[234:235], v27 offset:24576
  ds_read_b64_tr_b16 v[236:237], v27 offset:18432
  ds_read_b64_tr_b16 v[238:239], v27 offset:26624
  s_waitcnt lgkmcnt(0)
  s_barrier
  s_waitcnt vmcnt(16)
  ds_write_b128 v21, v[176:179] offset:0
  ds_write_b128 v21, v[180:183] offset:1024
  ds_write_b128 v21, v[240:243] offset:2048
  ds_write_b128 v21, v[244:247] offset:3072
  ds_write_b128 v21, v[184:187] offset:4096
  ds_write_b128 v21, v[188:191] offset:5120
  ds_write_b128 v21, v[248:251] offset:6144
  ds_write_b128 v21, v[252:255] offset:7168
  s_waitcnt lgkmcnt(0)
  s_barrier
  ds_read_b64_tr_b16 v[176:177], v26 offset:0
  ds_read_b64_tr_b16 v[178:179], v26 offset:8192
  ds_read_b64_tr_b16 v[180:181], v26 offset:2048
  ds_read_b64_tr_b16 v[182:183], v26 offset:10240
  ds_read_b64_tr_b16 v[240:241], v27 offset:0
  ds_read_b64_tr_b16 v[242:243], v27 offset:8192
  ds_read_b64_tr_b16 v[244:245], v27 offset:2048
  ds_read_b64_tr_b16 v[246:247], v27 offset:10240
  ds_read_b64_tr_b16 v[184:185], v26 offset:16384
  ds_read_b64_tr_b16 v[186:187], v26 offset:24576
  ds_read_b64_tr_b16 v[188:189], v26 offset:18432
  ds_read_b64_tr_b16 v[190:191], v26 offset:26624
  ds_read_b64_tr_b16 v[248:249], v27 offset:16384
  ds_read_b64_tr_b16 v[250:251], v27 offset:24576
  ds_read_b64_tr_b16 v[252:253], v27 offset:18432
  ds_read_b64_tr_b16 v[254:255], v27 offset:26624
  s_waitcnt lgkmcnt(0)
  s_barrier
  v_lshrrev_b32 v104, 2, v0
  v_and_b32 v104, 0x1c, v104
  v_bfe_u32 v103, v0, 4, 1
  v_lshl_add_u32 v103, v103, 11, s54
  v_add_u32 v105, 16384, v103
  v_add_u32 v106, 32768, v103
  global_load_dword v100, v104, s[6:7] sc1
  global_load_dword v101, v103, s[58:59] sc1
  global_load_dword v102, v105, s[58:59] sc1
  global_load_dword v5, v106, s[58:59] sc1
  s_waitcnt vmcnt(12)
  ds_write_b128 v21, v[128:131] offset:0
  ds_write_b128 v21, v[132:135] offset:1024
  ds_write_b128 v21, v[192:195] offset:2048
  ds_write_b128 v21, v[196:199] offset:3072
  ds_write_b128 v21, v[136:139] offset:4096
  ds_write_b128 v21, v[140:143] offset:5120
  ds_write_b128 v21, v[200:203] offset:6144
  ds_write_b128 v21, v[204:207] offset:7168
  s_waitcnt lgkmcnt(0)
  s_barrier
  ds_read_b64_tr_b16 v[128:129], v26 offset:0
  ds_read_b64_tr_b16 v[130:131], v26 offset:8192
  ds_read_b64_tr_b16 v[132:133], v26 offset:2048
  ds_read_b64_tr_b16 v[134:135], v26 offset:10240
  ds_read_b64_tr_b16 v[192:193], v27 offset:0
  ds_read_b64_tr_b16 v[194:195], v27 offset:8192
  ds_read_b64_tr_b16 v[196:197], v27 offset:2048
  ds_read_b64_tr_b16 v[198:199], v27 offset:10240
  ds_read_b64_tr_b16 v[136:137], v26 offset:16384
  ds_read_b64_tr_b16 v[138:139], v26 offset:24576
  ds_read_b64_tr_b16 v[140:141], v26 offset:18432
  ds_read_b64_tr_b16 v[142:143], v26 offset:26624
  ds_read_b64_tr_b16 v[200:201], v27 offset:16384
  ds_read_b64_tr_b16 v[202:203], v27 offset:24576
  ds_read_b64_tr_b16 v[204:205], v27 offset:18432
  ds_read_b64_tr_b16 v[206:207], v27 offset:26624
  s_waitcnt lgkmcnt(0)
  s_barrier
  s_waitcnt vmcnt(4)
  ds_write_b128 v21, v[144:147] offset:0
  ds_write_b128 v21, v[148:151] offset:1024
  ds_write_b128 v21, v[208:211] offset:2048
  ds_write_b128 v21, v[212:215] offset:3072
  ds_write_b128 v21, v[152:155] offset:4096
  ds_write_b128 v21, v[156:159] offset:5120
  ds_write_b128 v21, v[216:219] offset:6144
  ds_write_b128 v21, v[220:223] offset:7168
  s_waitcnt lgkmcnt(0)
  s_barrier
  ds_read_b64_tr_b16 v[144:145], v26 offset:0
  ds_read_b64_tr_b16 v[146:147], v26 offset:8192
  ds_read_b64_tr_b16 v[148:149], v26 offset:2048
  ds_read_b64_tr_b16 v[150:151], v26 offset:10240
  ds_read_b64_tr_b16 v[208:209], v27 offset:0
  ds_read_b64_tr_b16 v[210:211], v27 offset:8192
  ds_read_b64_tr_b16 v[212:213], v27 offset:2048
  ds_read_b64_tr_b16 v[214:215], v27 offset:10240
  ds_read_b64_tr_b16 v[152:153], v26 offset:16384
  ds_read_b64_tr_b16 v[154:155], v26 offset:24576
  ds_read_b64_tr_b16 v[156:157], v26 offset:18432
  ds_read_b64_tr_b16 v[158:159], v26 offset:26624
  ds_read_b64_tr_b16 v[216:217], v27 offset:16384
  ds_read_b64_tr_b16 v[218:219], v27 offset:24576
  ds_read_b64_tr_b16 v[220:221], v27 offset:18432
  ds_read_b64_tr_b16 v[222:223], v27 offset:26624
  s_waitcnt lgkmcnt(0)
  s_barrier
  s_waitcnt lgkmcnt(0)
  s_barrier
  s_branch L_wdone_2
L_wv_6:
  s_lshl_b32 s12, s8, 13
  s_add_u32 s12, s12, 131072
  v_add_u32 v21, s12, v0
  v_add_u32 v26, 131072, v26
  v_add_u32 v27, 131072, v27
  s_lshl_b32 s12, s9, 17
  s_add_u32 s44, s68, s12
  s_addc_u32 s45, s69, 0
  s_lshl_b32 s12, s8, 13
  s_add_u32 s12, s12, 0
  s_add_u32 s44, s44, s12
  s_addc_u32 s45, s45, 0
  v_xor_b32 v25, 0, v24
  s_add_u32 m0, s13, 0
  s_nop 0
  global_load_lds_dwordx4 v25, s[44:45] sc1
  s_add_u32 s44, s44, 1024
  s_addc_u32 s45, s45, 0
  v_xor_b32 v25, 32, v24
  s_add_u32 m0, s13, 1024
  s_nop 0
  global_load_lds_dwordx4 v25, s[44:45] sc1
  s_add_u32 s44, s44, 1024
  s_addc_u32 s45, s45, 0
  v_xor_b32 v25, 0, v24
  s_add_u32 m0, s13, 2048
  s_nop 0
  global_load_lds_dwordx4 v25, s[44:45] sc1
  s_add_u32 s44, s44, 1024
  s_addc_u32 s45, s45, 0
  v_xor_b32 v25, 32, v24
  s_add_u32 m0, s13, 3072
  s_nop 0
  global_load_lds_dwordx4 v25, s[44:45] sc1
  s_add_u32 s44, s44, 1024
  s_addc_u32 s45, s45, 0
  v_xor_b32 v25, 64, v24
  s_add_u32 m0, s13, 4096
  s_nop 0
  global_load_lds_dwordx4 v25, s[44:45] sc1
  s_add_u32 s44, s44, 1024
  s_addc_u32 s45, s45, 0
  v_xor_b32 v25, 96, v24
  s_add_u32 m0, s13, 5120
  s_nop 0
  global_load_lds_dwordx4 v25, s[44:45] sc1
  s_add_u32 s44, s44, 1024
  s_addc_u32 s45, s45, 0
  v_xor_b32 v25, 64, v24
  s_add_u32 m0, s13, 6144
  s_nop 0
  global_load_lds_dwordx4 v25, s[44:45] sc1
  s_add_u32 s44, s44, 1024
  s_addc_u32 s45, s45, 0
  v_xor_b32 v25, 96, v24
  s_add_u32 m0, s13, 7168
  s_nop 0
  global_load_lds_dwordx4 v25, s[44:45] sc1
  s_lshl_b32 s12, s9, 17
  s_add_u32 s44, s68, s12
  s_addc_u32 s45, s69, 0
  s_lshl_b32 s12, s8, 13
  s_add_u32 s12, s12, 32768
  s_add_u32 s44, s44, s12
  s_addc_u32 s45, s45, 0
  v_xor_b32 v25, 0, v24
  s_add_u32 m0, s13, 32768
  s_nop 0
  global_load_lds_dwordx4 v25, s[44:45] sc1
  s_add_u32 s44, s44, 1024
  s_addc_u32 s45, s45, 0
  v_xor_b32 v25, 32, v24
  s_add_u32 m0, s13, 33792
  s_nop 0
  global_load_lds_dwordx4 v25, s[44:45] sc1
  s_add_u32 s44, s44, 1024
  s_addc_u32 s45, s45, 0
  v_xor_b32 v25, 0, v24
  s_add_u32 m0, s13, 34816
  s_nop 0
  global_load_lds_dwordx4 v25, s[44:45] sc1
  s_add_u32 s44, s44, 1024
  s_addc_u32 s45, s45, 0
  v_xor_b32 v25, 32, v24
  s_add_u32 m0, s13, 35840
  s_nop 0
  global_load_lds_dwordx4 v25, s[44:45] sc1
  s_add_u32 s44, s44, 1024
  s_addc_u32 s45, s45, 0
  v_xor_b32 v25, 64, v24
  s_add_u32 m0, s13, 36864
  s_nop 0
  global_load_lds_dwordx4 v25, s[44:45] sc1
  s_add_u32 s44, s44, 1024
  s_addc_u32 s45, s45, 0
  v_xor_b32 v25, 96, v24
  s_add_u32 m0, s13, 37888
  s_nop 0
  global_load_lds_dwordx4 v25, s[44:45] sc1
  s_add_u32 s44, s44, 1024
  s_addc_u32 s45, s45, 0
  v_xor_b32 v25, 64, v24
  s_add_u32 m0, s13, 38912
  s_nop 0
  global_load_lds_dwordx4 v25, s[44:45] sc1
  s_add_u32 s44, s44, 1024
  s_addc_u32 s45, s45, 0
  v_xor_b32 v25, 96, v24
  s_add_u32 m0, s13, 39936
  s_nop 0
  global_load_lds_dwordx4 v25, s[44:45] sc1
  s_lshl_b32 s12, s9, 17
  s_add_u32 s44, s68, s12
  s_addc_u32 s45, s69, 0
  s_lshl_b32 s12, s8, 13
  s_add_u32 s12, s12, 65536
  s_add_u32 s44, s44, s12
  s_addc_u32 s45, s45, 0
  v_xor_b32 v25, 0, v24
  s_add_u32 m0, s13, 65536
  s_nop 0
  global_load_lds_dwordx4 v25, s[44:45] sc1
  s_add_u32 s44, s44, 1024
  s_addc_u32 s45, s45, 0
  v_xor_b32 v25, 32, v24
  s_add_u32 m0, s13, 66560
  s_nop 0
  global_load_lds_dwordx4 v25, s[44:45] sc1
  s_add_u32 s44, s44, 1024
  s_addc_u32 s45, s45, 0
  v_xor_b32 v25, 0, v24
  s_add_u32 m0, s13, 67584
  s_nop 0
  global_load_lds_dwordx4 v25, s[44:45] sc1
  s_add_u32 s44, s44, 1024
  s_addc_u32 s45, s45, 0
  v_xor_b32 v25, 32, v24
  s_add_u32 m0, s13, 68608
  s_nop 0
  global_load_lds_dwordx4 v25, s[44:45] sc1
  s_add_u32 s44, s44, 1024
  s_addc_u32 s45, s45, 0
  v_xor_b32 v25, 64, v24
  s_add_u32 m0, s13, 69632
  s_nop 0
  global_load_lds_dwordx4 v25, s[44:45] sc1
  s_add_u32 s44, s44, 1024
  s_addc_u32 s45, s45, 0
  v_xor_b32 v25, 96, v24
  s_add_u32 m0, s13, 70656
  s_nop 0
  global_load_lds_dwordx4 v25, s[44:45] sc1
  s_add_u32 s44, s44, 1024
  s_addc_u32 s45, s45, 0
  v_xor_b32 v25, 64, v24
  s_add_u32 m0, s13, 71680
  s_nop 0
  global_load_lds_dwordx4 v25, s[44:45] sc1
  s_add_u32 s44, s44, 1024
  s_addc_u32 s45, s45, 0
  v_xor_b32 v25, 96, v24
  s_add_u32 m0, s13, 72704
  s_nop 0
  global_load_lds_dwordx4 v25, s[44:45] sc1
  s_lshl_b32 s12, s9, 17
  s_add_u32 s44, s68, s12
  s_addc_u32 s45, s69, 0
  s_lshl_b32 s12, s8, 13
  s_add_u32 s12, s12, 98304
  s_add_u32 s44, s44, s12
  s_addc_u32 s45, s45, 0
  v_xor_b32 v25, 0, v24
  s_add_u32 m0, s13, 98304
  s_nop 0
  global_load_lds_dwordx4 v25, s[44:45] sc1
  s_add_u32 s44, s44, 1024
  s_addc_u32 s45, s45, 0
  v_xor_b32 v25, 32, v24
  s_add_u32 m0, s13, 99328
  s_nop 0
  global_load_lds_dwordx4 v25, s[44:45] sc1
  s_add_u32 s44, s44, 1024
  s_addc_u32 s45, s45, 0
  v_xor_b32 v25, 0, v24
  s_add_u32 m0, s13, 100352
  s_nop 0
  global_load_lds_dwordx4 v25, s[44:45] sc1
  s_add_u32 s44, s44, 1024
  s_addc_u32 s45, s45, 0
  v_xor_b32 v25, 32, v24
  s_add_u32 m0, s13, 101376
  s_nop 0
  global_load_lds_dwordx4 v25, s[44:45] sc1
  s_add_u32 s44, s44, 1024
  s_addc_u32 s45, s45, 0
  v_xor_b32 v25, 64, v24
  s_add_u32 m0, s13, 102400
  s_nop 0
  global_load_lds_dwordx4 v25, s[44:45] sc1
  s_add_u32 s44, s44, 1024
  s_addc_u32 s45, s45, 0
  v_xor_b32 v25, 96, v24
  s_add_u32 m0, s13, 103424
  s_nop 0
  global_load_lds_dwordx4 v25, s[44:45] sc1
  s_add_u32 s44, s44, 1024
  s_addc_u32 s45, s45, 0
  v_xor_b32 v25, 64, v24
  s_add_u32 m0, s13, 104448
  s_nop 0
  global_load_lds_dwordx4 v25, s[44:45] sc1
  s_add_u32 s44, s44, 1024
  s_addc_u32 s45, s45, 0
  v_xor_b32 v25, 96, v24
  s_add_u32 m0, s13, 105472
  s_nop 0
  global_load_lds_dwordx4 v25, s[44:45] sc1
  s_lshl_b32 s12, s9, 8
  s_add_u32 s44, s62, s12
  s_addc_u32 s45, s63, 0
  s_add_u32 s44, s44, 0
  s_addc_u32 s45, s45, 0
  global_load_dwordx4 a[16:19], v22, s[44:45] sc1
  s_add_u32 s44, s44, 32768
  s_addc_u32 s45, s45, 0
  global_load_dwordx4 a[20:23], v22, s[44:45] sc1
  s_add_u32 s44, s44, 32768
  s_addc_u32 s45, s45, 0
  global_load_dwordx4 a[80:83], v22, s[44:45] sc1
  s_add_u32 s44, s44, 32768
  s_addc_u32 s45, s45, 0
  global_load_dwordx4 a[84:87], v22, s[44:45] sc1
  s_add_u32 s44, s44, 32768
  s_addc_u32 s45, s45, 0
  global_load_dwordx4 a[24:27], v23, s[44:45] sc1
  s_add_u32 s44, s44, 32768
  s_addc_u32 s45, s45, 0
  global_load_dwordx4 a[28:31], v23, s[44:45] sc1
  s_add_u32 s44, s44, 32768
  s_addc_u32 s45, s45, 0
  global_load_dwordx4 a[88:91], v23, s[44:45] sc1
  s_add_u32 s44, s44, 32768
  s_addc_u32 s45, s45, 0
  global_load_dwordx4 a[92:95], v23, s[44:45] sc1
  s_lshl_b32 s12, s9, 8
  s_add_u32 s44, s62, s12
  s_addc_u32 s45, s63, 0
  s_add_u32 s44, s44, 1048576
  s_addc_u32 s45, s45, 0
  global_load_dwordx4 a[32:35], v22, s[44:45] sc1
  s_add_u32 s44, s44, 32768
  s_addc_u32 s45, s45, 0
  global_load_dwordx4 a[36:39], v22, s[44:45] sc1
  s_add_u32 s44, s44, 32768
  s_addc_u32 s45, s45, 0
  global_load_dwordx4 a[96:99], v22, s[44:45] sc1
  s_add_u32 s44, s44, 32768
  s_addc_u32 s45, s45, 0
  global_load_dwordx4 a[100:103], v22, s[44:45] sc1
  s_add_u32 s44, s44, 32768
  s_addc_u32 s45, s45, 0
  global_load_dwordx4 a[40:43], v23, s[44:45] sc1
  s_add_u32 s44, s44, 32768
  s_addc_u32 s45, s45, 0
  global_load_dwordx4 a[44:47], v23, s[44:45] sc1
  s_add_u32 s44, s44, 32768
  s_addc_u32 s45, s45, 0
  global_load_dwordx4 a[104:107], v23, s[44:45] sc1
  s_add_u32 s44, s44, 32768
  s_addc_u32 s45, s45, 0
  global_load_dwordx4 a[108:111], v23, s[44:45] sc1
  s_lshl_b32 s12, s9, 8
  s_add_u32 s44, s62, s12
  s_addc_u32 s45, s63, 0
  s_add_u32 s44, s44, 2097152
  s_addc_u32 s45, s45, 0
  global_load_dwordx4 a[48:51], v22, s[44:45] sc1
  s_add_u32 s44, s44, 32768
  s_addc_u32 s45, s45, 0
  global_load_dwordx4 a[52:55], v22, s[44:45] sc1
  s_add_u32 s44, s44, 32768
  s_addc_u32 s45, s45, 0
  global_load_dwordx4 a[112:115], v22, s[44:45] sc1
  s_add_u32 s44, s44, 32768
  s_addc_u32 s45, s45, 0
  global_load_dwordx4 a[116:119], v22, s[44:45] sc1
  s_add_u32 s44, s44, 32768
  s_addc_u32 s45, s45, 0
  global_load_dwordx4 a[56:59], v23, s[44:45] sc1
  s_add_u32 s44, s44, 32768
  s_addc_u32 s45, s45, 0
  global_load_dwordx4 a[60:63], v23, s[44:45] sc1
  s_add_u32 s44, s44, 32768
  s_addc_u32 s45, s45, 0
  global_load_dwordx4 a[120:123], v23, s[44:45] sc1
  s_add_u32 s44, s44, 32768
  s_addc_u32 s45, s45, 0
  global_load_dwordx4 a[124:127], v23, s[44:45] sc1
  v_mov_b32 v99, 16
  global_load_dword v99, v99, s[6:7] sc1
  s_waitcnt vmcnt(49)
  s_barrier
  v_add_u32 v29, 0, v28
  v_xor_b32 v30, 0, v29
  ds_read_b64_tr_b16 v[32:33], v30 offset:0
  ds_read_b64_tr_b16 v[34:35], v30 offset:2048
  v_xor_b32 v30, 32, v29
  ds_read_b64_tr_b16 v[36:37], v30 offset:0
  ds_read_b64_tr_b16 v[38:39], v30 offset:2048
  v_xor_b32 v30, 64, v29
  ds_read_b64_tr_b16 v[40:41], v30 offset:0
  ds_read_b64_tr_b16 v[42:43], v30 offset:2048
  v_xor_b32 v30, 96, v29
  ds_read_b64_tr_b16 v[44:45], v30 offset:0
  ds_read_b64_tr_b16 v[46:47], v30 offset:2048
  v_xor_b32 v30, 128, v29
  ds_read_b64_tr_b16 v[48:49], v30 offset:0
  ds_read_b64_tr_b16 v[50:51], v30 offset:2048
  v_xor_b32 v30, 160, v29
  ds_read_b64_tr_b16 v[52:53], v30 offset:0
  ds_read_b64_tr_b16 v[54:55], v30 offset:2048
  v_xor_b32 v30, 192, v29
  ds_read_b64_tr_b16 v[56:57], v30 offset:0
  ds_read_b64_tr_b16 v[58:59], v30 offset:2048
  v_xor_b32 v30, 224, v29
  ds_read_b64_tr_b16 v[60:61], v30 offset:0
  ds_read_b64_tr_b16 v[62:63], v30 offset:2048
  s_lshl_b32 s12, s9, 8
  s_add_u32 s44, s62, s12
  s_addc_u32 s45, s63, 0
  s_add_u32 s44, s44, 3145728
  s_addc_u32 s45, s45, 0
  global_load_dwordx4 a[0:3], v22, s[44:45] sc1
  s_add_u32 s44, s44, 32768
  s_addc_u32 s45, s45, 0
  global_load_dwordx4 a[4:7], v22, s[44:45] sc1
  s_add_u32 s44, s44, 32768
  s_addc_u32 s45, s45, 0
  global_load_dwordx4 a[64:67], v22, s[44:45] sc1
  s_add_u32 s44, s44, 32768
  s_addc_u32 s45, s45, 0
  global_load_dwordx4 a[68:71], v22, s[44:45] sc1
  s_add_u32 s44, s44, 32768
  s_addc_u32 s45, s45, 0
  global_load_dwordx4 a[8:11], v23, s[44:45] sc1
  s_add_u32 s44, s44, 32768
  s_addc_u32 s45, s45, 0
  global_load_dwordx4 a[12:15], v23, s[44:45] sc1
  s_add_u32 s44, s44, 32768
  s_addc_u32 s45, s45, 0
  global_load_dwordx4 a[72:75], v23, s[44:45] sc1
  s_add_u32 s44, s44, 32768
  s_addc_u32 s45, s45, 0
  global_load_dwordx4 a[76:79], v23, s[44:45] sc1
  s_waitcnt lgkmcnt(0)
  s_barrier
  ds_write_b128 v16, v[32:35] offset:0
  ds_write_b128 v16, v[36:39] offset:1024
  ds_write_b128 v16, v[40:43] offset:2048
  ds_write_b128 v16, v[44:47] offset:3072
  ds_write_b128 v16, v[48:51] offset:4096
  ds_write_b128 v16, v[52:55] offset:5120
  ds_write_b128 v16, v[56:59] offset:6144
  ds_write_b128 v16, v[60:63] offset:7168
  s_waitcnt vmcnt(49)
  s_barrier
  v_add_u32 v29, 32768, v28
  v_xor_b32 v30, 0, v29
  ds_read_b64_tr_b16 v[32:33], v30 offset:0
  ds_read_b64_tr_b16 v[34:35], v30 offset:2048
  v_xor_b32 v30, 32, v29
  ds_read_b64_tr_b16 v[36:37], v30 offset:0
  ds_read_b64_tr_b16 v[38:39], v30 offset:2048
  v_xor_b32 v30, 64, v29
  ds_read_b64_tr_b16 v[40:41], v30 offset:0
  ds_read_b64_tr_b16 v[42:43], v30 offset:2048
  v_xor_b32 v30, 96, v29
  ds_read_b64_tr_b16 v[44:45], v30 offset:0
  ds_read_b64_tr_b16 v[46:47], v30 offset:2048
  v_xor_b32 v30, 128, v29
  ds_read_b64_tr_b16 v[48:49], v30 offset:0
  ds_read_b64_tr_b16 v[50:51], v30 offset:2048
  v_xor_b32 v30, 160, v29
  ds_read_b64_tr_b16 v[52:53], v30 offset:0
  ds_read_b64_tr_b16 v[54:55], v30 offset:2048
  v_xor_b32 v30, 192, v29
  ds_read_b64_tr_b16 v[56:57], v30 offset:0
  ds_read_b64_tr_b16 v[58:59], v30 offset:2048
  v_xor_b32 v30, 224, v29
  ds_read_b64_tr_b16 v[60:61], v30 offset:0
  ds_read_b64_tr_b16 v[62:63], v30 offset:2048
  s_lshl_b32 s12, s9, 8
  s_add_u32 s44, s64, s12
  s_addc_u32 s45, s65, 0
  s_add_u32 s44, s44, 0
  s_addc_u32 s45, s45, 0
  global_load_dwordx4 a[144:147], v22, s[44:45] sc1
  s_add_u32 s44, s44, 32768
  s_addc_u32 s45, s45, 0
  global_load_dwordx4 a[148:151], v22, s[44:45] sc1
  s_add_u32 s44, s44, 32768
  s_addc_u32 s45, s45, 0
  global_load_dwordx4 a[208:211], v22, s[44:45] sc1
  s_add_u32 s44, s44, 32768
  s_addc_u32 s45, s45, 0
  global_load_dwordx4 a[212:215], v22, s[44:45] sc1
  s_add_u32 s44, s44, 32768
  s_addc_u32 s45, s45, 0
  global_load_dwordx4 a[152:155], v23, s[44:45] sc1
  s_add_u32 s44, s44, 32768
  s_addc_u32 s45, s45, 0
  global_load_dwordx4 a[156:159], v23, s[44:45] sc1
  s_add_u32 s44, s44, 32768
  s_addc_u32 s45, s45, 0
  global_load_dwordx4 a[216:219], v23, s[44:45] sc1
  s_add_u32 s44, s44, 32768
  s_addc_u32 s45, s45, 0
  global_load_dwordx4 a[220:223], v23, s[44:45] sc1
  s_waitcnt lgkmcnt(0)
  s_barrier
  ds_write_b128 v16, v[32:35] offset:32768
  ds_write_b128 v16, v[36:39] offset:33792
  ds_write_b128 v16, v[40:43] offset:34816
  ds_write_b128 v16, v[44:47] offset:35840
  ds_write_b128 v16, v[48:51] offset:36864
  ds_write_b128 v16, v[52:55] offset:37888
  ds_write_b128 v16, v[56:59] offset:38912
  ds_write_b128 v16, v[60:63] offset:39936
  s_waitcnt vmcnt(49)
  s_barrier
  v_add_u32 v29, 65536, v28
  v_xor_b32 v30, 0, v29
  ds_read_b64_tr_b16 v[32:33], v30 offset:0
  ds_read_b64_tr_b16 v[34:35], v30 offset:2048
  v_xor_b32 v30, 32, v29
  ds_read_b64_tr_b16 v[36:37], v30 offset:0
  ds_read_b64_tr_b16 v[38:39], v30 offset:2048
  v_xor_b32 v30, 64, v29
  ds_read_b64_tr_b16 v[40:41], v30 offset:0
  ds_read_b64_tr_b16 v[42:43], v30 offset:2048
  v_xor_b32 v30, 96, v29
  ds_read_b64_tr_b16 v[44:45], v30 offset:0
  ds_read_b64_tr_b16 v[46:47], v30 offset:2048
  v_xor_b32 v30, 128, v29
  ds_read_b64_tr_b16 v[48:49], v30 offset:0
  ds_read_b64_tr_b16 v[50:51], v30 offset:2048
  v_xor_b32 v30, 160, v29
  ds_read_b64_tr_b16 v[52:53], v30 offset:0
  ds_read_b64_tr_b16 v[54:55], v30 offset:2048
  v_xor_b32 v30, 192, v29
  ds_read_b64_tr_b16 v[56:57], v30 offset:0
  ds_read_b64_tr_b16 v[58:59], v30 offset:2048
  v_xor_b32 v30, 224, v29
  ds_read_b64_tr_b16 v[60:61], v30 offset:0
  ds_read_b64_tr_b16 v[62:63], v30 offset:2048
  s_lshl_b32 s12, s9, 8
  s_add_u32 s44, s64, s12
  s_addc_u32 s45, s65, 0
  s_add_u32 s44, s44, 1048576
  s_addc_u32 s45, s45, 0
  global_load_dwordx4 a[160:163], v22, s[44:45] sc1
  s_add_u32 s44, s44, 32768
  s_addc_u32 s45, s45, 0
  global_load_dwordx4 a[164:167], v22, s[44:45] sc1
  s_add_u32 s44, s44, 32768
  s_addc_u32 s45, s45, 0
  global_load_dwordx4 a[224:227], v22, s[44:45] sc1
  s_add_u32 s44, s44, 32768
  s_addc_u32 s45, s45, 0
  global_load_dwordx4 a[228:231], v22, s[44:45] sc1
  s_add_u32 s44, s44, 32768
  s_addc_u32 s45, s45, 0
  global_load_dwordx4 a[168:171], v23, s[44:45] sc1
  s_add_u32 s44, s44, 32768
  s_addc_u32 s45, s45, 0
  global_load_dwordx4 a[172:175], v23, s[44:45] sc1
  s_add_u32 s44, s44, 32768
  s_addc_u32 s45, s45, 0
  global_load_dwordx4 a[232:235], v23, s[44:45] sc1
  s_add_u32 s44, s44, 32768
  s_addc_u32 s45, s45, 0
  global_load_dwordx4 a[236:239], v23, s[44:45] sc1
  s_waitcnt lgkmcnt(0)
  s_barrier
  ds_write_b128 v17, v[32:35] offset:0
  ds_write_b128 v17, v[36:39] offset:1024
  ds_write_b128 v17, v[40:43] offset:2048
  ds_write_b128 v17, v[44:47] offset:3072
  ds_write_b128 v17, v[48:51] offset:4096
  ds_write_b128 v17, v[52:55] offset:5120
  ds_write_b128 v17, v[56:59] offset:6144
  ds_write_b128 v17, v[60:63] offset:7168
  s_waitcnt vmcnt(49)
  s_barrier
  v_add_u32 v29, 98304, v28
  v_xor_b32 v30, 0, v29
  ds_read_b64_tr_b16 v[32:33], v30 offset:0
  ds_read_b64_tr_b16 v[34:35], v30 offset:2048
  v_xor_b32 v30, 32, v29
  ds_read_b64_tr_b16 v[36:37], v30 offset:0
  ds_read_b64_tr_b16 v[38:39], v30 offset:2048
  v_xor_b32 v30, 64, v29
  ds_read_b64_tr_b16 v[40:41], v30 offset:0
  ds_read_b64_tr_b16 v[42:43], v30 offset:2048
  v_xor_b32 v30, 96, v29
  ds_read_b64_tr_b16 v[44:45], v30 offset:0
  ds_read_b64_tr_b16 v[46:47], v30 offset:2048
  v_xor_b32 v30, 128, v29
  ds_read_b64_tr_b16 v[48:49], v30 offset:0
  ds_read_b64_tr_b16 v[50:51], v30 offset:2048
  v_xor_b32 v30, 160, v29
  ds_read_b64_tr_b16 v[52:53], v30 offset:0
  ds_read_b64_tr_b16 v[54:55], v30 offset:2048
  v_xor_b32 v30, 192, v29
  ds_read_b64_tr_b16 v[56:57], v30 offset:0
  ds_read_b64_tr_b16 v[58:59], v30 offset:2048
  v_xor_b32 v30, 224, v29
  ds_read_b64_tr_b16 v[60:61], v30 offset:0
  ds_read_b64_tr_b16 v[62:63], v30 offset:2048
  s_lshl_b32 s12, s9, 8
  s_add_u32 s44, s64, s12
  s_addc_u32 s45, s65, 0
  s_add_u32 s44, s44, 2097152
  s_addc_u32 s45, s45, 0
  global_load_dwordx4 a[176:179], v22, s[44:45] sc1
  s_add_u32 s44, s44, 32768
  s_addc_u32 s45, s45, 0
  global_load_dwordx4 a[180:183], v22, s[44:45] sc1
  s_add_u32 s44, s44, 32768
  s_addc_u32 s45, s45, 0
  global_load_dwordx4 a[240:243], v22, s[44:45] sc1
  s_add_u32 s44, s44, 32768
  s_addc_u32 s45, s45, 0
  global_load_dwordx4 a[244:247], v22, s[44:45] sc1
  s_add_u32 s44, s44, 32768
  s_addc_u32 s45, s45, 0
  global_load_dwordx4 a[184:187], v23, s[44:45] sc1
  s_add_u32 s44, s44, 32768
  s_addc_u32 s45, s45, 0
  global_load_dwordx4 a[188:191], v23, s[44:45] sc1
  s_add_u32 s44, s44, 32768
  s_addc_u32 s45, s45, 0
  global_load_dwordx4 a[248:251], v23, s[44:45] sc1
  s_add_u32 s44, s44, 32768
  s_addc_u32 s45, s45, 0
  global_load_dwordx4 a[252:255], v23, s[44:45] sc1
  s_waitcnt lgkmcnt(0)
  s_barrier
  ds_write_b128 v17, v[32:35] offset:32768
  ds_write_b128 v17, v[36:39] offset:33792
  ds_write_b128 v17, v[40:43] offset:34816
  ds_write_b128 v17, v[44:47] offset:35840
  ds_write_b128 v17, v[48:51] offset:36864
  ds_write_b128 v17, v[52:55] offset:37888
  ds_write_b128 v17, v[56:59] offset:38912
  ds_write_b128 v17, v[60:63] offset:39936
  s_waitcnt vmcnt(49)
  ds_write_b128 v21, a[16:19] offset:0
  ds_write_b128 v21, a[20:23] offset:1024
  ds_write_b128 v21, a[80:83] offset:2048
  ds_write_b128 v21, a[84:87] offset:3072
  ds_write_b128 v21, a[24:27] offset:4096
  ds_write_b128 v21, a[28:31] offset:5120
  ds_write_b128 v21, a[88:91] offset:6144
  ds_write_b128 v21, a[92:95] offset:7168
  s_waitcnt lgkmcnt(0)
  s_barrier
  ds_read_b64_tr_b16 a[16:17], v26 offset:0
  ds_read_b64_tr_b16 a[18:19], v26 offset:8192
  ds_read_b64_tr_b16 a[20:21], v26 offset:2048
  ds_read_b64_tr_b16 a[22:23], v26 offset:10240
  ds_read_b64_tr_b16 a[80:81], v27 offset:0
  ds_read_b64_tr_b16 a[82:83], v27 offset:8192
  ds_read_b64_tr_b16 a[84:85], v27 offset:2048
  ds_read_b64_tr_b16 a[86:87], v27 offset:10240
  ds_read_b64_tr_b16 a[24:25], v26 offset:16384
  ds_read_b64_tr_b16 a[26:27], v26 offset:24576
  ds_read_b64_tr_b16 a[28:29], v26 offset:18432
  ds_read_b64_tr_b16 a[30:31], v26 offset:26624
  ds_read_b64_tr_b16 a[88:89], v27 offset:16384
  ds_read_b64_tr_b16 a[90:91], v27 offset:24576
  ds_read_b64_tr_b16 a[92:93], v27 offset:18432
  ds_read_b64_tr_b16 a[94:95], v27 offset:26624
  s_lshl_b32 s12, s9, 8
  s_add_u32 s44, s64, s12
  s_addc_u32 s45, s65, 0
  s_add_u32 s44, s44, 3145728
  s_addc_u32 s45, s45, 0
  global_load_dwordx4 a[128:131], v22, s[44:45] sc1
  s_add_u32 s44, s44, 32768
  s_addc_u32 s45, s45, 0
  global_load_dwordx4 a[132:135], v22, s[44:45] sc1
  s_add_u32 s44, s44, 32768
  s_addc_u32 s45, s45, 0
  global_load_dwordx4 a[192:195], v22, s[44:45] sc1
  s_add_u32 s44, s44, 32768
  s_addc_u32 s45, s45, 0
  global_load_dwordx4 a[196:199], v22, s[44:45] sc1
  s_add_u32 s44, s44, 32768
  s_addc_u32 s45, s45, 0
  global_load_dwordx4 a[136:139], v23, s[44:45] sc1
  s_add_u32 s44, s44, 32768
  s_addc_u32 s45, s45, 0
  global_load_dwordx4 a[140:143], v23, s[44:45] sc1
  s_add_u32 s44, s44, 32768
  s_addc_u32 s45, s45, 0
  global_load_dwordx4 a[200:203], v23, s[44:45] sc1
  s_add_u32 s44, s44, 32768
  s_addc_u32 s45, s45, 0
  global_load_dwordx4 a[204:207], v23, s[44:45] sc1
  s_waitcnt lgkmcnt(0)
  s_barrier
  s_waitcnt vmcnt(49)
  ds_write_b128 v21, a[32:35] offset:0
  ds_write_b128 v21, a[36:39] offset:1024
  ds_write_b128 v21, a[96:99] offset:2048
  ds_write_b128 v21, a[100:103] offset:3072
  ds_write_b128 v21, a[40:43] offset:4096
  ds_write_b128 v21, a[44:47] offset:5120
  ds_write_b128 v21, a[104:107] offset:6144
  ds_write_b128 v21, a[108:111] offset:7168
  s_waitcnt lgkmcnt(0)
  s_barrier
  ds_read_b64_tr_b16 a[32:33], v26 offset:0
  ds_read_b64_tr_b16 a[34:35], v26 offset:8192
  ds_read_b64_tr_b16 a[36:37], v26 offset:2048
  ds_read_b64_tr_b16 a[38:39], v26 offset:10240
  ds_read_b64_tr_b16 a[96:97], v27 offset:0
  ds_read_b64_tr_b16 a[98:99], v27 offset:8192
  ds_read_b64_tr_b16 a[100:101], v27 offset:2048
  ds_read_b64_tr_b16 a[102:103], v27 offset:10240
  ds_read_b64_tr_b16 a[40:41], v26 offset:16384
  ds_read_b64_tr_b16 a[42:43], v26 offset:24576
  ds_read_b64_tr_b16 a[44:45], v26 offset:18432
  ds_read_b64_tr_b16 a[46:47], v26 offset:26624
  ds_read_b64_tr_b16 a[104:105], v27 offset:16384
  ds_read_b64_tr_b16 a[106:107], v27 offset:24576
  ds_read_b64_tr_b16 a[108:109], v27 offset:18432
  ds_read_b64_tr_b16 a[110:111], v27 offset:26624
  s_lshl_b32 s12, s9, 8
  s_add_u32 s44, s66, s12
  s_addc_u32 s45, s67, 0
  s_add_u32 s44, s44, 0
  s_addc_u32 s45, s45, 0
  global_load_dwordx4 v[144:147], v22, s[44:45] sc1
  s_add_u32 s44, s44, 32768
  s_addc_u32 s45, s45, 0
  global_load_dwordx4 v[148:151], v22, s[44:45] sc1
  s_add_u32 s44, s44, 32768
  s_addc_u32 s45, s45, 0
  global_load_dwordx4 v[208:211], v22, s[44:45] sc1
  s_add_u32 s44, s44, 32768
  s_addc_u32 s45, s45, 0
  global_load_dwordx4 v[212:215], v22, s[44:45] sc1
  s_add_u32 s44, s44, 32768
  s_addc_u32 s45, s45, 0
  global_load_dwordx4 v[152:155], v23, s[44:45] sc1
  s_add_u32 s44, s44, 32768
  s_addc_u32 s45, s45, 0
  global_load_dwordx4 v[156:159], v23, s[44:45] sc1
  s_add_u32 s44, s44, 32768
  s_addc_u32 s45, s45, 0
  global_load_dwordx4 v[216:219], v23, s[44:45] sc1
  s_add_u32 s44, s44, 32768
  s_addc_u32 s45, s45, 0
  global_load_dwordx4 v[220:223], v23, s[44:45] sc1
  s_waitcnt lgkmcnt(0)
  s_barrier
  s_waitcnt vmcnt(49)
  ds_write_b128 v21, a[48:51] offset:0
  ds_write_b128 v21, a[52:55] offset:1024
  ds_write_b128 v21, a[112:115] offset:2048
  ds_write_b128 v21, a[116:119] offset:3072
  ds_write_b128 v21, a[56:59] offset:4096
  ds_write_b128 v21, a[60:63] offset:5120
  ds_write_b128 v21, a[120:123] offset:6144
  ds_write_b128 v21, a[124:127] offset:7168
  s_waitcnt lgkmcnt(0)
  s_barrier
  ds_read_b64_tr_b16 a[48:49], v26 offset:0
  ds_read_b64_tr_b16 a[50:51], v26 offset:8192
  ds_read_b64_tr_b16 a[52:53], v26 offset:2048
  ds_read_b64_tr_b16 a[54:55], v26 offset:10240
  ds_read_b64_tr_b16 a[112:113], v27 offset:0
  ds_read_b64_tr_b16 a[114:115], v27 offset:8192
  ds_read_b64_tr_b16 a[116:117], v27 offset:2048
  ds_read_b64_tr_b16 a[118:119], v27 offset:10240
  ds_read_b64_tr_b16 a[56:57], v26 offset:16384
  ds_read_b64_tr_b16 a[58:59], v26 offset:24576
  ds_read_b64_tr_b16 a[60:61], v26 offset:18432
  ds_read_b64_tr_b16 a[62:63], v26 offset:26624
  ds_read_b64_tr_b16 a[120:121], v27 offset:16384
  ds_read_b64_tr_b16 a[122:123], v27 offset:24576
  ds_read_b64_tr_b16 a[124:125], v27 offset:18432
  ds_read_b64_tr_b16 a[126:127], v27 offset:26624
  s_lshl_b32 s12, s9, 8
  s_add_u32 s44, s66, s12
  s_addc_u32 s45, s67, 0
  s_add_u32 s44, s44, 1048576
  s_addc_u32 s45, s45, 0
  global_load_dwordx4 v[160:163], v22, s[44:45] sc1
  s_add_u32 s44, s44, 32768
  s_addc_u32 s45, s45, 0
  global_load_dwordx4 v[164:167], v22, s[44:45] sc1
  s_add_u32 s44, s44, 32768
  s_addc_u32 s45, s45, 0
  global_load_dwordx4 v[224:227], v22, s[44:45] sc1
  s_add_u32 s44, s44, 32768
  s_addc_u32 s45, s45, 0
  global_load_dwordx4 v[228:231], v22, s[44:45] sc1
  s_add_u32 s44, s44, 32768
  s_addc_u32 s45, s45, 0
  global_load_dwordx4 v[168:171], v23, s[44:45] sc1
  s_add_u32 s44, s44, 32768
  s_addc_u32 s45, s45, 0
  global_load_dwordx4 v[172:175], v23, s[44:45] sc1
  s_add_u32 s44, s44, 32768
  s_addc_u32 s45, s45, 0
  global_load_dwordx4 v[232:235], v23, s[44:45] sc1
  s_add_u32 s44, s44, 32768
  s_addc_u32 s45, s45, 0
  global_load_dwordx4 v[236:239], v23, s[44:45] sc1
  s_waitcnt lgkmcnt(0)
  s_barrier
  s_waitcnt vmcnt(48)
  ds_write_b128 v21, a[0:3] offset:0
  ds_write_b128 v21, a[4:7] offset:1024
  ds_write_b128 v21, a[64:67] offset:2048
  ds_write_b128 v21, a[68:71] offset:3072
  ds_write_b128 v21, a[8:11] offset:4096
  ds_write_b128 v21, a[12:15] offset:5120
  ds_write_b128 v21, a[72:75] offset:6144
  ds_write_b128 v21, a[76:79] offset:7168
  s_waitcnt lgkmcnt(0)
  s_barrier
  ds_read_b64_tr_b16 a[0:1], v26 offset:0
  ds_read_b64_tr_b16 a[2:3], v26 offset:8192
  ds_read_b64_tr_b16 a[4:5], v26 offset:2048
  ds_read_b64_tr_b16 a[6:7], v26 offset:10240
  ds_read_b64_tr_b16 a[64:65], v27 offset:0
  ds_read_b64_tr_b16 a[66:67], v27 offset:8192
  ds_read_b64_tr_b16 a[68:69], v27 offset:2048
  ds_read_b64_tr_b16 a[70:71], v27 offset:10240
  ds_read_b64_tr_b16 a[8:9], v26 offset:16384
  ds_read_b64_tr_b16 a[10:11], v26 offset:24576
  ds_read_b64_tr_b16 a[12:13], v26 offset:18432
  ds_read_b64_tr_b16 a[14:15], v26 offset:26624
  ds_read_b64_tr_b16 a[72:73], v27 offset:16384
  ds_read_b64_tr_b16 a[74:75], v27 offset:24576
  ds_read_b64_tr_b16 a[76:77], v27 offset:18432
  ds_read_b64_tr_b16 a[78:79], v27 offset:26624
  s_lshl_b32 s12, s9, 8
  s_add_u32 s44, s66, s12
  s_addc_u32 s45, s67, 0
  s_add_u32 s44, s44, 2097152
  s_addc_u32 s45, s45, 0
  global_load_dwordx4 v[176:179], v22, s[44:45] sc1
  s_add_u32 s44, s44, 32768
  s_addc_u32 s45, s45, 0
  global_load_dwordx4 v[180:183], v22, s[44:45] sc1
  s_add_u32 s44, s44, 32768
  s_addc_u32 s45, s45, 0
  global_load_dwordx4 v[240:243], v22, s[44:45] sc1
  s_add_u32 s44, s44, 32768
  s_addc_u32 s45, s45, 0
  global_load_dwordx4 v[244:247], v22, s[44:45] sc1
  s_add_u32 s44, s44, 32768
  s_addc_u32 s45, s45, 0
  global_load_dwordx4 v[184:187], v23, s[44:45] sc1
  s_add_u32 s44, s44, 32768
  s_addc_u32 s45, s45, 0
  global_load_dwordx4 v[188:191], v23, s[44:45] sc1
  s_add_u32 s44, s44, 32768
  s_addc_u32 s45, s45, 0
  global_load_dwordx4 v[248:251], v23, s[44:45] sc1
  s_add_u32 s44, s44, 32768
  s_addc_u32 s45, s45, 0
  global_load_dwordx4 v[252:255], v23, s[44:45] sc1
  s_waitcnt lgkmcnt(0)
  s_barrier
  s_waitcnt vmcnt(48)
  ds_write_b128 v21, a[144:147] offset:0
  ds_write_b128 v21, a[148:151] offset:1024
  ds_write_b128 v21, a[208:211] offset:2048
  ds_write_b128 v21, a[212:215] offset:3072
  ds_write_b128 v21, a[152:155] offset:4096
  ds_write_b128 v21, a[156:159] offset:5120
  ds_write_b128 v21, a[216:219] offset:6144
  ds_write_b128 v21, a[220:223] offset:7168
  s_waitcnt lgkmcnt(0)
  s_barrier
  ds_read_b64_tr_b16 a[144:145], v26 offset:0
  ds_read_b64_tr_b16 a[146:147], v26 offset:8192
  ds_read_b64_tr_b16 a[148:149], v26 offset:2048
  ds_read_b64_tr_b16 a[150:151], v26 offset:10240
  ds_read_b64_tr_b16 a[208:209], v27 offset:0
  ds_read_b64_tr_b16 a[210:211], v27 offset:8192
  ds_read_b64_tr_b16 a[212:213], v27 offset:2048
  ds_read_b64_tr_b16 a[214:215], v27 offset:10240
  ds_read_b64_tr_b16 a[152:153], v26 offset:16384
  ds_read_b64_tr_b16 a[154:155], v26 offset:24576
  ds_read_b64_tr_b16 a[156:157], v26 offset:18432
  ds_read_b64_tr_b16 a[158:159], v26 offset:26624
  ds_read_b64_tr_b16 a[216:217], v27 offset:16384
  ds_read_b64_tr_b16 a[218:219], v27 offset:24576
  ds_read_b64_tr_b16 a[220:221], v27 offset:18432
  ds_read_b64_tr_b16 a[222:223], v27 offset:26624
  s_lshl_b32 s12, s9, 8
  s_add_u32 s44, s66, s12
  s_addc_u32 s45, s67, 0
  s_add_u32 s44, s44, 3145728
  s_addc_u32 s45, s45, 0
  global_load_dwordx4 v[128:131], v22, s[44:45] sc1
  s_add_u32 s44, s44, 32768
  s_addc_u32 s45, s45, 0
  global_load_dwordx4 v[132:135], v22, s[44:45] sc1
  s_add_u32 s44, s44, 32768
  s_addc_u32 s45, s45, 0
  global_load_dwordx4 v[192:195], v22, s[44:45] sc1
  s_add_u32 s44, s44, 32768
  s_addc_u32 s45, s45, 0
  global_load_dwordx4 v[196:199], v22, s[44:45] sc1
  s_add_u32 s44, s44, 32768
  s_addc_u32 s45, s45, 0
  global_load_dwordx4 v[136:139], v23, s[44:45] sc1
  s_add_u32 s44, s44, 32768
  s_addc_u32 s45, s45, 0
  global_load_dwordx4 v[140:143], v23, s[44:45] sc1
  s_add_u32 s44, s44, 32768
  s_addc_u32 s45, s45, 0
  global_load_dwordx4 v[200:203], v23, s[44:45] sc1
  s_add_u32 s44, s44, 32768
  s_addc_u32 s45, s45, 0
  global_load_dwordx4 v[204:207], v23, s[44:45] sc1
  s_waitcnt lgkmcnt(0)
  s_barrier
  s_waitcnt vmcnt(48)
  ds_write_b128 v21, a[160:163] offset:0
  ds_write_b128 v21, a[164:167] offset:1024
  ds_write_b128 v21, a[224:227] offset:2048
  ds_write_b128 v21, a[228:231] offset:3072
  ds_write_b128 v21, a[168:171] offset:4096
  ds_write_b128 v21, a[172:175] offset:5120
  ds_write_b128 v21, a[232:235] offset:6144
  ds_write_b128 v21, a[236:239] offset:7168
  s_waitcnt lgkmcnt(0)
  s_barrier
  ds_read_b64_tr_b16 a[160:161], v26 offset:0
  ds_read_b64_tr_b16 a[162:163], v26 offset:8192
  ds_read_b64_tr_b16 a[164:165], v26 offset:2048
  ds_read_b64_tr_b16 a[166:167], v26 offset:10240
  ds_read_b64_tr_b16 a[224:225], v27 offset:0
  ds_read_b64_tr_b16 a[226:227], v27 offset:8192
  ds_read_b64_tr_b16 a[228:229], v27 offset:2048
  ds_read_b64_tr_b16 a[230:231], v27 offset:10240
  ds_read_b64_tr_b16 a[168:169], v26 offset:16384
  ds_read_b64_tr_b16 a[170:171], v26 offset:24576
  ds_read_b64_tr_b16 a[172:173], v26 offset:18432
  ds_read_b64_tr_b16 a[174:175], v26 offset:26624
  ds_read_b64_tr_b16 a[232:233], v27 offset:16384
  ds_read_b64_tr_b16 a[234:235], v27 offset:24576
  ds_read_b64_tr_b16 a[236:237], v27 offset:18432
  ds_read_b64_tr_b16 a[238:239], v27 offset:26624
  s_waitcnt lgkmcnt(0)
  s_barrier
  s_waitcnt vmcnt(40)
  ds_write_b128 v21, a[176:179] offset:0
  ds_write_b128 v21, a[180:183] offset:1024
  ds_write_b128 v21, a[240:243] offset:2048
  ds_write_b128 v21, a[244:247] offset:3072
  ds_write_b128 v21, a[184:187] offset:4096
  ds_write_b128 v21, a[188:191] offset:5120
  ds_write_b128 v21, a[248:251] offset:6144
  ds_write_b128 v21, a[252:255] offset:7168
  s_waitcnt lgkmcnt(0)
  s_barrier
  ds_read_b64_tr_b16 a[176:177], v26 offset:0
  ds_read_b64_tr_b16 a[178:179], v26 offset:8192
  ds_read_b64_tr_b16 a[180:181], v26 offset:2048
  ds_read_b64_tr_b16 a[182:183], v26 offset:10240
  ds_read_b64_tr_b16 a[240:241], v27 offset:0
  ds_read_b64_tr_b16 a[242:243], v27 offset:8192
  ds_read_b64_tr_b16 a[244:245], v27 offset:2048
  ds_read_b64_tr_b16 a[246:247], v27 offset:10240
  ds_read_b64_tr_b16 a[184:185], v26 offset:16384
  ds_read_b64_tr_b16 a[186:187], v26 offset:24576
  ds_read_b64_tr_b16 a[188:189], v26 offset:18432
  ds_read_b64_tr_b16 a[190:191], v26 offset:26624
  ds_read_b64_tr_b16 a[248:249], v27 offset:16384
  ds_read_b64_tr_b16 a[250:251], v27 offset:24576
  ds_read_b64_tr_b16 a[252:253], v27 offset:18432
  ds_read_b64_tr_b16 a[254:255], v27 offset:26624
  s_waitcnt lgkmcnt(0)
  s_barrier
  s_waitcnt vmcnt(32)
  ds_write_b128 v21, a[128:131] offset:0
  ds_write_b128 v21, a[132:135] offset:1024
  ds_write_b128 v21, a[192:195] offset:2048
  ds_write_b128 v21, a[196:199] offset:3072
  ds_write_b128 v21, a[136:139] offset:4096
  ds_write_b128 v21, a[140:143] offset:5120
  ds_write_b128 v21, a[200:203] offset:6144
  ds_write_b128 v21, a[204:207] offset:7168
  s_waitcnt lgkmcnt(0)
  s_barrier
  ds_read_b64_tr_b16 a[128:129], v26 offset:0
  ds_read_b64_tr_b16 a[130:131], v26 offset:8192
  ds_read_b64_tr_b16 a[132:133], v26 offset:2048
  ds_read_b64_tr_b16 a[134:135], v26 offset:10240
  ds_read_b64_tr_b16 a[192:193], v27 offset:0
  ds_read_b64_tr_b16 a[194:195], v27 offset:8192
  ds_read_b64_tr_b16 a[196:197], v27 offset:2048
  ds_read_b64_tr_b16 a[198:199], v27 offset:10240
  ds_read_b64_tr_b16 a[136:137], v26 offset:16384
  ds_read_b64_tr_b16 a[138:139], v26 offset:24576
  ds_read_b64_tr_b16 a[140:141], v26 offset:18432
  ds_read_b64_tr_b16 a[142:143], v26 offset:26624
  ds_read_b64_tr_b16 a[200:201], v27 offset:16384
  ds_read_b64_tr_b16 a[202:203], v27 offset:24576
  ds_read_b64_tr_b16 a[204:205], v27 offset:18432
  ds_read_b64_tr_b16 a[206:207], v27 offset:26624
  s_waitcnt lgkmcnt(0)
  s_barrier
  s_waitcnt vmcnt(24)
  ds_write_b128 v21, v[144:147] offset:0
  ds_write_b128 v21, v[148:151] offset:1024
  ds_write_b128 v21, v[208:211] offset:2048
  ds_write_b128 v21, v[212:215] offset:3072
  ds_write_b128 v21, v[152:155] offset:4096
  ds_write_b128 v21, v[156:159] offset:5120
  ds_write_b128 v21, v[216:219] offset:6144
  ds_write_b128 v21, v[220:223] offset:7168
  s_waitcnt lgkmcnt(0)
  s_barrier
  ds_read_b64_tr_b16 v[144:145], v26 offset:0
  ds_read_b64_tr_b16 v[146:147], v26 offset:8192
  ds_read_b64_tr_b16 v[148:149], v26 offset:2048
  ds_read_b64_tr_b16 v[150:151], v26 offset:10240
  ds_read_b64_tr_b16 v[208:209], v27 offset:0
  ds_read_b64_tr_b16 v[210:211], v27 offset:8192
  ds_read_b64_tr_b16 v[212:213], v27 offset:2048
  ds_read_b64_tr_b16 v[214:215], v27 offset:10240
  ds_read_b64_tr_b16 v[152:153], v26 offset:16384
  ds_read_b64_tr_b16 v[154:155], v26 offset:24576
  ds_read_b64_tr_b16 v[156:157], v26 offset:18432
  ds_read_b64_tr_b16 v[158:159], v26 offset:26624
  ds_read_b64_tr_b16 v[216:217], v27 offset:16384
  ds_read_b64_tr_b16 v[218:219], v27 offset:24576
  ds_read_b64_tr_b16 v[220:221], v27 offset:18432
  ds_read_b64_tr_b16 v[222:223], v27 offset:26624
  s_waitcnt lgkmcnt(0)
  s_barrier
  s_waitcnt vmcnt(16)
  ds_write_b128 v21, v[160:163] offset:0
  ds_write_b128 v21, v[164:167] offset:1024
  ds_write_b128 v21, v[224:227] offset:2048
  ds_write_b128 v21, v[228:231] offset:3072
  ds_write_b128 v21, v[168:171] offset:4096
  ds_write_b128 v21, v[172:175] offset:5120
  ds_write_b128 v21, v[232:235] offset:6144
  ds_write_b128 v21, v[236:239] offset:7168
  s_waitcnt lgkmcnt(0)
  s_barrier
  ds_read_b64_tr_b16 v[160:161], v26 offset:0
  ds_read_b64_tr_b16 v[162:163], v26 offset:8192
  ds_read_b64_tr_b16 v[164:165], v26 offset:2048
  ds_read_b64_tr_b16 v[166:167], v26 offset:10240
  ds_read_b64_tr_b16 v[224:225], v27 offset:0
  ds_read_b64_tr_b16 v[226:227], v27 offset:8192
  ds_read_b64_tr_b16 v[228:229], v27 offset:2048
  ds_read_b64_tr_b16 v[230:231], v27 offset:10240
  ds_read_b64_tr_b16 v[168:169], v26 offset:16384
  ds_read_b64_tr_b16 v[170:171], v26 offset:24576
  ds_read_b64_tr_b16 v[172:173], v26 offset:18432
  ds_read_b64_tr_b16 v[174:175], v26 offset:26624
  ds_read_b64_tr_b16 v[232:233], v27 offset:16384
  ds_read_b64_tr_b16 v[234:235], v27 offset:24576
  ds_read_b64_tr_b16 v[236:237], v27 offset:18432
  ds_read_b64_tr_b16 v[238:239], v27 offset:26624
  s_waitcnt lgkmcnt(0)
  s_barrier
  v_lshrrev_b32 v104, 2, v0
  v_and_b32 v104, 0x1c, v104
  v_bfe_u32 v103, v0, 4, 1
  v_lshl_add_u32 v103, v103, 11, s54
  v_add_u32 v105, 16384, v103
  v_add_u32 v106, 32768, v103
  global_load_dword v100, v104, s[6:7] sc1
  global_load_dword v101, v103, s[58:59] sc1
  global_load_dword v102, v105, s[58:59] sc1
  global_load_dword v5, v106, s[58:59] sc1
  s_waitcnt vmcnt(12)
  ds_write_b128 v21, v[176:179] offset:0
  ds_write_b128 v21, v[180:183] offset:1024
  ds_write_b128 v21, v[240:243] offset:2048
  ds_write_b128 v21, v[244:247] offset:3072
  ds_write_b128 v21, v[184:187] offset:4096
  ds_write_b128 v21, v[188:191] offset:5120
  ds_write_b128 v21, v[248:251] offset:6144
  ds_write_b128 v21, v[252:255] offset:7168
  s_waitcnt lgkmcnt(0)
  s_barrier
  ds_read_b64_tr_b16 v[176:177], v26 offset:0
  ds_read_b64_tr_b16 v[178:179], v26 offset:8192
  ds_read_b64_tr_b16 v[180:181], v26 offset:2048
  ds_read_b64_tr_b16 v[182:183], v26 offset:10240
  ds_read_b64_tr_b16 v[240:241], v27 offset:0
  ds_read_b64_tr_b16 v[242:243], v27 offset:8192
  ds_read_b64_tr_b16 v[244:245], v27 offset:2048
  ds_read_b64_tr_b16 v[246:247], v27 offset:10240
  ds_read_b64_tr_b16 v[184:185], v26 offset:16384
  ds_read_b64_tr_b16 v[186:187], v26 offset:24576
  ds_read_b64_tr_b16 v[188:189], v26 offset:18432
  ds_read_b64_tr_b16 v[190:191], v26 offset:26624
  ds_read_b64_tr_b16 v[248:249], v27 offset:16384
  ds_read_b64_tr_b16 v[250:251], v27 offset:24576
  ds_read_b64_tr_b16 v[252:253], v27 offset:18432
  ds_read_b64_tr_b16 v[254:255], v27 offset:26624
  s_waitcnt lgkmcnt(0)
  s_barrier
  s_waitcnt vmcnt(4)
  ds_write_b128 v21, v[128:131] offset:0
  ds_write_b128 v21, v[132:135] offset:1024
  ds_write_b128 v21, v[192:195] offset:2048
  ds_write_b128 v21, v[196:199] offset:3072
  ds_write_b128 v21, v[136:139] offset:4096
  ds_write_b128 v21, v[140:143] offset:5120
  ds_write_b128 v21, v[200:203] offset:6144
  ds_write_b128 v21, v[204:207] offset:7168
  s_waitcnt lgkmcnt(0)
  s_barrier
  ds_read_b64_tr_b16 v[128:129], v26 offset:0
  ds_read_b64_tr_b16 v[130:131], v26 offset:8192
  ds_read_b64_tr_b16 v[132:133], v26 offset:2048
  ds_read_b64_tr_b16 v[134:135], v26 offset:10240
  ds_read_b64_tr_b16 v[192:193], v27 offset:0
  ds_read_b64_tr_b16 v[194:195], v27 offset:8192
  ds_read_b64_tr_b16 v[196:197], v27 offset:2048
  ds_read_b64_tr_b16 v[198:199], v27 offset:10240
  ds_read_b64_tr_b16 v[136:137], v26 offset:16384
  ds_read_b64_tr_b16 v[138:139], v26 offset:24576
  ds_read_b64_tr_b16 v[140:141], v26 offset:18432
  ds_read_b64_tr_b16 v[142:143], v26 offset:26624
  ds_read_b64_tr_b16 v[200:201], v27 offset:16384
  ds_read_b64_tr_b16 v[202:203], v27 offset:24576
  ds_read_b64_tr_b16 v[204:205], v27 offset:18432
  ds_read_b64_tr_b16 v[206:207], v27 offset:26624
  s_waitcnt lgkmcnt(0)
  s_barrier
  s_waitcnt lgkmcnt(0)
  s_barrier
  s_branch L_wdone_2
L_wdone_2:
  s_lshl_b32 s12, s9, 13
  s_add_u32 s32, s4, s12
  s_addc_u32 s33, s5, 0
  s_add_u32 s34, s32, 16777216
  s_addc_u32 s35, s33, 0
  s_and_b32 s12, s8, 1
  s_lshl_b32 s12, s12, 24
  s_add_u32 s48, s32, s12
  s_addc_u32 s49, s33, 0
  s_add_u32 s48, s48, 262144
  s_addc_u32 s49, s49, 0
  s_add_u32 s36, s4, 71303168
  s_addc_u32 s37, s5, 0
  s_mov_b32 s42, 0
  s_mov_b32 s11, 0
  s_mov_b32 s56, -1
  v_cmp_gt_u32 vcc, 256, v99
  s_nop 0
  s_cbranch_vccz L_cfo_8
  s_waitcnt vmcnt(0)
  v_mov_b32 v101, 0
  v_mov_b32 v24, 16
L_cfi_7:
  global_load_dword v25, v24, s[6:7] sc1
  s_add_u32 s42, s42, 1
  s_cmp_gt_u32 s42, 0x40000
  s_cbranch_scc1 L_chain_abort
  s_waitcnt vmcnt(0)
  v_cmp_gt_u32 vcc, 256, v25
  s_nop 0
  s_cbranch_vccnz L_cfi_7
L_cfo_8:
  s_waitcnt vmcnt(0)
  s_branch L_wchk_10
L_winit_9:
  global_load_dword v100, v104, s[6:7] sc1
  global_load_dword v101, v103, s[58:59] sc1
  global_load_dword v102, v105, s[58:59] sc1
  global_load_dword v5, v106, s[58:59] sc1
  s_add_u32 s42, s42, 1
  s_cmp_gt_u32 s42, 0x40000
  s_cbranch_scc1 L_chain_abort
  s_waitcnt vmcnt(0)
L_wchk_10:
  v_readlane_b32 s12, v100, 1
  v_readlane_b32 s57, v100, 3
  s_cmp_lt_u32 s12, 32
  s_cbranch_scc1 L_winit_9
  v_cmp_ne_u32 vcc, 0, v101
  s_nop 0
  s_and_b32 s12, vcc_lo, s56
  v_cmp_ne_u32 vcc, 0, v102
  s_nop 0
  s_and_b32 s12, s12, vcc_lo
  s_cmp_eq_u32 s12, s56
  s_cbranch_scc0 L_winit_9
  s_add_u32 s58, s58, 49152
  s_addc_u32 s59, s59, 0
  s_mov_b32 s11, s56
  s_add_u32 s48, s48, 262144
  s_addc_u32 s49, s49, 0
  s_bcnt1_i32_b32 s57, s57
  s_add_u32 m0, s50, 143360
  s_nop 0
  global_load_lds_dwordx4 v2, s[32:33] sc1
  global_load_lds_dwordx4 v2, s[32:33] offset:1024 sc1
  s_add_u32 m0, s50, 151552
  s_nop 0
  global_load_lds_dwordx4 v2, s[34:35] sc1
  global_load_lds_dwordx4 v2, s[34:35] offset:1024 sc1
  s_add_u32 s32, s32, 262144
  s_addc_u32 s33, s33, 0
  s_add_u32 s34, s34, 262144
  s_addc_u32 s35, s35, 0
  s_cmp_lg_u32 s8, 0
  s_cbranch_scc1 L_cw_11
  v_mov_b32 v24, 20
  v_mov_b32 v25, 1
  s_mov_b64 exec, 1
  global_atomic_add v24, v25, s[6:7]
  s_mov_b64 exec, -1
L_cw_11:
  s_mov_b32 s10, 0
  s_mov_b32 s42, 0
  s_and_b32 s43, s10, 1
  s_lshl_b32 s13, s43, 13
  s_add_u32 s13, s13, 69206016
  s_add_u32 s26, s4, s13
  s_addc_u32 s27, s5, 0
  s_xor_b32 s13, s13, 8192
  s_add_u32 s24, s4, s13
  s_addc_u32 s25, s5, 0
  v_mfma_f32_32x32x8_bf16 v[96:111], v[6:7], v[6:7], 0
  v_pk_mov_b32 v[112:113], 0, 0
  v_pk_mov_b32 v[114:115], 0, 0
  v_pk_mov_b32 v[116:117], 0, 0
  v_pk_mov_b32 v[118:119], 0, 0
  v_add_u32 v24, s50, v3
  v_add_u32 v25, s51, v3
  v_add_u32 v26, s52, v3
  v_add_u32 v27, s53, v3
  s_barrier
  s_cmp_lg_u32 s57, 1
  s_cbranch_scc1 L_main_slow
  s_cmp_eq_u32 s8, 2
  s_cbranch_scc1 L_step_fast_f2
  s_cmp_eq_u32 s8, 3
  s_cbranch_scc1 L_step_fast_f3
L_step_fast_n:
  s_nop 9
  global_load_dwordx4 v[32:35], v2, s[26:27] sc1
  global_load_dwordx4 v[36:39], v2, s[26:27] offset:1024 sc1
  s_nop 15
  s_nop 8
L_pollm_fast_n:
  global_load_dwordx4 v[64:67], v2, s[26:27] sc1
  global_load_dwordx4 v[68:71], v2, s[26:27] offset:1024 sc1
  s_waitcnt vmcnt(2)
  v_max3_u32 v124, v32, v33, v34
  v_max3_u32 v125, v35, v36, v37
  v_max3_u32 v124, v124, v38, v39
  v_max_u32 v124, v124, v125
  v_cmp_eq_u32 vcc, -1, v124
  s_nop 0
  s_cbranch_vccz L_gotm_fast_n
  global_load_dwordx4 v[32:35], v2, s[26:27] sc1
  global_load_dwordx4 v[36:39], v2, s[26:27] offset:1024 sc1
  s_add_u32 s42, s42, 1
  s_cmp_gt_u32 s42, 0x40000
  s_cbranch_scc1 L_chain_abort
  s_waitcnt vmcnt(2)
  v_max3_u32 v124, v64, v65, v66
  v_max3_u32 v125, v67, v68, v69
  v_max3_u32 v124, v124, v70, v71
  v_max_u32 v124, v124, v125
  v_cmp_eq_u32 vcc, -1, v124
  s_nop 0
  s_cbranch_vccnz L_pollm2_fast_n
  v_pk_mov_b32 v[32:33], v[64:65], v[64:65] op_sel:[0,1]
  v_pk_mov_b32 v[34:35], v[66:67], v[66:67] op_sel:[0,1]
  v_pk_mov_b32 v[36:37], v[68:69], v[68:69] op_sel:[0,1]
  v_pk_mov_b32 v[38:39], v[70:71], v[70:71] op_sel:[0,1]
  s_branch L_gotm2_fast_n
L_pollm2_fast_n:
  s_branch L_pollm_fast_n
L_gotm_fast_n:
L_gotm2_fast_n:
  ds_write_b128 v24, v[32:35]
  v_smfmac_f32_16x16x64_bf16 v[96:99], v[32:35], a[128:135], v1
  ds_write_b128 v24, v[36:39] offset:1024
  v_smfmac_f32_16x16x64_bf16 v[100:103], v[32:35], a[0:7], v1
  v_smfmac_f32_16x16x64_bf16 v[104:107], v[32:35], a[192:199], v1
  v_smfmac_f32_16x16x64_bf16 v[108:111], v[32:35], a[64:71], v1
  v_smfmac_f32_16x16x64_bf16 v[112:115], v[32:35], v[128:135], v1
  v_smfmac_f32_16x16x64_bf16 v[116:119], v[32:35], v[192:199], v1
  s_waitcnt lgkmcnt(0)
  s_barrier
  ds_read_b128 v[40:43], v25
  ds_read_b128 v[44:47], v25 offset:1024
  v_smfmac_f32_16x16x64_bf16 v[96:99], v[36:39], a[136:143], v1
  ds_read_b128 v[48:51], v26
  v_smfmac_f32_16x16x64_bf16 v[100:103], v[36:39], a[8:15], v1
  ds_read_b128 v[52:55], v26 offset:1024
  v_smfmac_f32_16x16x64_bf16 v[104:107], v[36:39], a[200:207], v1
  ds_read_b128 v[56:59], v27
  v_smfmac_f32_16x16x64_bf16 v[108:111], v[36:39], a[72:79], v1
  ds_read_b128 v[60:63], v27 offset:1024
  v_smfmac_f32_16x16x64_bf16 v[112:115], v[36:39], v[136:143], v1
  v_smfmac_f32_16x16x64_bf16 v[116:119], v[36:39], v[200:207], v1
  s_waitcnt lgkmcnt(4)
  v_smfmac_f32_16x16x64_bf16 v[96:99], v[40:43], a[144:151], v1
  v_smfmac_f32_16x16x64_bf16 v[100:103], v[40:43], a[16:23], v1
  v_smfmac_f32_16x16x64_bf16 v[104:107], v[40:43], a[208:215], v1
  v_smfmac_f32_16x16x64_bf16 v[108:111], v[40:43], a[80:87], v1
  v_smfmac_f32_16x16x64_bf16 v[96:99], v[44:47], a[152:159], v1
  v_smfmac_f32_16x16x64_bf16 v[100:103], v[44:47], a[24:31], v1
  v_smfmac_f32_16x16x64_bf16 v[104:107], v[44:47], a[216:223], v1
  v_smfmac_f32_16x16x64_bf16 v[108:111], v[44:47], a[88:95], v1
  s_waitcnt lgkmcnt(0)
  v_smfmac_f32_16x16x64_bf16 v[96:99], v[48:51], a[160:167], v1
  s_waitcnt vmcnt(0)
  ds_read_b128 v[64:67], v3 offset:8192
  v_smfmac_f32_16x16x64_bf16 v[100:103], v[48:51], a[32:39], v1
  ds_read_b128 v[80:83], v3 offset:12288
  v_smfmac_f32_16x16x64_bf16 v[104:107], v[48:51], a[224:231], v1
  ds_read_b128 v[68:71], v3 offset:9216
  v_smfmac_f32_16x16x64_bf16 v[108:111], v[48:51], a[96:103], v1
  ds_read_b128 v[84:87], v3 offset:13312
  v_smfmac_f32_16x16x64_bf16 v[96:99], v[52:55], a[168:175], v1
  ds_read_b128 v[72:75], v3 offset:10240
  v_smfmac_f32_16x16x64_bf16 v[100:103], v[52:55], a[40:47], v1
  ds_read_b128 v[88:91], v3 offset:14336
  v_smfmac_f32_16x16x64_bf16 v[104:107], v[52:55], a[232:239], v1
  ds_read_b128 v[76:79], v3 offset:11264
  v_smfmac_f32_16x16x64_bf16 v[108:111], v[52:55], a[104:111], v1
  ds_read_b128 v[92:95], v3 offset:15360
  v_smfmac_f32_16x16x64_bf16 v[96:99], v[56:59], a[176:183], v1
  v_smfmac_f32_16x16x64_bf16 v[100:103], v[56:59], a[48:55], v1
  v_smfmac_f32_16x16x64_bf16 v[104:107], v[56:59], a[240:247], v1
  v_smfmac_f32_16x16x64_bf16 v[108:111], v[56:59], a[112:119], v1
  v_smfmac_f32_16x16x64_bf16 v[96:99], v[60:63], a[184:191], v1
  v_smfmac_f32_16x16x64_bf16 v[100:103], v[60:63], a[56:63], v1
  v_smfmac_f32_16x16x64_bf16 v[104:107], v[60:63], a[248:255], v1
  v_smfmac_f32_16x16x64_bf16 v[108:111], v[60:63], a[120:127], v1
  v_smfmac_f32_16x16x64_bf16 v[112:115], v[40:43], v[144:151], v1
  v_smfmac_f32_16x16x64_bf16 v[116:119], v[40:43], v[208:215], v1
  v_pk_add_f32 v[96:97], v[96:97], v[98:99]
  v_pk_add_f32 v[100:101], v[100:101], v[102:103]
  v_pk_add_f32 v[104:105], v[104:105], v[106:107]
  v_cvt_pk_bf16_f32 v124, v96, v97
  v_cvt_pk_bf16_f32 v125, v100, v101
  v_pk_add_f32 v[108:109], v[108:109], v[110:111]
  ds_write_b64 v11, v[124:125]
  v_cvt_pk_bf16_f32 v126, v104, v105
  v_cvt_pk_bf16_f32 v127, v108, v109
  ds_write_b64 v11, v[126:127] offset:512
  v_smfmac_f32_16x16x64_bf16 v[112:115], v[44:47], v[152:159], v1
  v_smfmac_f32_16x16x64_bf16 v[116:119], v[44:47], v[216:223], v1
  v_smfmac_f32_16x16x64_bf16 v[112:115], v[48:51], v[160:167], v1
  v_smfmac_f32_16x16x64_bf16 v[116:119], v[48:51], v[224:231], v1
  v_smfmac_f32_16x16x64_bf16 v[112:115], v[52:55], v[168:175], v1
  v_smfmac_f32_16x16x64_bf16 v[116:119], v[52:55], v[232:239], v1
  s_waitcnt lgkmcnt(0)
  s_barrier
  ds_read_b64_tr_b16 v[96:97], v12 offset:0
  ds_read_b64_tr_b16 v[98:99], v13 offset:0
  ds_read_b64_tr_b16 v[100:101], v12 offset:1024
  ds_read_b64_tr_b16 v[102:103], v13 offset:1024
  ds_read_b64_tr_b16 v[104:105], v12 offset:2048
  ds_read_b64_tr_b16 v[106:107], v13 offset:2048
  ds_read_b64_tr_b16 v[108:109], v12 offset:3072
  ds_read_b64_tr_b16 v[110:111], v13 offset:3072
  v_smfmac_f32_16x16x64_bf16 v[112:115], v[56:59], v[176:183], v1
  v_smfmac_f32_16x16x64_bf16 v[116:119], v[56:59], v[240:247], v1
  v_smfmac_f32_16x16x64_bf16 v[112:115], v[60:63], v[184:191], v1
  v_smfmac_f32_16x16x64_bf16 v[116:119], v[60:63], v[248:255], v1
  s_waitcnt lgkmcnt(4)
  v_mfma_f32_16x16x32_bf16 v[24:27], v[64:67], v[96:99], 0
  v_mov_b32 v126, 0x3f803f80
  v_mfma_f32_16x16x32_bf16 v[28:31], v[80:83], v[96:99], 0
  ds_read_b128 v[32:35], v16 offset:0
  v_mfma_f32_16x16x32_bf16 v[120:123], v[96:99], v[96:99], 0
  ds_read_b128 v[36:39], v16 offset:32768
  v_mfma_f32_16x16x32_bf16 v[24:27], v[68:71], v[100:103], v[24:27]
  ds_read_b128 v[40:43], v17 offset:0
  v_mfma_f32_16x16x32_bf16 v[28:31], v[84:87], v[100:103], v[28:31]
  ds_read_b128 v[44:47], v17 offset:32768
  v_mfma_f32_16x16x32_bf16 v[120:123], v[100:103], v[100:103], v[120:123]
  v_pk_add_f32 v[112:113], v[112:113], v[114:115]
  s_waitcnt lgkmcnt(4)
  v_mfma_f32_16x16x32_bf16 v[24:27], v[72:75], v[104:107], v[24:27]
  v_pk_add_f32 v[116:117], v[116:117], v[118:119]
  ds_read_b128 v[64:67], v4
  v_mfma_f32_16x16x32_bf16 v[28:31], v[88:91], v[104:107], v[28:31]
  v_cvt_pk_bf16_f32 v20, v112, v113
  ds_read_b128 v[68:71], v4 offset:1024
  v_mfma_f32_16x16x32_bf16 v[120:123], v[104:107], v[104:107], v[120:123]
  v_cvt_pk_bf16_f32 v21, v116, v117
  v_mov_b32 v127, 0x3f803f80
  v_mfma_f32_16x16x32_bf16 v[24:27], v[76:79], v[108:111], v[24:27]
  v_cvt_pk_bf16_f32 v22, v116, v117
  v_mfma_f32_16x16x32_bf16 v[28:31], v[92:95], v[108:111], v[28:31]
  v_cvt_pk_bf16_f32 v23, v112, v113
  v_mfma_f32_16x16x32_bf16 v[120:123], v[108:111], v[108:111], v[120:123]
  ds_read_b128 v[48:51], v16 offset:1024
  s_cmp_eq_u32 s10, 63
  s_cbranch_scc1 L_chain_done
  ds_read_b128 v[52:55], v16 offset:33792
  v_max3_f32 v124, v24, v25, v26
  v_max3_f32 v125, v27, v28, v29
  v_max3_f32 v124, v124, v30, v31
  s_nop 0
  v_max3_f32 v125, v125, v120, v121
  v_max_f32 v124, v124, v125
  v_max_f32 v125, v124, v125
  ds_read_b128 v[56:59], v17 offset:1024
  s_nop 0
  v_permlane16_swap_b32 v124, v125
  v_max_f32 v124, v124, v125
  v_mov_b32 v125, v124
  ds_read_b128 v[60:63], v17 offset:33792
  s_nop 0
  v_permlane32_swap_b32 v124, v125
  v_max_f32 v124, v124, v125
  v_mul_f32 v124, s41, v124
  v_pk_fma_f32 v[24:25], v[24:25], s[40:41], v[124:125] op_sel_hi:[1,0,0]
  v_pk_fma_f32 v[26:27], v[26:27], s[40:41], v[124:125] op_sel_hi:[1,0,0]
  v_pk_fma_f32 v[28:29], v[28:29], s[40:41], v[124:125] op_sel_hi:[1,0,0]
  v_pk_fma_f32 v[30:31], v[30:31], s[40:41], v[124:125] op_sel_hi:[1,0,0]
  v_pk_fma_f32 v[120:121], v[120:121], s[40:41], v[124:125] op_sel_hi:[1,0,0]
  v_exp_f32 v24, v24
  v_exp_f32 v25, v25
  v_exp_f32 v26, v26
  v_exp_f32 v27, v27
  v_exp_f32 v28, v28
  v_exp_f32 v29, v29
  v_cvt_pk_bf16_f32 v72, v24, v25
  v_exp_f32 v30, v30
  v_exp_f32 v31, v31
  v_cvt_pk_bf16_f32 v73, v26, v27
  v_cvt_pk_bf16_f32 v74, v28, v29
  v_exp_f32 v120, v120
  v_cvt_pk_bf16_f32 v75, v30, v31
  v_exp_f32 v121, v121
  s_nop 0
  v_cvt_pk_bf16_f32 v18, v120, v121
  s_waitcnt lgkmcnt(4)
  v_mfma_f32_16x16x16_bf16 v[120:123], v[126:127], v[72:73], 0
  v_mfma_f32_16x16x16_bf16 v[120:123], v[126:127], v[74:75], v[120:123]
  v_mfma_f32_16x16x16_bf16 v[120:123], v[126:127], v[18:19], v[120:123]
  v_mfma_f32_16x16x32_bf16 v[80:83], v[64:67], v[72:75], 0
  ds_read_b128 v[112:115], v16 offset:2048
  v_mfma_f32_16x16x32_bf16 v[84:87], v[68:71], v[72:75], 0
  ds_read_b128 v[116:119], v16 offset:34816
  v_mfma_f32_16x16x16_bf16 v[80:83], v[20:21], v[18:19], v[80:83]
  v_rcp_f32 v124, v120
  v_mfma_f32_16x16x16_bf16 v[84:87], v[22:23], v[18:19], v[84:87]
  s_nop 4
  v_pk_mul_f32 v[80:81], v[80:81], v[124:125] op_sel_hi:[1,0]
  v_pk_mul_f32 v[82:83], v[82:83], v[124:125] op_sel_hi:[1,0]
  s_nop 0
  v_pk_mul_f32 v[84:85], v[84:85], v[124:125] op_sel_hi:[1,0]
  v_pk_mul_f32 v[86:87], v[86:87], v[124:125] op_sel_hi:[1,0]
  v_cvt_pk_bf16_f32 v24, v80, v81
  v_cvt_pk_bf16_f32 v25, v82, v83
  v_cvt_pk_bf16_f32 v26, v84, v85
  v_cvt_pk_bf16_f32 v27, v86, v87
  ds_write2_b64 v14, v[24:25], v[26:27] offset0:0 offset1:4
  v_mfma_f32_32x32x8_bf16 v[64:79], v[6:7], v[6:7], 0
  ds_read_b128 v[96:99], v17 offset:2048
  ds_read_b128 v[100:103], v17 offset:34816
  v_mfma_f32_32x32x8_bf16 v[80:95], v[6:7], v[6:7], 0
  ds_read_b128 v[104:107], v16 offset:3072
  ds_read_b128 v[108:111], v16 offset:35840
  s_waitcnt lgkmcnt(4)
  s_barrier
  ds_read_b128 v[24:27], v15
  ds_read_b128 v[28:31], v15 offset:128
  ds_read_b128 v[120:123], v17 offset:3072
  ds_read_b128 v[124:127], v17 offset:35840
  s_add_u32 m0, s50, 143360
  s_nop 0
  global_load_lds_dwordx4 v2, s[32:33] sc1
  global_load_lds_dwordx4 v2, s[32:33] offset:1024 sc1
  s_add_u32 m0, s50, 151552
  s_nop 0
  global_load_lds_dwordx4 v2, s[34:35] sc1
  global_load_lds_dwordx4 v2, s[34:35] offset:1024 sc1
  s_waitcnt lgkmcnt(2)
  v_smfmac_f32_16x16x64_bf16 v[64:67], v[24:27], v[32:39], v1
  ds_read_b128 v[32:35], v16 offset:4096
  ds_read_b128 v[36:39], v16 offset:36864
  v_smfmac_f32_16x16x64_bf16 v[64:67], v[28:31], v[40:47], v1
  ds_read_b128 v[40:43], v17 offset:4096
  ds_read_b128 v[44:47], v17 offset:36864
  v_smfmac_f32_16x16x64_bf16 v[68:71], v[24:27], v[48:55], v1
  ds_read_b128 v[48:51], v16 offset:5120
  ds_read_b128 v[52:55], v16 offset:37888
  v_smfmac_f32_16x16x64_bf16 v[68:71], v[28:31], v[56:63], v1
  ds_read_b128 v[56:59], v17 offset:5120
  ds_read_b128 v[60:63], v17 offset:37888
  v_pk_add_f32 v[64:65], v[64:65], v[66:67]
  v_cvt_pk_bf16_f32 v20, v64, v65
  v_smfmac_f32_16x16x64_bf16 v[72:75], v[24:27], v[112:119], v1
  ds_read_b128 v[112:115], v16 offset:6144
  ds_read_b128 v[116:119], v16 offset:38912
  v_smfmac_f32_16x16x64_bf16 v[72:75], v[28:31], v[96:103], v1
  ds_read_b128 v[96:99], v17 offset:6144
  ds_read_b128 v[100:103], v17 offset:38912
  v_pk_add_f32 v[68:69], v[68:69], v[70:71]
  v_cvt_pk_bf16_f32 v21, v68, v69
  v_smfmac_f32_16x16x64_bf16 v[76:79], v[24:27], v[104:111], v1
  ds_read_b128 v[104:107], v16 offset:7168
  ds_read_b128 v[108:111], v16 offset:39936
  s_waitcnt lgkmcnt(12)
  v_smfmac_f32_16x16x64_bf16 v[76:79], v[28:31], v[120:127], v1
  ds_read_b128 v[120:123], v17 offset:7168
  ds_read_b128 v[124:127], v17 offset:39936
  v_pk_add_f32 v[72:73], v[72:73], v[74:75]
  v_cvt_pk_bf16_f32 v22, v72, v73
  v_smfmac_f32_16x16x64_bf16 v[80:83], v[24:27], v[32:39], v1
  s_waitcnt lgkmcnt(10)
  v_smfmac_f32_16x16x64_bf16 v[80:83], v[28:31], v[40:47], v1
  v_pk_add_f32 v[76:77], v[76:77], v[78:79]
  v_cvt_pk_bf16_f32 v23, v76, v77
  v_bfi_b32 v20, 1, s43, v20
  global_store_dwordx4 v8, v[20:23], s[28:29]
  v_smfmac_f32_16x16x64_bf16 v[84:87], v[24:27], v[48:55], v1
  s_waitcnt lgkmcnt(6)
  v_smfmac_f32_16x16x64_bf16 v[84:87], v[28:31], v[56:63], v1
  v_pk_add_f32 v[80:81], v[80:81], v[82:83]
  v_cvt_pk_bf16_f32 v64, v80, v81
  v_smfmac_f32_16x16x64_bf16 v[88:91], v[24:27], v[112:119], v1
  s_waitcnt lgkmcnt(2)
  v_smfmac_f32_16x16x64_bf16 v[88:91], v[28:31], v[96:103], v1
  s_nop 0
  v_pk_add_f32 v[84:85], v[84:85], v[86:87]
  v_cvt_pk_bf16_f32 v65, v84, v85
  v_smfmac_f32_16x16x64_bf16 v[92:95], v[24:27], v[104:111], v1
  s_waitcnt lgkmcnt(0)
  v_smfmac_f32_16x16x64_bf16 v[92:95], v[28:31], v[120:127], v1
  s_nop 0
  v_pk_add_f32 v[88:89], v[88:89], v[90:91]
  v_cvt_pk_bf16_f32 v66, v88, v89
  v_bfi_b32 v64, 1, s43, v64
  s_nop 3
  v_pk_add_f32 v[92:93], v[92:93], v[94:95]
  v_cvt_pk_bf16_f32 v67, v92, v93
  global_store_dwordx4 v8, v[64:67], s[30:31]
  s_add_u32 s32, s32, 262144
  s_addc_u32 s33, s33, 0
  s_add_u32 s34, s34, 262144
  s_addc_u32 s35, s35, 0
  s_add_u32 s10, s10, 1
  v_mfma_f32_32x32x8_bf16 v[96:111], v[6:7], v[6:7], 0
  v_pk_mov_b32 v[112:113], 0, 0
  v_pk_mov_b32 v[114:115], 0, 0
  v_pk_mov_b32 v[116:117], 0, 0
  v_pk_mov_b32 v[118:119], 0, 0
  v_add_u32 v24, s50, v3
  v_add_u32 v25, s51, v3
  v_add_u32 v26, s52, v3
  v_add_u32 v27, s53, v3
  v_bfe_u32 v36, v0, 4, 3
  v_mov_b32 v37, 0x3f80
  v_mov_b32 v38, 0x3f800000
  v_cmp_eq_u32 vcc, 0, v36
  s_nop 1
  v_cndmask_b32 v32, 0, v37, vcc
  v_cmp_eq_u32 vcc, 1, v36
  s_nop 1
  v_cndmask_b32 v32, v32, v38, vcc
  v_cmp_eq_u32 vcc, 2, v36
  s_nop 1
  v_cndmask_b32 v33, 0, v37, vcc
  v_cmp_eq_u32 vcc, 3, v36
  s_nop 1
  v_cndmask_b32 v33, v33, v38, vcc
  v_cmp_eq_u32 vcc, 4, v36
  s_nop 1
  v_cndmask_b32 v34, 0, v37, vcc
  v_cmp_eq_u32 vcc, 5, v36
  s_nop 1
  v_cndmask_b32 v34, v34, v38, vcc
  v_cmp_eq_u32 vcc, 6, v36
  s_nop 1
  v_cndmask_b32 v35, 0, v37, vcc
  v_cmp_eq_u32 vcc, 7, v36
  s_nop 1
  v_cndmask_b32 v35, v35, v38, vcc
  s_nop 4
  global_load_dwordx4 v[68:71], v9, s[28:29] offset:0 sc1
  global_load_dwordx4 v[72:75], v9, s[28:29] offset:1024 sc1
  global_load_dwordx4 v[76:79], v9, s[28:29] offset:2048 sc1
  global_load_dwordx4 v[80:83], v9, s[28:29] offset:3072 sc1
  s_nop 15
  s_nop 15
  s_nop 7
L_pollp_fast_n:
  global_load_dwordx4 v[40:43], v9, s[28:29] offset:0 sc1
  global_load_dwordx4 v[44:47], v9, s[28:29] offset:1024 sc1
  global_load_dwordx4 v[48:51], v9, s[28:29] offset:2048 sc1
  global_load_dwordx4 v[52:55], v9, s[28:29] offset:3072 sc1
  s_waitcnt vmcnt(4)
  v_mfma_f32_16x16x32_bf16 v[84:87], v[32:35], v[68:71], 0
  v_mfma_f32_16x16x32_bf16 v[84:87], v[32:35], v[72:75], v[84:87]
  v_mfma_f32_16x16x32_bf16 v[84:87], v[32:35], v[76:79], v[84:87]
  v_mfma_f32_16x16x32_bf16 v[84:87], v[32:35], v[80:83], v[84:87]
  v_bitop3_b32 v124, v68, v72, s43 bitop3:0x7e
  v_bitop3_b32 v125, v76, v80, s43 bitop3:0x7e
  v_bitop3_b32 v124, v124, v125, 1 bitop3:0xa8
  v_cmp_ne_u32 vcc, 0, v124
  s_nop 0
  s_cbranch_vccz L_gotp_fast_n
  global_load_dwordx4 v[68:71], v9, s[28:29] offset:0 sc1
  global_load_dwordx4 v[72:75], v9, s[28:29] offset:1024 sc1
  global_load_dwordx4 v[76:79], v9, s[28:29] offset:2048 sc1
  global_load_dwordx4 v[80:83], v9, s[28:29] offset:3072 sc1
  s_add_u32 s42, s42, 1
  s_cmp_gt_u32 s42, 0x40000
  s_cbranch_scc1 L_chain_abort
  s_waitcnt vmcnt(4)
  v_mfma_f32_16x16x32_bf16 v[84:87], v[32:35], v[40:43], 0
  v_mfma_f32_16x16x32_bf16 v[84:87], v[32:35], v[44:47], v[84:87]
  v_mfma_f32_16x16x32_bf16 v[84:87], v[32:35], v[48:51], v[84:87]
  v_mfma_f32_16x16x32_bf16 v[84:87], v[32:35], v[52:55], v[84:87]
  v_bitop3_b32 v124, v40, v44, s43 bitop3:0x7e
  v_bitop3_b32 v125, v48, v52, s43 bitop3:0x7e
  v_bitop3_b32 v124, v124, v125, 1 bitop3:0xa8
  v_cmp_ne_u32 vcc, 0, v124
  s_nop 0
  s_cbranch_vccnz L_pollp_fast_n
L_gotp_fast_n:
  s_nop 1
  v_add_f32_dpp v84, v84, v84 row_ror:8 row_mask:0xf bank_mask:0xf
  v_add_f32_dpp v85, v85, v85 row_ror:8 row_mask:0xf bank_mask:0xf
  v_add_f32_dpp v86, v86, v86 row_ror:8 row_mask:0xf bank_mask:0xf
  v_add_f32_dpp v87, v87, v87 row_ror:8 row_mask:0xf bank_mask:0xf
  v_cvt_pk_bf16_f32 v124, v84, v86
  v_cvt_pk_bf16_f32 v125, v85, v87
  v_cndmask_b32 v124, v124, v125, s[46:47]
  global_store_dword v10, v124, s[24:25]
  v_mov_b32 v126, -1
  global_store_dword v10, v126, s[26:27]
  s_mov_b64 s[14:15], s[26:27]
  s_mov_b64 s[26:27], s[24:25]
  s_mov_b64 s[24:25], s[14:15]
  s_xor_b32 s43, s43, 1
  s_barrier
  s_branch L_step_fast_n
L_step_fast_f2:
  s_nop 9
  global_load_dwordx4 v[32:35], v2, s[26:27] sc1
  global_load_dwordx4 v[36:39], v2, s[26:27] offset:1024 sc1
  s_nop 15
  s_nop 8
L_pollm_fast_f2:
  global_load_dwordx4 v[64:67], v2, s[26:27] sc1
  global_load_dwordx4 v[68:71], v2, s[26:27] offset:1024 sc1
  s_waitcnt vmcnt(2)
  v_max3_u32 v124, v32, v33, v34
  v_max3_u32 v125, v35, v36, v37
  v_max3_u32 v124, v124, v38, v39
  v_max_u32 v124, v124, v125
  v_cmp_eq_u32 vcc, -1, v124
  s_nop 0
  s_cbranch_vccz L_gotm_fast_f2
  global_load_dwordx4 v[32:35], v2, s[26:27] sc1
  global_load_dwordx4 v[36:39], v2, s[26:27] offset:1024 sc1
  s_add_u32 s42, s42, 1
  s_cmp_gt_u32 s42, 0x40000
  s_cbranch_scc1 L_chain_abort
  s_waitcnt vmcnt(2)
  v_max3_u32 v124, v64, v65, v66
  v_max3_u32 v125, v67, v68, v69
  v_max3_u32 v124, v124, v70, v71
  v_max_u32 v124, v124, v125
  v_cmp_eq_u32 vcc, -1, v124
  s_nop 0
  s_cbranch_vccnz L_pollm2_fast_f2
  v_pk_mov_b32 v[32:33], v[64:65], v[64:65] op_sel:[0,1]
  v_pk_mov_b32 v[34:35], v[66:67], v[66:67] op_sel:[0,1]
  v_pk_mov_b32 v[36:37], v[68:69], v[68:69] op_sel:[0,1]
  v_pk_mov_b32 v[38:39], v[70:71], v[70:71] op_sel:[0,1]
  s_branch L_gotm2_fast_f2
L_pollm2_fast_f2:
  s_branch L_pollm_fast_f2
L_gotm_fast_f2:
L_gotm2_fast_f2:
  ds_write_b128 v24, v[32:35]
  v_smfmac_f32_16x16x64_bf16 v[96:99], v[32:35], a[128:135], v1
  ds_write_b128 v24, v[36:39] offset:1024
  v_smfmac_f32_16x16x64_bf16 v[100:103], v[32:35], a[0:7], v1
  v_cmp_ne_u32 vcc, 0, v5
  s_nop 0
  s_and_b32 s12, vcc_lo, s11
  s_cmp_eq_u32 s12, s11
  s_cbranch_scc0 L_fslow_fast_f2
L_fok_12:
  v_lshlrev_b32 v5, 3, v0
  global_load_dword v5, v5, s[48:49]
  v_smfmac_f32_16x16x64_bf16 v[104:107], v[32:35], a[192:199], v1
  v_bfe_u32 v20, v0, 4, 1
  v_lshl_add_u32 v20, v20, 11, s54
  global_load_dword v5, v20, s[58:59] sc1
  v_smfmac_f32_16x16x64_bf16 v[108:111], v[32:35], a[64:71], v1
  v_smfmac_f32_16x16x64_bf16 v[112:115], v[32:35], v[128:135], v1
  v_smfmac_f32_16x16x64_bf16 v[116:119], v[32:35], v[192:199], v1
  s_waitcnt lgkmcnt(0)
  s_barrier
  ds_read_b128 v[40:43], v25
  ds_read_b128 v[44:47], v25 offset:1024
  v_smfmac_f32_16x16x64_bf16 v[96:99], v[36:39], a[136:143], v1
  ds_read_b128 v[48:51], v26
  v_smfmac_f32_16x16x64_bf16 v[100:103], v[36:39], a[8:15], v1
  ds_read_b128 v[52:55], v26 offset:1024
  v_smfmac_f32_16x16x64_bf16 v[104:107], v[36:39], a[200:207], v1
  ds_read_b128 v[56:59], v27
  v_smfmac_f32_16x16x64_bf16 v[108:111], v[36:39], a[72:79], v1
  ds_read_b128 v[60:63], v27 offset:1024
  v_smfmac_f32_16x16x64_bf16 v[112:115], v[36:39], v[136:143], v1
  v_smfmac_f32_16x16x64_bf16 v[116:119], v[36:39], v[200:207], v1
  s_waitcnt lgkmcnt(4)
  v_smfmac_f32_16x16x64_bf16 v[96:99], v[40:43], a[144:151], v1
  v_smfmac_f32_16x16x64_bf16 v[100:103], v[40:43], a[16:23], v1
  v_smfmac_f32_16x16x64_bf16 v[104:107], v[40:43], a[208:215], v1
  v_smfmac_f32_16x16x64_bf16 v[108:111], v[40:43], a[80:87], v1
  v_smfmac_f32_16x16x64_bf16 v[96:99], v[44:47], a[152:159], v1
  v_smfmac_f32_16x16x64_bf16 v[100:103], v[44:47], a[24:31], v1
  v_smfmac_f32_16x16x64_bf16 v[104:107], v[44:47], a[216:223], v1
  v_smfmac_f32_16x16x64_bf16 v[108:111], v[44:47], a[88:95], v1
  s_waitcnt lgkmcnt(0)
  v_smfmac_f32_16x16x64_bf16 v[96:99], v[48:51], a[160:167], v1
  s_waitcnt vmcnt(2)
  ds_read_b128 v[64:67], v3 offset:8192
  v_smfmac_f32_16x16x64_bf16 v[100:103], v[48:51], a[32:39], v1
  ds_read_b128 v[80:83], v3 offset:12288
  v_smfmac_f32_16x16x64_bf16 v[104:107], v[48:51], a[224:231], v1
  ds_read_b128 v[68:71], v3 offset:9216
  v_smfmac_f32_16x16x64_bf16 v[108:111], v[48:51], a[96:103], v1
  ds_read_b128 v[84:87], v3 offset:13312
  v_smfmac_f32_16x16x64_bf16 v[96:99], v[52:55], a[168:175], v1
  ds_read_b128 v[72:75], v3 offset:10240
  v_smfmac_f32_16x16x64_bf16 v[100:103], v[52:55], a[40:47], v1
  ds_read_b128 v[88:91], v3 offset:14336
  v_smfmac_f32_16x16x64_bf16 v[104:107], v[52:55], a[232:239], v1
  ds_read_b128 v[76:79], v3 offset:11264
  v_smfmac_f32_16x16x64_bf16 v[108:111], v[52:55], a[104:111], v1
  ds_read_b128 v[92:95], v3 offset:15360
  v_smfmac_f32_16x16x64_bf16 v[96:99], v[56:59], a[176:183], v1
  v_and_b32 v20, 0xf0, v0
  v_smfmac_f32_16x16x64_bf16 v[100:103], v[56:59], a[48:55], v1
  v_add_u32 v21, s22, v20
  v_smfmac_f32_16x16x64_bf16 v[104:107], v[56:59], a[240:247], v1
  ds_read_b128 v[28:31], v21
  v_smfmac_f32_16x16x64_bf16 v[108:111], v[56:59], a[112:119], v1
  v_add_u32 v21, s23, v20
  v_smfmac_f32_16x16x64_bf16 v[96:99], v[60:63], a[184:191], v1
  v_smfmac_f32_16x16x64_bf16 v[100:103], v[60:63], a[56:63], v1
  v_smfmac_f32_16x16x64_bf16 v[104:107], v[60:63], a[248:255], v1
  v_smfmac_f32_16x16x64_bf16 v[108:111], v[60:63], a[120:127], v1
  v_smfmac_f32_16x16x64_bf16 v[112:115], v[40:43], v[144:151], v1
  v_smfmac_f32_16x16x64_bf16 v[116:119], v[40:43], v[208:215], v1
  v_pk_add_f32 v[96:97], v[96:97], v[98:99]
  v_pk_add_f32 v[100:101], v[100:101], v[102:103]
  v_pk_add_f32 v[104:105], v[104:105], v[106:107]
  v_cvt_pk_bf16_f32 v124, v96, v97
  v_cvt_pk_bf16_f32 v125, v100, v101
  v_pk_add_f32 v[108:109], v[108:109], v[110:111]
  ds_write_b64 v11, v[124:125]
  v_cvt_pk_bf16_f32 v126, v104, v105
  v_cvt_pk_bf16_f32 v127, v108, v109
  ds_write_b64 v11, v[126:127] offset:512
  v_smfmac_f32_16x16x64_bf16 v[112:115], v[44:47], v[152:159], v1
  v_smfmac_f32_16x16x64_bf16 v[116:119], v[44:47], v[216:223], v1
  v_smfmac_f32_16x16x64_bf16 v[112:115], v[48:51], v[160:167], v1
  v_smfmac_f32_16x16x64_bf16 v[116:119], v[48:51], v[224:231], v1
  v_smfmac_f32_16x16x64_bf16 v[112:115], v[52:55], v[168:175], v1
  v_smfmac_f32_16x16x64_bf16 v[116:119], v[52:55], v[232:239], v1
  s_waitcnt lgkmcnt(0)
  s_mov_b64 exec, 0xffff
  global_store_dwordx4 v21, v[28:31], s[36:37] sc1
  s_mov_b64 exec, -1
  s_barrier
  ds_read_b64_tr_b16 v[96:97], v12 offset:0
  ds_read_b64_tr_b16 v[98:99], v13 offset:0
  ds_read_b64_tr_b16 v[100:101], v12 offset:1024
  ds_read_b64_tr_b16 v[102:103], v13 offset:1024
  ds_read_b64_tr_b16 v[104:105], v12 offset:2048
  ds_read_b64_tr_b16 v[106:107], v13 offset:2048
  ds_read_b64_tr_b16 v[108:109], v12 offset:3072
  ds_read_b64_tr_b16 v[110:111], v13 offset:3072
  v_smfmac_f32_16x16x64_bf16 v[112:115], v[56:59], v[176:183], v1
  v_smfmac_f32_16x16x64_bf16 v[116:119], v[56:59], v[240:247], v1
  v_smfmac_f32_16x16x64_bf16 v[112:115], v[60:63], v[184:191], v1
  v_smfmac_f32_16x16x64_bf16 v[116:119], v[60:63], v[248:255], v1
  s_waitcnt lgkmcnt(4)
  v_mfma_f32_16x16x32_bf16 v[24:27], v[64:67], v[96:99], 0
  v_mov_b32 v126, 0x3f803f80
  v_mfma_f32_16x16x32_bf16 v[28:31], v[80:83], v[96:99], 0
  ds_read_b128 v[32:35], v16 offset:0
  v_mfma_f32_16x16x32_bf16 v[120:123], v[96:99], v[96:99], 0
  ds_read_b128 v[36:39], v16 offset:32768
  v_mfma_f32_16x16x32_bf16 v[24:27], v[68:71], v[100:103], v[24:27]
  ds_read_b128 v[40:43], v17 offset:0
  v_mfma_f32_16x16x32_bf16 v[28:31], v[84:87], v[100:103], v[28:31]
  ds_read_b128 v[44:47], v17 offset:32768
  v_mfma_f32_16x16x32_bf16 v[120:123], v[100:103], v[100:103], v[120:123]
  v_pk_add_f32 v[112:113], v[112:113], v[114:115]
  s_waitcnt lgkmcnt(4)
  v_mfma_f32_16x16x32_bf16 v[24:27], v[72:75], v[104:107], v[24:27]
  v_pk_add_f32 v[116:117], v[116:117], v[118:119]
  ds_read_b128 v[64:67], v4
  v_mfma_f32_16x16x32_bf16 v[28:31], v[88:91], v[104:107], v[28:31]
  v_cvt_pk_bf16_f32 v20, v112, v113
  ds_read_b128 v[68:71], v4 offset:1024
  v_mfma_f32_16x16x32_bf16 v[120:123], v[104:107], v[104:107], v[120:123]
  v_cvt_pk_bf16_f32 v21, v116, v117
  v_mov_b32 v127, 0x3f803f80
  v_mfma_f32_16x16x32_bf16 v[24:27], v[76:79], v[108:111], v[24:27]
  v_cvt_pk_bf16_f32 v22, v116, v117
  v_mfma_f32_16x16x32_bf16 v[28:31], v[92:95], v[108:111], v[28:31]
  v_cvt_pk_bf16_f32 v23, v112, v113
  v_mfma_f32_16x16x32_bf16 v[120:123], v[108:111], v[108:111], v[120:123]
  ds_read_b128 v[48:51], v16 offset:1024
  s_cmp_eq_u32 s10, 63
  s_cbranch_scc1 L_chain_done
  ds_read_b128 v[52:55], v16 offset:33792
  v_max3_f32 v124, v24, v25, v26
  v_max3_f32 v125, v27, v28, v29
  v_max3_f32 v124, v124, v30, v31
  s_nop 0
  v_max3_f32 v125, v125, v120, v121
  v_max_f32 v124, v124, v125
  v_max_f32 v125, v124, v125
  ds_read_b128 v[56:59], v17 offset:1024
  s_nop 0
  v_permlane16_swap_b32 v124, v125
  v_max_f32 v124, v124, v125
  v_mov_b32 v125, v124
  ds_read_b128 v[60:63], v17 offset:33792
  s_nop 0
  v_permlane32_swap_b32 v124, v125
  v_max_f32 v124, v124, v125
  v_mul_f32 v124, s41, v124
  v_pk_fma_f32 v[24:25], v[24:25], s[40:41], v[124:125] op_sel_hi:[1,0,0]
  v_pk_fma_f32 v[26:27], v[26:27], s[40:41], v[124:125] op_sel_hi:[1,0,0]
  v_pk_fma_f32 v[28:29], v[28:29], s[40:41], v[124:125] op_sel_hi:[1,0,0]
  v_pk_fma_f32 v[30:31], v[30:31], s[40:41], v[124:125] op_sel_hi:[1,0,0]
  v_pk_fma_f32 v[120:121], v[120:121], s[40:41], v[124:125] op_sel_hi:[1,0,0]
  v_exp_f32 v24, v24
  v_exp_f32 v25, v25
  v_exp_f32 v26, v26
  v_exp_f32 v27, v27
  v_exp_f32 v28, v28
  v_exp_f32 v29, v29
  v_cvt_pk_bf16_f32 v72, v24, v25
  v_exp_f32 v30, v30
  v_exp_f32 v31, v31
  v_cvt_pk_bf16_f32 v73, v26, v27
  v_cvt_pk_bf16_f32 v74, v28, v29
  v_exp_f32 v120, v120
  v_cvt_pk_bf16_f32 v75, v30, v31
  v_exp_f32 v121, v121
  s_nop 0
  v_cvt_pk_bf16_f32 v18, v120, v121
  s_waitcnt lgkmcnt(4)
  v_mfma_f32_16x16x16_bf16 v[120:123], v[126:127], v[72:73], 0
  v_mfma_f32_16x16x16_bf16 v[120:123], v[126:127], v[74:75], v[120:123]
  v_mfma_f32_16x16x16_bf16 v[120:123], v[126:127], v[18:19], v[120:123]
  v_mfma_f32_16x16x32_bf16 v[80:83], v[64:67], v[72:75], 0
  ds_read_b128 v[112:115], v16 offset:2048
  v_mfma_f32_16x16x32_bf16 v[84:87], v[68:71], v[72:75], 0
  ds_read_b128 v[116:119], v16 offset:34816
  v_mfma_f32_16x16x16_bf16 v[80:83], v[20:21], v[18:19], v[80:83]
  v_rcp_f32 v124, v120
  v_mfma_f32_16x16x16_bf16 v[84:87], v[22:23], v[18:19], v[84:87]
  s_nop 4
  v_pk_mul_f32 v[80:81], v[80:81], v[124:125] op_sel_hi:[1,0]
  v_pk_mul_f32 v[82:83], v[82:83], v[124:125] op_sel_hi:[1,0]
  s_nop 0
  v_pk_mul_f32 v[84:85], v[84:85], v[124:125] op_sel_hi:[1,0]
  v_pk_mul_f32 v[86:87], v[86:87], v[124:125] op_sel_hi:[1,0]
  v_cvt_pk_bf16_f32 v24, v80, v81
  v_cvt_pk_bf16_f32 v25, v82, v83
  v_cvt_pk_bf16_f32 v26, v84, v85
  v_cvt_pk_bf16_f32 v27, v86, v87
  ds_write2_b64 v14, v[24:25], v[26:27] offset0:0 offset1:4
  v_mfma_f32_32x32x8_bf16 v[64:79], v[6:7], v[6:7], 0
  ds_read_b128 v[96:99], v17 offset:2048
  ds_read_b128 v[100:103], v17 offset:34816
  v_mfma_f32_32x32x8_bf16 v[80:95], v[6:7], v[6:7], 0
  ds_read_b128 v[104:107], v16 offset:3072
  ds_read_b128 v[108:111], v16 offset:35840
  s_waitcnt lgkmcnt(4)
  s_barrier
  ds_read_b128 v[24:27], v15
  ds_read_b128 v[28:31], v15 offset:128
  ds_read_b128 v[120:123], v17 offset:3072
  ds_read_b128 v[124:127], v17 offset:35840
  s_add_u32 m0, s50, 143360
  s_nop 0
  global_load_lds_dwordx4 v2, s[32:33] sc1
  global_load_lds_dwordx4 v2, s[32:33] offset:1024 sc1
  s_add_u32 m0, s50, 151552
  s_nop 0
  global_load_lds_dwordx4 v2, s[34:35] sc1
  global_load_lds_dwordx4 v2, s[34:35] offset:1024 sc1
  s_waitcnt lgkmcnt(2)
  v_smfmac_f32_16x16x64_bf16 v[64:67], v[24:27], v[32:39], v1
  ds_read_b128 v[32:35], v16 offset:4096
  ds_read_b128 v[36:39], v16 offset:36864
  v_smfmac_f32_16x16x64_bf16 v[64:67], v[28:31], v[40:47], v1
  ds_read_b128 v[40:43], v17 offset:4096
  ds_read_b128 v[44:47], v17 offset:36864
  v_smfmac_f32_16x16x64_bf16 v[68:71], v[24:27], v[48:55], v1
  ds_read_b128 v[48:51], v16 offset:5120
  ds_read_b128 v[52:55], v16 offset:37888
  v_smfmac_f32_16x16x64_bf16 v[68:71], v[28:31], v[56:63], v1
  ds_read_b128 v[56:59], v17 offset:5120
  ds_read_b128 v[60:63], v17 offset:37888
  v_pk_add_f32 v[64:65], v[64:65], v[66:67]
  v_cvt_pk_bf16_f32 v20, v64, v65
  v_smfmac_f32_16x16x64_bf16 v[72:75], v[24:27], v[112:119], v1
  ds_read_b128 v[112:115], v16 offset:6144
  ds_read_b128 v[116:119], v16 offset:38912
  v_smfmac_f32_16x16x64_bf16 v[72:75], v[28:31], v[96:103], v1
  ds_read_b128 v[96:99], v17 offset:6144
  ds_read_b128 v[100:103], v17 offset:38912
  v_pk_add_f32 v[68:69], v[68:69], v[70:71]
  v_cvt_pk_bf16_f32 v21, v68, v69
  v_smfmac_f32_16x16x64_bf16 v[76:79], v[24:27], v[104:111], v1
  ds_read_b128 v[104:107], v16 offset:7168
  ds_read_b128 v[108:111], v16 offset:39936
  s_waitcnt lgkmcnt(12)
  v_smfmac_f32_16x16x64_bf16 v[76:79], v[28:31], v[120:127], v1
  ds_read_b128 v[120:123], v17 offset:7168
  ds_read_b128 v[124:127], v17 offset:39936
  v_pk_add_f32 v[72:73], v[72:73], v[74:75]
  v_cvt_pk_bf16_f32 v22, v72, v73
  v_smfmac_f32_16x16x64_bf16 v[80:83], v[24:27], v[32:39], v1
  s_waitcnt lgkmcnt(10)
  v_smfmac_f32_16x16x64_bf16 v[80:83], v[28:31], v[40:47], v1
  v_pk_add_f32 v[76:77], v[76:77], v[78:79]
  v_cvt_pk_bf16_f32 v23, v76, v77
  v_bfi_b32 v20, 1, s43, v20
  global_store_dwordx4 v8, v[20:23], s[28:29]
  v_smfmac_f32_16x16x64_bf16 v[84:87], v[24:27], v[48:55], v1
  s_waitcnt lgkmcnt(6)
  v_smfmac_f32_16x16x64_bf16 v[84:87], v[28:31], v[56:63], v1
  v_pk_add_f32 v[80:81], v[80:81], v[82:83]
  v_cvt_pk_bf16_f32 v64, v80, v81
  v_smfmac_f32_16x16x64_bf16 v[88:91], v[24:27], v[112:119], v1
  s_waitcnt lgkmcnt(2)
  v_smfmac_f32_16x16x64_bf16 v[88:91], v[28:31], v[96:103], v1
  s_nop 0
  v_pk_add_f32 v[84:85], v[84:85], v[86:87]
  v_cvt_pk_bf16_f32 v65, v84, v85
  v_smfmac_f32_16x16x64_bf16 v[92:95], v[24:27], v[104:111], v1
  s_waitcnt lgkmcnt(0)
  v_smfmac_f32_16x16x64_bf16 v[92:95], v[28:31], v[120:127], v1
  s_nop 0
  v_pk_add_f32 v[88:89], v[88:89], v[90:91]
  v_cvt_pk_bf16_f32 v66, v88, v89
  v_bfi_b32 v64, 1, s43, v64
  s_nop 3
  v_pk_add_f32 v[92:93], v[92:93], v[94:95]
  v_cvt_pk_bf16_f32 v67, v92, v93
  global_store_dwordx4 v8, v[64:67], s[30:31]
  s_add_u32 s32, s32, 262144
  s_addc_u32 s33, s33, 0
  s_add_u32 s34, s34, 262144
  s_addc_u32 s35, s35, 0
  s_add_u32 s10, s10, 1
  v_mfma_f32_32x32x8_bf16 v[96:111], v[6:7], v[6:7], 0
  v_pk_mov_b32 v[112:113], 0, 0
  v_pk_mov_b32 v[114:115], 0, 0
  v_pk_mov_b32 v[116:117], 0, 0
  v_pk_mov_b32 v[118:119], 0, 0
  v_add_u32 v24, s50, v3
  v_add_u32 v25, s51, v3
  v_add_u32 v26, s52, v3
  v_add_u32 v27, s53, v3
  s_add_u32 s36, s36, 8192
  s_addc_u32 s37, s37, 0
  s_cmp_lt_u32 s10, 62
  s_cselect_b32 s12, 262144, 0
  s_cselect_b32 s13, 16384, 0
  s_cselect_b32 s11, s56, 0
  s_add_u32 s48, s48, s12
  s_addc_u32 s49, s49, 0
  s_add_u32 s58, s58, s13
  s_addc_u32 s59, s59, 0
  s_waitcnt vmcnt(0)
  s_mov_b64 s[14:15], s[26:27]
  s_mov_b64 s[26:27], s[24:25]
  s_mov_b64 s[24:25], s[14:15]
  s_xor_b32 s43, s43, 1
  s_barrier
  s_branch L_step_fast_f2
L_step_fast_f3:
  s_nop 9
  global_load_dwordx4 v[32:35], v2, s[26:27] sc1
  global_load_dwordx4 v[36:39], v2, s[26:27] offset:1024 sc1
  s_nop 15
  s_nop 8
L_pollm_fast_f3:
  global_load_dwordx4 v[64:67], v2, s[26:27] sc1
  global_load_dwordx4 v[68:71], v2, s[26:27] offset:1024 sc1
  s_waitcnt vmcnt(2)
  v_max3_u32 v124, v32, v33, v34
  v_max3_u32 v125, v35, v36, v37
  v_max3_u32 v124, v124, v38, v39
  v_max_u32 v124, v124, v125
  v_cmp_eq_u32 vcc, -1, v124
  s_nop 0
  s_cbranch_vccz L_gotm_fast_f3
  global_load_dwordx4 v[32:35], v2, s[26:27] sc1
  global_load_dwordx4 v[36:39], v2, s[26:27] offset:1024 sc1
  s_add_u32 s42, s42, 1
  s_cmp_gt_u32 s42, 0x40000
  s_cbranch_scc1 L_chain_abort
  s_waitcnt vmcnt(2)
  v_max3_u32 v124, v64, v65, v66
  v_max3_u32 v125, v67, v68, v69
  v_max3_u32 v124, v124, v70, v71
  v_max_u32 v124, v124, v125
  v_cmp_eq_u32 vcc, -1, v124
  s_nop 0
  s_cbranch_vccnz L_pollm2_fast_f3
  v_pk_mov_b32 v[32:33], v[64:65], v[64:65] op_sel:[0,1]
  v_pk_mov_b32 v[34:35], v[66:67], v[66:67] op_sel:[0,1]
  v_pk_mov_b32 v[36:37], v[68:69], v[68:69] op_sel:[0,1]
  v_pk_mov_b32 v[38:39], v[70:71], v[70:71] op_sel:[0,1]
  s_branch L_gotm2_fast_f3
L_pollm2_fast_f3:
  s_branch L_pollm_fast_f3
L_gotm_fast_f3:
L_gotm2_fast_f3:
  ds_write_b128 v24, v[32:35]
  v_smfmac_f32_16x16x64_bf16 v[96:99], v[32:35], a[128:135], v1
  ds_write_b128 v24, v[36:39] offset:1024
  v_smfmac_f32_16x16x64_bf16 v[100:103], v[32:35], a[0:7], v1
  v_cmp_ne_u32 vcc, 0, v5
  s_nop 0
  s_and_b32 s12, vcc_lo, s11
  s_cmp_eq_u32 s12, s11
  s_cbranch_scc0 L_fslow_fast_f3
L_fok_13:
  v_lshlrev_b32 v5, 3, v0
  global_load_dword v5, v5, s[48:49]
  v_smfmac_f32_16x16x64_bf16 v[104:107], v[32:35], a[192:199], v1
  v_bfe_u32 v20, v0, 4, 1
  v_lshl_add_u32 v20, v20, 11, s54
  global_load_dword v5, v20, s[58:59] sc1
  v_smfmac_f32_16x16x64_bf16 v[108:111], v[32:35], a[64:71], v1
  v_smfmac_f32_16x16x64_bf16 v[112:115], v[32:35], v[128:135], v1
  v_smfmac_f32_16x16x64_bf16 v[116:119], v[32:35], v[192:199], v1
  s_waitcnt lgkmcnt(0)
  s_barrier
  ds_read_b128 v[40:43], v25
  ds_read_b128 v[44:47], v25 offset:1024
  v_smfmac_f32_16x16x64_bf16 v[96:99], v[36:39], a[136:143], v1
  ds_read_b128 v[48:51], v26
  v_smfmac_f32_16x16x64_bf16 v[100:103], v[36:39], a[8:15], v1
  ds_read_b128 v[52:55], v26 offset:1024
  v_smfmac_f32_16x16x64_bf16 v[104:107], v[36:39], a[200:207], v1
  ds_read_b128 v[56:59], v27
  v_smfmac_f32_16x16x64_bf16 v[108:111], v[36:39], a[72:79], v1
  ds_read_b128 v[60:63], v27 offset:1024
  v_smfmac_f32_16x16x64_bf16 v[112:115], v[36:39], v[136:143], v1
  v_smfmac_f32_16x16x64_bf16 v[116:119], v[36:39], v[200:207], v1
  s_waitcnt lgkmcnt(4)
  v_smfmac_f32_16x16x64_bf16 v[96:99], v[40:43], a[144:151], v1
  v_smfmac_f32_16x16x64_bf16 v[100:103], v[40:43], a[16:23], v1
  v_smfmac_f32_16x16x64_bf16 v[104:107], v[40:43], a[208:215], v1
  v_smfmac_f32_16x16x64_bf16 v[108:111], v[40:43], a[80:87], v1
  v_smfmac_f32_16x16x64_bf16 v[96:99], v[44:47], a[152:159], v1
  v_smfmac_f32_16x16x64_bf16 v[100:103], v[44:47], a[24:31], v1
  v_smfmac_f32_16x16x64_bf16 v[104:107], v[44:47], a[216:223], v1
  v_smfmac_f32_16x16x64_bf16 v[108:111], v[44:47], a[88:95], v1
  s_waitcnt lgkmcnt(0)
  v_smfmac_f32_16x16x64_bf16 v[96:99], v[48:51], a[160:167], v1
  s_waitcnt vmcnt(2)
  ds_read_b128 v[64:67], v3 offset:8192
  v_smfmac_f32_16x16x64_bf16 v[100:103], v[48:51], a[32:39], v1
  ds_read_b128 v[80:83], v3 offset:12288
  v_smfmac_f32_16x16x64_bf16 v[104:107], v[48:51], a[224:231], v1
  ds_read_b128 v[68:71], v3 offset:9216
  v_smfmac_f32_16x16x64_bf16 v[108:111], v[48:51], a[96:103], v1
  ds_read_b128 v[84:87], v3 offset:13312
  v_smfmac_f32_16x16x64_bf16 v[96:99], v[52:55], a[168:175], v1
  ds_read_b128 v[72:75], v3 offset:10240
  v_smfmac_f32_16x16x64_bf16 v[100:103], v[52:55], a[40:47], v1
  ds_read_b128 v[88:91], v3 offset:14336
  v_smfmac_f32_16x16x64_bf16 v[104:107], v[52:55], a[232:239], v1
  ds_read_b128 v[76:79], v3 offset:11264
  v_smfmac_f32_16x16x64_bf16 v[108:111], v[52:55], a[104:111], v1
  ds_read_b128 v[92:95], v3 offset:15360
  v_smfmac_f32_16x16x64_bf16 v[96:99], v[56:59], a[176:183], v1
  v_smfmac_f32_16x16x64_bf16 v[100:103], v[56:59], a[48:55], v1
  v_smfmac_f32_16x16x64_bf16 v[104:107], v[56:59], a[240:247], v1
  v_smfmac_f32_16x16x64_bf16 v[108:111], v[56:59], a[112:119], v1
  v_smfmac_f32_16x16x64_bf16 v[96:99], v[60:63], a[184:191], v1
  v_smfmac_f32_16x16x64_bf16 v[100:103], v[60:63], a[56:63], v1
  v_smfmac_f32_16x16x64_bf16 v[104:107], v[60:63], a[248:255], v1
  v_smfmac_f32_16x16x64_bf16 v[108:111], v[60:63], a[120:127], v1
  v_smfmac_f32_16x16x64_bf16 v[112:115], v[40:43], v[144:151], v1
  v_smfmac_f32_16x16x64_bf16 v[116:119], v[40:43], v[208:215], v1
  v_pk_add_f32 v[96:97], v[96:97], v[98:99]
  v_pk_add_f32 v[100:101], v[100:101], v[102:103]
  v_pk_add_f32 v[104:105], v[104:105], v[106:107]
  v_cvt_pk_bf16_f32 v124, v96, v97
  v_cvt_pk_bf16_f32 v125, v100, v101
  v_pk_add_f32 v[108:109], v[108:109], v[110:111]
  ds_write_b64 v11, v[124:125]
  v_cvt_pk_bf16_f32 v126, v104, v105
  v_cvt_pk_bf16_f32 v127, v108, v109
  ds_write_b64 v11, v[126:127] offset:512
  v_smfmac_f32_16x16x64_bf16 v[112:115], v[44:47], v[152:159], v1
  v_smfmac_f32_16x16x64_bf16 v[116:119], v[44:47], v[216:223], v1
  v_smfmac_f32_16x16x64_bf16 v[112:115], v[48:51], v[160:167], v1
  v_smfmac_f32_16x16x64_bf16 v[116:119], v[48:51], v[224:231], v1
  v_smfmac_f32_16x16x64_bf16 v[112:115], v[52:55], v[168:175], v1
  v_smfmac_f32_16x16x64_bf16 v[116:119], v[52:55], v[232:239], v1
  s_waitcnt lgkmcnt(0)
  s_barrier
  ds_read_b64_tr_b16 v[96:97], v12 offset:0
  ds_read_b64_tr_b16 v[98:99], v13 offset:0
  ds_read_b64_tr_b16 v[100:101], v12 offset:1024
  ds_read_b64_tr_b16 v[102:103], v13 offset:1024
  ds_read_b64_tr_b16 v[104:105], v12 offset:2048
  ds_read_b64_tr_b16 v[106:107], v13 offset:2048
  ds_read_b64_tr_b16 v[108:109], v12 offset:3072
  ds_read_b64_tr_b16 v[110:111], v13 offset:3072
  v_smfmac_f32_16x16x64_bf16 v[112:115], v[56:59], v[176:183], v1
  v_smfmac_f32_16x16x64_bf16 v[116:119], v[56:59], v[240:247], v1
  v_smfmac_f32_16x16x64_bf16 v[112:115], v[60:63], v[184:191], v1
  v_smfmac_f32_16x16x64_bf16 v[116:119], v[60:63], v[248:255], v1
  s_waitcnt lgkmcnt(4)
  v_mfma_f32_16x16x32_bf16 v[24:27], v[64:67], v[96:99], 0
  v_mov_b32 v126, 0x3f803f80
  v_mfma_f32_16x16x32_bf16 v[28:31], v[80:83], v[96:99], 0
  ds_read_b128 v[32:35], v16 offset:0
  v_mfma_f32_16x16x32_bf16 v[120:123], v[96:99], v[96:99], 0
  ds_read_b128 v[36:39], v16 offset:32768
  v_mfma_f32_16x16x32_bf16 v[24:27], v[68:71], v[100:103], v[24:27]
  ds_read_b128 v[40:43], v17 offset:0
  v_mfma_f32_16x16x32_bf16 v[28:31], v[84:87], v[100:103], v[28:31]
  ds_read_b128 v[44:47], v17 offset:32768
  v_mfma_f32_16x16x32_bf16 v[120:123], v[100:103], v[100:103], v[120:123]
  v_pk_add_f32 v[112:113], v[112:113], v[114:115]
  s_waitcnt lgkmcnt(4)
  v_mfma_f32_16x16x32_bf16 v[24:27], v[72:75], v[104:107], v[24:27]
  v_pk_add_f32 v[116:117], v[116:117], v[118:119]
  ds_read_b128 v[64:67], v4
  v_mfma_f32_16x16x32_bf16 v[28:31], v[88:91], v[104:107], v[28:31]
  v_cvt_pk_bf16_f32 v20, v112, v113
  ds_read_b128 v[68:71], v4 offset:1024
  v_mfma_f32_16x16x32_bf16 v[120:123], v[104:107], v[104:107], v[120:123]
  v_cvt_pk_bf16_f32 v21, v116, v117
  v_mov_b32 v127, 0x3f803f80
  v_mfma_f32_16x16x32_bf16 v[24:27], v[76:79], v[108:111], v[24:27]
  v_cvt_pk_bf16_f32 v22, v116, v117
  v_mfma_f32_16x16x32_bf16 v[28:31], v[92:95], v[108:111], v[28:31]
  v_cvt_pk_bf16_f32 v23, v112, v113
  v_mfma_f32_16x16x32_bf16 v[120:123], v[108:111], v[108:111], v[120:123]
  ds_read_b128 v[48:51], v16 offset:1024
  s_cmp_eq_u32 s10, 63
  s_cbranch_scc1 L_chain_done
  ds_read_b128 v[52:55], v16 offset:33792
  v_max3_f32 v124, v24, v25, v26
  v_max3_f32 v125, v27, v28, v29
  v_max3_f32 v124, v124, v30, v31
  s_nop 0
  v_max3_f32 v125, v125, v120, v121
  v_max_f32 v124, v124, v125
  v_max_f32 v125, v124, v125
  ds_read_b128 v[56:59], v17 offset:1024
  s_nop 0
  v_permlane16_swap_b32 v124, v125
  v_max_f32 v124, v124, v125
  v_mov_b32 v125, v124
  ds_read_b128 v[60:63], v17 offset:33792
  s_nop 0
  v_permlane32_swap_b32 v124, v125
  v_max_f32 v124, v124, v125
  v_mul_f32 v124, s41, v124
  v_pk_fma_f32 v[24:25], v[24:25], s[40:41], v[124:125] op_sel_hi:[1,0,0]
  v_pk_fma_f32 v[26:27], v[26:27], s[40:41], v[124:125] op_sel_hi:[1,0,0]
  v_pk_fma_f32 v[28:29], v[28:29], s[40:41], v[124:125] op_sel_hi:[1,0,0]
  v_pk_fma_f32 v[30:31], v[30:31], s[40:41], v[124:125] op_sel_hi:[1,0,0]
  v_pk_fma_f32 v[120:121], v[120:121], s[40:41], v[124:125] op_sel_hi:[1,0,0]
  v_exp_f32 v24, v24
  v_exp_f32 v25, v25
  v_exp_f32 v26, v26
  v_exp_f32 v27, v27
  v_exp_f32 v28, v28
  v_exp_f32 v29, v29
  v_cvt_pk_bf16_f32 v72, v24, v25
  v_exp_f32 v30, v30
  v_exp_f32 v31, v31
  v_cvt_pk_bf16_f32 v73, v26, v27
  v_cvt_pk_bf16_f32 v74, v28, v29
  v_exp_f32 v120, v120
  v_cvt_pk_bf16_f32 v75, v30, v31
  v_exp_f32 v121, v121
  s_nop 0
  v_cvt_pk_bf16_f32 v18, v120, v121
  s_waitcnt lgkmcnt(4)
  v_mfma_f32_16x16x16_bf16 v[120:123], v[126:127], v[72:73], 0
  v_mfma_f32_16x16x16_bf16 v[120:123], v[126:127], v[74:75], v[120:123]
  v_mfma_f32_16x16x16_bf16 v[120:123], v[126:127], v[18:19], v[120:123]
  v_mfma_f32_16x16x32_bf16 v[80:83], v[64:67], v[72:75], 0
  ds_read_b128 v[112:115], v16 offset:2048
  v_mfma_f32_16x16x32_bf16 v[84:87], v[68:71], v[72:75], 0
  ds_read_b128 v[116:119], v16 offset:34816
  v_mfma_f32_16x16x16_bf16 v[80:83], v[20:21], v[18:19], v[80:83]
  v_rcp_f32 v124, v120
  v_mfma_f32_16x16x16_bf16 v[84:87], v[22:23], v[18:19], v[84:87]
  s_nop 4
  v_pk_mul_f32 v[80:81], v[80:81], v[124:125] op_sel_hi:[1,0]
  v_pk_mul_f32 v[82:83], v[82:83], v[124:125] op_sel_hi:[1,0]
  s_nop 0
  v_pk_mul_f32 v[84:85], v[84:85], v[124:125] op_sel_hi:[1,0]
  v_pk_mul_f32 v[86:87], v[86:87], v[124:125] op_sel_hi:[1,0]
  v_cvt_pk_bf16_f32 v24, v80, v81
  v_cvt_pk_bf16_f32 v25, v82, v83
  v_cvt_pk_bf16_f32 v26, v84, v85
  v_cvt_pk_bf16_f32 v27, v86, v87
  ds_write2_b64 v14, v[24:25], v[26:27] offset0:0 offset1:4
  v_mfma_f32_32x32x8_bf16 v[64:79], v[6:7], v[6:7], 0
  ds_read_b128 v[96:99], v17 offset:2048
  ds_read_b128 v[100:103], v17 offset:34816
  v_mfma_f32_32x32x8_bf16 v[80:95], v[6:7], v[6:7], 0
  ds_read_b128 v[104:107], v16 offset:3072
  ds_read_b128 v[108:111], v16 offset:35840
  s_waitcnt lgkmcnt(4)
  s_barrier
  ds_read_b128 v[24:27], v15
  ds_read_b128 v[28:31], v15 offset:128
  ds_read_b128 v[120:123], v17 offset:3072
  ds_read_b128 v[124:127], v17 offset:35840
  s_add_u32 m0, s50, 143360
  s_nop 0
  global_load_lds_dwordx4 v2, s[32:33] sc1
  global_load_lds_dwordx4 v2, s[32:33] offset:1024 sc1
  s_add_u32 m0, s50, 151552
  s_nop 0
  global_load_lds_dwordx4 v2, s[34:35] sc1
  global_load_lds_dwordx4 v2, s[34:35] offset:1024 sc1
  s_waitcnt lgkmcnt(2)
  v_smfmac_f32_16x16x64_bf16 v[64:67], v[24:27], v[32:39], v1
  ds_read_b128 v[32:35], v16 offset:4096
  ds_read_b128 v[36:39], v16 offset:36864
  v_smfmac_f32_16x16x64_bf16 v[64:67], v[28:31], v[40:47], v1
  ds_read_b128 v[40:43], v17 offset:4096
  ds_read_b128 v[44:47], v17 offset:36864
  v_smfmac_f32_16x16x64_bf16 v[68:71], v[24:27], v[48:55], v1
  ds_read_b128 v[48:51], v16 offset:5120
  ds_read_b128 v[52:55], v16 offset:37888
  v_smfmac_f32_16x16x64_bf16 v[68:71], v[28:31], v[56:63], v1
  ds_read_b128 v[56:59], v17 offset:5120
  ds_read_b128 v[60:63], v17 offset:37888
  v_pk_add_f32 v[64:65], v[64:65], v[66:67]
  v_cvt_pk_bf16_f32 v20, v64, v65
  v_smfmac_f32_16x16x64_bf16 v[72:75], v[24:27], v[112:119], v1
  ds_read_b128 v[112:115], v16 offset:6144
  ds_read_b128 v[116:119], v16 offset:38912
  v_smfmac_f32_16x16x64_bf16 v[72:75], v[28:31], v[96:103], v1
  ds_read_b128 v[96:99], v17 offset:6144
  ds_read_b128 v[100:103], v17 offset:38912
  v_pk_add_f32 v[68:69], v[68:69], v[70:71]
  v_cvt_pk_bf16_f32 v21, v68, v69
  v_smfmac_f32_16x16x64_bf16 v[76:79], v[24:27], v[104:111], v1
  ds_read_b128 v[104:107], v16 offset:7168
  ds_read_b128 v[108:111], v16 offset:39936
  s_waitcnt lgkmcnt(12)
  v_smfmac_f32_16x16x64_bf16 v[76:79], v[28:31], v[120:127], v1
  ds_read_b128 v[120:123], v17 offset:7168
  ds_read_b128 v[124:127], v17 offset:39936
  v_pk_add_f32 v[72:73], v[72:73], v[74:75]
  v_cvt_pk_bf16_f32 v22, v72, v73
  v_smfmac_f32_16x16x64_bf16 v[80:83], v[24:27], v[32:39], v1
  s_waitcnt lgkmcnt(10)
  v_smfmac_f32_16x16x64_bf16 v[80:83], v[28:31], v[40:47], v1
  v_pk_add_f32 v[76:77], v[76:77], v[78:79]
  v_cvt_pk_bf16_f32 v23, v76, v77
  v_bfi_b32 v20, 1, s43, v20
  global_store_dwordx4 v8, v[20:23], s[28:29]
  v_smfmac_f32_16x16x64_bf16 v[84:87], v[24:27], v[48:55], v1
  s_waitcnt lgkmcnt(6)
  v_smfmac_f32_16x16x64_bf16 v[84:87], v[28:31], v[56:63], v1
  v_pk_add_f32 v[80:81], v[80:81], v[82:83]
  v_cvt_pk_bf16_f32 v64, v80, v81
  v_smfmac_f32_16x16x64_bf16 v[88:91], v[24:27], v[112:119], v1
  s_waitcnt lgkmcnt(2)
  v_smfmac_f32_16x16x64_bf16 v[88:91], v[28:31], v[96:103], v1
  s_nop 0
  v_pk_add_f32 v[84:85], v[84:85], v[86:87]
  v_cvt_pk_bf16_f32 v65, v84, v85
  v_smfmac_f32_16x16x64_bf16 v[92:95], v[24:27], v[104:111], v1
  s_waitcnt lgkmcnt(0)
  v_smfmac_f32_16x16x64_bf16 v[92:95], v[28:31], v[120:127], v1
  s_nop 0
  v_pk_add_f32 v[88:89], v[88:89], v[90:91]
  v_cvt_pk_bf16_f32 v66, v88, v89
  v_bfi_b32 v64, 1, s43, v64
  s_nop 3
  v_pk_add_f32 v[92:93], v[92:93], v[94:95]
  v_cvt_pk_bf16_f32 v67, v92, v93
  global_store_dwordx4 v8, v[64:67], s[30:31]
  s_add_u32 s32, s32, 262144
  s_addc_u32 s33, s33, 0
  s_add_u32 s34, s34, 262144
  s_addc_u32 s35, s35, 0
  s_add_u32 s10, s10, 1
  v_mfma_f32_32x32x8_bf16 v[96:111], v[6:7], v[6:7], 0
  v_pk_mov_b32 v[112:113], 0, 0
  v_pk_mov_b32 v[114:115], 0, 0
  v_pk_mov_b32 v[116:117], 0, 0
  v_pk_mov_b32 v[118:119], 0, 0
  v_add_u32 v24, s50, v3
  v_add_u32 v25, s51, v3
  v_add_u32 v26, s52, v3
  v_add_u32 v27, s53, v3
  s_add_u32 s36, s36, 8192
  s_addc_u32 s37, s37, 0
  s_cmp_lt_u32 s10, 62
  s_cselect_b32 s12, 262144, 0
  s_cselect_b32 s13, 16384, 0
  s_cselect_b32 s11, s56, 0
  s_add_u32 s48, s48, s12
  s_addc_u32 s49, s49, 0
  s_add_u32 s58, s58, s13
  s_addc_u32 s59, s59, 0
  s_waitcnt vmcnt(0)
  s_mov_b64 s[14:15], s[26:27]
  s_mov_b64 s[26:27], s[24:25]
  s_mov_b64 s[24:25], s[14:15]
  s_xor_b32 s43, s43, 1
  s_barrier
  s_branch L_step_fast_f3
L_fslow_fast_f2:
  v_bfe_u32 v20, v0, 4, 1
  v_lshl_add_u32 v20, v20, 11, s54
  s_sub_u32 s14, s58, 16384
  s_subb_u32 s15, s59, 0
  global_load_dword v5, v20, s[14:15] sc1
  s_add_u32 s42, s42, 1
  s_cmp_gt_u32 s42, 0x40000
  s_cbranch_scc1 L_chain_abort
  s_waitcnt vmcnt(0)
  v_cmp_ne_u32 vcc, 0, v5
  s_nop 0
  s_and_b32 s12, vcc_lo, s11
  s_cmp_eq_u32 s12, s11
  s_cbranch_scc1 L_fok_12
  s_sleep 1
  s_branch L_fslow_fast_f2
L_fslow_fast_f3:
  v_bfe_u32 v20, v0, 4, 1
  v_lshl_add_u32 v20, v20, 11, s54
  s_sub_u32 s14, s58, 16384
  s_subb_u32 s15, s59, 0
  global_load_dword v5, v20, s[14:15] sc1
  s_add_u32 s42, s42, 1
  s_cmp_gt_u32 s42, 0x40000
  s_cbranch_scc1 L_chain_abort
  s_waitcnt vmcnt(0)
  v_cmp_ne_u32 vcc, 0, v5
  s_nop 0
  s_and_b32 s12, vcc_lo, s11
  s_cmp_eq_u32 s12, s11
  s_cbranch_scc1 L_fok_13
  s_sleep 1
  s_branch L_fslow_fast_f3
L_main_slow:
  s_cmp_eq_u32 s8, 2
  s_cbranch_scc1 L_step_slow_f2
  s_cmp_eq_u32 s8, 3
  s_cbranch_scc1 L_step_slow_f3
L_step_slow_n:
  s_nop 9
  global_load_dwordx4 v[32:35], v2, s[26:27] sc1
  global_load_dwordx4 v[36:39], v2, s[26:27] offset:1024 sc1
  s_nop 15
  s_nop 8
L_pollm_slow_n:
  global_load_dwordx4 v[64:67], v2, s[26:27] sc1
  global_load_dwordx4 v[68:71], v2, s[26:27] offset:1024 sc1
  s_waitcnt vmcnt(2)
  v_max3_u32 v124, v32, v33, v34
  v_max3_u32 v125, v35, v36, v37
  v_max3_u32 v124, v124, v38, v39
  v_max_u32 v124, v124, v125
  v_cmp_eq_u32 vcc, -1, v124
  s_nop 0
  s_cbranch_vccz L_gotm_slow_n
  global_load_dwordx4 v[32:35], v2, s[26:27] sc1
  global_load_dwordx4 v[36:39], v2, s[26:27] offset:1024 sc1
  s_add_u32 s42, s42, 1
  s_cmp_gt_u32 s42, 0x40000
  s_cbranch_scc1 L_chain_abort
  s_waitcnt vmcnt(2)
  v_max3_u32 v124, v64, v65, v66
  v_max3_u32 v125, v67, v68, v69
  v_max3_u32 v124, v124, v70, v71
  v_max_u32 v124, v124, v125
  v_cmp_eq_u32 vcc, -1, v124
  s_nop 0
  s_cbranch_vccnz L_pollm2_slow_n
  v_pk_mov_b32 v[32:33], v[64:65], v[64:65] op_sel:[0,1]
  v_pk_mov_b32 v[34:35], v[66:67], v[66:67] op_sel:[0,1]
  v_pk_mov_b32 v[36:37], v[68:69], v[68:69] op_sel:[0,1]
  v_pk_mov_b32 v[38:39], v[70:71], v[70:71] op_sel:[0,1]
  s_branch L_gotm2_slow_n
L_pollm2_slow_n:
  s_branch L_pollm_slow_n
L_gotm_slow_n:
L_gotm2_slow_n:
  ds_write_b128 v24, v[32:35]
  v_smfmac_f32_16x16x64_bf16 v[96:99], v[32:35], a[128:135], v1
  ds_write_b128 v24, v[36:39] offset:1024
  v_smfmac_f32_16x16x64_bf16 v[100:103], v[32:35], a[0:7], v1
  v_smfmac_f32_16x16x64_bf16 v[104:107], v[32:35], a[192:199], v1
  v_smfmac_f32_16x16x64_bf16 v[108:111], v[32:35], a[64:71], v1
  v_smfmac_f32_16x16x64_bf16 v[112:115], v[32:35], v[128:135], v1
  v_smfmac_f32_16x16x64_bf16 v[116:119], v[32:35], v[192:199], v1
  s_waitcnt lgkmcnt(0)
  s_barrier
  ds_read_b128 v[40:43], v25
  ds_read_b128 v[44:47], v25 offset:1024
  v_smfmac_f32_16x16x64_bf16 v[96:99], v[36:39], a[136:143], v1
  ds_read_b128 v[48:51], v26
  v_smfmac_f32_16x16x64_bf16 v[100:103], v[36:39], a[8:15], v1
  ds_read_b128 v[52:55], v26 offset:1024
  v_smfmac_f32_16x16x64_bf16 v[104:107], v[36:39], a[200:207], v1
  ds_read_b128 v[56:59], v27
  v_smfmac_f32_16x16x64_bf16 v[108:111], v[36:39], a[72:79], v1
  ds_read_b128 v[60:63], v27 offset:1024
  v_smfmac_f32_16x16x64_bf16 v[112:115], v[36:39], v[136:143], v1
  v_smfmac_f32_16x16x64_bf16 v[116:119], v[36:39], v[200:207], v1
  s_waitcnt lgkmcnt(4)
  v_smfmac_f32_16x16x64_bf16 v[96:99], v[40:43], a[144:151], v1
  v_smfmac_f32_16x16x64_bf16 v[100:103], v[40:43], a[16:23], v1
  v_smfmac_f32_16x16x64_bf16 v[104:107], v[40:43], a[208:215], v1
  v_smfmac_f32_16x16x64_bf16 v[108:111], v[40:43], a[80:87], v1
  v_smfmac_f32_16x16x64_bf16 v[96:99], v[44:47], a[152:159], v1
  v_smfmac_f32_16x16x64_bf16 v[100:103], v[44:47], a[24:31], v1
  v_smfmac_f32_16x16x64_bf16 v[104:107], v[44:47], a[216:223], v1
  v_smfmac_f32_16x16x64_bf16 v[108:111], v[44:47], a[88:95], v1
  s_waitcnt lgkmcnt(0)
  v_smfmac_f32_16x16x64_bf16 v[96:99], v[48:51], a[160:167], v1
  s_waitcnt vmcnt(0)
  ds_read_b128 v[64:67], v3 offset:8192
  v_smfmac_f32_16x16x64_bf16 v[100:103], v[48:51], a[32:39], v1
  ds_read_b128 v[80:83], v3 offset:12288
  v_smfmac_f32_16x16x64_bf16 v[104:107], v[48:51], a[224:231], v1
  ds_read_b128 v[68:71], v3 offset:9216
  v_smfmac_f32_16x16x64_bf16 v[108:111], v[48:51], a[96:103], v1
  ds_read_b128 v[84:87], v3 offset:13312
  v_smfmac_f32_16x16x64_bf16 v[96:99], v[52:55], a[168:175], v1
  ds_read_b128 v[72:75], v3 offset:10240
  v_smfmac_f32_16x16x64_bf16 v[100:103], v[52:55], a[40:47], v1
  ds_read_b128 v[88:91], v3 offset:14336
  v_smfmac_f32_16x16x64_bf16 v[104:107], v[52:55], a[232:239], v1
  ds_read_b128 v[76:79], v3 offset:11264
  v_smfmac_f32_16x16x64_bf16 v[108:111], v[52:55], a[104:111], v1
  ds_read_b128 v[92:95], v3 offset:15360
  v_smfmac_f32_16x16x64_bf16 v[96:99], v[56:59], a[176:183], v1
  v_smfmac_f32_16x16x64_bf16 v[100:103], v[56:59], a[48:55], v1
  v_smfmac_f32_16x16x64_bf16 v[104:107], v[56:59], a[240:247], v1
  v_smfmac_f32_16x16x64_bf16 v[108:111], v[56:59], a[112:119], v1
  v_smfmac_f32_16x16x64_bf16 v[96:99], v[60:63], a[184:191], v1
  v_smfmac_f32_16x16x64_bf16 v[100:103], v[60:63], a[56:63], v1
  v_smfmac_f32_16x16x64_bf16 v[104:107], v[60:63], a[248:255], v1
  v_smfmac_f32_16x16x64_bf16 v[108:111], v[60:63], a[120:127], v1
  v_smfmac_f32_16x16x64_bf16 v[112:115], v[40:43], v[144:151], v1
  v_smfmac_f32_16x16x64_bf16 v[116:119], v[40:43], v[208:215], v1
  v_pk_add_f32 v[96:97], v[96:97], v[98:99]
  v_pk_add_f32 v[100:101], v[100:101], v[102:103]
  v_pk_add_f32 v[104:105], v[104:105], v[106:107]
  v_cvt_pk_bf16_f32 v124, v96, v97
  v_cvt_pk_bf16_f32 v125, v100, v101
  v_pk_add_f32 v[108:109], v[108:109], v[110:111]
  ds_write_b64 v11, v[124:125]
  v_cvt_pk_bf16_f32 v126, v104, v105
  v_cvt_pk_bf16_f32 v127, v108, v109
  ds_write_b64 v11, v[126:127] offset:512
  v_smfmac_f32_16x16x64_bf16 v[112:115], v[44:47], v[152:159], v1
  v_smfmac_f32_16x16x64_bf16 v[116:119], v[44:47], v[216:223], v1
  v_smfmac_f32_16x16x64_bf16 v[112:115], v[48:51], v[160:167], v1
  v_smfmac_f32_16x16x64_bf16 v[116:119], v[48:51], v[224:231], v1
  v_smfmac_f32_16x16x64_bf16 v[112:115], v[52:55], v[168:175], v1
  v_smfmac_f32_16x16x64_bf16 v[116:119], v[52:55], v[232:239], v1
  s_waitcnt lgkmcnt(0)
  s_barrier
  ds_read_b64_tr_b16 v[96:97], v12 offset:0
  ds_read_b64_tr_b16 v[98:99], v13 offset:0
  ds_read_b64_tr_b16 v[100:101], v12 offset:1024
  ds_read_b64_tr_b16 v[102:103], v13 offset:1024
  ds_read_b64_tr_b16 v[104:105], v12 offset:2048
  ds_read_b64_tr_b16 v[106:107], v13 offset:2048
  ds_read_b64_tr_b16 v[108:109], v12 offset:3072
  ds_read_b64_tr_b16 v[110:111], v13 offset:3072
  v_smfmac_f32_16x16x64_bf16 v[112:115], v[56:59], v[176:183], v1
  v_smfmac_f32_16x16x64_bf16 v[116:119], v[56:59], v[240:247], v1
  v_smfmac_f32_16x16x64_bf16 v[112:115], v[60:63], v[184:191], v1
  v_smfmac_f32_16x16x64_bf16 v[116:119], v[60:63], v[248:255], v1
  s_waitcnt lgkmcnt(4)
  v_mfma_f32_16x16x32_bf16 v[24:27], v[64:67], v[96:99], 0
  v_mov_b32 v126, 0x3f803f80
  v_mfma_f32_16x16x32_bf16 v[28:31], v[80:83], v[96:99], 0
  ds_read_b128 v[32:35], v16 offset:0
  v_mfma_f32_16x16x32_bf16 v[120:123], v[96:99], v[96:99], 0
  ds_read_b128 v[36:39], v16 offset:32768
  v_mfma_f32_16x16x32_bf16 v[24:27], v[68:71], v[100:103], v[24:27]
  ds_read_b128 v[40:43], v17 offset:0
  v_mfma_f32_16x16x32_bf16 v[28:31], v[84:87], v[100:103], v[28:31]
  ds_read_b128 v[44:47], v17 offset:32768
  v_mfma_f32_16x16x32_bf16 v[120:123], v[100:103], v[100:103], v[120:123]
  v_pk_add_f32 v[112:113], v[112:113], v[114:115]
  s_waitcnt lgkmcnt(4)
  v_mfma_f32_16x16x32_bf16 v[24:27], v[72:75], v[104:107], v[24:27]
  v_pk_add_f32 v[116:117], v[116:117], v[118:119]
  ds_read_b128 v[64:67], v4
  v_mfma_f32_16x16x32_bf16 v[28:31], v[88:91], v[104:107], v[28:31]
  v_cvt_pk_bf16_f32 v20, v112, v113
  ds_read_b128 v[68:71], v4 offset:1024
  v_mfma_f32_16x16x32_bf16 v[120:123], v[104:107], v[104:107], v[120:123]
  v_cvt_pk_bf16_f32 v21, v116, v117
  v_mov_b32 v127, 0x3f803f80
  v_mfma_f32_16x16x32_bf16 v[24:27], v[76:79], v[108:111], v[24:27]
  v_cvt_pk_bf16_f32 v22, v116, v117
  v_mfma_f32_16x16x32_bf16 v[28:31], v[92:95], v[108:111], v[28:31]
  v_cvt_pk_bf16_f32 v23, v112, v113
  v_mfma_f32_16x16x32_bf16 v[120:123], v[108:111], v[108:111], v[120:123]
  ds_read_b128 v[48:51], v16 offset:1024
  s_cmp_eq_u32 s10, 63
  s_cbranch_scc1 L_chain_done
  ds_read_b128 v[52:55], v16 offset:33792
  v_max3_f32 v124, v24, v25, v26
  v_max3_f32 v125, v27, v28, v29
  v_max3_f32 v124, v124, v30, v31
  s_nop 0
  v_max3_f32 v125, v125, v120, v121
  v_max_f32 v124, v124, v125
  v_max_f32 v125, v124, v125
  ds_read_b128 v[56:59], v17 offset:1024
  s_nop 0
  v_permlane16_swap_b32 v124, v125
  v_max_f32 v124, v124, v125
  v_mov_b32 v125, v124
  ds_read_b128 v[60:63], v17 offset:33792
  s_nop 0
  v_permlane32_swap_b32 v124, v125
  v_max_f32 v124, v124, v125
  v_mul_f32 v124, s41, v124
  v_pk_fma_f32 v[24:25], v[24:25], s[40:41], v[124:125] op_sel_hi:[1,0,0]
  v_pk_fma_f32 v[26:27], v[26:27], s[40:41], v[124:125] op_sel_hi:[1,0,0]
  v_pk_fma_f32 v[28:29], v[28:29], s[40:41], v[124:125] op_sel_hi:[1,0,0]
  v_pk_fma_f32 v[30:31], v[30:31], s[40:41], v[124:125] op_sel_hi:[1,0,0]
  v_pk_fma_f32 v[120:121], v[120:121], s[40:41], v[124:125] op_sel_hi:[1,0,0]
  v_exp_f32 v24, v24
  v_exp_f32 v25, v25
  v_exp_f32 v26, v26
  v_exp_f32 v27, v27
  v_exp_f32 v28, v28
  v_exp_f32 v29, v29
  v_cvt_pk_bf16_f32 v72, v24, v25
  v_exp_f32 v30, v30
  v_exp_f32 v31, v31
  v_cvt_pk_bf16_f32 v73, v26, v27
  v_cvt_pk_bf16_f32 v74, v28, v29
  v_exp_f32 v120, v120
  v_cvt_pk_bf16_f32 v75, v30, v31
  v_exp_f32 v121, v121
  s_nop 0
  v_cvt_pk_bf16_f32 v18, v120, v121
  s_waitcnt lgkmcnt(4)
  v_mfma_f32_16x16x16_bf16 v[120:123], v[126:127], v[72:73], 0
  v_mfma_f32_16x16x16_bf16 v[120:123], v[126:127], v[74:75], v[120:123]
  v_mfma_f32_16x16x16_bf16 v[120:123], v[126:127], v[18:19], v[120:123]
  v_mfma_f32_16x16x32_bf16 v[80:83], v[64:67], v[72:75], 0
  ds_read_b128 v[112:115], v16 offset:2048
  v_mfma_f32_16x16x32_bf16 v[84:87], v[68:71], v[72:75], 0
  ds_read_b128 v[116:119], v16 offset:34816
  v_mfma_f32_16x16x16_bf16 v[80:83], v[20:21], v[18:19], v[80:83]
  v_rcp_f32 v124, v120
  v_mfma_f32_16x16x16_bf16 v[84:87], v[22:23], v[18:19], v[84:87]
  s_nop 4
  v_pk_mul_f32 v[80:81], v[80:81], v[124:125] op_sel_hi:[1,0]
  v_pk_mul_f32 v[82:83], v[82:83], v[124:125] op_sel_hi:[1,0]
  s_nop 0
  v_pk_mul_f32 v[84:85], v[84:85], v[124:125] op_sel_hi:[1,0]
  v_pk_mul_f32 v[86:87], v[86:87], v[124:125] op_sel_hi:[1,0]
  v_cvt_pk_bf16_f32 v24, v80, v81
  v_cvt_pk_bf16_f32 v25, v82, v83
  v_cvt_pk_bf16_f32 v26, v84, v85
  v_cvt_pk_bf16_f32 v27, v86, v87
  ds_write2_b64 v14, v[24:25], v[26:27] offset0:0 offset1:4
  v_mfma_f32_32x32x8_bf16 v[64:79], v[6:7], v[6:7], 0
  ds_read_b128 v[96:99], v17 offset:2048
  ds_read_b128 v[100:103], v17 offset:34816
  v_mfma_f32_32x32x8_bf16 v[80:95], v[6:7], v[6:7], 0
  ds_read_b128 v[104:107], v16 offset:3072
  ds_read_b128 v[108:111], v16 offset:35840
  s_waitcnt lgkmcnt(4)
  s_barrier
  ds_read_b128 v[24:27], v15
  ds_read_b128 v[28:31], v15 offset:128
  ds_read_b128 v[120:123], v17 offset:3072
  ds_read_b128 v[124:127], v17 offset:35840
  s_add_u32 m0, s50, 143360
  s_nop 0
  global_load_lds_dwordx4 v2, s[32:33] sc1
  global_load_lds_dwordx4 v2, s[32:33] offset:1024 sc1
  s_add_u32 m0, s50, 151552
  s_nop 0
  global_load_lds_dwordx4 v2, s[34:35] sc1
  global_load_lds_dwordx4 v2, s[34:35] offset:1024 sc1
  s_waitcnt lgkmcnt(2)
  v_smfmac_f32_16x16x64_bf16 v[64:67], v[24:27], v[32:39], v1
  ds_read_b128 v[32:35], v16 offset:4096
  ds_read_b128 v[36:39], v16 offset:36864
  v_smfmac_f32_16x16x64_bf16 v[64:67], v[28:31], v[40:47], v1
  ds_read_b128 v[40:43], v17 offset:4096
  ds_read_b128 v[44:47], v17 offset:36864
  v_smfmac_f32_16x16x64_bf16 v[68:71], v[24:27], v[48:55], v1
  ds_read_b128 v[48:51], v16 offset:5120
  ds_read_b128 v[52:55], v16 offset:37888
  v_smfmac_f32_16x16x64_bf16 v[68:71], v[28:31], v[56:63], v1
  ds_read_b128 v[56:59], v17 offset:5120
  ds_read_b128 v[60:63], v17 offset:37888
  v_pk_add_f32 v[64:65], v[64:65], v[66:67]
  v_cvt_pk_bf16_f32 v20, v64, v65
  v_smfmac_f32_16x16x64_bf16 v[72:75], v[24:27], v[112:119], v1
  ds_read_b128 v[112:115], v16 offset:6144
  ds_read_b128 v[116:119], v16 offset:38912
  v_smfmac_f32_16x16x64_bf16 v[72:75], v[28:31], v[96:103], v1
  ds_read_b128 v[96:99], v17 offset:6144
  ds_read_b128 v[100:103], v17 offset:38912
  v_pk_add_f32 v[68:69], v[68:69], v[70:71]
  v_cvt_pk_bf16_f32 v21, v68, v69
  v_smfmac_f32_16x16x64_bf16 v[76:79], v[24:27], v[104:111], v1
  ds_read_b128 v[104:107], v16 offset:7168
  ds_read_b128 v[108:111], v16 offset:39936
  s_waitcnt lgkmcnt(12)
  v_smfmac_f32_16x16x64_bf16 v[76:79], v[28:31], v[120:127], v1
  ds_read_b128 v[120:123], v17 offset:7168
  ds_read_b128 v[124:127], v17 offset:39936
  v_pk_add_f32 v[72:73], v[72:73], v[74:75]
  v_cvt_pk_bf16_f32 v22, v72, v73
  v_smfmac_f32_16x16x64_bf16 v[80:83], v[24:27], v[32:39], v1
  s_waitcnt lgkmcnt(10)
  v_smfmac_f32_16x16x64_bf16 v[80:83], v[28:31], v[40:47], v1
  v_pk_add_f32 v[76:77], v[76:77], v[78:79]
  v_cvt_pk_bf16_f32 v23, v76, v77
  v_bfi_b32 v20, 1, s43, v20
  global_store_dwordx4 v8, v[20:23], s[28:29] sc1
  v_smfmac_f32_16x16x64_bf16 v[84:87], v[24:27], v[48:55], v1
  s_waitcnt lgkmcnt(6)
  v_smfmac_f32_16x16x64_bf16 v[84:87], v[28:31], v[56:63], v1
  v_pk_add_f32 v[80:81], v[80:81], v[82:83]
  v_cvt_pk_bf16_f32 v64, v80, v81
  v_smfmac_f32_16x16x64_bf16 v[88:91], v[24:27], v[112:119], v1
  s_waitcnt lgkmcnt(2)
  v_smfmac_f32_16x16x64_bf16 v[88:91], v[28:31], v[96:103], v1
  s_nop 0
  v_pk_add_f32 v[84:85], v[84:85], v[86:87]
  v_cvt_pk_bf16_f32 v65, v84, v85
  v_smfmac_f32_16x16x64_bf16 v[92:95], v[24:27], v[104:111], v1
  s_waitcnt lgkmcnt(0)
  v_smfmac_f32_16x16x64_bf16 v[92:95], v[28:31], v[120:127], v1
  s_nop 0
  v_pk_add_f32 v[88:89], v[88:89], v[90:91]
  v_cvt_pk_bf16_f32 v66, v88, v89
  v_bfi_b32 v64, 1, s43, v64
  s_nop 3
  v_pk_add_f32 v[92:93], v[92:93], v[94:95]
  v_cvt_pk_bf16_f32 v67, v92, v93
  global_store_dwordx4 v8, v[64:67], s[30:31] sc1
  s_add_u32 s32, s32, 262144
  s_addc_u32 s33, s33, 0
  s_add_u32 s34, s34, 262144
  s_addc_u32 s35, s35, 0
  s_add_u32 s10, s10, 1
  v_mfma_f32_32x32x8_bf16 v[96:111], v[6:7], v[6:7], 0
  v_pk_mov_b32 v[112:113], 0, 0
  v_pk_mov_b32 v[114:115], 0, 0
  v_pk_mov_b32 v[116:117], 0, 0
  v_pk_mov_b32 v[118:119], 0, 0
  v_add_u32 v24, s50, v3
  v_add_u32 v25, s51, v3
  v_add_u32 v26, s52, v3
  v_add_u32 v27, s53, v3
  v_bfe_u32 v36, v0, 4, 3
  v_mov_b32 v37, 0x3f80
  v_mov_b32 v38, 0x3f800000
  v_cmp_eq_u32 vcc, 0, v36
  s_nop 1
  v_cndmask_b32 v32, 0, v37, vcc
  v_cmp_eq_u32 vcc, 1, v36
  s_nop 1
  v_cndmask_b32 v32, v32, v38, vcc
  v_cmp_eq_u32 vcc, 2, v36
  s_nop 1
  v_cndmask_b32 v33, 0, v37, vcc
  v_cmp_eq_u32 vcc, 3, v36
  s_nop 1
  v_cndmask_b32 v33, v33, v38, vcc
  v_cmp_eq_u32 vcc, 4, v36
  s_nop 1
  v_cndmask_b32 v34, 0, v37, vcc
  v_cmp_eq_u32 vcc, 5, v36
  s_nop 1
  v_cndmask_b32 v34, v34, v38, vcc
  v_cmp_eq_u32 vcc, 6, v36
  s_nop 1
  v_cndmask_b32 v35, 0, v37, vcc
  v_cmp_eq_u32 vcc, 7, v36
  s_nop 1
  v_cndmask_b32 v35, v35, v38, vcc
  s_nop 4
  global_load_dwordx4 v[68:71], v9, s[28:29] offset:0 sc1
  global_load_dwordx4 v[72:75], v9, s[28:29] offset:1024 sc1
  global_load_dwordx4 v[76:79], v9, s[28:29] offset:2048 sc1
  global_load_dwordx4 v[80:83], v9, s[28:29] offset:3072 sc1
  s_nop 15
  s_nop 15
  s_nop 7
L_pollp_slow_n:
  global_load_dwordx4 v[40:43], v9, s[28:29] offset:0 sc1
  global_load_dwordx4 v[44:47], v9, s[28:29] offset:1024 sc1
  global_load_dwordx4 v[48:51], v9, s[28:29] offset:2048 sc1
  global_load_dwordx4 v[52:55], v9, s[28:29] offset:3072 sc1
  s_waitcnt vmcnt(4)
  v_mfma_f32_16x16x32_bf16 v[84:87], v[32:35], v[68:71], 0
  v_mfma_f32_16x16x32_bf16 v[84:87], v[32:35], v[72:75], v[84:87]
  v_mfma_f32_16x16x32_bf16 v[84:87], v[32:35], v[76:79], v[84:87]
  v_mfma_f32_16x16x32_bf16 v[84:87], v[32:35], v[80:83], v[84:87]
  v_bitop3_b32 v124, v68, v72, s43 bitop3:0x7e
  v_bitop3_b32 v125, v76, v80, s43 bitop3:0x7e
  v_bitop3_b32 v124, v124, v125, 1 bitop3:0xa8
  v_cmp_ne_u32 vcc, 0, v124
  s_nop 0
  s_cbranch_vccz L_gotp_slow_n
  global_load_dwordx4 v[68:71], v9, s[28:29] offset:0 sc1
  global_load_dwordx4 v[72:75], v9, s[28:29] offset:1024 sc1
  global_load_dwordx4 v[76:79], v9, s[28:29] offset:2048 sc1
  global_load_dwordx4 v[80:83], v9, s[28:29] offset:3072 sc1
  s_add_u32 s42, s42, 1
  s_cmp_gt_u32 s42, 0x40000
  s_cbranch_scc1 L_chain_abort
  s_waitcnt vmcnt(4)
  v_mfma_f32_16x16x32_bf16 v[84:87], v[32:35], v[40:43], 0
  v_mfma_f32_16x16x32_bf16 v[84:87], v[32:35], v[44:47], v[84:87]
  v_mfma_f32_16x16x32_bf16 v[84:87], v[32:35], v[48:51], v[84:87]
  v_mfma_f32_16x16x32_bf16 v[84:87], v[32:35], v[52:55], v[84:87]
  v_bitop3_b32 v124, v40, v44, s43 bitop3:0x7e
  v_bitop3_b32 v125, v48, v52, s43 bitop3:0x7e
  v_bitop3_b32 v124, v124, v125, 1 bitop3:0xa8
  v_cmp_ne_u32 vcc, 0, v124
  s_nop 0
  s_cbranch_vccnz L_pollp_slow_n
L_gotp_slow_n:
  s_nop 1
  v_add_f32_dpp v84, v84, v84 row_ror:8 row_mask:0xf bank_mask:0xf
  v_add_f32_dpp v85, v85, v85 row_ror:8 row_mask:0xf bank_mask:0xf
  v_add_f32_dpp v86, v86, v86 row_ror:8 row_mask:0xf bank_mask:0xf
  v_add_f32_dpp v87, v87, v87 row_ror:8 row_mask:0xf bank_mask:0xf
  v_cvt_pk_bf16_f32 v124, v84, v86
  v_cvt_pk_bf16_f32 v125, v85, v87
  v_cndmask_b32 v124, v124, v125, s[46:47]
  global_store_dword v10, v124, s[24:25] sc1
  v_mov_b32 v126, -1
  global_store_dword v10, v126, s[26:27] sc1
  s_mov_b64 s[14:15], s[26:27]
  s_mov_b64 s[26:27], s[24:25]
  s_mov_b64 s[24:25], s[14:15]
  s_xor_b32 s43, s43, 1
  s_barrier
  s_branch L_step_slow_n
L_step_slow_f2:
  s_nop 9
  global_load_dwordx4 v[32:35], v2, s[26:27] sc1
  global_load_dwordx4 v[36:39], v2, s[26:27] offset:1024 sc1
  s_nop 15
  s_nop 8
L_pollm_slow_f2:
  global_load_dwordx4 v[64:67], v2, s[26:27] sc1
  global_load_dwordx4 v[68:71], v2, s[26:27] offset:1024 sc1
  s_waitcnt vmcnt(2)
  v_max3_u32 v124, v32, v33, v34
  v_max3_u32 v125, v35, v36, v37
  v_max3_u32 v124, v124, v38, v39
  v_max_u32 v124, v124, v125
  v_cmp_eq_u32 vcc, -1, v124
  s_nop 0
  s_cbranch_vccz L_gotm_slow_f2
  global_load_dwordx4 v[32:35], v2, s[26:27] sc1
  global_load_dwordx4 v[36:39], v2, s[26:27] offset:1024 sc1
  s_add_u32 s42, s42, 1
  s_cmp_gt_u32 s42, 0x40000
  s_cbranch_scc1 L_chain_abort
  s_waitcnt vmcnt(2)
  v_max3_u32 v124, v64, v65, v66
  v_max3_u32 v125, v67, v68, v69
  v_max3_u32 v124, v124, v70, v71
  v_max_u32 v124, v124, v125
  v_cmp_eq_u32 vcc, -1, v124
  s_nop 0
  s_cbranch_vccnz L_pollm2_slow_f2
  v_pk_mov_b32 v[32:33], v[64:65], v[64:65] op_sel:[0,1]
  v_pk_mov_b32 v[34:35], v[66:67], v[66:67] op_sel:[0,1]
  v_pk_mov_b32 v[36:37], v[68:69], v[68:69] op_sel:[0,1]
  v_pk_mov_b32 v[38:39], v[70:71], v[70:71] op_sel:[0,1]
  s_branch L_gotm2_slow_f2
L_pollm2_slow_f2:
  s_branch L_pollm_slow_f2
L_gotm_slow_f2:
L_gotm2_slow_f2:
  ds_write_b128 v24, v[32:35]
  v_smfmac_f32_16x16x64_bf16 v[96:99], v[32:35], a[128:135], v1
  ds_write_b128 v24, v[36:39] offset:1024
  v_smfmac_f32_16x16x64_bf16 v[100:103], v[32:35], a[0:7], v1
  v_cmp_ne_u32 vcc, 0, v5
  s_nop 0
  s_and_b32 s12, vcc_lo, s11
  s_cmp_eq_u32 s12, s11
  s_cbranch_scc0 L_fslow_slow_f2
L_fok_14:
  v_lshlrev_b32 v5, 3, v0
  global_load_dword v5, v5, s[48:49]
  v_smfmac_f32_16x16x64_bf16 v[104:107], v[32:35], a[192:199], v1
  v_bfe_u32 v20, v0, 4, 1
  v_lshl_add_u32 v20, v20, 11, s54
  global_load_dword v5, v20, s[58:59] sc1
  v_smfmac_f32_16x16x64_bf16 v[108:111], v[32:35], a[64:71], v1
  v_smfmac_f32_16x16x64_bf16 v[112:115], v[32:35], v[128:135], v1
  v_smfmac_f32_16x16x64_bf16 v[116:119], v[32:35], v[192:199], v1
  s_waitcnt lgkmcnt(0)
  s_barrier
  ds_read_b128 v[40:43], v25
  ds_read_b128 v[44:47], v25 offset:1024
  v_smfmac_f32_16x16x64_bf16 v[96:99], v[36:39], a[136:143], v1
  ds_read_b128 v[48:51], v26
  v_smfmac_f32_16x16x64_bf16 v[100:103], v[36:39], a[8:15], v1
  ds_read_b128 v[52:55], v26 offset:1024
  v_smfmac_f32_16x16x64_bf16 v[104:107], v[36:39], a[200:207], v1
  ds_read_b128 v[56:59], v27
  v_smfmac_f32_16x16x64_bf16 v[108:111], v[36:39], a[72:79], v1
  ds_read_b128 v[60:63], v27 offset:1024
  v_smfmac_f32_16x16x64_bf16 v[112:115], v[36:39], v[136:143], v1
  v_smfmac_f32_16x16x64_bf16 v[116:119], v[36:39], v[200:207], v1
  s_waitcnt lgkmcnt(4)
  v_smfmac_f32_16x16x64_bf16 v[96:99], v[40:43], a[144:151], v1
  v_smfmac_f32_16x16x64_bf16 v[100:103], v[40:43], a[16:23], v1
  v_smfmac_f32_16x16x64_bf16 v[104:107], v[40:43], a[208:215], v1
  v_smfmac_f32_16x16x64_bf16 v[108:111], v[40:43], a[80:87], v1
  v_smfmac_f32_16x16x64_bf16 v[96:99], v[44:47], a[152:159], v1
  v_smfmac_f32_16x16x64_bf16 v[100:103], v[44:47], a[24:31], v1
  v_smfmac_f32_16x16x64_bf16 v[104:107], v[44:47], a[216:223], v1
  v_smfmac_f32_16x16x64_bf16 v[108:111], v[44:47], a[88:95], v1
  s_waitcnt lgkmcnt(0)
  v_smfmac_f32_16x16x64_bf16 v[96:99], v[48:51], a[160:167], v1
  s_waitcnt vmcnt(2)
  ds_read_b128 v[64:67], v3 offset:8192
  v_smfmac_f32_16x16x64_bf16 v[100:103], v[48:51], a[32:39], v1
  ds_read_b128 v[80:83], v3 offset:12288
  v_smfmac_f32_16x16x64_bf16 v[104:107], v[48:51], a[224:231], v1
  ds_read_b128 v[68:71], v3 offset:9216
  v_smfmac_f32_16x16x64_bf16 v[108:111], v[48:51], a[96:103], v1
  ds_read_b128 v[84:87], v3 offset:13312
  v_smfmac_f32_16x16x64_bf16 v[96:99], v[52:55], a[168:175], v1
  ds_read_b128 v[72:75], v3 offset:10240
  v_smfmac_f32_16x16x64_bf16 v[100:103], v[52:55], a[40:47], v1
  ds_read_b128 v[88:91], v3 offset:14336
  v_smfmac_f32_16x16x64_bf16 v[104:107], v[52:55], a[232:239], v1
  ds_read_b128 v[76:79], v3 offset:11264
  v_smfmac_f32_16x16x64_bf16 v[108:111], v[52:55], a[104:111], v1
  ds_read_b128 v[92:95], v3 offset:15360
  v_smfmac_f32_16x16x64_bf16 v[96:99], v[56:59], a[176:183], v1
  v_and_b32 v20, 0xf0, v0
  v_smfmac_f32_16x16x64_bf16 v[100:103], v[56:59], a[48:55], v1
  v_add_u32 v21, s22, v20
  v_smfmac_f32_16x16x64_bf16 v[104:107], v[56:59], a[240:247], v1
  ds_read_b128 v[28:31], v21
  v_smfmac_f32_16x16x64_bf16 v[108:111], v[56:59], a[112:119], v1
  v_add_u32 v21, s23, v20
  v_smfmac_f32_16x16x64_bf16 v[96:99], v[60:63], a[184:191], v1
  v_smfmac_f32_16x16x64_bf16 v[100:103], v[60:63], a[56:63], v1
  v_smfmac_f32_16x16x64_bf16 v[104:107], v[60:63], a[248:255], v1
  v_smfmac_f32_16x16x64_bf16 v[108:111], v[60:63], a[120:127], v1
  v_smfmac_f32_16x16x64_bf16 v[112:115], v[40:43], v[144:151], v1
  v_smfmac_f32_16x16x64_bf16 v[116:119], v[40:43], v[208:215], v1
  v_pk_add_f32 v[96:97], v[96:97], v[98:99]
  v_pk_add_f32 v[100:101], v[100:101], v[102:103]
  v_pk_add_f32 v[104:105], v[104:105], v[106:107]
  v_cvt_pk_bf16_f32 v124, v96, v97
  v_cvt_pk_bf16_f32 v125, v100, v101
  v_pk_add_f32 v[108:109], v[108:109], v[110:111]
  ds_write_b64 v11, v[124:125]
  v_cvt_pk_bf16_f32 v126, v104, v105
  v_cvt_pk_bf16_f32 v127, v108, v109
  ds_write_b64 v11, v[126:127] offset:512
  v_smfmac_f32_16x16x64_bf16 v[112:115], v[44:47], v[152:159], v1
  v_smfmac_f32_16x16x64_bf16 v[116:119], v[44:47], v[216:223], v1
  v_smfmac_f32_16x16x64_bf16 v[112:115], v[48:51], v[160:167], v1
  v_smfmac_f32_16x16x64_bf16 v[116:119], v[48:51], v[224:231], v1
  v_smfmac_f32_16x16x64_bf16 v[112:115], v[52:55], v[168:175], v1
  v_smfmac_f32_16x16x64_bf16 v[116:119], v[52:55], v[232:239], v1
  s_waitcnt lgkmcnt(0)
  s_mov_b64 exec, 0xffff
  global_store_dwordx4 v21, v[28:31], s[36:37] sc1
  s_mov_b64 exec, -1
  s_barrier
  ds_read_b64_tr_b16 v[96:97], v12 offset:0
  ds_read_b64_tr_b16 v[98:99], v13 offset:0
  ds_read_b64_tr_b16 v[100:101], v12 offset:1024
  ds_read_b64_tr_b16 v[102:103], v13 offset:1024
  ds_read_b64_tr_b16 v[104:105], v12 offset:2048
  ds_read_b64_tr_b16 v[106:107], v13 offset:2048
  ds_read_b64_tr_b16 v[108:109], v12 offset:3072
  ds_read_b64_tr_b16 v[110:111], v13 offset:3072
  v_smfmac_f32_16x16x64_bf16 v[112:115], v[56:59], v[176:183], v1
  v_smfmac_f32_16x16x64_bf16 v[116:119], v[56:59], v[240:247], v1
  v_smfmac_f32_16x16x64_bf16 v[112:115], v[60:63], v[184:191], v1
  v_smfmac_f32_16x16x64_bf16 v[116:119], v[60:63], v[248:255], v1
  s_waitcnt lgkmcnt(4)
  v_mfma_f32_16x16x32_bf16 v[24:27], v[64:67], v[96:99], 0
  v_mov_b32 v126, 0x3f803f80
  v_mfma_f32_16x16x32_bf16 v[28:31], v[80:83], v[96:99], 0
  ds_read_b128 v[32:35], v16 offset:0
  v_mfma_f32_16x16x32_bf16 v[120:123], v[96:99], v[96:99], 0
  ds_read_b128 v[36:39], v16 offset:32768
  v_mfma_f32_16x16x32_bf16 v[24:27], v[68:71], v[100:103], v[24:27]
  ds_read_b128 v[40:43], v17 offset:0
  v_mfma_f32_16x16x32_bf16 v[28:31], v[84:87], v[100:103], v[28:31]
  ds_read_b128 v[44:47], v17 offset:32768
  v_mfma_f32_16x16x32_bf16 v[120:123], v[100:103], v[100:103], v[120:123]
  v_pk_add_f32 v[112:113], v[112:113], v[114:115]
  s_waitcnt lgkmcnt(4)
  v_mfma_f32_16x16x32_bf16 v[24:27], v[72:75], v[104:107], v[24:27]
  v_pk_add_f32 v[116:117], v[116:117], v[118:119]
  ds_read_b128 v[64:67], v4
  v_mfma_f32_16x16x32_bf16 v[28:31], v[88:91], v[104:107], v[28:31]
  v_cvt_pk_bf16_f32 v20, v112, v113
  ds_read_b128 v[68:71], v4 offset:1024
  v_mfma_f32_16x16x32_bf16 v[120:123], v[104:107], v[104:107], v[120:123]
  v_cvt_pk_bf16_f32 v21, v116, v117
  v_mov_b32 v127, 0x3f803f80
  v_mfma_f32_16x16x32_bf16 v[24:27], v[76:79], v[108:111], v[24:27]
  v_cvt_pk_bf16_f32 v22, v116, v117
  v_mfma_f32_16x16x32_bf16 v[28:31], v[92:95], v[108:111], v[28:31]
  v_cvt_pk_bf16_f32 v23, v112, v113
  v_mfma_f32_16x16x32_bf16 v[120:123], v[108:111], v[108:111], v[120:123]
  ds_read_b128 v[48:51], v16 offset:1024
  s_cmp_eq_u32 s10, 63
  s_cbranch_scc1 L_chain_done
  ds_read_b128 v[52:55], v16 offset:33792
  v_max3_f32 v124, v24, v25, v26
  v_max3_f32 v125, v27, v28, v29
  v_max3_f32 v124, v124, v30, v31
  s_nop 0
  v_max3_f32 v125, v125, v120, v121
  v_max_f32 v124, v124, v125
  v_max_f32 v125, v124, v125
  ds_read_b128 v[56:59], v17 offset:1024
  s_nop 0
  v_permlane16_swap_b32 v124, v125
  v_max_f32 v124, v124, v125
  v_mov_b32 v125, v124
  ds_read_b128 v[60:63], v17 offset:33792
  s_nop 0
  v_permlane32_swap_b32 v124, v125
  v_max_f32 v124, v124, v125
  v_mul_f32 v124, s41, v124
  v_pk_fma_f32 v[24:25], v[24:25], s[40:41], v[124:125] op_sel_hi:[1,0,0]
  v_pk_fma_f32 v[26:27], v[26:27], s[40:41], v[124:125] op_sel_hi:[1,0,0]
  v_pk_fma_f32 v[28:29], v[28:29], s[40:41], v[124:125] op_sel_hi:[1,0,0]
  v_pk_fma_f32 v[30:31], v[30:31], s[40:41], v[124:125] op_sel_hi:[1,0,0]
  v_pk_fma_f32 v[120:121], v[120:121], s[40:41], v[124:125] op_sel_hi:[1,0,0]
  v_exp_f32 v24, v24
  v_exp_f32 v25, v25
  v_exp_f32 v26, v26
  v_exp_f32 v27, v27
  v_exp_f32 v28, v28
  v_exp_f32 v29, v29
  v_cvt_pk_bf16_f32 v72, v24, v25
  v_exp_f32 v30, v30
  v_exp_f32 v31, v31
  v_cvt_pk_bf16_f32 v73, v26, v27
  v_cvt_pk_bf16_f32 v74, v28, v29
  v_exp_f32 v120, v120
  v_cvt_pk_bf16_f32 v75, v30, v31
  v_exp_f32 v121, v121
  s_nop 0
  v_cvt_pk_bf16_f32 v18, v120, v121
  s_waitcnt lgkmcnt(4)
  v_mfma_f32_16x16x16_bf16 v[120:123], v[126:127], v[72:73], 0
  v_mfma_f32_16x16x16_bf16 v[120:123], v[126:127], v[74:75], v[120:123]
  v_mfma_f32_16x16x16_bf16 v[120:123], v[126:127], v[18:19], v[120:123]
  v_mfma_f32_16x16x32_bf16 v[80:83], v[64:67], v[72:75], 0
  ds_read_b128 v[112:115], v16 offset:2048
  v_mfma_f32_16x16x32_bf16 v[84:87], v[68:71], v[72:75], 0
  ds_read_b128 v[116:119], v16 offset:34816
  v_mfma_f32_16x16x16_bf16 v[80:83], v[20:21], v[18:19], v[80:83]
  v_rcp_f32 v124, v120
  v_mfma_f32_16x16x16_bf16 v[84:87], v[22:23], v[18:19], v[84:87]
  s_nop 4
  v_pk_mul_f32 v[80:81], v[80:81], v[124:125] op_sel_hi:[1,0]
  v_pk_mul_f32 v[82:83], v[82:83], v[124:125] op_sel_hi:[1,0]
  s_nop 0
  v_pk_mul_f32 v[84:85], v[84:85], v[124:125] op_sel_hi:[1,0]
  v_pk_mul_f32 v[86:87], v[86:87], v[124:125] op_sel_hi:[1,0]
  v_cvt_pk_bf16_f32 v24, v80, v81
  v_cvt_pk_bf16_f32 v25, v82, v83
  v_cvt_pk_bf16_f32 v26, v84, v85
  v_cvt_pk_bf16_f32 v27, v86, v87
  ds_write2_b64 v14, v[24:25], v[26:27] offset0:0 offset1:4
  v_mfma_f32_32x32x8_bf16 v[64:79], v[6:7], v[6:7], 0
  ds_read_b128 v[96:99], v17 offset:2048
  ds_read_b128 v[100:103], v17 offset:34816
  v_mfma_f32_32x32x8_bf16 v[80:95], v[6:7], v[6:7], 0
  ds_read_b128 v[104:107], v16 offset:3072
  ds_read_b128 v[108:111], v16 offset:35840
  s_waitcnt lgkmcnt(4)
  s_barrier
  ds_read_b128 v[24:27], v15
  ds_read_b128 v[28:31], v15 offset:128
  ds_read_b128 v[120:123], v17 offset:3072
  ds_read_b128 v[124:127], v17 offset:35840
  s_add_u32 m0, s50, 143360
  s_nop 0
  global_load_lds_dwordx4 v2, s[32:33] sc1
  global_load_lds_dwordx4 v2, s[32:33] offset:1024 sc1
  s_add_u32 m0, s50, 151552
  s_nop 0
  global_load_lds_dwordx4 v2, s[34:35] sc1
  global_load_lds_dwordx4 v2, s[34:35] offset:1024 sc1
  s_waitcnt lgkmcnt(2)
  v_smfmac_f32_16x16x64_bf16 v[64:67], v[24:27], v[32:39], v1
  ds_read_b128 v[32:35], v16 offset:4096
  ds_read_b128 v[36:39], v16 offset:36864
  v_smfmac_f32_16x16x64_bf16 v[64:67], v[28:31], v[40:47], v1
  ds_read_b128 v[40:43], v17 offset:4096
  ds_read_b128 v[44:47], v17 offset:36864
  v_smfmac_f32_16x16x64_bf16 v[68:71], v[24:27], v[48:55], v1
  ds_read_b128 v[48:51], v16 offset:5120
  ds_read_b128 v[52:55], v16 offset:37888
  v_smfmac_f32_16x16x64_bf16 v[68:71], v[28:31], v[56:63], v1
  ds_read_b128 v[56:59], v17 offset:5120
  ds_read_b128 v[60:63], v17 offset:37888
  v_pk_add_f32 v[64:65], v[64:65], v[66:67]
  v_cvt_pk_bf16_f32 v20, v64, v65
  v_smfmac_f32_16x16x64_bf16 v[72:75], v[24:27], v[112:119], v1
  ds_read_b128 v[112:115], v16 offset:6144
  ds_read_b128 v[116:119], v16 offset:38912
  v_smfmac_f32_16x16x64_bf16 v[72:75], v[28:31], v[96:103], v1
  ds_read_b128 v[96:99], v17 offset:6144
  ds_read_b128 v[100:103], v17 offset:38912
  v_pk_add_f32 v[68:69], v[68:69], v[70:71]
  v_cvt_pk_bf16_f32 v21, v68, v69
  v_smfmac_f32_16x16x64_bf16 v[76:79], v[24:27], v[104:111], v1
  ds_read_b128 v[104:107], v16 offset:7168
  ds_read_b128 v[108:111], v16 offset:39936
  s_waitcnt lgkmcnt(12)
  v_smfmac_f32_16x16x64_bf16 v[76:79], v[28:31], v[120:127], v1
  ds_read_b128 v[120:123], v17 offset:7168
  ds_read_b128 v[124:127], v17 offset:39936
  v_pk_add_f32 v[72:73], v[72:73], v[74:75]
  v_cvt_pk_bf16_f32 v22, v72, v73
  v_smfmac_f32_16x16x64_bf16 v[80:83], v[24:27], v[32:39], v1
  s_waitcnt lgkmcnt(10)
  v_smfmac_f32_16x16x64_bf16 v[80:83], v[28:31], v[40:47], v1
  v_pk_add_f32 v[76:77], v[76:77], v[78:79]
  v_cvt_pk_bf16_f32 v23, v76, v77
  v_bfi_b32 v20, 1, s43, v20
  global_store_dwordx4 v8, v[20:23], s[28:29] sc1
  v_smfmac_f32_16x16x64_bf16 v[84:87], v[24:27], v[48:55], v1
  s_waitcnt lgkmcnt(6)
  v_smfmac_f32_16x16x64_bf16 v[84:87], v[28:31], v[56:63], v1
  v_pk_add_f32 v[80:81], v[80:81], v[82:83]
  v_cvt_pk_bf16_f32 v64, v80, v81
  v_smfmac_f32_16x16x64_bf16 v[88:91], v[24:27], v[112:119], v1
  s_waitcnt lgkmcnt(2)
  v_smfmac_f32_16x16x64_bf16 v[88:91], v[28:31], v[96:103], v1
  s_nop 0
  v_pk_add_f32 v[84:85], v[84:85], v[86:87]
  v_cvt_pk_bf16_f32 v65, v84, v85
  v_smfmac_f32_16x16x64_bf16 v[92:95], v[24:27], v[104:111], v1
  s_waitcnt lgkmcnt(0)
  v_smfmac_f32_16x16x64_bf16 v[92:95], v[28:31], v[120:127], v1
  s_nop 0
  v_pk_add_f32 v[88:89], v[88:89], v[90:91]
  v_cvt_pk_bf16_f32 v66, v88, v89
  v_bfi_b32 v64, 1, s43, v64
  s_nop 3
  v_pk_add_f32 v[92:93], v[92:93], v[94:95]
  v_cvt_pk_bf16_f32 v67, v92, v93
  global_store_dwordx4 v8, v[64:67], s[30:31] sc1
  s_add_u32 s32, s32, 262144
  s_addc_u32 s33, s33, 0
  s_add_u32 s34, s34, 262144
  s_addc_u32 s35, s35, 0
  s_add_u32 s10, s10, 1
  v_mfma_f32_32x32x8_bf16 v[96:111], v[6:7], v[6:7], 0
  v_pk_mov_b32 v[112:113], 0, 0
  v_pk_mov_b32 v[114:115], 0, 0
  v_pk_mov_b32 v[116:117], 0, 0
  v_pk_mov_b32 v[118:119], 0, 0
  v_add_u32 v24, s50, v3
  v_add_u32 v25, s51, v3
  v_add_u32 v26, s52, v3
  v_add_u32 v27, s53, v3
  s_add_u32 s36, s36, 8192
  s_addc_u32 s37, s37, 0
  s_cmp_lt_u32 s10, 62
  s_cselect_b32 s12, 262144, 0
  s_cselect_b32 s13, 16384, 0
  s_cselect_b32 s11, s56, 0
  s_add_u32 s48, s48, s12
  s_addc_u32 s49, s49, 0
  s_add_u32 s58, s58, s13
  s_addc_u32 s59, s59, 0
  s_waitcnt vmcnt(0)
  s_mov_b64 s[14:15], s[26:27]
  s_mov_b64 s[26:27], s[24:25]
  s_mov_b64 s[24:25], s[14:15]
  s_xor_b32 s43, s43, 1
  s_barrier
  s_branch L_step_slow_f2
L_step_slow_f3:
  s_nop 9
  global_load_dwordx4 v[32:35], v2, s[26:27] sc1
  global_load_dwordx4 v[36:39], v2, s[26:27] offset:1024 sc1
  s_nop 15
  s_nop 8
L_pollm_slow_f3:
  global_load_dwordx4 v[64:67], v2, s[26:27] sc1
  global_load_dwordx4 v[68:71], v2, s[26:27] offset:1024 sc1
  s_waitcnt vmcnt(2)
  v_max3_u32 v124, v32, v33, v34
  v_max3_u32 v125, v35, v36, v37
  v_max3_u32 v124, v124, v38, v39
  v_max_u32 v124, v124, v125
  v_cmp_eq_u32 vcc, -1, v124
  s_nop 0
  s_cbranch_vccz L_gotm_slow_f3
  global_load_dwordx4 v[32:35], v2, s[26:27] sc1
  global_load_dwordx4 v[36:39], v2, s[26:27] offset:1024 sc1
  s_add_u32 s42, s42, 1
  s_cmp_gt_u32 s42, 0x40000
  s_cbranch_scc1 L_chain_abort
  s_waitcnt vmcnt(2)
  v_max3_u32 v124, v64, v65, v66
  v_max3_u32 v125, v67, v68, v69
  v_max3_u32 v124, v124, v70, v71
  v_max_u32 v124, v124, v125
  v_cmp_eq_u32 vcc, -1, v124
  s_nop 0
  s_cbranch_vccnz L_pollm2_slow_f3
  v_pk_mov_b32 v[32:33], v[64:65], v[64:65] op_sel:[0,1]
  v_pk_mov_b32 v[34:35], v[66:67], v[66:67] op_sel:[0,1]
  v_pk_mov_b32 v[36:37], v[68:69], v[68:69] op_sel:[0,1]
  v_pk_mov_b32 v[38:39], v[70:71], v[70:71] op_sel:[0,1]
  s_branch L_gotm2_slow_f3
L_pollm2_slow_f3:
  s_branch L_pollm_slow_f3
L_gotm_slow_f3:
L_gotm2_slow_f3:
  ds_write_b128 v24, v[32:35]
  v_smfmac_f32_16x16x64_bf16 v[96:99], v[32:35], a[128:135], v1
  ds_write_b128 v24, v[36:39] offset:1024
  v_smfmac_f32_16x16x64_bf16 v[100:103], v[32:35], a[0:7], v1
  v_cmp_ne_u32 vcc, 0, v5
  s_nop 0
  s_and_b32 s12, vcc_lo, s11
  s_cmp_eq_u32 s12, s11
  s_cbranch_scc0 L_fslow_slow_f3
L_fok_15:
  v_lshlrev_b32 v5, 3, v0
  global_load_dword v5, v5, s[48:49]
  v_smfmac_f32_16x16x64_bf16 v[104:107], v[32:35], a[192:199], v1
  v_bfe_u32 v20, v0, 4, 1
  v_lshl_add_u32 v20, v20, 11, s54
  global_load_dword v5, v20, s[58:59] sc1
  v_smfmac_f32_16x16x64_bf16 v[108:111], v[32:35], a[64:71], v1
  v_smfmac_f32_16x16x64_bf16 v[112:115], v[32:35], v[128:135], v1
  v_smfmac_f32_16x16x64_bf16 v[116:119], v[32:35], v[192:199], v1
  s_waitcnt lgkmcnt(0)
  s_barrier
  ds_read_b128 v[40:43], v25
  ds_read_b128 v[44:47], v25 offset:1024
  v_smfmac_f32_16x16x64_bf16 v[96:99], v[36:39], a[136:143], v1
  ds_read_b128 v[48:51], v26
  v_smfmac_f32_16x16x64_bf16 v[100:103], v[36:39], a[8:15], v1
  ds_read_b128 v[52:55], v26 offset:1024
  v_smfmac_f32_16x16x64_bf16 v[104:107], v[36:39], a[200:207], v1
  ds_read_b128 v[56:59], v27
  v_smfmac_f32_16x16x64_bf16 v[108:111], v[36:39], a[72:79], v1
  ds_read_b128 v[60:63], v27 offset:1024
  v_smfmac_f32_16x16x64_bf16 v[112:115], v[36:39], v[136:143], v1
  v_smfmac_f32_16x16x64_bf16 v[116:119], v[36:39], v[200:207], v1
  s_waitcnt lgkmcnt(4)
  v_smfmac_f32_16x16x64_bf16 v[96:99], v[40:43], a[144:151], v1
  v_smfmac_f32_16x16x64_bf16 v[100:103], v[40:43], a[16:23], v1
  v_smfmac_f32_16x16x64_bf16 v[104:107], v[40:43], a[208:215], v1
  v_smfmac_f32_16x16x64_bf16 v[108:111], v[40:43], a[80:87], v1
  v_smfmac_f32_16x16x64_bf16 v[96:99], v[44:47], a[152:159], v1
  v_smfmac_f32_16x16x64_bf16 v[100:103], v[44:47], a[24:31], v1
  v_smfmac_f32_16x16x64_bf16 v[104:107], v[44:47], a[216:223], v1
  v_smfmac_f32_16x16x64_bf16 v[108:111], v[44:47], a[88:95], v1
  s_waitcnt lgkmcnt(0)
  v_smfmac_f32_16x16x64_bf16 v[96:99], v[48:51], a[160:167], v1
  s_waitcnt vmcnt(2)
  ds_read_b128 v[64:67], v3 offset:8192
  v_smfmac_f32_16x16x64_bf16 v[100:103], v[48:51], a[32:39], v1
  ds_read_b128 v[80:83], v3 offset:12288
  v_smfmac_f32_16x16x64_bf16 v[104:107], v[48:51], a[224:231], v1
  ds_read_b128 v[68:71], v3 offset:9216
  v_smfmac_f32_16x16x64_bf16 v[108:111], v[48:51], a[96:103], v1
  ds_read_b128 v[84:87], v3 offset:13312
  v_smfmac_f32_16x16x64_bf16 v[96:99], v[52:55], a[168:175], v1
  ds_read_b128 v[72:75], v3 offset:10240
  v_smfmac_f32_16x16x64_bf16 v[100:103], v[52:55], a[40:47], v1
  ds_read_b128 v[88:91], v3 offset:14336
  v_smfmac_f32_16x16x64_bf16 v[104:107], v[52:55], a[232:239], v1
  ds_read_b128 v[76:79], v3 offset:11264
  v_smfmac_f32_16x16x64_bf16 v[108:111], v[52:55], a[104:111], v1
  ds_read_b128 v[92:95], v3 offset:15360
  v_smfmac_f32_16x16x64_bf16 v[96:99], v[56:59], a[176:183], v1
  v_smfmac_f32_16x16x64_bf16 v[100:103], v[56:59], a[48:55], v1
  v_smfmac_f32_16x16x64_bf16 v[104:107], v[56:59], a[240:247], v1
  v_smfmac_f32_16x16x64_bf16 v[108:111], v[56:59], a[112:119], v1
  v_smfmac_f32_16x16x64_bf16 v[96:99], v[60:63], a[184:191], v1
  v_smfmac_f32_16x16x64_bf16 v[100:103], v[60:63], a[56:63], v1
  v_smfmac_f32_16x16x64_bf16 v[104:107], v[60:63], a[248:255], v1
  v_smfmac_f32_16x16x64_bf16 v[108:111], v[60:63], a[120:127], v1
  v_smfmac_f32_16x16x64_bf16 v[112:115], v[40:43], v[144:151], v1
  v_smfmac_f32_16x16x64_bf16 v[116:119], v[40:43], v[208:215], v1
  v_pk_add_f32 v[96:97], v[96:97], v[98:99]
  v_pk_add_f32 v[100:101], v[100:101], v[102:103]
  v_pk_add_f32 v[104:105], v[104:105], v[106:107]
  v_cvt_pk_bf16_f32 v124, v96, v97
  v_cvt_pk_bf16_f32 v125, v100, v101
  v_pk_add_f32 v[108:109], v[108:109], v[110:111]
  ds_write_b64 v11, v[124:125]
  v_cvt_pk_bf16_f32 v126, v104, v105
  v_cvt_pk_bf16_f32 v127, v108, v109
  ds_write_b64 v11, v[126:127] offset:512
  v_smfmac_f32_16x16x64_bf16 v[112:115], v[44:47], v[152:159], v1
  v_smfmac_f32_16x16x64_bf16 v[116:119], v[44:47], v[216:223], v1
  v_smfmac_f32_16x16x64_bf16 v[112:115], v[48:51], v[160:167], v1
  v_smfmac_f32_16x16x64_bf16 v[116:119], v[48:51], v[224:231], v1
  v_smfmac_f32_16x16x64_bf16 v[112:115], v[52:55], v[168:175], v1
  v_smfmac_f32_16x16x64_bf16 v[116:119], v[52:55], v[232:239], v1
  s_waitcnt lgkmcnt(0)
  s_barrier
  ds_read_b64_tr_b16 v[96:97], v12 offset:0
  ds_read_b64_tr_b16 v[98:99], v13 offset:0
  ds_read_b64_tr_b16 v[100:101], v12 offset:1024
  ds_read_b64_tr_b16 v[102:103], v13 offset:1024
  ds_read_b64_tr_b16 v[104:105], v12 offset:2048
  ds_read_b64_tr_b16 v[106:107], v13 offset:2048
  ds_read_b64_tr_b16 v[108:109], v12 offset:3072
  ds_read_b64_tr_b16 v[110:111], v13 offset:3072
  v_smfmac_f32_16x16x64_bf16 v[112:115], v[56:59], v[176:183], v1
  v_smfmac_f32_16x16x64_bf16 v[116:119], v[56:59], v[240:247], v1
  v_smfmac_f32_16x16x64_bf16 v[112:115], v[60:63], v[184:191], v1
  v_smfmac_f32_16x16x64_bf16 v[116:119], v[60:63], v[248:255], v1
  s_waitcnt lgkmcnt(4)
  v_mfma_f32_16x16x32_bf16 v[24:27], v[64:67], v[96:99], 0
  v_mov_b32 v126, 0x3f803f80
  v_mfma_f32_16x16x32_bf16 v[28:31], v[80:83], v[96:99], 0
  ds_read_b128 v[32:35], v16 offset:0
  v_mfma_f32_16x16x32_bf16 v[120:123], v[96:99], v[96:99], 0
  ds_read_b128 v[36:39], v16 offset:32768
  v_mfma_f32_16x16x32_bf16 v[24:27], v[68:71], v[100:103], v[24:27]
  ds_read_b128 v[40:43], v17 offset:0
  v_mfma_f32_16x16x32_bf16 v[28:31], v[84:87], v[100:103], v[28:31]
  ds_read_b128 v[44:47], v17 offset:32768
  v_mfma_f32_16x16x32_bf16 v[120:123], v[100:103], v[100:103], v[120:123]
  v_pk_add_f32 v[112:113], v[112:113], v[114:115]
  s_waitcnt lgkmcnt(4)
  v_mfma_f32_16x16x32_bf16 v[24:27], v[72:75], v[104:107], v[24:27]
  v_pk_add_f32 v[116:117], v[116:117], v[118:119]
  ds_read_b128 v[64:67], v4
  v_mfma_f32_16x16x32_bf16 v[28:31], v[88:91], v[104:107], v[28:31]
  v_cvt_pk_bf16_f32 v20, v112, v113
  ds_read_b128 v[68:71], v4 offset:1024
  v_mfma_f32_16x16x32_bf16 v[120:123], v[104:107], v[104:107], v[120:123]
  v_cvt_pk_bf16_f32 v21, v116, v117
  v_mov_b32 v127, 0x3f803f80
  v_mfma_f32_16x16x32_bf16 v[24:27], v[76:79], v[108:111], v[24:27]
  v_cvt_pk_bf16_f32 v22, v116, v117
  v_mfma_f32_16x16x32_bf16 v[28:31], v[92:95], v[108:111], v[28:31]
  v_cvt_pk_bf16_f32 v23, v112, v113
  v_mfma_f32_16x16x32_bf16 v[120:123], v[108:111], v[108:111], v[120:123]
  ds_read_b128 v[48:51], v16 offset:1024
  s_cmp_eq_u32 s10, 63
  s_cbranch_scc1 L_chain_done
  ds_read_b128 v[52:55], v16 offset:33792
  v_max3_f32 v124, v24, v25, v26
  v_max3_f32 v125, v27, v28, v29
  v_max3_f32 v124, v124, v30, v31
  s_nop 0
  v_max3_f32 v125, v125, v120, v121
  v_max_f32 v124, v124, v125
  v_max_f32 v125, v124, v125
  ds_read_b128 v[56:59], v17 offset:1024
  s_nop 0
  v_permlane16_swap_b32 v124, v125
  v_max_f32 v124, v124, v125
  v_mov_b32 v125, v124
  ds_read_b128 v[60:63], v17 offset:33792
  s_nop 0
  v_permlane32_swap_b32 v124, v125
  v_max_f32 v124, v124, v125
  v_mul_f32 v124, s41, v124
  v_pk_fma_f32 v[24:25], v[24:25], s[40:41], v[124:125] op_sel_hi:[1,0,0]
  v_pk_fma_f32 v[26:27], v[26:27], s[40:41], v[124:125] op_sel_hi:[1,0,0]
  v_pk_fma_f32 v[28:29], v[28:29], s[40:41], v[124:125] op_sel_hi:[1,0,0]
  v_pk_fma_f32 v[30:31], v[30:31], s[40:41], v[124:125] op_sel_hi:[1,0,0]
  v_pk_fma_f32 v[120:121], v[120:121], s[40:41], v[124:125] op_sel_hi:[1,0,0]
  v_exp_f32 v24, v24
  v_exp_f32 v25, v25
  v_exp_f32 v26, v26
  v_exp_f32 v27, v27
  v_exp_f32 v28, v28
  v_exp_f32 v29, v29
  v_cvt_pk_bf16_f32 v72, v24, v25
  v_exp_f32 v30, v30
  v_exp_f32 v31, v31
  v_cvt_pk_bf16_f32 v73, v26, v27
  v_cvt_pk_bf16_f32 v74, v28, v29
  v_exp_f32 v120, v120
  v_cvt_pk_bf16_f32 v75, v30, v31
  v_exp_f32 v121, v121
  s_nop 0
  v_cvt_pk_bf16_f32 v18, v120, v121
  s_waitcnt lgkmcnt(4)
  v_mfma_f32_16x16x16_bf16 v[120:123], v[126:127], v[72:73], 0
  v_mfma_f32_16x16x16_bf16 v[120:123], v[126:127], v[74:75], v[120:123]
  v_mfma_f32_16x16x16_bf16 v[120:123], v[126:127], v[18:19], v[120:123]
  v_mfma_f32_16x16x32_bf16 v[80:83], v[64:67], v[72:75], 0
  ds_read_b128 v[112:115], v16 offset:2048
  v_mfma_f32_16x16x32_bf16 v[84:87], v[68:71], v[72:75], 0
  ds_read_b128 v[116:119], v16 offset:34816
  v_mfma_f32_16x16x16_bf16 v[80:83], v[20:21], v[18:19], v[80:83]
  v_rcp_f32 v124, v120
  v_mfma_f32_16x16x16_bf16 v[84:87], v[22:23], v[18:19], v[84:87]
  s_nop 4
  v_pk_mul_f32 v[80:81], v[80:81], v[124:125] op_sel_hi:[1,0]
  v_pk_mul_f32 v[82:83], v[82:83], v[124:125] op_sel_hi:[1,0]
  s_nop 0
  v_pk_mul_f32 v[84:85], v[84:85], v[124:125] op_sel_hi:[1,0]
  v_pk_mul_f32 v[86:87], v[86:87], v[124:125] op_sel_hi:[1,0]
  v_cvt_pk_bf16_f32 v24, v80, v81
  v_cvt_pk_bf16_f32 v25, v82, v83
  v_cvt_pk_bf16_f32 v26, v84, v85
  v_cvt_pk_bf16_f32 v27, v86, v87
  ds_write2_b64 v14, v[24:25], v[26:27] offset0:0 offset1:4
  v_mfma_f32_32x32x8_bf16 v[64:79], v[6:7], v[6:7], 0
  ds_read_b128 v[96:99], v17 offset:2048
  ds_read_b128 v[100:103], v17 offset:34816
  v_mfma_f32_32x32x8_bf16 v[80:95], v[6:7], v[6:7], 0
  ds_read_b128 v[104:107], v16 offset:3072
  ds_read_b128 v[108:111], v16 offset:35840
  s_waitcnt lgkmcnt(4)
  s_barrier
  ds_read_b128 v[24:27], v15
  ds_read_b128 v[28:31], v15 offset:128
  ds_read_b128 v[120:123], v17 offset:3072
  ds_read_b128 v[124:127], v17 offset:35840
  s_add_u32 m0, s50, 143360
  s_nop 0
  global_load_lds_dwordx4 v2, s[32:33] sc1
  global_load_lds_dwordx4 v2, s[32:33] offset:1024 sc1
  s_add_u32 m0, s50, 151552
  s_nop 0
  global_load_lds_dwordx4 v2, s[34:35] sc1
  global_load_lds_dwordx4 v2, s[34:35] offset:1024 sc1
  s_waitcnt lgkmcnt(2)
  v_smfmac_f32_16x16x64_bf16 v[64:67], v[24:27], v[32:39], v1
  ds_read_b128 v[32:35], v16 offset:4096
  ds_read_b128 v[36:39], v16 offset:36864
  v_smfmac_f32_16x16x64_bf16 v[64:67], v[28:31], v[40:47], v1
  ds_read_b128 v[40:43], v17 offset:4096
  ds_read_b128 v[44:47], v17 offset:36864
  v_smfmac_f32_16x16x64_bf16 v[68:71], v[24:27], v[48:55], v1
  ds_read_b128 v[48:51], v16 offset:5120
  ds_read_b128 v[52:55], v16 offset:37888
  v_smfmac_f32_16x16x64_bf16 v[68:71], v[28:31], v[56:63], v1
  ds_read_b128 v[56:59], v17 offset:5120
  ds_read_b128 v[60:63], v17 offset:37888
  v_pk_add_f32 v[64:65], v[64:65], v[66:67]
  v_cvt_pk_bf16_f32 v20, v64, v65
  v_smfmac_f32_16x16x64_bf16 v[72:75], v[24:27], v[112:119], v1
  ds_read_b128 v[112:115], v16 offset:6144
  ds_read_b128 v[116:119], v16 offset:38912
  v_smfmac_f32_16x16x64_bf16 v[72:75], v[28:31], v[96:103], v1
  ds_read_b128 v[96:99], v17 offset:6144
  ds_read_b128 v[100:103], v17 offset:38912
  v_pk_add_f32 v[68:69], v[68:69], v[70:71]
  v_cvt_pk_bf16_f32 v21, v68, v69
  v_smfmac_f32_16x16x64_bf16 v[76:79], v[24:27], v[104:111], v1
  ds_read_b128 v[104:107], v16 offset:7168
  ds_read_b128 v[108:111], v16 offset:39936
  s_waitcnt lgkmcnt(12)
  v_smfmac_f32_16x16x64_bf16 v[76:79], v[28:31], v[120:127], v1
  ds_read_b128 v[120:123], v17 offset:7168
  ds_read_b128 v[124:127], v17 offset:39936
  v_pk_add_f32 v[72:73], v[72:73], v[74:75]
  v_cvt_pk_bf16_f32 v22, v72, v73
  v_smfmac_f32_16x16x64_bf16 v[80:83], v[24:27], v[32:39], v1
  s_waitcnt lgkmcnt(10)
  v_smfmac_f32_16x16x64_bf16 v[80:83], v[28:31], v[40:47], v1
  v_pk_add_f32 v[76:77], v[76:77], v[78:79]
  v_cvt_pk_bf16_f32 v23, v76, v77
  v_bfi_b32 v20, 1, s43, v20
  global_store_dwordx4 v8, v[20:23], s[28:29] sc1
  v_smfmac_f32_16x16x64_bf16 v[84:87], v[24:27], v[48:55], v1
  s_waitcnt lgkmcnt(6)
  v_smfmac_f32_16x16x64_bf16 v[84:87], v[28:31], v[56:63], v1
  v_pk_add_f32 v[80:81], v[80:81], v[82:83]
  v_cvt_pk_bf16_f32 v64, v80, v81
  v_smfmac_f32_16x16x64_bf16 v[88:91], v[24:27], v[112:119], v1
  s_waitcnt lgkmcnt(2)
  v_smfmac_f32_16x16x64_bf16 v[88:91], v[28:31], v[96:103], v1
  s_nop 0
  v_pk_add_f32 v[84:85], v[84:85], v[86:87]
  v_cvt_pk_bf16_f32 v65, v84, v85
  v_smfmac_f32_16x16x64_bf16 v[92:95], v[24:27], v[104:111], v1
  s_waitcnt lgkmcnt(0)
  v_smfmac_f32_16x16x64_bf16 v[92:95], v[28:31], v[120:127], v1
  s_nop 0
  v_pk_add_f32 v[88:89], v[88:89], v[90:91]
  v_cvt_pk_bf16_f32 v66, v88, v89
  v_bfi_b32 v64, 1, s43, v64
  s_nop 3
  v_pk_add_f32 v[92:93], v[92:93], v[94:95]
  v_cvt_pk_bf16_f32 v67, v92, v93
  global_store_dwordx4 v8, v[64:67], s[30:31] sc1
  s_add_u32 s32, s32, 262144
  s_addc_u32 s33, s33, 0
  s_add_u32 s34, s34, 262144
  s_addc_u32 s35, s35, 0
  s_add_u32 s10, s10, 1
  v_mfma_f32_32x32x8_bf16 v[96:111], v[6:7], v[6:7], 0
  v_pk_mov_b32 v[112:113], 0, 0
  v_pk_mov_b32 v[114:115], 0, 0
  v_pk_mov_b32 v[116:117], 0, 0
  v_pk_mov_b32 v[118:119], 0, 0
  v_add_u32 v24, s50, v3
  v_add_u32 v25, s51, v3
  v_add_u32 v26, s52, v3
  v_add_u32 v27, s53, v3
  s_add_u32 s36, s36, 8192
  s_addc_u32 s37, s37, 0
  s_cmp_lt_u32 s10, 62
  s_cselect_b32 s12, 262144, 0
  s_cselect_b32 s13, 16384, 0
  s_cselect_b32 s11, s56, 0
  s_add_u32 s48, s48, s12
  s_addc_u32 s49, s49, 0
  s_add_u32 s58, s58, s13
  s_addc_u32 s59, s59, 0
  s_waitcnt vmcnt(0)
  s_mov_b64 s[14:15], s[26:27]
  s_mov_b64 s[26:27], s[24:25]
  s_mov_b64 s[24:25], s[14:15]
  s_xor_b32 s43, s43, 1
  s_barrier
  s_branch L_step_slow_f3
L_fslow_slow_f2:
  v_bfe_u32 v20, v0, 4, 1
  v_lshl_add_u32 v20, v20, 11, s54
  s_sub_u32 s14, s58, 16384
  s_subb_u32 s15, s59, 0
  global_load_dword v5, v20, s[14:15] sc1
  s_add_u32 s42, s42, 1
  s_cmp_gt_u32 s42, 0x40000
  s_cbranch_scc1 L_chain_abort
  s_waitcnt vmcnt(0)
  v_cmp_ne_u32 vcc, 0, v5
  s_nop 0
  s_and_b32 s12, vcc_lo, s11
  s_cmp_eq_u32 s12, s11
  s_cbranch_scc1 L_fok_14
  s_sleep 1
  s_branch L_fslow_slow_f2
L_fslow_slow_f3:
  v_bfe_u32 v20, v0, 4, 1
  v_lshl_add_u32 v20, v20, 11, s54
  s_sub_u32 s14, s58, 16384
  s_subb_u32 s15, s59, 0
  global_load_dword v5, v20, s[14:15] sc1
  s_add_u32 s42, s42, 1
  s_cmp_gt_u32 s42, 0x40000
  s_cbranch_scc1 L_chain_abort
  s_waitcnt vmcnt(0)
  v_cmp_ne_u32 vcc, 0, v5
  s_nop 0
  s_and_b32 s12, vcc_lo, s11
  s_cmp_eq_u32 s12, s11
  s_cbranch_scc1 L_fok_15
  s_sleep 1
  s_branch L_fslow_slow_f3
L_chain_abort:
  s_mov_b32 s10, 0xdead
  s_branch L_chain_end
L_chain_done:
  s_lshl_b32 s12, s9, 12
  s_add_u32 s12, s12, 8257536
  s_add_u32 s14, s4, s12
  s_addc_u32 s15, s5, 0
  s_add_u32 s16, s14, 59899904
  s_addc_u32 s17, s15, 0
  s_add_u32 s14, s14, 50462720
  s_addc_u32 s15, s15, 0
  s_cmp_eq_u32 s8, 1
  s_cbranch_scc1 L_lk_17
  s_cmp_eq_u32 s8, 2
  s_cbranch_scc1 L_lk_18
  s_cmp_eq_u32 s8, 3
  s_cbranch_scc1 L_lk_19
L_lk_16:
  global_store_dwordx4 v0, v[96:99], s[14:15] offset:0 sc1
  v_lshrrev_b32 v124, 1, v0
  global_store_dwordx2 v124, v[20:21], s[16:17] offset:0 sc1
  s_branch L_lk_20
L_lk_17:
  global_store_dwordx4 v0, v[100:103], s[14:15] offset:1024 sc1
  v_lshrrev_b32 v124, 1, v0
  global_store_dwordx2 v124, v[20:21], s[16:17] offset:512 sc1
  s_branch L_lk_20
L_lk_18:
  global_store_dwordx4 v0, v[104:107], s[14:15] offset:2048 sc1
  v_lshrrev_b32 v124, 1, v0
  global_store_dwordx2 v124, v[20:21], s[16:17] offset:1024 sc1
  s_branch L_lk_20
L_lk_19:
  global_store_dwordx4 v0, v[108:111], s[14:15] offset:3072 sc1
  v_lshrrev_b32 v124, 1, v0
  global_store_dwordx2 v124, v[20:21], s[16:17] offset:1536 sc1
  s_branch L_lk_20
L_lk_20:
  s_waitcnt vmcnt(0)
  s_barrier
  s_cmp_lg_u32 s8, 0
  s_cbranch_scc1 L_cfin_21
  s_lshl_b32 s12, s9, 7
  s_add_u32 s12, s12, 152039424
  v_mov_b32 v124, s12
  s_mov_b64 exec, 1
  global_store_dword v124, v1, s[4:5] sc1
  s_mov_b64 exec, -1
L_cfin_21:
L_chain_end:
  s_waitcnt vmcnt(0)
  s_endpgm
L_worker:
  s_sub_u32 s58, s14, 32
  s_load_dwordx2 s[60:61], s[0:1], 0
  s_load_dwordx2 s[62:63], s[0:1], 16
  s_load_dwordx2 s[64:65], s[0:1], 24
  s_load_dwordx2 s[66:67], s[0:1], 32
  s_load_dwordx2 s[68:69], s[0:1], 40
  s_load_dwordx2 s[70:71], s[0:1], 64
  s_load_dwordx2 s[72:73], s[0:1], 72
  s_load_dwordx2 s[74:75], s[0:1], 80
  s_load_dwordx2 s[76:77], s[0:1], 88
  s_load_dwordx2 s[78:79], s[0:1], 96
  s_load_dwordx2 s[6:7], s[0:1], 104
  s_load_dwordx2 s[4:5], s[0:1], 112
  v_lshrrev_b32 v1, 6, v0
  s_nop 0
  v_readfirstlane_b32 s8, v1
  v_and_b32 v0, 63, v0
  v_lshlrev_b32 v1, 4, v0
  s_waitcnt lgkmcnt(0)
  s_add_u32 s46, s4, 150999040
  s_addc_u32 s47, s5, 0
  s_cmp_lt_u32 s58, 128
  s_cbranch_scc0 L_w1b
  s_lshr_b32 s36, s58, 2
  s_and_b32 s12, s58, 3
  s_cmp_eq_u32 s12, 0
  s_cbranch_scc0 L_w1p
  s_and_b32 s12, s36, 15
  s_lshl_b32 s12, s12, 18
  s_lshl_b32 s13, s8, 16
  s_add_u32 s12, s12, s13
  s_cmp_lt_u32 s36, 16
  s_cselect_b32 s14, s62, s68
  s_cselect_b32 s15, s63, s69
  s_add_u32 s14, s14, s12
  s_addc_u32 s15, s15, 0
  global_load_dwordx4 v[32:35], v1, s[14:15]
  s_add_u32 s14, s14, 1024
  s_addc_u32 s15, s15, 0
  global_load_dwordx4 v[36:39], v1, s[14:15]
  s_add_u32 s14, s14, 1024
  s_addc_u32 s15, s15, 0
  global_load_dwordx4 v[40:43], v1, s[14:15]
  s_add_u32 s14, s14, 1024
  s_addc_u32 s15, s15, 0
  global_load_dwordx4 v[44:47], v1, s[14:15]
  s_add_u32 s14, s14, 1024
  s_addc_u32 s15, s15, 0
  global_load_dwordx4 v[48:51], v1, s[14:15]
  s_add_u32 s14, s14, 1024
  s_addc_u32 s15, s15, 0
  global_load_dwordx4 v[52:55], v1, s[14:15]
  s_add_u32 s14, s14, 1024
  s_addc_u32 s15, s15, 0
  global_load_dwordx4 v[56:59], v1, s[14:15]
  s_add_u32 s14, s14, 1024
  s_addc_u32 s15, s15, 0
  global_load_dwordx4 v[60:63], v1, s[14:15]
  s_add_u32 s14, s14, 1024
  s_addc_u32 s15, s15, 0
  global_load_dwordx4 v[64:67], v1, s[14:15]
  s_add_u32 s14, s14, 1024
  s_addc_u32 s15, s15, 0
  global_load_dwordx4 v[68:71], v1, s[14:15]
  s_add_u32 s14, s14, 1024
  s_addc_u32 s15, s15, 0
  global_load_dwordx4 v[72:75], v1, s[14:15]
  s_add_u32 s14, s14, 1024
  s_addc_u32 s15, s15, 0
  global_load_dwordx4 v[76:79], v1, s[14:15]
  s_add_u32 s14, s14, 1024
  s_addc_u32 s15, s15, 0
  global_load_dwordx4 v[80:83], v1, s[14:15]
  s_add_u32 s14, s14, 1024
  s_addc_u32 s15, s15, 0
  global_load_dwordx4 v[84:87], v1, s[14:15]
  s_add_u32 s14, s14, 1024
  s_addc_u32 s15, s15, 0
  global_load_dwordx4 v[88:91], v1, s[14:15]
  s_add_u32 s14, s14, 1024
  s_addc_u32 s15, s15, 0
  global_load_dwordx4 v[92:95], v1, s[14:15]
  s_add_u32 s14, s14, 1024
  s_addc_u32 s15, s15, 0
  global_load_dwordx4 v[96:99], v1, s[14:15]
  s_add_u32 s14, s14, 1024
  s_addc_u32 s15, s15, 0
  global_load_dwordx4 v[100:103], v1, s[14:15]
  s_add_u32 s14, s14, 1024
  s_addc_u32 s15, s15, 0
  global_load_dwordx4 v[104:107], v1, s[14:15]
  s_add_u32 s14, s14, 1024
  s_addc_u32 s15, s15, 0
  global_load_dwordx4 v[108:111], v1, s[14:15]
  s_add_u32 s14, s14, 1024
  s_addc_u32 s15, s15, 0
  global_load_dwordx4 v[112:115], v1, s[14:15]
  s_add_u32 s14, s14, 1024
  s_addc_u32 s15, s15, 0
  global_load_dwordx4 v[116:119], v1, s[14:15]
  s_add_u32 s14, s14, 1024
  s_addc_u32 s15, s15, 0
  global_load_dwordx4 v[120:123], v1, s[14:15]
  s_add_u32 s14, s14, 1024
  s_addc_u32 s15, s15, 0
  global_load_dwordx4 v[124:127], v1, s[14:15]
  s_add_u32 s14, s14, 1024
  s_addc_u32 s15, s15, 0
  global_load_dwordx4 v[128:131], v1, s[14:15]
  s_add_u32 s14, s14, 1024
  s_addc_u32 s15, s15, 0
  global_load_dwordx4 v[132:135], v1, s[14:15]
  s_add_u32 s14, s14, 1024
  s_addc_u32 s15, s15, 0
  global_load_dwordx4 v[136:139], v1, s[14:15]
  s_add_u32 s14, s14, 1024
  s_addc_u32 s15, s15, 0
  global_load_dwordx4 v[140:143], v1, s[14:15]
  s_add_u32 s14, s14, 1024
  s_addc_u32 s15, s15, 0
  global_load_dwordx4 v[144:147], v1, s[14:15]
  s_add_u32 s14, s14, 1024
  s_addc_u32 s15, s15, 0
  global_load_dwordx4 v[148:151], v1, s[14:15]
  s_add_u32 s14, s14, 1024
  s_addc_u32 s15, s15, 0
  global_load_dwordx4 v[152:155], v1, s[14:15]
  s_add_u32 s14, s14, 1024
  s_addc_u32 s15, s15, 0
  global_load_dwordx4 v[156:159], v1, s[14:15]
  s_add_u32 s14, s14, 1024
  s_addc_u32 s15, s15, 0
  global_load_dwordx4 v[160:163], v1, s[14:15]
  s_add_u32 s14, s14, 1024
  s_addc_u32 s15, s15, 0
  global_load_dwordx4 v[164:167], v1, s[14:15]
  s_add_u32 s14, s14, 1024
  s_addc_u32 s15, s15, 0
  global_load_dwordx4 v[168:171], v1, s[14:15]
  s_add_u32 s14, s14, 1024
  s_addc_u32 s15, s15, 0
  global_load_dwordx4 v[172:175], v1, s[14:15]
  s_add_u32 s14, s14, 1024
  s_addc_u32 s15, s15, 0
  global_load_dwordx4 v[176:179], v1, s[14:15]
  s_add_u32 s14, s14, 1024
  s_addc_u32 s15, s15, 0
  global_load_dwordx4 v[180:183], v1, s[14:15]
  s_add_u32 s14, s14, 1024
  s_addc_u32 s15, s15, 0
  global_load_dwordx4 v[184:187], v1, s[14:15]
  s_add_u32 s14, s14, 1024
  s_addc_u32 s15, s15, 0
  global_load_dwordx4 v[188:191], v1, s[14:15]
  s_add_u32 s14, s14, 1024
  s_addc_u32 s15, s15, 0
  global_load_dwordx4 v[192:195], v1, s[14:15]
  s_add_u32 s14, s14, 1024
  s_addc_u32 s15, s15, 0
  global_load_dwordx4 v[196:199], v1, s[14:15]
  s_add_u32 s14, s14, 1024
  s_addc_u32 s15, s15, 0
  global_load_dwordx4 v[200:203], v1, s[14:15]
  s_add_u32 s14, s14, 1024
  s_addc_u32 s15, s15, 0
  global_load_dwordx4 v[204:207], v1, s[14:15]
  s_add_u32 s14, s14, 1024
  s_addc_u32 s15, s15, 0
  global_load_dwordx4 v[208:211], v1, s[14:15]
  s_add_u32 s14, s14, 1024
  s_addc_u32 s15, s15, 0
  global_load_dwordx4 v[212:215], v1, s[14:15]
  s_add_u32 s14, s14, 1024
  s_addc_u32 s15, s15, 0
  global_load_dwordx4 v[216:219], v1, s[14:15]
  s_add_u32 s14, s14, 1024
  s_addc_u32 s15, s15, 0
  global_load_dwordx4 v[220:223], v1, s[14:15]
  s_add_u32 s14, s14, 1024
  s_addc_u32 s15, s15, 0
  global_load_dwordx4 v[32:35], v1, s[14:15]
  s_add_u32 s14, s14, 1024
  s_addc_u32 s15, s15, 0
  global_load_dwordx4 v[36:39], v1, s[14:15]
  s_add_u32 s14, s14, 1024
  s_addc_u32 s15, s15, 0
  global_load_dwordx4 v[40:43], v1, s[14:15]
  s_add_u32 s14, s14, 1024
  s_addc_u32 s15, s15, 0
  global_load_dwordx4 v[44:47], v1, s[14:15]
  s_add_u32 s14, s14, 1024
  s_addc_u32 s15, s15, 0
  global_load_dwordx4 v[48:51], v1, s[14:15]
  s_add_u32 s14, s14, 1024
  s_addc_u32 s15, s15, 0
  global_load_dwordx4 v[52:55], v1, s[14:15]
  s_add_u32 s14, s14, 1024
  s_addc_u32 s15, s15, 0
  global_load_dwordx4 v[56:59], v1, s[14:15]
  s_add_u32 s14, s14, 1024
  s_addc_u32 s15, s15, 0
  global_load_dwordx4 v[60:63], v1, s[14:15]
  s_add_u32 s14, s14, 1024
  s_addc_u32 s15, s15, 0
  global_load_dwordx4 v[64:67], v1, s[14:15]
  s_add_u32 s14, s14, 1024
  s_addc_u32 s15, s15, 0
  global_load_dwordx4 v[68:71], v1, s[14:15]
  s_add_u32 s14, s14, 1024
  s_addc_u32 s15, s15, 0
  global_load_dwordx4 v[72:75], v1, s[14:15]
  s_add_u32 s14, s14, 1024
  s_addc_u32 s15, s15, 0
  global_load_dwordx4 v[76:79], v1, s[14:15]
  s_add_u32 s14, s14, 1024
  s_addc_u32 s15, s15, 0
  global_load_dwordx4 v[32:35], v1, s[14:15] offset:0
  global_load_dwordx4 v[36:39], v1, s[14:15] offset:1024
  global_load_dwordx4 v[40:43], v1, s[14:15] offset:2048
  global_load_dwordx4 v[44:47], v1, s[14:15] offset:3072
  s_waitcnt vmcnt(0)
  s_cmp_lg_u32 s8, 0
  s_cbranch_scc1 L_wcwok_23
  v_mov_b32 v254, 20
  s_mov_b32 s49, 0
L_wcw_22:
  s_sleep 40
  global_load_dword v255, v254, s[6:7] sc1
  s_add_u32 s49, s49, 1
  s_cmp_gt_u32 s49, 0x4000
  s_cbranch_scc1 L_wcwok_23
  s_waitcnt vmcnt(0)
  v_cmp_gt_u32 vcc, 32, v255
  s_nop 0
  s_cbranch_vccnz L_wcw_22
L_wcwok_23:
  s_barrier
  s_cmp_lg_u32 s8, 0
  s_cbranch_scc1 L_wfiok_25
  v_mov_b32 v254, 16
  s_mov_b32 s49, 0
L_wfi_24:
  global_load_dword v255, v254, s[6:7] sc1
  s_add_u32 s49, s49, 1
  s_cmp_gt_u32 s49, 0x20000
  s_cbranch_scc1 L_wfiok_25
  s_waitcnt vmcnt(0)
  v_cmp_gt_u32 vcc, 256, v255
  s_nop 0
  s_cbranch_vccz L_wfiok_25
  s_sleep 8
  s_branch L_wfi_24
L_wfiok_25:
  s_barrier
  s_cmp_ge_u32 s36, 16
  s_cbranch_scc1 L_kvmv_27
  s_and_b32 s18, s36, 15
  s_lshl_b32 s12, s18, 9
  s_add_u32 s20, s64, s12
  s_addc_u32 s21, s65, 0
  s_mov_b32 s24, 8192
  s_lshr_b32 s12, s8, 1
  s_lshl_b32 s13, s18, 1
  s_add_u32 s12, s12, s13
  s_lshl_b32 s37, s12, 12
  s_and_b32 s12, s8, 1
  s_lshl_b32 s12, s12, 11
  s_add_u32 s37, s37, s12
  v_lshrrev_b32 v12, 5, v0
  v_and_b32 v13, 31, v0
  v_add_u32 v14, 0, v12
  v_lshlrev_b32 v14, 2, v14
  v_xor_b32 v14, v14, v13
  v_lshlrev_b32 v15, 4, v14
  v_mov_b32 v17, s21
  v_add_co_u32 v16, vcc, s20, v15
  s_nop 1
  v_addc_co_u32 v17, vcc, 0, v17, vcc
  s_lshl_b32 s12, s8, 4
  s_add_u32 s12, s12, 0
  v_add_u32 v15, s12, v12
  v_mul_lo_u32 v15, v15, s24
  v_add_co_u32 v16, vcc, v16, v15
  s_nop 1
  v_addc_co_u32 v17, vcc, 0, v17, vcc
  v_add_u32 v14, 2, v12
  v_lshlrev_b32 v14, 2, v14
  v_xor_b32 v14, v14, v13
  v_lshlrev_b32 v15, 4, v14
  v_mov_b32 v19, s21
  v_add_co_u32 v18, vcc, s20, v15
  s_nop 1
  v_addc_co_u32 v19, vcc, 0, v19, vcc
  s_lshl_b32 s12, s8, 4
  s_add_u32 s12, s12, 2
  v_add_u32 v15, s12, v12
  v_mul_lo_u32 v15, v15, s24
  v_add_co_u32 v18, vcc, v18, v15
  s_nop 1
  v_addc_co_u32 v19, vcc, 0, v19, vcc
  s_lshl_b32 s14, s24, 2
  s_mul_i32 s15, s24, 48
  s_lshl_b32 s13, s8, 13
  v_bfe_u32 v22, v0, 2, 2
  v_and_b32 v23, 3, v0
  v_and_b32 v24, 1, v23
  v_lshlrev_b32 v24, 1, v24
  v_lshrrev_b32 v23, 1, v23
  v_or_b32 v23, v23, v24
  v_bfe_u32 v24, v0, 4, 1
  v_lshrrev_b32 v25, 5, v0
  v_lshrrev_b32 v26, 1, v23
  v_lshl_add_u32 v26, v24, 1, v26
  v_lshl_add_u32 v25, v25, 3, v22
  s_lshl_b32 s12, s8, 3
  s_add_u32 s12, s12, 0
  v_add_u32 v27, s12, v26
  v_lshlrev_b32 v28, 2, v22
  v_xor_b32 v27, v27, v28
  v_lshlrev_b32 v27, 4, v27
  v_lshl_add_u32 v27, v25, 9, v27
  v_and_b32 v28, 1, v23
  v_lshl_add_u32 v29, v28, 3, v27
  s_lshl_b32 s12, s8, 3
  s_add_u32 s12, s12, 4
  v_add_u32 v27, s12, v26
  v_lshlrev_b32 v28, 2, v22
  v_xor_b32 v27, v27, v28
  v_lshlrev_b32 v27, 4, v27
  v_lshl_add_u32 v27, v25, 9, v27
  v_and_b32 v28, 1, v23
  v_lshl_add_u32 v30, v28, 3, v27
  v_add_u32 v21, s13, v1
  global_load_dwordx4 a[0:3], v[16:17], off
  v_add_co_u32 v16, vcc, s14, v16
  s_nop 1
  v_addc_co_u32 v17, vcc, 0, v17, vcc
  global_load_dwordx4 a[4:7], v[18:19], off
  v_add_co_u32 v18, vcc, s14, v18
  s_nop 1
  v_addc_co_u32 v19, vcc, 0, v19, vcc
  global_load_dwordx4 a[8:11], v[16:17], off
  v_add_co_u32 v16, vcc, s14, v16
  s_nop 1
  v_addc_co_u32 v17, vcc, 0, v17, vcc
  global_load_dwordx4 a[12:15], v[18:19], off
  v_add_co_u32 v18, vcc, s14, v18
  s_nop 1
  v_addc_co_u32 v19, vcc, 0, v19, vcc
  global_load_dwordx4 a[128:131], v[16:17], off
  v_add_co_u32 v16, vcc, s14, v16
  s_nop 1
  v_addc_co_u32 v17, vcc, 0, v17, vcc
  global_load_dwordx4 a[132:135], v[18:19], off
  v_add_co_u32 v18, vcc, s14, v18
  s_nop 1
  v_addc_co_u32 v19, vcc, 0, v19, vcc
  global_load_dwordx4 a[136:139], v[16:17], off
  v_add_co_u32 v16, vcc, s14, v16
  s_nop 1
  v_addc_co_u32 v17, vcc, 0, v17, vcc
  global_load_dwordx4 a[140:143], v[18:19], off
  v_add_co_u32 v18, vcc, s14, v18
  s_nop 1
  v_addc_co_u32 v19, vcc, 0, v19, vcc
  v_add_co_u32 v16, vcc, s15, v16
  s_nop 1
  v_addc_co_u32 v17, vcc, 0, v17, vcc
  v_add_co_u32 v18, vcc, s15, v18
  s_nop 1
  v_addc_co_u32 v19, vcc, 0, v19, vcc
  global_load_dwordx4 a[16:19], v[16:17], off
  v_add_co_u32 v16, vcc, s14, v16
  s_nop 1
  v_addc_co_u32 v17, vcc, 0, v17, vcc
  global_load_dwordx4 a[20:23], v[18:19], off
  v_add_co_u32 v18, vcc, s14, v18
  s_nop 1
  v_addc_co_u32 v19, vcc, 0, v19, vcc
  global_load_dwordx4 a[24:27], v[16:17], off
  v_add_co_u32 v16, vcc, s14, v16
  s_nop 1
  v_addc_co_u32 v17, vcc, 0, v17, vcc
  global_load_dwordx4 a[28:31], v[18:19], off
  v_add_co_u32 v18, vcc, s14, v18
  s_nop 1
  v_addc_co_u32 v19, vcc, 0, v19, vcc
  global_load_dwordx4 a[144:147], v[16:17], off
  v_add_co_u32 v16, vcc, s14, v16
  s_nop 1
  v_addc_co_u32 v17, vcc, 0, v17, vcc
  global_load_dwordx4 a[148:151], v[18:19], off
  v_add_co_u32 v18, vcc, s14, v18
  s_nop 1
  v_addc_co_u32 v19, vcc, 0, v19, vcc
  global_load_dwordx4 a[152:155], v[16:17], off
  v_add_co_u32 v16, vcc, s14, v16
  s_nop 1
  v_addc_co_u32 v17, vcc, 0, v17, vcc
  global_load_dwordx4 a[156:159], v[18:19], off
  v_add_co_u32 v18, vcc, s14, v18
  s_nop 1
  v_addc_co_u32 v19, vcc, 0, v19, vcc
  v_add_co_u32 v16, vcc, s15, v16
  s_nop 1
  v_addc_co_u32 v17, vcc, 0, v17, vcc
  v_add_co_u32 v18, vcc, s15, v18
  s_nop 1
  v_addc_co_u32 v19, vcc, 0, v19, vcc
  global_load_dwordx4 a[32:35], v[16:17], off
  v_add_co_u32 v16, vcc, s14, v16
  s_nop 1
  v_addc_co_u32 v17, vcc, 0, v17, vcc
  global_load_dwordx4 a[36:39], v[18:19], off
  v_add_co_u32 v18, vcc, s14, v18
  s_nop 1
  v_addc_co_u32 v19, vcc, 0, v19, vcc
  global_load_dwordx4 a[40:43], v[16:17], off
  v_add_co_u32 v16, vcc, s14, v16
  s_nop 1
  v_addc_co_u32 v17, vcc, 0, v17, vcc
  global_load_dwordx4 a[44:47], v[18:19], off
  v_add_co_u32 v18, vcc, s14, v18
  s_nop 1
  v_addc_co_u32 v19, vcc, 0, v19, vcc
  global_load_dwordx4 a[160:163], v[16:17], off
  v_add_co_u32 v16, vcc, s14, v16
  s_nop 1
  v_addc_co_u32 v17, vcc, 0, v17, vcc
  global_load_dwordx4 a[164:167], v[18:19], off
  v_add_co_u32 v18, vcc, s14, v18
  s_nop 1
  v_addc_co_u32 v19, vcc, 0, v19, vcc
  global_load_dwordx4 a[168:171], v[16:17], off
  v_add_co_u32 v16, vcc, s14, v16
  s_nop 1
  v_addc_co_u32 v17, vcc, 0, v17, vcc
  global_load_dwordx4 a[172:175], v[18:19], off
  v_add_co_u32 v18, vcc, s14, v18
  s_nop 1
  v_addc_co_u32 v19, vcc, 0, v19, vcc
  v_add_co_u32 v16, vcc, s15, v16
  s_nop 1
  v_addc_co_u32 v17, vcc, 0, v17, vcc
  v_add_co_u32 v18, vcc, s15, v18
  s_nop 1
  v_addc_co_u32 v19, vcc, 0, v19, vcc
  global_load_dwordx4 a[48:51], v[16:17], off
  v_add_co_u32 v16, vcc, s14, v16
  s_nop 1
  v_addc_co_u32 v17, vcc, 0, v17, vcc
  global_load_dwordx4 a[52:55], v[18:19], off
  v_add_co_u32 v18, vcc, s14, v18
  s_nop 1
  v_addc_co_u32 v19, vcc, 0, v19, vcc
  global_load_dwordx4 a[56:59], v[16:17], off
  v_add_co_u32 v16, vcc, s14, v16
  s_nop 1
  v_addc_co_u32 v17, vcc, 0, v17, vcc
  global_load_dwordx4 a[60:63], v[18:19], off
  v_add_co_u32 v18, vcc, s14, v18
  s_nop 1
  v_addc_co_u32 v19, vcc, 0, v19, vcc
  global_load_dwordx4 a[176:179], v[16:17], off
  v_add_co_u32 v16, vcc, s14, v16
  s_nop 1
  v_addc_co_u32 v17, vcc, 0, v17, vcc
  global_load_dwordx4 a[180:183], v[18:19], off
  v_add_co_u32 v18, vcc, s14, v18
  s_nop 1
  v_addc_co_u32 v19, vcc, 0, v19, vcc
  global_load_dwordx4 a[184:187], v[16:17], off
  v_add_co_u32 v16, vcc, s14, v16
  s_nop 1
  v_addc_co_u32 v17, vcc, 0, v17, vcc
  global_load_dwordx4 a[188:191], v[18:19], off
  v_add_co_u32 v18, vcc, s14, v18
  s_nop 1
  v_addc_co_u32 v19, vcc, 0, v19, vcc
  v_add_co_u32 v16, vcc, s15, v16
  s_nop 1
  v_addc_co_u32 v17, vcc, 0, v17, vcc
  v_add_co_u32 v18, vcc, s15, v18
  s_nop 1
  v_addc_co_u32 v19, vcc, 0, v19, vcc
  global_load_dwordx4 a[64:67], v[16:17], off
  v_add_co_u32 v16, vcc, s14, v16
  s_nop 1
  v_addc_co_u32 v17, vcc, 0, v17, vcc
  global_load_dwordx4 a[68:71], v[18:19], off
  v_add_co_u32 v18, vcc, s14, v18
  s_nop 1
  v_addc_co_u32 v19, vcc, 0, v19, vcc
  global_load_dwordx4 a[72:75], v[16:17], off
  v_add_co_u32 v16, vcc, s14, v16
  s_nop 1
  v_addc_co_u32 v17, vcc, 0, v17, vcc
  global_load_dwordx4 a[76:79], v[18:19], off
  v_add_co_u32 v18, vcc, s14, v18
  s_nop 1
  v_addc_co_u32 v19, vcc, 0, v19, vcc
  global_load_dwordx4 a[192:195], v[16:17], off
  v_add_co_u32 v16, vcc, s14, v16
  s_nop 1
  v_addc_co_u32 v17, vcc, 0, v17, vcc
  global_load_dwordx4 a[196:199], v[18:19], off
  v_add_co_u32 v18, vcc, s14, v18
  s_nop 1
  v_addc_co_u32 v19, vcc, 0, v19, vcc
  global_load_dwordx4 a[200:203], v[16:17], off
  v_add_co_u32 v16, vcc, s14, v16
  s_nop 1
  v_addc_co_u32 v17, vcc, 0, v17, vcc
  global_load_dwordx4 a[204:207], v[18:19], off
  v_add_co_u32 v18, vcc, s14, v18
  s_nop 1
  v_addc_co_u32 v19, vcc, 0, v19, vcc
  v_add_co_u32 v16, vcc, s15, v16
  s_nop 1
  v_addc_co_u32 v17, vcc, 0, v17, vcc
  v_add_co_u32 v18, vcc, s15, v18
  s_nop 1
  v_addc_co_u32 v19, vcc, 0, v19, vcc
  global_load_dwordx4 a[80:83], v[16:17], off
  v_add_co_u32 v16, vcc, s14, v16
  s_nop 1
  v_addc_co_u32 v17, vcc, 0, v17, vcc
  global_load_dwordx4 a[84:87], v[18:19], off
  v_add_co_u32 v18, vcc, s14, v18
  s_nop 1
  v_addc_co_u32 v19, vcc, 0, v19, vcc
  global_load_dwordx4 a[88:91], v[16:17], off
  v_add_co_u32 v16, vcc, s14, v16
  s_nop 1
  v_addc_co_u32 v17, vcc, 0, v17, vcc
  global_load_dwordx4 a[92:95], v[18:19], off
  v_add_co_u32 v18, vcc, s14, v18
  s_nop 1
  v_addc_co_u32 v19, vcc, 0, v19, vcc
  global_load_dwordx4 a[208:211], v[16:17], off
  v_add_co_u32 v16, vcc, s14, v16
  s_nop 1
  v_addc_co_u32 v17, vcc, 0, v17, vcc
  global_load_dwordx4 a[212:215], v[18:19], off
  v_add_co_u32 v18, vcc, s14, v18
  s_nop 1
  v_addc_co_u32 v19, vcc, 0, v19, vcc
  global_load_dwordx4 a[216:219], v[16:17], off
  v_add_co_u32 v16, vcc, s14, v16
  s_nop 1
  v_addc_co_u32 v17, vcc, 0, v17, vcc
  global_load_dwordx4 a[220:223], v[18:19], off
  v_add_co_u32 v18, vcc, s14, v18
  s_nop 1
  v_addc_co_u32 v19, vcc, 0, v19, vcc
  v_add_co_u32 v16, vcc, s15, v16
  s_nop 1
  v_addc_co_u32 v17, vcc, 0, v17, vcc
  v_add_co_u32 v18, vcc, s15, v18
  s_nop 1
  v_addc_co_u32 v19, vcc, 0, v19, vcc
  global_load_dwordx4 a[96:99], v[16:17], off
  v_add_co_u32 v16, vcc, s14, v16
  s_nop 1
  v_addc_co_u32 v17, vcc, 0, v17, vcc
  global_load_dwordx4 a[100:103], v[18:19], off
  v_add_co_u32 v18, vcc, s14, v18
  s_nop 1
  v_addc_co_u32 v19, vcc, 0, v19, vcc
  global_load_dwordx4 a[104:107], v[16:17], off
  v_add_co_u32 v16, vcc, s14, v16
  s_nop 1
  v_addc_co_u32 v17, vcc, 0, v17, vcc
  global_load_dwordx4 a[108:111], v[18:19], off
  v_add_co_u32 v18, vcc, s14, v18
  s_nop 1
  v_addc_co_u32 v19, vcc, 0, v19, vcc
  global_load_dwordx4 a[224:227], v[16:17], off
  v_add_co_u32 v16, vcc, s14, v16
  s_nop 1
  v_addc_co_u32 v17, vcc, 0, v17, vcc
  global_load_dwordx4 a[228:231], v[18:19], off
  v_add_co_u32 v18, vcc, s14, v18
  s_nop 1
  v_addc_co_u32 v19, vcc, 0, v19, vcc
  global_load_dwordx4 a[232:235], v[16:17], off
  v_add_co_u32 v16, vcc, s14, v16
  s_nop 1
  v_addc_co_u32 v17, vcc, 0, v17, vcc
  global_load_dwordx4 a[236:239], v[18:19], off
  v_add_co_u32 v18, vcc, s14, v18
  s_nop 1
  v_addc_co_u32 v19, vcc, 0, v19, vcc
  v_add_co_u32 v16, vcc, s15, v16
  s_nop 1
  v_addc_co_u32 v17, vcc, 0, v17, vcc
  v_add_co_u32 v18, vcc, s15, v18
  s_nop 1
  v_addc_co_u32 v19, vcc, 0, v19, vcc
  s_waitcnt vmcnt(48)
  ds_write_b128 v21, a[0:3] offset:0
  ds_write_b128 v21, a[4:7] offset:1024
  ds_write_b128 v21, a[8:11] offset:2048
  ds_write_b128 v21, a[12:15] offset:3072
  ds_write_b128 v21, a[128:131] offset:4096
  ds_write_b128 v21, a[132:135] offset:5120
  ds_write_b128 v21, a[136:139] offset:6144
  ds_write_b128 v21, a[140:143] offset:7168
  s_waitcnt lgkmcnt(0)
  s_barrier
  ds_read_b64_tr_b16 a[0:1], v29 offset:0
  ds_read_b64_tr_b16 a[2:3], v29 offset:2048
  ds_read_b64_tr_b16 a[4:5], v29 offset:8192
  ds_read_b64_tr_b16 a[6:7], v29 offset:10240
  ds_read_b64_tr_b16 a[8:9], v29 offset:16384
  ds_read_b64_tr_b16 a[10:11], v29 offset:18432
  ds_read_b64_tr_b16 a[12:13], v29 offset:24576
  ds_read_b64_tr_b16 a[14:15], v29 offset:26624
  ds_read_b64_tr_b16 a[128:129], v30 offset:0
  ds_read_b64_tr_b16 a[130:131], v30 offset:2048
  ds_read_b64_tr_b16 a[132:133], v30 offset:8192
  ds_read_b64_tr_b16 a[134:135], v30 offset:10240
  ds_read_b64_tr_b16 a[136:137], v30 offset:16384
  ds_read_b64_tr_b16 a[138:139], v30 offset:18432
  ds_read_b64_tr_b16 a[140:141], v30 offset:24576
  ds_read_b64_tr_b16 a[142:143], v30 offset:26624
  global_load_dwordx4 a[112:115], v[16:17], off
  v_add_co_u32 v16, vcc, s14, v16
  s_nop 1
  v_addc_co_u32 v17, vcc, 0, v17, vcc
  global_load_dwordx4 a[116:119], v[18:19], off
  v_add_co_u32 v18, vcc, s14, v18
  s_nop 1
  v_addc_co_u32 v19, vcc, 0, v19, vcc
  global_load_dwordx4 a[120:123], v[16:17], off
  v_add_co_u32 v16, vcc, s14, v16
  s_nop 1
  v_addc_co_u32 v17, vcc, 0, v17, vcc
  global_load_dwordx4 a[124:127], v[18:19], off
  v_add_co_u32 v18, vcc, s14, v18
  s_nop 1
  v_addc_co_u32 v19, vcc, 0, v19, vcc
  global_load_dwordx4 a[240:243], v[16:17], off
  v_add_co_u32 v16, vcc, s14, v16
  s_nop 1
  v_addc_co_u32 v17, vcc, 0, v17, vcc
  global_load_dwordx4 a[244:247], v[18:19], off
  v_add_co_u32 v18, vcc, s14, v18
  s_nop 1
  v_addc_co_u32 v19, vcc, 0, v19, vcc
  global_load_dwordx4 a[248:251], v[16:17], off
  v_add_co_u32 v16, vcc, s14, v16
  s_nop 1
  v_addc_co_u32 v17, vcc, 0, v17, vcc
  global_load_dwordx4 a[252:255], v[18:19], off
  v_add_co_u32 v18, vcc, s14, v18
  s_nop 1
  v_addc_co_u32 v19, vcc, 0, v19, vcc
  v_add_co_u32 v16, vcc, s15, v16
  s_nop 1
  v_addc_co_u32 v17, vcc, 0, v17, vcc
  v_add_co_u32 v18, vcc, s15, v18
  s_nop 1
  v_addc_co_u32 v19, vcc, 0, v19, vcc
  s_waitcnt lgkmcnt(0)
  s_waitcnt vmcnt(48)
  ds_write_b128 v21, a[16:19] offset:32768
  ds_write_b128 v21, a[20:23] offset:33792
  ds_write_b128 v21, a[24:27] offset:34816
  ds_write_b128 v21, a[28:31] offset:35840
  ds_write_b128 v21, a[144:147] offset:36864
  ds_write_b128 v21, a[148:151] offset:37888
  ds_write_b128 v21, a[152:155] offset:38912
  ds_write_b128 v21, a[156:159] offset:39936
  s_waitcnt lgkmcnt(0)
  s_barrier
  ds_read_b64_tr_b16 a[16:17], v29 offset:32768
  ds_read_b64_tr_b16 a[18:19], v29 offset:34816
  ds_read_b64_tr_b16 a[20:21], v29 offset:40960
  ds_read_b64_tr_b16 a[22:23], v29 offset:43008
  ds_read_b64_tr_b16 a[24:25], v29 offset:49152
  ds_read_b64_tr_b16 a[26:27], v29 offset:51200
  ds_read_b64_tr_b16 a[28:29], v29 offset:57344
  ds_read_b64_tr_b16 a[30:31], v29 offset:59392
  ds_read_b64_tr_b16 a[144:145], v30 offset:32768
  ds_read_b64_tr_b16 a[146:147], v30 offset:34816
  ds_read_b64_tr_b16 a[148:149], v30 offset:40960
  ds_read_b64_tr_b16 a[150:151], v30 offset:43008
  ds_read_b64_tr_b16 a[152:153], v30 offset:49152
  ds_read_b64_tr_b16 a[154:155], v30 offset:51200
  ds_read_b64_tr_b16 a[156:157], v30 offset:57344
  ds_read_b64_tr_b16 a[158:159], v30 offset:59392
  s_waitcnt lgkmcnt(0)
  s_waitcnt vmcnt(40)
  ds_write_b128 v21, a[32:35] offset:0
  ds_write_b128 v21, a[36:39] offset:1024
  ds_write_b128 v21, a[40:43] offset:2048
  ds_write_b128 v21, a[44:47] offset:3072
  ds_write_b128 v21, a[160:163] offset:4096
  ds_write_b128 v21, a[164:167] offset:5120
  ds_write_b128 v21, a[168:171] offset:6144
  ds_write_b128 v21, a[172:175] offset:7168
  s_waitcnt lgkmcnt(0)
  s_barrier
  ds_read_b64_tr_b16 a[32:33], v29 offset:0
  ds_read_b64_tr_b16 a[34:35], v29 offset:2048
  ds_read_b64_tr_b16 a[36:37], v29 offset:8192
  ds_read_b64_tr_b16 a[38:39], v29 offset:10240
  ds_read_b64_tr_b16 a[40:41], v29 offset:16384
  ds_read_b64_tr_b16 a[42:43], v29 offset:18432
  ds_read_b64_tr_b16 a[44:45], v29 offset:24576
  ds_read_b64_tr_b16 a[46:47], v29 offset:26624
  ds_read_b64_tr_b16 a[160:161], v30 offset:0
  ds_read_b64_tr_b16 a[162:163], v30 offset:2048
  ds_read_b64_tr_b16 a[164:165], v30 offset:8192
  ds_read_b64_tr_b16 a[166:167], v30 offset:10240
  ds_read_b64_tr_b16 a[168:169], v30 offset:16384
  ds_read_b64_tr_b16 a[170:171], v30 offset:18432
  ds_read_b64_tr_b16 a[172:173], v30 offset:24576
  ds_read_b64_tr_b16 a[174:175], v30 offset:26624
  s_waitcnt lgkmcnt(0)
  s_waitcnt vmcnt(32)
  ds_write_b128 v21, a[48:51] offset:32768
  ds_write_b128 v21, a[52:55] offset:33792
  ds_write_b128 v21, a[56:59] offset:34816
  ds_write_b128 v21, a[60:63] offset:35840
  ds_write_b128 v21, a[176:179] offset:36864
  ds_write_b128 v21, a[180:183] offset:37888
  ds_write_b128 v21, a[184:187] offset:38912
  ds_write_b128 v21, a[188:191] offset:39936
  s_waitcnt lgkmcnt(0)
  s_barrier
  ds_read_b64_tr_b16 a[48:49], v29 offset:32768
  ds_read_b64_tr_b16 a[50:51], v29 offset:34816
  ds_read_b64_tr_b16 a[52:53], v29 offset:40960
  ds_read_b64_tr_b16 a[54:55], v29 offset:43008
  ds_read_b64_tr_b16 a[56:57], v29 offset:49152
  ds_read_b64_tr_b16 a[58:59], v29 offset:51200
  ds_read_b64_tr_b16 a[60:61], v29 offset:57344
  ds_read_b64_tr_b16 a[62:63], v29 offset:59392
  ds_read_b64_tr_b16 a[176:177], v30 offset:32768
  ds_read_b64_tr_b16 a[178:179], v30 offset:34816
  ds_read_b64_tr_b16 a[180:181], v30 offset:40960
  ds_read_b64_tr_b16 a[182:183], v30 offset:43008
  ds_read_b64_tr_b16 a[184:185], v30 offset:49152
  ds_read_b64_tr_b16 a[186:187], v30 offset:51200
  ds_read_b64_tr_b16 a[188:189], v30 offset:57344
  ds_read_b64_tr_b16 a[190:191], v30 offset:59392
  s_waitcnt lgkmcnt(0)
  s_waitcnt vmcnt(24)
  ds_write_b128 v21, a[64:67] offset:0
  ds_write_b128 v21, a[68:71] offset:1024
  ds_write_b128 v21, a[72:75] offset:2048
  ds_write_b128 v21, a[76:79] offset:3072
  ds_write_b128 v21, a[192:195] offset:4096
  ds_write_b128 v21, a[196:199] offset:5120
  ds_write_b128 v21, a[200:203] offset:6144
  ds_write_b128 v21, a[204:207] offset:7168
  s_waitcnt lgkmcnt(0)
  s_barrier
  ds_read_b64_tr_b16 a[64:65], v29 offset:0
  ds_read_b64_tr_b16 a[66:67], v29 offset:2048
  ds_read_b64_tr_b16 a[68:69], v29 offset:8192
  ds_read_b64_tr_b16 a[70:71], v29 offset:10240
  ds_read_b64_tr_b16 a[72:73], v29 offset:16384
  ds_read_b64_tr_b16 a[74:75], v29 offset:18432
  ds_read_b64_tr_b16 a[76:77], v29 offset:24576
  ds_read_b64_tr_b16 a[78:79], v29 offset:26624
  ds_read_b64_tr_b16 a[192:193], v30 offset:0
  ds_read_b64_tr_b16 a[194:195], v30 offset:2048
  ds_read_b64_tr_b16 a[196:197], v30 offset:8192
  ds_read_b64_tr_b16 a[198:199], v30 offset:10240
  ds_read_b64_tr_b16 a[200:201], v30 offset:16384
  ds_read_b64_tr_b16 a[202:203], v30 offset:18432
  ds_read_b64_tr_b16 a[204:205], v30 offset:24576
  ds_read_b64_tr_b16 a[206:207], v30 offset:26624
  s_waitcnt lgkmcnt(0)
  s_waitcnt vmcnt(16)
  ds_write_b128 v21, a[80:83] offset:32768
  ds_write_b128 v21, a[84:87] offset:33792
  ds_write_b128 v21, a[88:91] offset:34816
  ds_write_b128 v21, a[92:95] offset:35840
  ds_write_b128 v21, a[208:211] offset:36864
  ds_write_b128 v21, a[212:215] offset:37888
  ds_write_b128 v21, a[216:219] offset:38912
  ds_write_b128 v21, a[220:223] offset:39936
  s_waitcnt lgkmcnt(0)
  s_barrier
  ds_read_b64_tr_b16 a[80:81], v29 offset:32768
  ds_read_b64_tr_b16 a[82:83], v29 offset:34816
  ds_read_b64_tr_b16 a[84:85], v29 offset:40960
  ds_read_b64_tr_b16 a[86:87], v29 offset:43008
  ds_read_b64_tr_b16 a[88:89], v29 offset:49152
  ds_read_b64_tr_b16 a[90:91], v29 offset:51200
  ds_read_b64_tr_b16 a[92:93], v29 offset:57344
  ds_read_b64_tr_b16 a[94:95], v29 offset:59392
  ds_read_b64_tr_b16 a[208:209], v30 offset:32768
  ds_read_b64_tr_b16 a[210:211], v30 offset:34816
  ds_read_b64_tr_b16 a[212:213], v30 offset:40960
  ds_read_b64_tr_b16 a[214:215], v30 offset:43008
  ds_read_b64_tr_b16 a[216:217], v30 offset:49152
  ds_read_b64_tr_b16 a[218:219], v30 offset:51200
  ds_read_b64_tr_b16 a[220:221], v30 offset:57344
  ds_read_b64_tr_b16 a[222:223], v30 offset:59392
  s_waitcnt lgkmcnt(0)
  s_waitcnt vmcnt(8)
  ds_write_b128 v21, a[96:99] offset:0
  ds_write_b128 v21, a[100:103] offset:1024
  ds_write_b128 v21, a[104:107] offset:2048
  ds_write_b128 v21, a[108:111] offset:3072
  ds_write_b128 v21, a[224:227] offset:4096
  ds_write_b128 v21, a[228:231] offset:5120
  ds_write_b128 v21, a[232:235] offset:6144
  ds_write_b128 v21, a[236:239] offset:7168
  s_waitcnt lgkmcnt(0)
  s_barrier
  ds_read_b64_tr_b16 a[96:97], v29 offset:0
  ds_read_b64_tr_b16 a[98:99], v29 offset:2048
  ds_read_b64_tr_b16 a[100:101], v29 offset:8192
  ds_read_b64_tr_b16 a[102:103], v29 offset:10240
  ds_read_b64_tr_b16 a[104:105], v29 offset:16384
  ds_read_b64_tr_b16 a[106:107], v29 offset:18432
  ds_read_b64_tr_b16 a[108:109], v29 offset:24576
  ds_read_b64_tr_b16 a[110:111], v29 offset:26624
  ds_read_b64_tr_b16 a[224:225], v30 offset:0
  ds_read_b64_tr_b16 a[226:227], v30 offset:2048
  ds_read_b64_tr_b16 a[228:229], v30 offset:8192
  ds_read_b64_tr_b16 a[230:231], v30 offset:10240
  ds_read_b64_tr_b16 a[232:233], v30 offset:16384
  ds_read_b64_tr_b16 a[234:235], v30 offset:18432
  ds_read_b64_tr_b16 a[236:237], v30 offset:24576
  ds_read_b64_tr_b16 a[238:239], v30 offset:26624
  s_waitcnt lgkmcnt(0)
  s_waitcnt vmcnt(0)
  ds_write_b128 v21, a[112:115] offset:32768
  ds_write_b128 v21, a[116:119] offset:33792
  ds_write_b128 v21, a[120:123] offset:34816
  ds_write_b128 v21, a[124:127] offset:35840
  ds_write_b128 v21, a[240:243] offset:36864
  ds_write_b128 v21, a[244:247] offset:37888
  ds_write_b128 v21, a[248:251] offset:38912
  ds_write_b128 v21, a[252:255] offset:39936
  s_waitcnt lgkmcnt(0)
  s_barrier
  ds_read_b64_tr_b16 a[112:113], v29 offset:32768
  ds_read_b64_tr_b16 a[114:115], v29 offset:34816
  ds_read_b64_tr_b16 a[116:117], v29 offset:40960
  ds_read_b64_tr_b16 a[118:119], v29 offset:43008
  ds_read_b64_tr_b16 a[120:121], v29 offset:49152
  ds_read_b64_tr_b16 a[122:123], v29 offset:51200
  ds_read_b64_tr_b16 a[124:125], v29 offset:57344
  ds_read_b64_tr_b16 a[126:127], v29 offset:59392
  ds_read_b64_tr_b16 a[240:241], v30 offset:32768
  ds_read_b64_tr_b16 a[242:243], v30 offset:34816
  ds_read_b64_tr_b16 a[244:245], v30 offset:40960
  ds_read_b64_tr_b16 a[246:247], v30 offset:43008
  ds_read_b64_tr_b16 a[248:249], v30 offset:49152
  ds_read_b64_tr_b16 a[250:251], v30 offset:51200
  ds_read_b64_tr_b16 a[252:253], v30 offset:57344
  ds_read_b64_tr_b16 a[254:255], v30 offset:59392
  s_waitcnt lgkmcnt(0)
  s_barrier
  v_and_b32 v12, 31, v0
  v_lshrrev_b32 v13, 5, v0
  v_and_b32 v14, 15, v0
  v_add_u32 v15, 0, v13
  v_xor_b32 v15, v15, v14
  v_lshlrev_b32 v15, 4, v15
  v_lshl_add_u32 v2, v12, 10, v15
  v_add_u32 v15, 2, v13
  v_xor_b32 v15, v15, v14
  v_lshlrev_b32 v15, 4, v15
  v_lshl_add_u32 v3, v12, 10, v15
  v_add_u32 v15, 4, v13
  v_xor_b32 v15, v15, v14
  v_lshlrev_b32 v15, 4, v15
  v_lshl_add_u32 v4, v12, 10, v15
  v_add_u32 v15, 6, v13
  v_xor_b32 v15, v15, v14
  v_lshlrev_b32 v15, 4, v15
  v_lshl_add_u32 v5, v12, 10, v15
  v_add_u32 v15, 8, v13
  v_xor_b32 v15, v15, v14
  v_lshlrev_b32 v15, 4, v15
  v_lshl_add_u32 v6, v12, 10, v15
  v_add_u32 v15, 10, v13
  v_xor_b32 v15, v15, v14
  v_lshlrev_b32 v15, 4, v15
  v_lshl_add_u32 v7, v12, 10, v15
  v_add_u32 v15, 12, v13
  v_xor_b32 v15, v15, v14
  v_lshlrev_b32 v15, 4, v15
  v_lshl_add_u32 v8, v12, 10, v15
  v_add_u32 v15, 14, v13
  v_xor_b32 v15, v15, v14
  v_lshlrev_b32 v15, 4, v15
  v_lshl_add_u32 v9, v12, 10, v15
  v_and_b32 v12, 15, v0
  v_lshrrev_b32 v13, 4, v0
  v_lshrrev_b32 v14, 2, v12
  v_and_b32 v15, 1, v12
  v_lshl_add_u32 v14, v14, 1, v15
  v_bfe_u32 v15, v12, 1, 1
  v_lshrrev_b32 v16, 1, v13
  v_xor_b32 v16, v16, v14
  v_lshlrev_b32 v16, 4, v16
  v_lshl_add_u32 v16, v14, 10, v16
  v_and_b32 v17, 1, v13
  v_lshlrev_b32 v17, 3, v17
  v_lshl_add_u32 v17, v15, 2, v17
  v_add_u32 v16, v16, v17
  s_lshl_b32 s12, s8, 8
  v_add_u32 v10, s12, v16
  s_lshl_b32 s12, s8, 11
  v_add_u32 v11, s12, v1
  v_and_b32 v12, 7, v0
  v_lshrrev_b32 v13, 1, v12
  v_and_b32 v14, 1, v12
  v_lshl_add_u32 v13, v13, 2, v14
  v_lshrrev_b32 v14, 5, v0
  v_lshl_add_u32 v13, v14, 4, v13
  v_lshlrev_b32 v13, 4, v13
  v_bfe_u32 v14, v0, 3, 2
  v_lshl_add_u32 v116, v14, 17, v13
  s_mov_b32 s30, 0
  s_add_u32 s26, s4, 71303168
  s_addc_u32 s27, s5, 0
L_kvms_28:
  s_mov_b32 s49, 0
L_kvmp_30:
  global_load_dwordx4 v[32:35], v11, s[26:27] sc1
  global_load_dwordx4 v[36:39], v11, s[26:27] offset:1024 sc1
  s_add_u32 s49, s49, 1
  s_cmp_gt_u32 s49, 0x20000
  s_cbranch_scc1 L_kvmok_31
  s_waitcnt vmcnt(0)
  v_max3_u32 v12, v32, v33, v34
  v_max3_u32 v13, v35, v36, v37
  v_max3_u32 v12, v12, v38, v39
  v_max_u32 v12, v12, v13
  v_cmp_eq_u32 vcc, -1, v12
  s_nop 0
  s_cbranch_vccz L_kvmok_31
  s_sleep 2
  s_branch L_kvmp_30
L_kvmok_31:
  s_waitcnt vmcnt(0)
  v_xor_b32 v15, 0, v10
  v_add_u32 v15, 0, v15
  v_xor_b32 v14, 0, v15
  ds_write_b16 v14, v32 offset:0
  ds_write_b16 v14, v34 offset:2
  v_xor_b32 v14, 32, v15
  ds_write_b16_d16_hi v14, v32 offset:0
  ds_write_b16_d16_hi v14, v34 offset:2
  v_xor_b32 v14, 64, v15
  ds_write_b16 v14, v33 offset:0
  ds_write_b16 v14, v35 offset:2
  v_xor_b32 v14, 96, v15
  ds_write_b16_d16_hi v14, v33 offset:0
  ds_write_b16_d16_hi v14, v35 offset:2
  v_xor_b32 v14, 128, v15
  ds_write_b16 v14, v36 offset:0
  ds_write_b16 v14, v38 offset:2
  v_xor_b32 v14, 160, v15
  ds_write_b16_d16_hi v14, v36 offset:0
  ds_write_b16_d16_hi v14, v38 offset:2
  v_xor_b32 v14, 192, v15
  ds_write_b16 v14, v37 offset:0
  ds_write_b16 v14, v39 offset:2
  v_xor_b32 v14, 224, v15
  ds_write_b16_d16_hi v14, v37 offset:0
  ds_write_b16_d16_hi v14, v39 offset:2
  s_waitcnt lgkmcnt(0)
  s_add_u32 s26, s26, 8192
  s_addc_u32 s27, s27, 0
  s_mov_b32 s49, 0
L_kvmp_32:
  global_load_dwordx4 v[32:35], v11, s[26:27] sc1
  global_load_dwordx4 v[36:39], v11, s[26:27] offset:1024 sc1
  s_add_u32 s49, s49, 1
  s_cmp_gt_u32 s49, 0x20000
  s_cbranch_scc1 L_kvmok_33
  s_waitcnt vmcnt(0)
  v_max3_u32 v12, v32, v33, v34
  v_max3_u32 v13, v35, v36, v37
  v_max3_u32 v12, v12, v38, v39
  v_max_u32 v12, v12, v13
  v_cmp_eq_u32 vcc, -1, v12
  s_nop 0
  s_cbranch_vccz L_kvmok_33
  s_sleep 2
  s_branch L_kvmp_32
L_kvmok_33:
  s_waitcnt vmcnt(0)
  v_xor_b32 v15, 128, v10
  v_add_u32 v15, 8192, v15
  v_xor_b32 v14, 0, v15
  ds_write_b16 v14, v32 offset:0
  ds_write_b16 v14, v34 offset:2
  v_xor_b32 v14, 32, v15
  ds_write_b16_d16_hi v14, v32 offset:0
  ds_write_b16_d16_hi v14, v34 offset:2
  v_xor_b32 v14, 64, v15
  ds_write_b16 v14, v33 offset:0
  ds_write_b16 v14, v35 offset:2
  v_xor_b32 v14, 96, v15
  ds_write_b16_d16_hi v14, v33 offset:0
  ds_write_b16_d16_hi v14, v35 offset:2
  v_xor_b32 v14, 128, v15
  ds_write_b16 v14, v36 offset:0
  ds_write_b16 v14, v38 offset:2
  v_xor_b32 v14, 160, v15
  ds_write_b16_d16_hi v14, v36 offset:0
  ds_write_b16_d16_hi v14, v38 offset:2
  v_xor_b32 v14, 192, v15
  ds_write_b16 v14, v37 offset:0
  ds_write_b16 v14, v39 offset:2
  v_xor_b32 v14, 224, v15
  ds_write_b16_d16_hi v14, v37 offset:0
  ds_write_b16_d16_hi v14, v39 offset:2
  s_waitcnt lgkmcnt(0)
  s_add_u32 s26, s26, 8192
  s_addc_u32 s27, s27, 0
  s_mov_b32 s49, 0
L_kvmp_34:
  global_load_dwordx4 v[32:35], v11, s[26:27] sc1
  global_load_dwordx4 v[36:39], v11, s[26:27] offset:1024 sc1
  s_add_u32 s49, s49, 1
  s_cmp_gt_u32 s49, 0x20000
  s_cbranch_scc1 L_kvmok_35
  s_waitcnt vmcnt(0)
  v_max3_u32 v12, v32, v33, v34
  v_max3_u32 v13, v35, v36, v37
  v_max3_u32 v12, v12, v38, v39
  v_max_u32 v12, v12, v13
  v_cmp_eq_u32 vcc, -1, v12
  s_nop 0
  s_cbranch_vccz L_kvmok_35
  s_sleep 2
  s_branch L_kvmp_34
L_kvmok_35:
  s_waitcnt vmcnt(0)
  v_xor_b32 v15, 0, v10
  v_add_u32 v15, 16384, v15
  v_xor_b32 v14, 0, v15
  ds_write_b16 v14, v32 offset:0
  ds_write_b16 v14, v34 offset:2
  v_xor_b32 v14, 32, v15
  ds_write_b16_d16_hi v14, v32 offset:0
  ds_write_b16_d16_hi v14, v34 offset:2
  v_xor_b32 v14, 64, v15
  ds_write_b16 v14, v33 offset:0
  ds_write_b16 v14, v35 offset:2
  v_xor_b32 v14, 96, v15
  ds_write_b16_d16_hi v14, v33 offset:0
  ds_write_b16_d16_hi v14, v35 offset:2
  v_xor_b32 v14, 128, v15
  ds_write_b16 v14, v36 offset:0
  ds_write_b16 v14, v38 offset:2
  v_xor_b32 v14, 160, v15
  ds_write_b16_d16_hi v14, v36 offset:0
  ds_write_b16_d16_hi v14, v38 offset:2
  v_xor_b32 v14, 192, v15
  ds_write_b16 v14, v37 offset:0
  ds_write_b16 v14, v39 offset:2
  v_xor_b32 v14, 224, v15
  ds_write_b16_d16_hi v14, v37 offset:0
  ds_write_b16_d16_hi v14, v39 offset:2
  s_waitcnt lgkmcnt(0)
  s_add_u32 s26, s26, 8192
  s_addc_u32 s27, s27, 0
  s_cmp_eq_u32 s30, 60
  s_cbranch_scc1 L_kvm3_29
  s_mov_b32 s49, 0
L_kvmp_36:
  global_load_dwordx4 v[32:35], v11, s[26:27] sc1
  global_load_dwordx4 v[36:39], v11, s[26:27] offset:1024 sc1
  s_add_u32 s49, s49, 1
  s_cmp_gt_u32 s49, 0x20000
  s_cbranch_scc1 L_kvmok_37
  s_waitcnt vmcnt(0)
  v_max3_u32 v12, v32, v33, v34
  v_max3_u32 v13, v35, v36, v37
  v_max3_u32 v12, v12, v38, v39
  v_max_u32 v12, v12, v13
  v_cmp_eq_u32 vcc, -1, v12
  s_nop 0
  s_cbranch_vccz L_kvmok_37
  s_sleep 2
  s_branch L_kvmp_36
L_kvmok_37:
  s_waitcnt vmcnt(0)
  v_xor_b32 v15, 128, v10
  v_add_u32 v15, 24576, v15
  v_xor_b32 v14, 0, v15
  ds_write_b16 v14, v32 offset:0
  ds_write_b16 v14, v34 offset:2
  v_xor_b32 v14, 32, v15
  ds_write_b16_d16_hi v14, v32 offset:0
  ds_write_b16_d16_hi v14, v34 offset:2
  v_xor_b32 v14, 64, v15
  ds_write_b16 v14, v33 offset:0
  ds_write_b16 v14, v35 offset:2
  v_xor_b32 v14, 96, v15
  ds_write_b16_d16_hi v14, v33 offset:0
  ds_write_b16_d16_hi v14, v35 offset:2
  v_xor_b32 v14, 128, v15
  ds_write_b16 v14, v36 offset:0
  ds_write_b16 v14, v38 offset:2
  v_xor_b32 v14, 160, v15
  ds_write_b16_d16_hi v14, v36 offset:0
  ds_write_b16_d16_hi v14, v38 offset:2
  v_xor_b32 v14, 192, v15
  ds_write_b16 v14, v37 offset:0
  ds_write_b16 v14, v39 offset:2
  v_xor_b32 v14, 224, v15
  ds_write_b16_d16_hi v14, v37 offset:0
  ds_write_b16_d16_hi v14, v39 offset:2
  s_waitcnt lgkmcnt(0)
  s_add_u32 s26, s26, 8192
  s_addc_u32 s27, s27, 0
L_kvm3_29:
  s_barrier
  s_lshl_b32 s12, s30, 17
  s_add_u32 s12, s12, s37
  s_add_u32 s12, s12, 50462720
  s_add_u32 s28, s4, s12
  s_addc_u32 s29, s5, 0
  ds_read_b128 v[32:35], v2 offset:0
  ds_read_b128 v[36:39], v3 offset:0
  ds_read_b128 v[40:43], v4 offset:0
  ds_read_b128 v[44:47], v5 offset:0
  ds_read_b128 v[48:51], v6 offset:0
  ds_read_b128 v[52:55], v7 offset:0
  s_waitcnt lgkmcnt(5)
  v_mfma_f32_32x32x16_bf16 v[64:79], a[0:3], v[32:35], 0
  ds_read_b128 v[56:59], v8 offset:0
  v_mfma_f32_32x32x16_bf16 v[80:95], a[128:131], v[32:35], 0
  s_waitcnt lgkmcnt(5)
  v_mfma_f32_32x32x16_bf16 v[64:79], a[4:7], v[36:39], v[64:79]
  ds_read_b128 v[60:63], v9 offset:0
  v_mfma_f32_32x32x16_bf16 v[80:95], a[132:135], v[36:39], v[80:95]
  s_waitcnt lgkmcnt(5)
  v_mfma_f32_32x32x16_bf16 v[64:79], a[8:11], v[40:43], v[64:79]
  ds_read_b128 v[32:35], v2 offset:256
  v_mfma_f32_32x32x16_bf16 v[80:95], a[136:139], v[40:43], v[80:95]
  s_waitcnt lgkmcnt(5)
  v_mfma_f32_32x32x16_bf16 v[64:79], a[12:15], v[44:47], v[64:79]
  ds_read_b128 v[36:39], v3 offset:256
  v_mfma_f32_32x32x16_bf16 v[80:95], a[140:143], v[44:47], v[80:95]
  s_waitcnt lgkmcnt(5)
  v_mfma_f32_32x32x16_bf16 v[64:79], a[16:19], v[48:51], v[64:79]
  ds_read_b128 v[40:43], v4 offset:256
  v_mfma_f32_32x32x16_bf16 v[80:95], a[144:147], v[48:51], v[80:95]
  s_waitcnt lgkmcnt(5)
  v_mfma_f32_32x32x16_bf16 v[64:79], a[20:23], v[52:55], v[64:79]
  ds_read_b128 v[44:47], v5 offset:256
  v_mfma_f32_32x32x16_bf16 v[80:95], a[148:151], v[52:55], v[80:95]
  s_waitcnt lgkmcnt(5)
  v_mfma_f32_32x32x16_bf16 v[64:79], a[24:27], v[56:59], v[64:79]
  ds_read_b128 v[48:51], v6 offset:256
  v_mfma_f32_32x32x16_bf16 v[80:95], a[152:155], v[56:59], v[80:95]
  s_waitcnt lgkmcnt(5)
  v_mfma_f32_32x32x16_bf16 v[64:79], a[28:31], v[60:63], v[64:79]
  ds_read_b128 v[52:55], v7 offset:256
  v_mfma_f32_32x32x16_bf16 v[80:95], a[156:159], v[60:63], v[80:95]
  s_waitcnt lgkmcnt(5)
  v_mfma_f32_32x32x16_bf16 v[64:79], a[32:35], v[32:35], v[64:79]
  ds_read_b128 v[56:59], v8 offset:256
  v_mfma_f32_32x32x16_bf16 v[80:95], a[160:163], v[32:35], v[80:95]
  s_waitcnt lgkmcnt(5)
  v_mfma_f32_32x32x16_bf16 v[64:79], a[36:39], v[36:39], v[64:79]
  ds_read_b128 v[60:63], v9 offset:256
  v_mfma_f32_32x32x16_bf16 v[80:95], a[164:167], v[36:39], v[80:95]
  s_waitcnt lgkmcnt(5)
  v_mfma_f32_32x32x16_bf16 v[64:79], a[40:43], v[40:43], v[64:79]
  ds_read_b128 v[32:35], v2 offset:512
  v_mfma_f32_32x32x16_bf16 v[80:95], a[168:171], v[40:43], v[80:95]
  s_waitcnt lgkmcnt(5)
  v_mfma_f32_32x32x16_bf16 v[64:79], a[44:47], v[44:47], v[64:79]
  ds_read_b128 v[36:39], v3 offset:512
  v_mfma_f32_32x32x16_bf16 v[80:95], a[172:175], v[44:47], v[80:95]
  s_waitcnt lgkmcnt(5)
  v_mfma_f32_32x32x16_bf16 v[64:79], a[48:51], v[48:51], v[64:79]
  ds_read_b128 v[40:43], v4 offset:512
  v_mfma_f32_32x32x16_bf16 v[80:95], a[176:179], v[48:51], v[80:95]
  s_waitcnt lgkmcnt(5)
  v_mfma_f32_32x32x16_bf16 v[64:79], a[52:55], v[52:55], v[64:79]
  ds_read_b128 v[44:47], v5 offset:512
  v_mfma_f32_32x32x16_bf16 v[80:95], a[180:183], v[52:55], v[80:95]
  s_waitcnt lgkmcnt(5)
  v_mfma_f32_32x32x16_bf16 v[64:79], a[56:59], v[56:59], v[64:79]
  ds_read_b128 v[48:51], v6 offset:512
  v_mfma_f32_32x32x16_bf16 v[80:95], a[184:187], v[56:59], v[80:95]
  s_waitcnt lgkmcnt(5)
  v_mfma_f32_32x32x16_bf16 v[64:79], a[60:63], v[60:63], v[64:79]
  ds_read_b128 v[52:55], v7 offset:512
  v_mfma_f32_32x32x16_bf16 v[80:95], a[188:191], v[60:63], v[80:95]
  s_waitcnt lgkmcnt(5)
  v_mfma_f32_32x32x16_bf16 v[64:79], a[64:67], v[32:35], v[64:79]
  ds_read_b128 v[56:59], v8 offset:512
  v_mfma_f32_32x32x16_bf16 v[80:95], a[192:195], v[32:35], v[80:95]
  s_waitcnt lgkmcnt(5)
  v_mfma_f32_32x32x16_bf16 v[64:79], a[68:71], v[36:39], v[64:79]
  ds_read_b128 v[60:63], v9 offset:512
  v_mfma_f32_32x32x16_bf16 v[80:95], a[196:199], v[36:39], v[80:95]
  s_waitcnt lgkmcnt(5)
  v_mfma_f32_32x32x16_bf16 v[64:79], a[72:75], v[40:43], v[64:79]
  ds_read_b128 v[32:35], v2 offset:768
  v_mfma_f32_32x32x16_bf16 v[80:95], a[200:203], v[40:43], v[80:95]
  s_waitcnt lgkmcnt(5)
  v_mfma_f32_32x32x16_bf16 v[64:79], a[76:79], v[44:47], v[64:79]
  ds_read_b128 v[36:39], v3 offset:768
  v_mfma_f32_32x32x16_bf16 v[80:95], a[204:207], v[44:47], v[80:95]
  s_waitcnt lgkmcnt(5)
  v_mfma_f32_32x32x16_bf16 v[64:79], a[80:83], v[48:51], v[64:79]
  ds_read_b128 v[40:43], v4 offset:768
  v_mfma_f32_32x32x16_bf16 v[80:95], a[208:211], v[48:51], v[80:95]
  s_waitcnt lgkmcnt(5)
  v_mfma_f32_32x32x16_bf16 v[64:79], a[84:87], v[52:55], v[64:79]
  ds_read_b128 v[44:47], v5 offset:768
  v_mfma_f32_32x32x16_bf16 v[80:95], a[212:215], v[52:55], v[80:95]
  s_waitcnt lgkmcnt(5)
  v_mfma_f32_32x32x16_bf16 v[64:79], a[88:91], v[56:59], v[64:79]
  ds_read_b128 v[48:51], v6 offset:768
  v_mfma_f32_32x32x16_bf16 v[80:95], a[216:219], v[56:59], v[80:95]
  s_waitcnt lgkmcnt(5)
  v_mfma_f32_32x32x16_bf16 v[64:79], a[92:95], v[60:63], v[64:79]
  ds_read_b128 v[52:55], v7 offset:768
  v_mfma_f32_32x32x16_bf16 v[80:95], a[220:223], v[60:63], v[80:95]
  s_waitcnt lgkmcnt(5)
  v_mfma_f32_32x32x16_bf16 v[64:79], a[96:99], v[32:35], v[64:79]
  ds_read_b128 v[56:59], v8 offset:768
  v_mfma_f32_32x32x16_bf16 v[80:95], a[224:227], v[32:35], v[80:95]
  s_waitcnt lgkmcnt(5)
  v_mfma_f32_32x32x16_bf16 v[64:79], a[100:103], v[36:39], v[64:79]
  ds_read_b128 v[60:63], v9 offset:768
  v_mfma_f32_32x32x16_bf16 v[80:95], a[228:231], v[36:39], v[80:95]
  s_waitcnt lgkmcnt(5)
  v_mfma_f32_32x32x16_bf16 v[64:79], a[104:107], v[40:43], v[64:79]
  v_mfma_f32_32x32x16_bf16 v[80:95], a[232:235], v[40:43], v[80:95]
  s_waitcnt lgkmcnt(4)
  v_mfma_f32_32x32x16_bf16 v[64:79], a[108:111], v[44:47], v[64:79]
  v_mfma_f32_32x32x16_bf16 v[80:95], a[236:239], v[44:47], v[80:95]
  s_waitcnt lgkmcnt(3)
  v_mfma_f32_32x32x16_bf16 v[64:79], a[112:115], v[48:51], v[64:79]
  v_mfma_f32_32x32x16_bf16 v[80:95], a[240:243], v[48:51], v[80:95]
  s_waitcnt lgkmcnt(2)
  v_mfma_f32_32x32x16_bf16 v[64:79], a[116:119], v[52:55], v[64:79]
  v_mfma_f32_32x32x16_bf16 v[80:95], a[244:247], v[52:55], v[80:95]
  s_waitcnt lgkmcnt(1)
  v_mfma_f32_32x32x16_bf16 v[64:79], a[120:123], v[56:59], v[64:79]
  v_mfma_f32_32x32x16_bf16 v[80:95], a[248:251], v[56:59], v[80:95]
  s_waitcnt lgkmcnt(0)
  v_mfma_f32_32x32x16_bf16 v[64:79], a[124:127], v[60:63], v[64:79]
  v_mfma_f32_32x32x16_bf16 v[80:95], a[252:255], v[60:63], v[80:95]
  v_xor_b32 v2, 32768, v2
  v_xor_b32 v3, 32768, v3
  v_xor_b32 v4, 32768, v4
  v_xor_b32 v5, 32768, v5
  v_xor_b32 v6, 32768, v6
  v_xor_b32 v7, 32768, v7
  v_xor_b32 v8, 32768, v8
  v_xor_b32 v9, 32768, v9
  v_xor_b32 v10, 32768, v10
  s_cmp_eq_u32 s30, 60
  s_cselect_b32 s50, 0x00ffffff, -1
  v_cvt_pk_bf16_f32 v96, v64, v65
  v_cvt_pk_bf16_f32 v97, v66, v67
  v_cvt_pk_bf16_f32 v98, v68, v69
  v_cvt_pk_bf16_f32 v99, v70, v71
  v_cvt_pk_bf16_f32 v100, v72, v73
  v_cvt_pk_bf16_f32 v101, v74, v75
  v_cvt_pk_bf16_f32 v102, v76, v77
  v_cvt_pk_bf16_f32 v103, v78, v79
  v_cvt_pk_bf16_f32 v104, v80, v81
  v_cvt_pk_bf16_f32 v105, v82, v83
  v_cvt_pk_bf16_f32 v106, v84, v85
  v_cvt_pk_bf16_f32 v107, v86, v87
  v_cvt_pk_bf16_f32 v108, v88, v89
  v_cvt_pk_bf16_f32 v109, v90, v91
  v_cvt_pk_bf16_f32 v110, v92, v93
  v_cvt_pk_bf16_f32 v111, v94, v95
  s_mov_b32 exec_lo, s50
  s_mov_b32 exec_hi, s50
  global_store_dwordx4 v116, v[96:99], s[28:29] offset:0 sc1
  global_store_dwordx4 v116, v[100:103], s[28:29] offset:512 sc1
  global_store_dwordx4 v116, v[104:107], s[28:29] offset:1024 sc1
  global_store_dwordx4 v116, v[108:111], s[28:29] offset:1536 sc1
  s_mov_b64 exec, -1
  s_waitcnt vmcnt(0)
  s_barrier
  s_cmp_lg_u32 s8, 0
  s_cbranch_scc1 L_fs_38
  s_lshl_b32 s48, s30, 14
  s_lshl_b32 s49, s36, 7
  s_add_u32 s48, s48, s49
  s_add_u32 s48, s48, 8192
  v_mov_b32 v254, s48
  v_mov_b32 v255, 1
  s_mov_b64 exec, 1
  global_store_dword v254, v255, s[46:47] sc1
  s_mov_b64 exec, -1
L_fs_38:
  s_add_u32 s30, s30, 1
  s_cmp_lg_u32 s8, 0
  s_cbranch_scc1 L_fs_39
  s_lshl_b32 s48, s30, 14
  s_lshl_b32 s49, s36, 7
  s_add_u32 s48, s48, s49
  s_add_u32 s48, s48, 8192
  v_mov_b32 v254, s48
  v_mov_b32 v255, 1
  s_mov_b64 exec, 1
  global_store_dword v254, v255, s[46:47] sc1
  s_mov_b64 exec, -1
L_fs_39:
  s_add_u32 s30, s30, 1
  s_cmp_lg_u32 s8, 0
  s_cbranch_scc1 L_fs_40
  s_lshl_b32 s48, s30, 14
  s_lshl_b32 s49, s36, 7
  s_add_u32 s48, s48, s49
  s_add_u32 s48, s48, 8192
  v_mov_b32 v254, s48
  v_mov_b32 v255, 1
  s_mov_b64 exec, 1
  global_store_dword v254, v255, s[46:47] sc1
  s_mov_b64 exec, -1
L_fs_40:
  s_add_u32 s30, s30, 1
  s_cmp_eq_u32 s30, 63
  s_cbranch_scc1 L_kf3_41
  s_cmp_lg_u32 s8, 0
  s_cbranch_scc1 L_fs_42
  s_lshl_b32 s48, s30, 14
  s_lshl_b32 s49, s36, 7
  s_add_u32 s48, s48, s49
  s_add_u32 s48, s48, 8192
  v_mov_b32 v254, s48
  v_mov_b32 v255, 1
  s_mov_b64 exec, 1
  global_store_dword v254, v255, s[46:47] sc1
  s_mov_b64 exec, -1
L_fs_42:
L_kf3_41:
  s_add_u32 s30, s30, 1
  s_cmp_lt_u32 s30, 64
  s_cbranch_scc1 L_kvms_28
  s_branch L_kvmdone_26
L_kvmv_27:
  s_and_b32 s18, s36, 15
  s_lshl_b32 s12, s18, 9
  s_add_u32 s20, s66, s12
  s_addc_u32 s21, s67, 0
  s_mov_b32 s24, 8192
  s_lshr_b32 s12, s8, 1
  s_lshl_b32 s13, s18, 1
  s_add_u32 s12, s12, s13
  s_lshl_b32 s37, s12, 12
  s_and_b32 s12, s8, 1
  s_lshl_b32 s12, s12, 10
  s_add_u32 s37, s37, s12
  v_lshrrev_b32 v12, 5, v0
  v_and_b32 v13, 31, v0
  v_add_u32 v14, 0, v12
  v_lshlrev_b32 v14, 2, v14
  v_xor_b32 v14, v14, v13
  v_lshlrev_b32 v15, 4, v14
  v_mov_b32 v17, s21
  v_add_co_u32 v16, vcc, s20, v15
  s_nop 1
  v_addc_co_u32 v17, vcc, 0, v17, vcc
  s_lshl_b32 s12, s8, 4
  s_add_u32 s12, s12, 0
  v_add_u32 v15, s12, v12
  v_mul_lo_u32 v15, v15, s24
  v_add_co_u32 v16, vcc, v16, v15
  s_nop 1
  v_addc_co_u32 v17, vcc, 0, v17, vcc
  v_add_u32 v14, 2, v12
  v_lshlrev_b32 v14, 2, v14
  v_xor_b32 v14, v14, v13
  v_lshlrev_b32 v15, 4, v14
  v_mov_b32 v19, s21
  v_add_co_u32 v18, vcc, s20, v15
  s_nop 1
  v_addc_co_u32 v19, vcc, 0, v19, vcc
  s_lshl_b32 s12, s8, 4
  s_add_u32 s12, s12, 2
  v_add_u32 v15, s12, v12
  v_mul_lo_u32 v15, v15, s24
  v_add_co_u32 v18, vcc, v18, v15
  s_nop 1
  v_addc_co_u32 v19, vcc, 0, v19, vcc
  s_lshl_b32 s14, s24, 2
  s_mul_i32 s15, s24, 48
  s_lshl_b32 s13, s8, 13
  v_bfe_u32 v22, v0, 2, 2
  v_and_b32 v23, 3, v0
  v_bfe_u32 v24, v0, 4, 1
  v_lshrrev_b32 v25, 5, v0
  v_lshrrev_b32 v26, 1, v23
  v_lshl_add_u32 v26, v24, 1, v26
  v_lshl_add_u32 v25, v25, 3, v22
  s_lshl_b32 s12, s8, 3
  s_add_u32 s12, s12, 0
  v_add_u32 v27, s12, v26
  v_lshlrev_b32 v28, 2, v22
  v_xor_b32 v27, v27, v28
  v_lshlrev_b32 v27, 4, v27
  v_lshl_add_u32 v27, v25, 9, v27
  v_and_b32 v28, 1, v23
  v_lshl_add_u32 v29, v28, 3, v27
  s_lshl_b32 s12, s8, 3
  s_add_u32 s12, s12, 4
  v_add_u32 v27, s12, v26
  v_lshlrev_b32 v28, 2, v22
  v_xor_b32 v27, v27, v28
  v_lshlrev_b32 v27, 4, v27
  v_lshl_add_u32 v27, v25, 9, v27
  v_and_b32 v28, 1, v23
  v_lshl_add_u32 v30, v28, 3, v27
  v_add_u32 v21, s13, v1
  global_load_dwordx4 a[0:3], v[16:17], off
  v_add_co_u32 v16, vcc, s14, v16
  s_nop 1
  v_addc_co_u32 v17, vcc, 0, v17, vcc
  global_load_dwordx4 a[4:7], v[18:19], off
  v_add_co_u32 v18, vcc, s14, v18
  s_nop 1
  v_addc_co_u32 v19, vcc, 0, v19, vcc
  global_load_dwordx4 a[8:11], v[16:17], off
  v_add_co_u32 v16, vcc, s14, v16
  s_nop 1
  v_addc_co_u32 v17, vcc, 0, v17, vcc
  global_load_dwordx4 a[12:15], v[18:19], off
  v_add_co_u32 v18, vcc, s14, v18
  s_nop 1
  v_addc_co_u32 v19, vcc, 0, v19, vcc
  global_load_dwordx4 a[128:131], v[16:17], off
  v_add_co_u32 v16, vcc, s14, v16
  s_nop 1
  v_addc_co_u32 v17, vcc, 0, v17, vcc
  global_load_dwordx4 a[132:135], v[18:19], off
  v_add_co_u32 v18, vcc, s14, v18
  s_nop 1
  v_addc_co_u32 v19, vcc, 0, v19, vcc
  global_load_dwordx4 a[136:139], v[16:17], off
  v_add_co_u32 v16, vcc, s14, v16
  s_nop 1
  v_addc_co_u32 v17, vcc, 0, v17, vcc
  global_load_dwordx4 a[140:143], v[18:19], off
  v_add_co_u32 v18, vcc, s14, v18
  s_nop 1
  v_addc_co_u32 v19, vcc, 0, v19, vcc
  v_add_co_u32 v16, vcc, s15, v16
  s_nop 1
  v_addc_co_u32 v17, vcc, 0, v17, vcc
  v_add_co_u32 v18, vcc, s15, v18
  s_nop 1
  v_addc_co_u32 v19, vcc, 0, v19, vcc
  global_load_dwordx4 a[16:19], v[16:17], off
  v_add_co_u32 v16, vcc, s14, v16
  s_nop 1
  v_addc_co_u32 v17, vcc, 0, v17, vcc
  global_load_dwordx4 a[20:23], v[18:19], off
  v_add_co_u32 v18, vcc, s14, v18
  s_nop 1
  v_addc_co_u32 v19, vcc, 0, v19, vcc
  global_load_dwordx4 a[24:27], v[16:17], off
  v_add_co_u32 v16, vcc, s14, v16
  s_nop 1
  v_addc_co_u32 v17, vcc, 0, v17, vcc
  global_load_dwordx4 a[28:31], v[18:19], off
  v_add_co_u32 v18, vcc, s14, v18
  s_nop 1
  v_addc_co_u32 v19, vcc, 0, v19, vcc
  global_load_dwordx4 a[144:147], v[16:17], off
  v_add_co_u32 v16, vcc, s14, v16
  s_nop 1
  v_addc_co_u32 v17, vcc, 0, v17, vcc
  global_load_dwordx4 a[148:151], v[18:19], off
  v_add_co_u32 v18, vcc, s14, v18
  s_nop 1
  v_addc_co_u32 v19, vcc, 0, v19, vcc
  global_load_dwordx4 a[152:155], v[16:17], off
  v_add_co_u32 v16, vcc, s14, v16
  s_nop 1
  v_addc_co_u32 v17, vcc, 0, v17, vcc
  global_load_dwordx4 a[156:159], v[18:19], off
  v_add_co_u32 v18, vcc, s14, v18
  s_nop 1
  v_addc_co_u32 v19, vcc, 0, v19, vcc
  v_add_co_u32 v16, vcc, s15, v16
  s_nop 1
  v_addc_co_u32 v17, vcc, 0, v17, vcc
  v_add_co_u32 v18, vcc, s15, v18
  s_nop 1
  v_addc_co_u32 v19, vcc, 0, v19, vcc
  global_load_dwordx4 a[32:35], v[16:17], off
  v_add_co_u32 v16, vcc, s14, v16
  s_nop 1
  v_addc_co_u32 v17, vcc, 0, v17, vcc
  global_load_dwordx4 a[36:39], v[18:19], off
  v_add_co_u32 v18, vcc, s14, v18
  s_nop 1
  v_addc_co_u32 v19, vcc, 0, v19, vcc
  global_load_dwordx4 a[40:43], v[16:17], off
  v_add_co_u32 v16, vcc, s14, v16
  s_nop 1
  v_addc_co_u32 v17, vcc, 0, v17, vcc
  global_load_dwordx4 a[44:47], v[18:19], off
  v_add_co_u32 v18, vcc, s14, v18
  s_nop 1
  v_addc_co_u32 v19, vcc, 0, v19, vcc
  global_load_dwordx4 a[160:163], v[16:17], off
  v_add_co_u32 v16, vcc, s14, v16
  s_nop 1
  v_addc_co_u32 v17, vcc, 0, v17, vcc
  global_load_dwordx4 a[164:167], v[18:19], off
  v_add_co_u32 v18, vcc, s14, v18
  s_nop 1
  v_addc_co_u32 v19, vcc, 0, v19, vcc
  global_load_dwordx4 a[168:171], v[16:17], off
  v_add_co_u32 v16, vcc, s14, v16
  s_nop 1
  v_addc_co_u32 v17, vcc, 0, v17, vcc
  global_load_dwordx4 a[172:175], v[18:19], off
  v_add_co_u32 v18, vcc, s14, v18
  s_nop 1
  v_addc_co_u32 v19, vcc, 0, v19, vcc
  v_add_co_u32 v16, vcc, s15, v16
  s_nop 1
  v_addc_co_u32 v17, vcc, 0, v17, vcc
  v_add_co_u32 v18, vcc, s15, v18
  s_nop 1
  v_addc_co_u32 v19, vcc, 0, v19, vcc
  global_load_dwordx4 a[48:51], v[16:17], off
  v_add_co_u32 v16, vcc, s14, v16
  s_nop 1
  v_addc_co_u32 v17, vcc, 0, v17, vcc
  global_load_dwordx4 a[52:55], v[18:19], off
  v_add_co_u32 v18, vcc, s14, v18
  s_nop 1
  v_addc_co_u32 v19, vcc, 0, v19, vcc
  global_load_dwordx4 a[56:59], v[16:17], off
  v_add_co_u32 v16, vcc, s14, v16
  s_nop 1
  v_addc_co_u32 v17, vcc, 0, v17, vcc
  global_load_dwordx4 a[60:63], v[18:19], off
  v_add_co_u32 v18, vcc, s14, v18
  s_nop 1
  v_addc_co_u32 v19, vcc, 0, v19, vcc
  global_load_dwordx4 a[176:179], v[16:17], off
  v_add_co_u32 v16, vcc, s14, v16
  s_nop 1
  v_addc_co_u32 v17, vcc, 0, v17, vcc
  global_load_dwordx4 a[180:183], v[18:19], off
  v_add_co_u32 v18, vcc, s14, v18
  s_nop 1
  v_addc_co_u32 v19, vcc, 0, v19, vcc
  global_load_dwordx4 a[184:187], v[16:17], off
  v_add_co_u32 v16, vcc, s14, v16
  s_nop 1
  v_addc_co_u32 v17, vcc, 0, v17, vcc
  global_load_dwordx4 a[188:191], v[18:19], off
  v_add_co_u32 v18, vcc, s14, v18
  s_nop 1
  v_addc_co_u32 v19, vcc, 0, v19, vcc
  v_add_co_u32 v16, vcc, s15, v16
  s_nop 1
  v_addc_co_u32 v17, vcc, 0, v17, vcc
  v_add_co_u32 v18, vcc, s15, v18
  s_nop 1
  v_addc_co_u32 v19, vcc, 0, v19, vcc
  global_load_dwordx4 a[64:67], v[16:17], off
  v_add_co_u32 v16, vcc, s14, v16
  s_nop 1
  v_addc_co_u32 v17, vcc, 0, v17, vcc
  global_load_dwordx4 a[68:71], v[18:19], off
  v_add_co_u32 v18, vcc, s14, v18
  s_nop 1
  v_addc_co_u32 v19, vcc, 0, v19, vcc
  global_load_dwordx4 a[72:75], v[16:17], off
  v_add_co_u32 v16, vcc, s14, v16
  s_nop 1
  v_addc_co_u32 v17, vcc, 0, v17, vcc
  global_load_dwordx4 a[76:79], v[18:19], off
  v_add_co_u32 v18, vcc, s14, v18
  s_nop 1
  v_addc_co_u32 v19, vcc, 0, v19, vcc
  global_load_dwordx4 a[192:195], v[16:17], off
  v_add_co_u32 v16, vcc, s14, v16
  s_nop 1
  v_addc_co_u32 v17, vcc, 0, v17, vcc
  global_load_dwordx4 a[196:199], v[18:19], off
  v_add_co_u32 v18, vcc, s14, v18
  s_nop 1
  v_addc_co_u32 v19, vcc, 0, v19, vcc
  global_load_dwordx4 a[200:203], v[16:17], off
  v_add_co_u32 v16, vcc, s14, v16
  s_nop 1
  v_addc_co_u32 v17, vcc, 0, v17, vcc
  global_load_dwordx4 a[204:207], v[18:19], off
  v_add_co_u32 v18, vcc, s14, v18
  s_nop 1
  v_addc_co_u32 v19, vcc, 0, v19, vcc
  v_add_co_u32 v16, vcc, s15, v16
  s_nop 1
  v_addc_co_u32 v17, vcc, 0, v17, vcc
  v_add_co_u32 v18, vcc, s15, v18
  s_nop 1
  v_addc_co_u32 v19, vcc, 0, v19, vcc
  global_load_dwordx4 a[80:83], v[16:17], off
  v_add_co_u32 v16, vcc, s14, v16
  s_nop 1
  v_addc_co_u32 v17, vcc, 0, v17, vcc
  global_load_dwordx4 a[84:87], v[18:19], off
  v_add_co_u32 v18, vcc, s14, v18
  s_nop 1
  v_addc_co_u32 v19, vcc, 0, v19, vcc
  global_load_dwordx4 a[88:91], v[16:17], off
  v_add_co_u32 v16, vcc, s14, v16
  s_nop 1
  v_addc_co_u32 v17, vcc, 0, v17, vcc
  global_load_dwordx4 a[92:95], v[18:19], off
  v_add_co_u32 v18, vcc, s14, v18
  s_nop 1
  v_addc_co_u32 v19, vcc, 0, v19, vcc
  global_load_dwordx4 a[208:211], v[16:17], off
  v_add_co_u32 v16, vcc, s14, v16
  s_nop 1
  v_addc_co_u32 v17, vcc, 0, v17, vcc
  global_load_dwordx4 a[212:215], v[18:19], off
  v_add_co_u32 v18, vcc, s14, v18
  s_nop 1
  v_addc_co_u32 v19, vcc, 0, v19, vcc
  global_load_dwordx4 a[216:219], v[16:17], off
  v_add_co_u32 v16, vcc, s14, v16
  s_nop 1
  v_addc_co_u32 v17, vcc, 0, v17, vcc
  global_load_dwordx4 a[220:223], v[18:19], off
  v_add_co_u32 v18, vcc, s14, v18
  s_nop 1
  v_addc_co_u32 v19, vcc, 0, v19, vcc
  v_add_co_u32 v16, vcc, s15, v16
  s_nop 1
  v_addc_co_u32 v17, vcc, 0, v17, vcc
  v_add_co_u32 v18, vcc, s15, v18
  s_nop 1
  v_addc_co_u32 v19, vcc, 0, v19, vcc
  global_load_dwordx4 a[96:99], v[16:17], off
  v_add_co_u32 v16, vcc, s14, v16
  s_nop 1
  v_addc_co_u32 v17, vcc, 0, v17, vcc
  global_load_dwordx4 a[100:103], v[18:19], off
  v_add_co_u32 v18, vcc, s14, v18
  s_nop 1
  v_addc_co_u32 v19, vcc, 0, v19, vcc
  global_load_dwordx4 a[104:107], v[16:17], off
  v_add_co_u32 v16, vcc, s14, v16
  s_nop 1
  v_addc_co_u32 v17, vcc, 0, v17, vcc
  global_load_dwordx4 a[108:111], v[18:19], off
  v_add_co_u32 v18, vcc, s14, v18
  s_nop 1
  v_addc_co_u32 v19, vcc, 0, v19, vcc
  global_load_dwordx4 a[224:227], v[16:17], off
  v_add_co_u32 v16, vcc, s14, v16
  s_nop 1
  v_addc_co_u32 v17, vcc, 0, v17, vcc
  global_load_dwordx4 a[228:231], v[18:19], off
  v_add_co_u32 v18, vcc, s14, v18
  s_nop 1
  v_addc_co_u32 v19, vcc, 0, v19, vcc
  global_load_dwordx4 a[232:235], v[16:17], off
  v_add_co_u32 v16, vcc, s14, v16
  s_nop 1
  v_addc_co_u32 v17, vcc, 0, v17, vcc
  global_load_dwordx4 a[236:239], v[18:19], off
  v_add_co_u32 v18, vcc, s14, v18
  s_nop 1
  v_addc_co_u32 v19, vcc, 0, v19, vcc
  v_add_co_u32 v16, vcc, s15, v16
  s_nop 1
  v_addc_co_u32 v17, vcc, 0, v17, vcc
  v_add_co_u32 v18, vcc, s15, v18
  s_nop 1
  v_addc_co_u32 v19, vcc, 0, v19, vcc
  s_waitcnt vmcnt(48)
  ds_write_b128 v21, a[0:3] offset:0
  ds_write_b128 v21, a[4:7] offset:1024
  ds_write_b128 v21, a[8:11] offset:2048
  ds_write_b128 v21, a[12:15] offset:3072
  ds_write_b128 v21, a[128:131] offset:4096
  ds_write_b128 v21, a[132:135] offset:5120
  ds_write_b128 v21, a[136:139] offset:6144
  ds_write_b128 v21, a[140:143] offset:7168
  s_waitcnt lgkmcnt(0)
  s_barrier
  ds_read_b64_tr_b16 a[0:1], v29 offset:0
  ds_read_b64_tr_b16 a[2:3], v29 offset:2048
  ds_read_b64_tr_b16 a[4:5], v29 offset:8192
  ds_read_b64_tr_b16 a[6:7], v29 offset:10240
  ds_read_b64_tr_b16 a[8:9], v29 offset:16384
  ds_read_b64_tr_b16 a[10:11], v29 offset:18432
  ds_read_b64_tr_b16 a[12:13], v29 offset:24576
  ds_read_b64_tr_b16 a[14:15], v29 offset:26624
  ds_read_b64_tr_b16 a[128:129], v30 offset:0
  ds_read_b64_tr_b16 a[130:131], v30 offset:2048
  ds_read_b64_tr_b16 a[132:133], v30 offset:8192
  ds_read_b64_tr_b16 a[134:135], v30 offset:10240
  ds_read_b64_tr_b16 a[136:137], v30 offset:16384
  ds_read_b64_tr_b16 a[138:139], v30 offset:18432
  ds_read_b64_tr_b16 a[140:141], v30 offset:24576
  ds_read_b64_tr_b16 a[142:143], v30 offset:26624
  global_load_dwordx4 a[112:115], v[16:17], off
  v_add_co_u32 v16, vcc, s14, v16
  s_nop 1
  v_addc_co_u32 v17, vcc, 0, v17, vcc
  global_load_dwordx4 a[116:119], v[18:19], off
  v_add_co_u32 v18, vcc, s14, v18
  s_nop 1
  v_addc_co_u32 v19, vcc, 0, v19, vcc
  global_load_dwordx4 a[120:123], v[16:17], off
  v_add_co_u32 v16, vcc, s14, v16
  s_nop 1
  v_addc_co_u32 v17, vcc, 0, v17, vcc
  global_load_dwordx4 a[124:127], v[18:19], off
  v_add_co_u32 v18, vcc, s14, v18
  s_nop 1
  v_addc_co_u32 v19, vcc, 0, v19, vcc
  global_load_dwordx4 a[240:243], v[16:17], off
  v_add_co_u32 v16, vcc, s14, v16
  s_nop 1
  v_addc_co_u32 v17, vcc, 0, v17, vcc
  global_load_dwordx4 a[244:247], v[18:19], off
  v_add_co_u32 v18, vcc, s14, v18
  s_nop 1
  v_addc_co_u32 v19, vcc, 0, v19, vcc
  global_load_dwordx4 a[248:251], v[16:17], off
  v_add_co_u32 v16, vcc, s14, v16
  s_nop 1
  v_addc_co_u32 v17, vcc, 0, v17, vcc
  global_load_dwordx4 a[252:255], v[18:19], off
  v_add_co_u32 v18, vcc, s14, v18
  s_nop 1
  v_addc_co_u32 v19, vcc, 0, v19, vcc
  v_add_co_u32 v16, vcc, s15, v16
  s_nop 1
  v_addc_co_u32 v17, vcc, 0, v17, vcc
  v_add_co_u32 v18, vcc, s15, v18
  s_nop 1
  v_addc_co_u32 v19, vcc, 0, v19, vcc
  s_waitcnt lgkmcnt(0)
  s_waitcnt vmcnt(48)
  ds_write_b128 v21, a[16:19] offset:32768
  ds_write_b128 v21, a[20:23] offset:33792
  ds_write_b128 v21, a[24:27] offset:34816
  ds_write_b128 v21, a[28:31] offset:35840
  ds_write_b128 v21, a[144:147] offset:36864
  ds_write_b128 v21, a[148:151] offset:37888
  ds_write_b128 v21, a[152:155] offset:38912
  ds_write_b128 v21, a[156:159] offset:39936
  s_waitcnt lgkmcnt(0)
  s_barrier
  ds_read_b64_tr_b16 a[16:17], v29 offset:32768
  ds_read_b64_tr_b16 a[18:19], v29 offset:34816
  ds_read_b64_tr_b16 a[20:21], v29 offset:40960
  ds_read_b64_tr_b16 a[22:23], v29 offset:43008
  ds_read_b64_tr_b16 a[24:25], v29 offset:49152
  ds_read_b64_tr_b16 a[26:27], v29 offset:51200
  ds_read_b64_tr_b16 a[28:29], v29 offset:57344
  ds_read_b64_tr_b16 a[30:31], v29 offset:59392
  ds_read_b64_tr_b16 a[144:145], v30 offset:32768
  ds_read_b64_tr_b16 a[146:147], v30 offset:34816
  ds_read_b64_tr_b16 a[148:149], v30 offset:40960
  ds_read_b64_tr_b16 a[150:151], v30 offset:43008
  ds_read_b64_tr_b16 a[152:153], v30 offset:49152
  ds_read_b64_tr_b16 a[154:155], v30 offset:51200
  ds_read_b64_tr_b16 a[156:157], v30 offset:57344
  ds_read_b64_tr_b16 a[158:159], v30 offset:59392
  s_waitcnt lgkmcnt(0)
  s_waitcnt vmcnt(40)
  ds_write_b128 v21, a[32:35] offset:0
  ds_write_b128 v21, a[36:39] offset:1024
  ds_write_b128 v21, a[40:43] offset:2048
  ds_write_b128 v21, a[44:47] offset:3072
  ds_write_b128 v21, a[160:163] offset:4096
  ds_write_b128 v21, a[164:167] offset:5120
  ds_write_b128 v21, a[168:171] offset:6144
  ds_write_b128 v21, a[172:175] offset:7168
  s_waitcnt lgkmcnt(0)
  s_barrier
  ds_read_b64_tr_b16 a[32:33], v29 offset:0
  ds_read_b64_tr_b16 a[34:35], v29 offset:2048
  ds_read_b64_tr_b16 a[36:37], v29 offset:8192
  ds_read_b64_tr_b16 a[38:39], v29 offset:10240
  ds_read_b64_tr_b16 a[40:41], v29 offset:16384
  ds_read_b64_tr_b16 a[42:43], v29 offset:18432
  ds_read_b64_tr_b16 a[44:45], v29 offset:24576
  ds_read_b64_tr_b16 a[46:47], v29 offset:26624
  ds_read_b64_tr_b16 a[160:161], v30 offset:0
  ds_read_b64_tr_b16 a[162:163], v30 offset:2048
  ds_read_b64_tr_b16 a[164:165], v30 offset:8192
  ds_read_b64_tr_b16 a[166:167], v30 offset:10240
  ds_read_b64_tr_b16 a[168:169], v30 offset:16384
  ds_read_b64_tr_b16 a[170:171], v30 offset:18432
  ds_read_b64_tr_b16 a[172:173], v30 offset:24576
  ds_read_b64_tr_b16 a[174:175], v30 offset:26624
  s_waitcnt lgkmcnt(0)
  s_waitcnt vmcnt(32)
  ds_write_b128 v21, a[48:51] offset:32768
  ds_write_b128 v21, a[52:55] offset:33792
  ds_write_b128 v21, a[56:59] offset:34816
  ds_write_b128 v21, a[60:63] offset:35840
  ds_write_b128 v21, a[176:179] offset:36864
  ds_write_b128 v21, a[180:183] offset:37888
  ds_write_b128 v21, a[184:187] offset:38912
  ds_write_b128 v21, a[188:191] offset:39936
  s_waitcnt lgkmcnt(0)
  s_barrier
  ds_read_b64_tr_b16 a[48:49], v29 offset:32768
  ds_read_b64_tr_b16 a[50:51], v29 offset:34816
  ds_read_b64_tr_b16 a[52:53], v29 offset:40960
  ds_read_b64_tr_b16 a[54:55], v29 offset:43008
  ds_read_b64_tr_b16 a[56:57], v29 offset:49152
  ds_read_b64_tr_b16 a[58:59], v29 offset:51200
  ds_read_b64_tr_b16 a[60:61], v29 offset:57344
  ds_read_b64_tr_b16 a[62:63], v29 offset:59392
  ds_read_b64_tr_b16 a[176:177], v30 offset:32768
  ds_read_b64_tr_b16 a[178:179], v30 offset:34816
  ds_read_b64_tr_b16 a[180:181], v30 offset:40960
  ds_read_b64_tr_b16 a[182:183], v30 offset:43008
  ds_read_b64_tr_b16 a[184:185], v30 offset:49152
  ds_read_b64_tr_b16 a[186:187], v30 offset:51200
  ds_read_b64_tr_b16 a[188:189], v30 offset:57344
  ds_read_b64_tr_b16 a[190:191], v30 offset:59392
  s_waitcnt lgkmcnt(0)
  s_waitcnt vmcnt(24)
  ds_write_b128 v21, a[64:67] offset:0
  ds_write_b128 v21, a[68:71] offset:1024
  ds_write_b128 v21, a[72:75] offset:2048
  ds_write_b128 v21, a[76:79] offset:3072
  ds_write_b128 v21, a[192:195] offset:4096
  ds_write_b128 v21, a[196:199] offset:5120
  ds_write_b128 v21, a[200:203] offset:6144
  ds_write_b128 v21, a[204:207] offset:7168
  s_waitcnt lgkmcnt(0)
  s_barrier
  ds_read_b64_tr_b16 a[64:65], v29 offset:0
  ds_read_b64_tr_b16 a[66:67], v29 offset:2048
  ds_read_b64_tr_b16 a[68:69], v29 offset:8192
  ds_read_b64_tr_b16 a[70:71], v29 offset:10240
  ds_read_b64_tr_b16 a[72:73], v29 offset:16384
  ds_read_b64_tr_b16 a[74:75], v29 offset:18432
  ds_read_b64_tr_b16 a[76:77], v29 offset:24576
  ds_read_b64_tr_b16 a[78:79], v29 offset:26624
  ds_read_b64_tr_b16 a[192:193], v30 offset:0
  ds_read_b64_tr_b16 a[194:195], v30 offset:2048
  ds_read_b64_tr_b16 a[196:197], v30 offset:8192
  ds_read_b64_tr_b16 a[198:199], v30 offset:10240
  ds_read_b64_tr_b16 a[200:201], v30 offset:16384
  ds_read_b64_tr_b16 a[202:203], v30 offset:18432
  ds_read_b64_tr_b16 a[204:205], v30 offset:24576
  ds_read_b64_tr_b16 a[206:207], v30 offset:26624
  s_waitcnt lgkmcnt(0)
  s_waitcnt vmcnt(16)
  ds_write_b128 v21, a[80:83] offset:32768
  ds_write_b128 v21, a[84:87] offset:33792
  ds_write_b128 v21, a[88:91] offset:34816
  ds_write_b128 v21, a[92:95] offset:35840
  ds_write_b128 v21, a[208:211] offset:36864
  ds_write_b128 v21, a[212:215] offset:37888
  ds_write_b128 v21, a[216:219] offset:38912
  ds_write_b128 v21, a[220:223] offset:39936
  s_waitcnt lgkmcnt(0)
  s_barrier
  ds_read_b64_tr_b16 a[80:81], v29 offset:32768
  ds_read_b64_tr_b16 a[82:83], v29 offset:34816
  ds_read_b64_tr_b16 a[84:85], v29 offset:40960
  ds_read_b64_tr_b16 a[86:87], v29 offset:43008
  ds_read_b64_tr_b16 a[88:89], v29 offset:49152
  ds_read_b64_tr_b16 a[90:91], v29 offset:51200
  ds_read_b64_tr_b16 a[92:93], v29 offset:57344
  ds_read_b64_tr_b16 a[94:95], v29 offset:59392
  ds_read_b64_tr_b16 a[208:209], v30 offset:32768
  ds_read_b64_tr_b16 a[210:211], v30 offset:34816
  ds_read_b64_tr_b16 a[212:213], v30 offset:40960
  ds_read_b64_tr_b16 a[214:215], v30 offset:43008
  ds_read_b64_tr_b16 a[216:217], v30 offset:49152
  ds_read_b64_tr_b16 a[218:219], v30 offset:51200
  ds_read_b64_tr_b16 a[220:221], v30 offset:57344
  ds_read_b64_tr_b16 a[222:223], v30 offset:59392
  s_waitcnt lgkmcnt(0)
  s_waitcnt vmcnt(8)
  ds_write_b128 v21, a[96:99] offset:0
  ds_write_b128 v21, a[100:103] offset:1024
  ds_write_b128 v21, a[104:107] offset:2048
  ds_write_b128 v21, a[108:111] offset:3072
  ds_write_b128 v21, a[224:227] offset:4096
  ds_write_b128 v21, a[228:231] offset:5120
  ds_write_b128 v21, a[232:235] offset:6144
  ds_write_b128 v21, a[236:239] offset:7168
  s_waitcnt lgkmcnt(0)
  s_barrier
  ds_read_b64_tr_b16 a[96:97], v29 offset:0
  ds_read_b64_tr_b16 a[98:99], v29 offset:2048
  ds_read_b64_tr_b16 a[100:101], v29 offset:8192
  ds_read_b64_tr_b16 a[102:103], v29 offset:10240
  ds_read_b64_tr_b16 a[104:105], v29 offset:16384
  ds_read_b64_tr_b16 a[106:107], v29 offset:18432
  ds_read_b64_tr_b16 a[108:109], v29 offset:24576
  ds_read_b64_tr_b16 a[110:111], v29 offset:26624
  ds_read_b64_tr_b16 a[224:225], v30 offset:0
  ds_read_b64_tr_b16 a[226:227], v30 offset:2048
  ds_read_b64_tr_b16 a[228:229], v30 offset:8192
  ds_read_b64_tr_b16 a[230:231], v30 offset:10240
  ds_read_b64_tr_b16 a[232:233], v30 offset:16384
  ds_read_b64_tr_b16 a[234:235], v30 offset:18432
  ds_read_b64_tr_b16 a[236:237], v30 offset:24576
  ds_read_b64_tr_b16 a[238:239], v30 offset:26624
  s_waitcnt lgkmcnt(0)
  s_waitcnt vmcnt(0)
  ds_write_b128 v21, a[112:115] offset:32768
  ds_write_b128 v21, a[116:119] offset:33792
  ds_write_b128 v21, a[120:123] offset:34816
  ds_write_b128 v21, a[124:127] offset:35840
  ds_write_b128 v21, a[240:243] offset:36864
  ds_write_b128 v21, a[244:247] offset:37888
  ds_write_b128 v21, a[248:251] offset:38912
  ds_write_b128 v21, a[252:255] offset:39936
  s_waitcnt lgkmcnt(0)
  s_barrier
  ds_read_b64_tr_b16 a[112:113], v29 offset:32768
  ds_read_b64_tr_b16 a[114:115], v29 offset:34816
  ds_read_b64_tr_b16 a[116:117], v29 offset:40960
  ds_read_b64_tr_b16 a[118:119], v29 offset:43008
  ds_read_b64_tr_b16 a[120:121], v29 offset:49152
  ds_read_b64_tr_b16 a[122:123], v29 offset:51200
  ds_read_b64_tr_b16 a[124:125], v29 offset:57344
  ds_read_b64_tr_b16 a[126:127], v29 offset:59392
  ds_read_b64_tr_b16 a[240:241], v30 offset:32768
  ds_read_b64_tr_b16 a[242:243], v30 offset:34816
  ds_read_b64_tr_b16 a[244:245], v30 offset:40960
  ds_read_b64_tr_b16 a[246:247], v30 offset:43008
  ds_read_b64_tr_b16 a[248:249], v30 offset:49152
  ds_read_b64_tr_b16 a[250:251], v30 offset:51200
  ds_read_b64_tr_b16 a[252:253], v30 offset:57344
  ds_read_b64_tr_b16 a[254:255], v30 offset:59392
  s_waitcnt lgkmcnt(0)
  s_barrier
  v_and_b32 v12, 31, v0
  v_lshrrev_b32 v13, 5, v0
  v_and_b32 v14, 15, v0
  v_add_u32 v15, 0, v13
  v_xor_b32 v15, v15, v14
  v_lshlrev_b32 v15, 4, v15
  v_lshl_add_u32 v2, v12, 10, v15
  v_add_u32 v15, 2, v13
  v_xor_b32 v15, v15, v14
  v_lshlrev_b32 v15, 4, v15
  v_lshl_add_u32 v3, v12, 10, v15
  v_add_u32 v15, 4, v13
  v_xor_b32 v15, v15, v14
  v_lshlrev_b32 v15, 4, v15
  v_lshl_add_u32 v4, v12, 10, v15
  v_add_u32 v15, 6, v13
  v_xor_b32 v15, v15, v14
  v_lshlrev_b32 v15, 4, v15
  v_lshl_add_u32 v5, v12, 10, v15
  v_add_u32 v15, 8, v13
  v_xor_b32 v15, v15, v14
  v_lshlrev_b32 v15, 4, v15
  v_lshl_add_u32 v6, v12, 10, v15
  v_add_u32 v15, 10, v13
  v_xor_b32 v15, v15, v14
  v_lshlrev_b32 v15, 4, v15
  v_lshl_add_u32 v7, v12, 10, v15
  v_add_u32 v15, 12, v13
  v_xor_b32 v15, v15, v14
  v_lshlrev_b32 v15, 4, v15
  v_lshl_add_u32 v8, v12, 10, v15
  v_add_u32 v15, 14, v13
  v_xor_b32 v15, v15, v14
  v_lshlrev_b32 v15, 4, v15
  v_lshl_add_u32 v9, v12, 10, v15
  v_and_b32 v12, 15, v0
  v_lshrrev_b32 v13, 4, v0
  v_lshrrev_b32 v14, 2, v12
  v_and_b32 v15, 1, v12
  v_lshl_add_u32 v14, v14, 1, v15
  v_bfe_u32 v15, v12, 1, 1
  v_lshrrev_b32 v16, 1, v13
  v_xor_b32 v16, v16, v14
  v_lshlrev_b32 v16, 4, v16
  v_lshl_add_u32 v16, v14, 10, v16
  v_and_b32 v17, 1, v13
  v_lshlrev_b32 v17, 3, v17
  v_lshl_add_u32 v17, v15, 2, v17
  v_add_u32 v16, v16, v17
  s_lshl_b32 s12, s8, 8
  v_add_u32 v10, s12, v16
  s_lshl_b32 s12, s8, 11
  v_add_u32 v11, s12, v1
  v_and_b32 v12, 15, v0
  v_bfe_u32 v13, v0, 4, 1
  v_lshrrev_b32 v14, 5, v0
  v_lshl_add_u32 v14, v14, 5, v12
  v_lshlrev_b32 v14, 3, v14
  v_lshl_add_u32 v116, v13, 2, v14
  v_add_u32 v117, 131072, v116
  v_add_u32 v118, 262144, v116
  v_add_u32 v119, 393216, v116
  s_mov_b32 s30, 0
  s_add_u32 s26, s4, 71303168
  s_addc_u32 s27, s5, 0
L_kvms_43:
  s_mov_b32 s49, 0
L_kvmp_45:
  global_load_dwordx4 v[32:35], v11, s[26:27] sc1
  global_load_dwordx4 v[36:39], v11, s[26:27] offset:1024 sc1
  s_add_u32 s49, s49, 1
  s_cmp_gt_u32 s49, 0x20000
  s_cbranch_scc1 L_kvmok_46
  s_waitcnt vmcnt(0)
  v_max3_u32 v12, v32, v33, v34
  v_max3_u32 v13, v35, v36, v37
  v_max3_u32 v12, v12, v38, v39
  v_max_u32 v12, v12, v13
  v_cmp_eq_u32 vcc, -1, v12
  s_nop 0
  s_cbranch_vccz L_kvmok_46
  s_sleep 2
  s_branch L_kvmp_45
L_kvmok_46:
  s_waitcnt vmcnt(0)
  v_xor_b32 v15, 0, v10
  v_add_u32 v15, 0, v15
  v_xor_b32 v14, 0, v15
  ds_write_b16 v14, v32 offset:0
  ds_write_b16 v14, v34 offset:2
  v_xor_b32 v14, 32, v15
  ds_write_b16_d16_hi v14, v32 offset:0
  ds_write_b16_d16_hi v14, v34 offset:2
  v_xor_b32 v14, 64, v15
  ds_write_b16 v14, v33 offset:0
  ds_write_b16 v14, v35 offset:2
  v_xor_b32 v14, 96, v15
  ds_write_b16_d16_hi v14, v33 offset:0
  ds_write_b16_d16_hi v14, v35 offset:2
  v_xor_b32 v14, 128, v15
  ds_write_b16 v14, v36 offset:0
  ds_write_b16 v14, v38 offset:2
  v_xor_b32 v14, 160, v15
  ds_write_b16_d16_hi v14, v36 offset:0
  ds_write_b16_d16_hi v14, v38 offset:2
  v_xor_b32 v14, 192, v15
  ds_write_b16 v14, v37 offset:0
  ds_write_b16 v14, v39 offset:2
  v_xor_b32 v14, 224, v15
  ds_write_b16_d16_hi v14, v37 offset:0
  ds_write_b16_d16_hi v14, v39 offset:2
  s_waitcnt lgkmcnt(0)
  s_add_u32 s26, s26, 8192
  s_addc_u32 s27, s27, 0
  s_mov_b32 s49, 0
L_kvmp_47:
  global_load_dwordx4 v[32:35], v11, s[26:27] sc1
  global_load_dwordx4 v[36:39], v11, s[26:27] offset:1024 sc1
  s_add_u32 s49, s49, 1
  s_cmp_gt_u32 s49, 0x20000
  s_cbranch_scc1 L_kvmok_48
  s_waitcnt vmcnt(0)
  v_max3_u32 v12, v32, v33, v34
  v_max3_u32 v13, v35, v36, v37
  v_max3_u32 v12, v12, v38, v39
  v_max_u32 v12, v12, v13
  v_cmp_eq_u32 vcc, -1, v12
  s_nop 0
  s_cbranch_vccz L_kvmok_48
  s_sleep 2
  s_branch L_kvmp_47
L_kvmok_48:
  s_waitcnt vmcnt(0)
  v_xor_b32 v15, 128, v10
  v_add_u32 v15, 8192, v15
  v_xor_b32 v14, 0, v15
  ds_write_b16 v14, v32 offset:0
  ds_write_b16 v14, v34 offset:2
  v_xor_b32 v14, 32, v15
  ds_write_b16_d16_hi v14, v32 offset:0
  ds_write_b16_d16_hi v14, v34 offset:2
  v_xor_b32 v14, 64, v15
  ds_write_b16 v14, v33 offset:0
  ds_write_b16 v14, v35 offset:2
  v_xor_b32 v14, 96, v15
  ds_write_b16_d16_hi v14, v33 offset:0
  ds_write_b16_d16_hi v14, v35 offset:2
  v_xor_b32 v14, 128, v15
  ds_write_b16 v14, v36 offset:0
  ds_write_b16 v14, v38 offset:2
  v_xor_b32 v14, 160, v15
  ds_write_b16_d16_hi v14, v36 offset:0
  ds_write_b16_d16_hi v14, v38 offset:2
  v_xor_b32 v14, 192, v15
  ds_write_b16 v14, v37 offset:0
  ds_write_b16 v14, v39 offset:2
  v_xor_b32 v14, 224, v15
  ds_write_b16_d16_hi v14, v37 offset:0
  ds_write_b16_d16_hi v14, v39 offset:2
  s_waitcnt lgkmcnt(0)
  s_add_u32 s26, s26, 8192
  s_addc_u32 s27, s27, 0
  s_mov_b32 s49, 0
L_kvmp_49:
  global_load_dwordx4 v[32:35], v11, s[26:27] sc1
  global_load_dwordx4 v[36:39], v11, s[26:27] offset:1024 sc1
  s_add_u32 s49, s49, 1
  s_cmp_gt_u32 s49, 0x20000
  s_cbranch_scc1 L_kvmok_50
  s_waitcnt vmcnt(0)
  v_max3_u32 v12, v32, v33, v34
  v_max3_u32 v13, v35, v36, v37
  v_max3_u32 v12, v12, v38, v39
  v_max_u32 v12, v12, v13
  v_cmp_eq_u32 vcc, -1, v12
  s_nop 0
  s_cbranch_vccz L_kvmok_50
  s_sleep 2
  s_branch L_kvmp_49
L_kvmok_50:
  s_waitcnt vmcnt(0)
  v_xor_b32 v15, 0, v10
  v_add_u32 v15, 16384, v15
  v_xor_b32 v14, 0, v15
  ds_write_b16 v14, v32 offset:0
  ds_write_b16 v14, v34 offset:2
  v_xor_b32 v14, 32, v15
  ds_write_b16_d16_hi v14, v32 offset:0
  ds_write_b16_d16_hi v14, v34 offset:2
  v_xor_b32 v14, 64, v15
  ds_write_b16 v14, v33 offset:0
  ds_write_b16 v14, v35 offset:2
  v_xor_b32 v14, 96, v15
  ds_write_b16_d16_hi v14, v33 offset:0
  ds_write_b16_d16_hi v14, v35 offset:2
  v_xor_b32 v14, 128, v15
  ds_write_b16 v14, v36 offset:0
  ds_write_b16 v14, v38 offset:2
  v_xor_b32 v14, 160, v15
  ds_write_b16_d16_hi v14, v36 offset:0
  ds_write_b16_d16_hi v14, v38 offset:2
  v_xor_b32 v14, 192, v15
  ds_write_b16 v14, v37 offset:0
  ds_write_b16 v14, v39 offset:2
  v_xor_b32 v14, 224, v15
  ds_write_b16_d16_hi v14, v37 offset:0
  ds_write_b16_d16_hi v14, v39 offset:2
  s_waitcnt lgkmcnt(0)
  s_add_u32 s26, s26, 8192
  s_addc_u32 s27, s27, 0
  s_cmp_eq_u32 s30, 60
  s_cbranch_scc1 L_kvm3_44
  s_mov_b32 s49, 0
L_kvmp_51:
  global_load_dwordx4 v[32:35], v11, s[26:27] sc1
  global_load_dwordx4 v[36:39], v11, s[26:27] offset:1024 sc1
  s_add_u32 s49, s49, 1
  s_cmp_gt_u32 s49, 0x20000
  s_cbranch_scc1 L_kvmok_52
  s_waitcnt vmcnt(0)
  v_max3_u32 v12, v32, v33, v34
  v_max3_u32 v13, v35, v36, v37
  v_max3_u32 v12, v12, v38, v39
  v_max_u32 v12, v12, v13
  v_cmp_eq_u32 vcc, -1, v12
  s_nop 0
  s_cbranch_vccz L_kvmok_52
  s_sleep 2
  s_branch L_kvmp_51
L_kvmok_52:
  s_waitcnt vmcnt(0)
  v_xor_b32 v15, 128, v10
  v_add_u32 v15, 24576, v15
  v_xor_b32 v14, 0, v15
  ds_write_b16 v14, v32 offset:0
  ds_write_b16 v14, v34 offset:2
  v_xor_b32 v14, 32, v15
  ds_write_b16_d16_hi v14, v32 offset:0
  ds_write_b16_d16_hi v14, v34 offset:2
  v_xor_b32 v14, 64, v15
  ds_write_b16 v14, v33 offset:0
  ds_write_b16 v14, v35 offset:2
  v_xor_b32 v14, 96, v15
  ds_write_b16_d16_hi v14, v33 offset:0
  ds_write_b16_d16_hi v14, v35 offset:2
  v_xor_b32 v14, 128, v15
  ds_write_b16 v14, v36 offset:0
  ds_write_b16 v14, v38 offset:2
  v_xor_b32 v14, 160, v15
  ds_write_b16_d16_hi v14, v36 offset:0
  ds_write_b16_d16_hi v14, v38 offset:2
  v_xor_b32 v14, 192, v15
  ds_write_b16 v14, v37 offset:0
  ds_write_b16 v14, v39 offset:2
  v_xor_b32 v14, 224, v15
  ds_write_b16_d16_hi v14, v37 offset:0
  ds_write_b16_d16_hi v14, v39 offset:2
  s_waitcnt lgkmcnt(0)
  s_add_u32 s26, s26, 8192
  s_addc_u32 s27, s27, 0
L_kvm3_44:
  s_barrier
  s_lshl_b32 s12, s30, 17
  s_add_u32 s12, s12, s37
  s_add_u32 s12, s12, 59899904
  s_add_u32 s28, s4, s12
  s_addc_u32 s29, s5, 0
  ds_read_b128 v[32:35], v2 offset:0
  ds_read_b128 v[36:39], v3 offset:0
  ds_read_b128 v[40:43], v4 offset:0
  ds_read_b128 v[44:47], v5 offset:0
  ds_read_b128 v[48:51], v6 offset:0
  ds_read_b128 v[52:55], v7 offset:0
  s_waitcnt lgkmcnt(5)
  v_mfma_f32_32x32x16_bf16 v[64:79], v[32:35], a[0:3], 0
  ds_read_b128 v[56:59], v8 offset:0
  v_mfma_f32_32x32x16_bf16 v[80:95], v[32:35], a[128:131], 0
  s_waitcnt lgkmcnt(5)
  v_mfma_f32_32x32x16_bf16 v[64:79], v[36:39], a[4:7], v[64:79]
  ds_read_b128 v[60:63], v9 offset:0
  v_mfma_f32_32x32x16_bf16 v[80:95], v[36:39], a[132:135], v[80:95]
  s_waitcnt lgkmcnt(5)
  v_mfma_f32_32x32x16_bf16 v[64:79], v[40:43], a[8:11], v[64:79]
  ds_read_b128 v[32:35], v2 offset:256
  v_mfma_f32_32x32x16_bf16 v[80:95], v[40:43], a[136:139], v[80:95]
  s_waitcnt lgkmcnt(5)
  v_mfma_f32_32x32x16_bf16 v[64:79], v[44:47], a[12:15], v[64:79]
  ds_read_b128 v[36:39], v3 offset:256
  v_mfma_f32_32x32x16_bf16 v[80:95], v[44:47], a[140:143], v[80:95]
  s_waitcnt lgkmcnt(5)
  v_mfma_f32_32x32x16_bf16 v[64:79], v[48:51], a[16:19], v[64:79]
  ds_read_b128 v[40:43], v4 offset:256
  v_mfma_f32_32x32x16_bf16 v[80:95], v[48:51], a[144:147], v[80:95]
  s_waitcnt lgkmcnt(5)
  v_mfma_f32_32x32x16_bf16 v[64:79], v[52:55], a[20:23], v[64:79]
  ds_read_b128 v[44:47], v5 offset:256
  v_mfma_f32_32x32x16_bf16 v[80:95], v[52:55], a[148:151], v[80:95]
  s_waitcnt lgkmcnt(5)
  v_mfma_f32_32x32x16_bf16 v[64:79], v[56:59], a[24:27], v[64:79]
  ds_read_b128 v[48:51], v6 offset:256
  v_mfma_f32_32x32x16_bf16 v[80:95], v[56:59], a[152:155], v[80:95]
  s_waitcnt lgkmcnt(5)
  v_mfma_f32_32x32x16_bf16 v[64:79], v[60:63], a[28:31], v[64:79]
  ds_read_b128 v[52:55], v7 offset:256
  v_mfma_f32_32x32x16_bf16 v[80:95], v[60:63], a[156:159], v[80:95]
  s_waitcnt lgkmcnt(5)
  v_mfma_f32_32x32x16_bf16 v[64:79], v[32:35], a[32:35], v[64:79]
  ds_read_b128 v[56:59], v8 offset:256
  v_mfma_f32_32x32x16_bf16 v[80:95], v[32:35], a[160:163], v[80:95]
  s_waitcnt lgkmcnt(5)
  v_mfma_f32_32x32x16_bf16 v[64:79], v[36:39], a[36:39], v[64:79]
  ds_read_b128 v[60:63], v9 offset:256
  v_mfma_f32_32x32x16_bf16 v[80:95], v[36:39], a[164:167], v[80:95]
  s_waitcnt lgkmcnt(5)
  v_mfma_f32_32x32x16_bf16 v[64:79], v[40:43], a[40:43], v[64:79]
  ds_read_b128 v[32:35], v2 offset:512
  v_mfma_f32_32x32x16_bf16 v[80:95], v[40:43], a[168:171], v[80:95]
  s_waitcnt lgkmcnt(5)
  v_mfma_f32_32x32x16_bf16 v[64:79], v[44:47], a[44:47], v[64:79]
  ds_read_b128 v[36:39], v3 offset:512
  v_mfma_f32_32x32x16_bf16 v[80:95], v[44:47], a[172:175], v[80:95]
  s_waitcnt lgkmcnt(5)
  v_mfma_f32_32x32x16_bf16 v[64:79], v[48:51], a[48:51], v[64:79]
  ds_read_b128 v[40:43], v4 offset:512
  v_mfma_f32_32x32x16_bf16 v[80:95], v[48:51], a[176:179], v[80:95]
  s_waitcnt lgkmcnt(5)
  v_mfma_f32_32x32x16_bf16 v[64:79], v[52:55], a[52:55], v[64:79]
  ds_read_b128 v[44:47], v5 offset:512
  v_mfma_f32_32x32x16_bf16 v[80:95], v[52:55], a[180:183], v[80:95]
  s_waitcnt lgkmcnt(5)
  v_mfma_f32_32x32x16_bf16 v[64:79], v[56:59], a[56:59], v[64:79]
  ds_read_b128 v[48:51], v6 offset:512
  v_mfma_f32_32x32x16_bf16 v[80:95], v[56:59], a[184:187], v[80:95]
  s_waitcnt lgkmcnt(5)
  v_mfma_f32_32x32x16_bf16 v[64:79], v[60:63], a[60:63], v[64:79]
  ds_read_b128 v[52:55], v7 offset:512
  v_mfma_f32_32x32x16_bf16 v[80:95], v[60:63], a[188:191], v[80:95]
  s_waitcnt lgkmcnt(5)
  v_mfma_f32_32x32x16_bf16 v[64:79], v[32:35], a[64:67], v[64:79]
  ds_read_b128 v[56:59], v8 offset:512
  v_mfma_f32_32x32x16_bf16 v[80:95], v[32:35], a[192:195], v[80:95]
  s_waitcnt lgkmcnt(5)
  v_mfma_f32_32x32x16_bf16 v[64:79], v[36:39], a[68:71], v[64:79]
  ds_read_b128 v[60:63], v9 offset:512
  v_mfma_f32_32x32x16_bf16 v[80:95], v[36:39], a[196:199], v[80:95]
  s_waitcnt lgkmcnt(5)
  v_mfma_f32_32x32x16_bf16 v[64:79], v[40:43], a[72:75], v[64:79]
  ds_read_b128 v[32:35], v2 offset:768
  v_mfma_f32_32x32x16_bf16 v[80:95], v[40:43], a[200:203], v[80:95]
  s_waitcnt lgkmcnt(5)
  v_mfma_f32_32x32x16_bf16 v[64:79], v[44:47], a[76:79], v[64:79]
  ds_read_b128 v[36:39], v3 offset:768
  v_mfma_f32_32x32x16_bf16 v[80:95], v[44:47], a[204:207], v[80:95]
  s_waitcnt lgkmcnt(5)
  v_mfma_f32_32x32x16_bf16 v[64:79], v[48:51], a[80:83], v[64:79]
  ds_read_b128 v[40:43], v4 offset:768
  v_mfma_f32_32x32x16_bf16 v[80:95], v[48:51], a[208:211], v[80:95]
  s_waitcnt lgkmcnt(5)
  v_mfma_f32_32x32x16_bf16 v[64:79], v[52:55], a[84:87], v[64:79]
  ds_read_b128 v[44:47], v5 offset:768
  v_mfma_f32_32x32x16_bf16 v[80:95], v[52:55], a[212:215], v[80:95]
  s_waitcnt lgkmcnt(5)
  v_mfma_f32_32x32x16_bf16 v[64:79], v[56:59], a[88:91], v[64:79]
  ds_read_b128 v[48:51], v6 offset:768
  v_mfma_f32_32x32x16_bf16 v[80:95], v[56:59], a[216:219], v[80:95]
  s_waitcnt lgkmcnt(5)
  v_mfma_f32_32x32x16_bf16 v[64:79], v[60:63], a[92:95], v[64:79]
  ds_read_b128 v[52:55], v7 offset:768
  v_mfma_f32_32x32x16_bf16 v[80:95], v[60:63], a[220:223], v[80:95]
  s_waitcnt lgkmcnt(5)
  v_mfma_f32_32x32x16_bf16 v[64:79], v[32:35], a[96:99], v[64:79]
  ds_read_b128 v[56:59], v8 offset:768
  v_mfma_f32_32x32x16_bf16 v[80:95], v[32:35], a[224:227], v[80:95]
  s_waitcnt lgkmcnt(5)
  v_mfma_f32_32x32x16_bf16 v[64:79], v[36:39], a[100:103], v[64:79]
  ds_read_b128 v[60:63], v9 offset:768
  v_mfma_f32_32x32x16_bf16 v[80:95], v[36:39], a[228:231], v[80:95]
  s_waitcnt lgkmcnt(5)
  v_mfma_f32_32x32x16_bf16 v[64:79], v[40:43], a[104:107], v[64:79]
  v_mfma_f32_32x32x16_bf16 v[80:95], v[40:43], a[232:235], v[80:95]
  s_waitcnt lgkmcnt(4)
  v_mfma_f32_32x32x16_bf16 v[64:79], v[44:47], a[108:111], v[64:79]
  v_mfma_f32_32x32x16_bf16 v[80:95], v[44:47], a[236:239], v[80:95]
  s_waitcnt lgkmcnt(3)
  v_mfma_f32_32x32x16_bf16 v[64:79], v[48:51], a[112:115], v[64:79]
  v_mfma_f32_32x32x16_bf16 v[80:95], v[48:51], a[240:243], v[80:95]
  s_waitcnt lgkmcnt(2)
  v_mfma_f32_32x32x16_bf16 v[64:79], v[52:55], a[116:119], v[64:79]
  v_mfma_f32_32x32x16_bf16 v[80:95], v[52:55], a[244:247], v[80:95]
  s_waitcnt lgkmcnt(1)
  v_mfma_f32_32x32x16_bf16 v[64:79], v[56:59], a[120:123], v[64:79]
  v_mfma_f32_32x32x16_bf16 v[80:95], v[56:59], a[248:251], v[80:95]
  s_waitcnt lgkmcnt(0)
  v_mfma_f32_32x32x16_bf16 v[64:79], v[60:63], a[124:127], v[64:79]
  v_mfma_f32_32x32x16_bf16 v[80:95], v[60:63], a[252:255], v[80:95]
  v_xor_b32 v2, 32768, v2
  v_xor_b32 v3, 32768, v3
  v_xor_b32 v4, 32768, v4
  v_xor_b32 v5, 32768, v5
  v_xor_b32 v6, 32768, v6
  v_xor_b32 v7, 32768, v7
  v_xor_b32 v8, 32768, v8
  v_xor_b32 v9, 32768, v9
  v_xor_b32 v10, 32768, v10
  s_cmp_eq_u32 s30, 60
  s_cselect_b32 s50, 0x00ffffff, -1
  v_cvt_pk_bf16_f32 v96, v64, v65
  v_cvt_pk_bf16_f32 v97, v66, v67
  global_store_dword v116, v96, s[28:29] offset:0 sc1
  global_store_dword v116, v97, s[28:29] offset:128 sc1
  v_cvt_pk_bf16_f32 v98, v68, v69
  v_cvt_pk_bf16_f32 v99, v70, v71
  global_store_dword v117, v98, s[28:29] offset:0 sc1
  global_store_dword v117, v99, s[28:29] offset:128 sc1
  v_cvt_pk_bf16_f32 v100, v72, v73
  v_cvt_pk_bf16_f32 v101, v74, v75
  global_store_dword v118, v100, s[28:29] offset:0 sc1
  global_store_dword v118, v101, s[28:29] offset:128 sc1
  v_cvt_pk_bf16_f32 v102, v76, v77
  v_cvt_pk_bf16_f32 v103, v78, v79
  s_cmp_eq_u32 s30, 60
  s_cbranch_scc1 L_kv3_53
  global_store_dword v119, v102, s[28:29] offset:0 sc1
  global_store_dword v119, v103, s[28:29] offset:128 sc1
L_kv3_53:
  v_cvt_pk_bf16_f32 v104, v80, v81
  v_cvt_pk_bf16_f32 v105, v82, v83
  global_store_dword v116, v104, s[28:29] offset:512 sc1
  global_store_dword v116, v105, s[28:29] offset:640 sc1
  v_cvt_pk_bf16_f32 v106, v84, v85
  v_cvt_pk_bf16_f32 v107, v86, v87
  global_store_dword v117, v106, s[28:29] offset:512 sc1
  global_store_dword v117, v107, s[28:29] offset:640 sc1
  v_cvt_pk_bf16_f32 v108, v88, v89
  v_cvt_pk_bf16_f32 v109, v90, v91
  global_store_dword v118, v108, s[28:29] offset:512 sc1
  global_store_dword v118, v109, s[28:29] offset:640 sc1
  v_cvt_pk_bf16_f32 v110, v92, v93
  v_cvt_pk_bf16_f32 v111, v94, v95
  s_cmp_eq_u32 s30, 60
  s_cbranch_scc1 L_kv3_54
  global_store_dword v119, v110, s[28:29] offset:512 sc1
  global_store_dword v119, v111, s[28:29] offset:640 sc1
L_kv3_54:
  s_waitcnt vmcnt(0)
  s_barrier
  s_cmp_lg_u32 s8, 0
  s_cbranch_scc1 L_fs_55
  s_lshl_b32 s48, s30, 14
  s_lshl_b32 s49, s36, 7
  s_add_u32 s48, s48, s49
  s_add_u32 s48, s48, 8192
  v_mov_b32 v254, s48
  v_mov_b32 v255, 1
  s_mov_b64 exec, 1
  global_store_dword v254, v255, s[46:47] sc1
  s_mov_b64 exec, -1
L_fs_55:
  s_add_u32 s30, s30, 1
  s_cmp_lg_u32 s8, 0
  s_cbranch_scc1 L_fs_56
  s_lshl_b32 s48, s30, 14
  s_lshl_b32 s49, s36, 7
  s_add_u32 s48, s48, s49
  s_add_u32 s48, s48, 8192
  v_mov_b32 v254, s48
  v_mov_b32 v255, 1
  s_mov_b64 exec, 1
  global_store_dword v254, v255, s[46:47] sc1
  s_mov_b64 exec, -1
L_fs_56:
  s_add_u32 s30, s30, 1
  s_cmp_lg_u32 s8, 0
  s_cbranch_scc1 L_fs_57
  s_lshl_b32 s48, s30, 14
  s_lshl_b32 s49, s36, 7
  s_add_u32 s48, s48, s49
  s_add_u32 s48, s48, 8192
  v_mov_b32 v254, s48
  v_mov_b32 v255, 1
  s_mov_b64 exec, 1
  global_store_dword v254, v255, s[46:47] sc1
  s_mov_b64 exec, -1
L_fs_57:
  s_add_u32 s30, s30, 1
  s_cmp_eq_u32 s30, 63
  s_cbranch_scc1 L_kf3_58
  s_cmp_lg_u32 s8, 0
  s_cbranch_scc1 L_fs_59
  s_lshl_b32 s48, s30, 14
  s_lshl_b32 s49, s36, 7
  s_add_u32 s48, s48, s49
  s_add_u32 s48, s48, 8192
  v_mov_b32 v254, s48
  v_mov_b32 v255, 1
  s_mov_b64 exec, 1
  global_store_dword v254, v255, s[46:47] sc1
  s_mov_b64 exec, -1
L_fs_59:
L_kf3_58:
  s_add_u32 s30, s30, 1
  s_cmp_lt_u32 s30, 64
  s_cbranch_scc1 L_kvms_43
  s_branch L_kvmdone_26
L_kvmdone_26:
  s_branch L_wend
L_w1p:
  s_sub_u32 s30, s12, 1
  s_branch L_w1go
L_w1b:
  s_cmp_lt_u32 s58, 218
  s_cbranch_scc0 L_w2
  s_cmp_lg_u32 s8, 0
  s_cbranch_scc1 L_wcwok_61
  v_mov_b32 v254, 20
  s_mov_b32 s49, 0
L_wcw_60:
  s_sleep 40
  global_load_dword v255, v254, s[6:7] sc1
  s_add_u32 s49, s49, 1
  s_cmp_gt_u32 s49, 0x4000
  s_cbranch_scc1 L_wcwok_61
  s_waitcnt vmcnt(0)
  v_cmp_gt_u32 vcc, 32, v255
  s_nop 0
  s_cbranch_vccnz L_wcw_60
L_wcwok_61:
  s_barrier
  s_sub_u32 s12, s58, 128
  s_mul_i32 s13, s12, 21846
  s_lshr_b32 s13, s13, 16
  s_add_u32 s36, s13, 32
  s_mul_i32 s13, s13, 3
  s_sub_u32 s30, s12, s13
L_w1go:
  s_mov_b32 s33, 3
  s_cmp_eq_u32 s30, 0
  s_cselect_b32 s35, 22, 21
  s_cmp_lt_u32 s36, 16
  s_cbranch_scc1 L_pk_63
  s_cmp_lt_u32 s36, 32
  s_cbranch_scc1 L_pv_64
  s_cmp_lt_u32 s36, 48
  s_cbranch_scc1 L_pq_65
  s_branch L_pf_66
L_pk_63:
  s_sub_u32 s18, s36, 0
  s_lshl_b32 s12, s18, 9
  s_add_u32 s20, s64, s12
  s_addc_u32 s21, s65, 0
  s_mov_b32 s24, 8192
  s_lshr_b32 s12, s8, 1
  s_lshl_b32 s13, s18, 1
  s_add_u32 s12, s12, s13
  s_lshl_b32 s37, s12, 13
  s_and_b32 s12, s8, 1
  s_lshl_b32 s12, s12, 11
  s_add_u32 s37, s37, s12
  v_lshrrev_b32 v12, 5, v0
  v_and_b32 v13, 31, v0
  v_add_u32 v14, 0, v12
  v_lshlrev_b32 v14, 2, v14
  v_xor_b32 v14, v14, v13
  v_lshlrev_b32 v15, 4, v14
  v_mov_b32 v17, s21
  v_add_co_u32 v16, vcc, s20, v15
  s_nop 1
  v_addc_co_u32 v17, vcc, 0, v17, vcc
  s_lshl_b32 s12, s8, 4
  s_add_u32 s12, s12, 0
  v_add_u32 v15, s12, v12
  v_mul_lo_u32 v15, v15, s24
  v_add_co_u32 v16, vcc, v16, v15
  s_nop 1
  v_addc_co_u32 v17, vcc, 0, v17, vcc
  v_add_u32 v14, 2, v12
  v_lshlrev_b32 v14, 2, v14
  v_xor_b32 v14, v14, v13
  v_lshlrev_b32 v15, 4, v14
  v_mov_b32 v19, s21
  v_add_co_u32 v18, vcc, s20, v15
  s_nop 1
  v_addc_co_u32 v19, vcc, 0, v19, vcc
  s_lshl_b32 s12, s8, 4
  s_add_u32 s12, s12, 2
  v_add_u32 v15, s12, v12
  v_mul_lo_u32 v15, v15, s24
  v_add_co_u32 v18, vcc, v18, v15
  s_nop 1
  v_addc_co_u32 v19, vcc, 0, v19, vcc
  s_lshl_b32 s14, s24, 2
  s_mul_i32 s15, s24, 48
  s_lshl_b32 s13, s8, 13
  v_bfe_u32 v22, v0, 2, 2
  v_and_b32 v23, 3, v0
  v_and_b32 v24, 1, v23
  v_lshlrev_b32 v24, 1, v24
  v_lshrrev_b32 v23, 1, v23
  v_or_b32 v23, v23, v24
  v_bfe_u32 v24, v0, 4, 1
  v_lshrrev_b32 v25, 5, v0
  v_lshrrev_b32 v26, 1, v23
  v_lshl_add_u32 v26, v24, 1, v26
  v_lshl_add_u32 v25, v25, 3, v22
  s_lshl_b32 s12, s8, 3
  s_add_u32 s12, s12, 0
  v_add_u32 v27, s12, v26
  v_lshlrev_b32 v28, 2, v22
  v_xor_b32 v27, v27, v28
  v_lshlrev_b32 v27, 4, v27
  v_lshl_add_u32 v27, v25, 9, v27
  v_and_b32 v28, 1, v23
  v_lshl_add_u32 v29, v28, 3, v27
  s_lshl_b32 s12, s8, 3
  s_add_u32 s12, s12, 4
  v_add_u32 v27, s12, v26
  v_lshlrev_b32 v28, 2, v22
  v_xor_b32 v27, v27, v28
  v_lshlrev_b32 v27, 4, v27
  v_lshl_add_u32 v27, v25, 9, v27
  v_and_b32 v28, 1, v23
  v_lshl_add_u32 v30, v28, 3, v27
  v_add_u32 v21, s13, v1
  global_load_dwordx4 a[0:3], v[16:17], off
  v_add_co_u32 v16, vcc, s14, v16
  s_nop 1
  v_addc_co_u32 v17, vcc, 0, v17, vcc
  global_load_dwordx4 a[4:7], v[18:19], off
  v_add_co_u32 v18, vcc, s14, v18
  s_nop 1
  v_addc_co_u32 v19, vcc, 0, v19, vcc
  global_load_dwordx4 a[8:11], v[16:17], off
  v_add_co_u32 v16, vcc, s14, v16
  s_nop 1
  v_addc_co_u32 v17, vcc, 0, v17, vcc
  global_load_dwordx4 a[12:15], v[18:19], off
  v_add_co_u32 v18, vcc, s14, v18
  s_nop 1
  v_addc_co_u32 v19, vcc, 0, v19, vcc
  global_load_dwordx4 a[128:131], v[16:17], off
  v_add_co_u32 v16, vcc, s14, v16
  s_nop 1
  v_addc_co_u32 v17, vcc, 0, v17, vcc
  global_load_dwordx4 a[132:135], v[18:19], off
  v_add_co_u32 v18, vcc, s14, v18
  s_nop 1
  v_addc_co_u32 v19, vcc, 0, v19, vcc
  global_load_dwordx4 a[136:139], v[16:17], off
  v_add_co_u32 v16, vcc, s14, v16
  s_nop 1
  v_addc_co_u32 v17, vcc, 0, v17, vcc
  global_load_dwordx4 a[140:143], v[18:19], off
  v_add_co_u32 v18, vcc, s14, v18
  s_nop 1
  v_addc_co_u32 v19, vcc, 0, v19, vcc
  v_add_co_u32 v16, vcc, s15, v16
  s_nop 1
  v_addc_co_u32 v17, vcc, 0, v17, vcc
  v_add_co_u32 v18, vcc, s15, v18
  s_nop 1
  v_addc_co_u32 v19, vcc, 0, v19, vcc
  global_load_dwordx4 a[16:19], v[16:17], off
  v_add_co_u32 v16, vcc, s14, v16
  s_nop 1
  v_addc_co_u32 v17, vcc, 0, v17, vcc
  global_load_dwordx4 a[20:23], v[18:19], off
  v_add_co_u32 v18, vcc, s14, v18
  s_nop 1
  v_addc_co_u32 v19, vcc, 0, v19, vcc
  global_load_dwordx4 a[24:27], v[16:17], off
  v_add_co_u32 v16, vcc, s14, v16
  s_nop 1
  v_addc_co_u32 v17, vcc, 0, v17, vcc
  global_load_dwordx4 a[28:31], v[18:19], off
  v_add_co_u32 v18, vcc, s14, v18
  s_nop 1
  v_addc_co_u32 v19, vcc, 0, v19, vcc
  global_load_dwordx4 a[144:147], v[16:17], off
  v_add_co_u32 v16, vcc, s14, v16
  s_nop 1
  v_addc_co_u32 v17, vcc, 0, v17, vcc
  global_load_dwordx4 a[148:151], v[18:19], off
  v_add_co_u32 v18, vcc, s14, v18
  s_nop 1
  v_addc_co_u32 v19, vcc, 0, v19, vcc
  global_load_dwordx4 a[152:155], v[16:17], off
  v_add_co_u32 v16, vcc, s14, v16
  s_nop 1
  v_addc_co_u32 v17, vcc, 0, v17, vcc
  global_load_dwordx4 a[156:159], v[18:19], off
  v_add_co_u32 v18, vcc, s14, v18
  s_nop 1
  v_addc_co_u32 v19, vcc, 0, v19, vcc
  v_add_co_u32 v16, vcc, s15, v16
  s_nop 1
  v_addc_co_u32 v17, vcc, 0, v17, vcc
  v_add_co_u32 v18, vcc, s15, v18
  s_nop 1
  v_addc_co_u32 v19, vcc, 0, v19, vcc
  global_load_dwordx4 a[32:35], v[16:17], off
  v_add_co_u32 v16, vcc, s14, v16
  s_nop 1
  v_addc_co_u32 v17, vcc, 0, v17, vcc
  global_load_dwordx4 a[36:39], v[18:19], off
  v_add_co_u32 v18, vcc, s14, v18
  s_nop 1
  v_addc_co_u32 v19, vcc, 0, v19, vcc
  global_load_dwordx4 a[40:43], v[16:17], off
  v_add_co_u32 v16, vcc, s14, v16
  s_nop 1
  v_addc_co_u32 v17, vcc, 0, v17, vcc
  global_load_dwordx4 a[44:47], v[18:19], off
  v_add_co_u32 v18, vcc, s14, v18
  s_nop 1
  v_addc_co_u32 v19, vcc, 0, v19, vcc
  global_load_dwordx4 a[160:163], v[16:17], off
  v_add_co_u32 v16, vcc, s14, v16
  s_nop 1
  v_addc_co_u32 v17, vcc, 0, v17, vcc
  global_load_dwordx4 a[164:167], v[18:19], off
  v_add_co_u32 v18, vcc, s14, v18
  s_nop 1
  v_addc_co_u32 v19, vcc, 0, v19, vcc
  global_load_dwordx4 a[168:171], v[16:17], off
  v_add_co_u32 v16, vcc, s14, v16
  s_nop 1
  v_addc_co_u32 v17, vcc, 0, v17, vcc
  global_load_dwordx4 a[172:175], v[18:19], off
  v_add_co_u32 v18, vcc, s14, v18
  s_nop 1
  v_addc_co_u32 v19, vcc, 0, v19, vcc
  v_add_co_u32 v16, vcc, s15, v16
  s_nop 1
  v_addc_co_u32 v17, vcc, 0, v17, vcc
  v_add_co_u32 v18, vcc, s15, v18
  s_nop 1
  v_addc_co_u32 v19, vcc, 0, v19, vcc
  global_load_dwordx4 a[48:51], v[16:17], off
  v_add_co_u32 v16, vcc, s14, v16
  s_nop 1
  v_addc_co_u32 v17, vcc, 0, v17, vcc
  global_load_dwordx4 a[52:55], v[18:19], off
  v_add_co_u32 v18, vcc, s14, v18
  s_nop 1
  v_addc_co_u32 v19, vcc, 0, v19, vcc
  global_load_dwordx4 a[56:59], v[16:17], off
  v_add_co_u32 v16, vcc, s14, v16
  s_nop 1
  v_addc_co_u32 v17, vcc, 0, v17, vcc
  global_load_dwordx4 a[60:63], v[18:19], off
  v_add_co_u32 v18, vcc, s14, v18
  s_nop 1
  v_addc_co_u32 v19, vcc, 0, v19, vcc
  global_load_dwordx4 a[176:179], v[16:17], off
  v_add_co_u32 v16, vcc, s14, v16
  s_nop 1
  v_addc_co_u32 v17, vcc, 0, v17, vcc
  global_load_dwordx4 a[180:183], v[18:19], off
  v_add_co_u32 v18, vcc, s14, v18
  s_nop 1
  v_addc_co_u32 v19, vcc, 0, v19, vcc
  global_load_dwordx4 a[184:187], v[16:17], off
  v_add_co_u32 v16, vcc, s14, v16
  s_nop 1
  v_addc_co_u32 v17, vcc, 0, v17, vcc
  global_load_dwordx4 a[188:191], v[18:19], off
  v_add_co_u32 v18, vcc, s14, v18
  s_nop 1
  v_addc_co_u32 v19, vcc, 0, v19, vcc
  v_add_co_u32 v16, vcc, s15, v16
  s_nop 1
  v_addc_co_u32 v17, vcc, 0, v17, vcc
  v_add_co_u32 v18, vcc, s15, v18
  s_nop 1
  v_addc_co_u32 v19, vcc, 0, v19, vcc
  global_load_dwordx4 a[64:67], v[16:17], off
  v_add_co_u32 v16, vcc, s14, v16
  s_nop 1
  v_addc_co_u32 v17, vcc, 0, v17, vcc
  global_load_dwordx4 a[68:71], v[18:19], off
  v_add_co_u32 v18, vcc, s14, v18
  s_nop 1
  v_addc_co_u32 v19, vcc, 0, v19, vcc
  global_load_dwordx4 a[72:75], v[16:17], off
  v_add_co_u32 v16, vcc, s14, v16
  s_nop 1
  v_addc_co_u32 v17, vcc, 0, v17, vcc
  global_load_dwordx4 a[76:79], v[18:19], off
  v_add_co_u32 v18, vcc, s14, v18
  s_nop 1
  v_addc_co_u32 v19, vcc, 0, v19, vcc
  global_load_dwordx4 a[192:195], v[16:17], off
  v_add_co_u32 v16, vcc, s14, v16
  s_nop 1
  v_addc_co_u32 v17, vcc, 0, v17, vcc
  global_load_dwordx4 a[196:199], v[18:19], off
  v_add_co_u32 v18, vcc, s14, v18
  s_nop 1
  v_addc_co_u32 v19, vcc, 0, v19, vcc
  global_load_dwordx4 a[200:203], v[16:17], off
  v_add_co_u32 v16, vcc, s14, v16
  s_nop 1
  v_addc_co_u32 v17, vcc, 0, v17, vcc
  global_load_dwordx4 a[204:207], v[18:19], off
  v_add_co_u32 v18, vcc, s14, v18
  s_nop 1
  v_addc_co_u32 v19, vcc, 0, v19, vcc
  v_add_co_u32 v16, vcc, s15, v16
  s_nop 1
  v_addc_co_u32 v17, vcc, 0, v17, vcc
  v_add_co_u32 v18, vcc, s15, v18
  s_nop 1
  v_addc_co_u32 v19, vcc, 0, v19, vcc
  global_load_dwordx4 a[80:83], v[16:17], off
  v_add_co_u32 v16, vcc, s14, v16
  s_nop 1
  v_addc_co_u32 v17, vcc, 0, v17, vcc
  global_load_dwordx4 a[84:87], v[18:19], off
  v_add_co_u32 v18, vcc, s14, v18
  s_nop 1
  v_addc_co_u32 v19, vcc, 0, v19, vcc
  global_load_dwordx4 a[88:91], v[16:17], off
  v_add_co_u32 v16, vcc, s14, v16
  s_nop 1
  v_addc_co_u32 v17, vcc, 0, v17, vcc
  global_load_dwordx4 a[92:95], v[18:19], off
  v_add_co_u32 v18, vcc, s14, v18
  s_nop 1
  v_addc_co_u32 v19, vcc, 0, v19, vcc
  global_load_dwordx4 a[208:211], v[16:17], off
  v_add_co_u32 v16, vcc, s14, v16
  s_nop 1
  v_addc_co_u32 v17, vcc, 0, v17, vcc
  global_load_dwordx4 a[212:215], v[18:19], off
  v_add_co_u32 v18, vcc, s14, v18
  s_nop 1
  v_addc_co_u32 v19, vcc, 0, v19, vcc
  global_load_dwordx4 a[216:219], v[16:17], off
  v_add_co_u32 v16, vcc, s14, v16
  s_nop 1
  v_addc_co_u32 v17, vcc, 0, v17, vcc
  global_load_dwordx4 a[220:223], v[18:19], off
  v_add_co_u32 v18, vcc, s14, v18
  s_nop 1
  v_addc_co_u32 v19, vcc, 0, v19, vcc
  v_add_co_u32 v16, vcc, s15, v16
  s_nop 1
  v_addc_co_u32 v17, vcc, 0, v17, vcc
  v_add_co_u32 v18, vcc, s15, v18
  s_nop 1
  v_addc_co_u32 v19, vcc, 0, v19, vcc
  global_load_dwordx4 a[96:99], v[16:17], off
  v_add_co_u32 v16, vcc, s14, v16
  s_nop 1
  v_addc_co_u32 v17, vcc, 0, v17, vcc
  global_load_dwordx4 a[100:103], v[18:19], off
  v_add_co_u32 v18, vcc, s14, v18
  s_nop 1
  v_addc_co_u32 v19, vcc, 0, v19, vcc
  global_load_dwordx4 a[104:107], v[16:17], off
  v_add_co_u32 v16, vcc, s14, v16
  s_nop 1
  v_addc_co_u32 v17, vcc, 0, v17, vcc
  global_load_dwordx4 a[108:111], v[18:19], off
  v_add_co_u32 v18, vcc, s14, v18
  s_nop 1
  v_addc_co_u32 v19, vcc, 0, v19, vcc
  global_load_dwordx4 a[224:227], v[16:17], off
  v_add_co_u32 v16, vcc, s14, v16
  s_nop 1
  v_addc_co_u32 v17, vcc, 0, v17, vcc
  global_load_dwordx4 a[228:231], v[18:19], off
  v_add_co_u32 v18, vcc, s14, v18
  s_nop 1
  v_addc_co_u32 v19, vcc, 0, v19, vcc
  global_load_dwordx4 a[232:235], v[16:17], off
  v_add_co_u32 v16, vcc, s14, v16
  s_nop 1
  v_addc_co_u32 v17, vcc, 0, v17, vcc
  global_load_dwordx4 a[236:239], v[18:19], off
  v_add_co_u32 v18, vcc, s14, v18
  s_nop 1
  v_addc_co_u32 v19, vcc, 0, v19, vcc
  v_add_co_u32 v16, vcc, s15, v16
  s_nop 1
  v_addc_co_u32 v17, vcc, 0, v17, vcc
  v_add_co_u32 v18, vcc, s15, v18
  s_nop 1
  v_addc_co_u32 v19, vcc, 0, v19, vcc
  s_waitcnt vmcnt(48)
  ds_write_b128 v21, a[0:3] offset:0
  ds_write_b128 v21, a[4:7] offset:1024
  ds_write_b128 v21, a[8:11] offset:2048
  ds_write_b128 v21, a[12:15] offset:3072
  ds_write_b128 v21, a[128:131] offset:4096
  ds_write_b128 v21, a[132:135] offset:5120
  ds_write_b128 v21, a[136:139] offset:6144
  ds_write_b128 v21, a[140:143] offset:7168
  s_waitcnt lgkmcnt(0)
  s_barrier
  ds_read_b64_tr_b16 a[0:1], v29 offset:0
  ds_read_b64_tr_b16 a[2:3], v29 offset:2048
  ds_read_b64_tr_b16 a[4:5], v29 offset:8192
  ds_read_b64_tr_b16 a[6:7], v29 offset:10240
  ds_read_b64_tr_b16 a[8:9], v29 offset:16384
  ds_read_b64_tr_b16 a[10:11], v29 offset:18432
  ds_read_b64_tr_b16 a[12:13], v29 offset:24576
  ds_read_b64_tr_b16 a[14:15], v29 offset:26624
  ds_read_b64_tr_b16 a[128:129], v30 offset:0
  ds_read_b64_tr_b16 a[130:131], v30 offset:2048
  ds_read_b64_tr_b16 a[132:133], v30 offset:8192
  ds_read_b64_tr_b16 a[134:135], v30 offset:10240
  ds_read_b64_tr_b16 a[136:137], v30 offset:16384
  ds_read_b64_tr_b16 a[138:139], v30 offset:18432
  ds_read_b64_tr_b16 a[140:141], v30 offset:24576
  ds_read_b64_tr_b16 a[142:143], v30 offset:26624
  global_load_dwordx4 a[112:115], v[16:17], off
  v_add_co_u32 v16, vcc, s14, v16
  s_nop 1
  v_addc_co_u32 v17, vcc, 0, v17, vcc
  global_load_dwordx4 a[116:119], v[18:19], off
  v_add_co_u32 v18, vcc, s14, v18
  s_nop 1
  v_addc_co_u32 v19, vcc, 0, v19, vcc
  global_load_dwordx4 a[120:123], v[16:17], off
  v_add_co_u32 v16, vcc, s14, v16
  s_nop 1
  v_addc_co_u32 v17, vcc, 0, v17, vcc
  global_load_dwordx4 a[124:127], v[18:19], off
  v_add_co_u32 v18, vcc, s14, v18
  s_nop 1
  v_addc_co_u32 v19, vcc, 0, v19, vcc
  global_load_dwordx4 a[240:243], v[16:17], off
  v_add_co_u32 v16, vcc, s14, v16
  s_nop 1
  v_addc_co_u32 v17, vcc, 0, v17, vcc
  global_load_dwordx4 a[244:247], v[18:19], off
  v_add_co_u32 v18, vcc, s14, v18
  s_nop 1
  v_addc_co_u32 v19, vcc, 0, v19, vcc
  global_load_dwordx4 a[248:251], v[16:17], off
  v_add_co_u32 v16, vcc, s14, v16
  s_nop 1
  v_addc_co_u32 v17, vcc, 0, v17, vcc
  global_load_dwordx4 a[252:255], v[18:19], off
  v_add_co_u32 v18, vcc, s14, v18
  s_nop 1
  v_addc_co_u32 v19, vcc, 0, v19, vcc
  v_add_co_u32 v16, vcc, s15, v16
  s_nop 1
  v_addc_co_u32 v17, vcc, 0, v17, vcc
  v_add_co_u32 v18, vcc, s15, v18
  s_nop 1
  v_addc_co_u32 v19, vcc, 0, v19, vcc
  s_waitcnt lgkmcnt(0)
  s_waitcnt vmcnt(48)
  ds_write_b128 v21, a[16:19] offset:32768
  ds_write_b128 v21, a[20:23] offset:33792
  ds_write_b128 v21, a[24:27] offset:34816
  ds_write_b128 v21, a[28:31] offset:35840
  ds_write_b128 v21, a[144:147] offset:36864
  ds_write_b128 v21, a[148:151] offset:37888
  ds_write_b128 v21, a[152:155] offset:38912
  ds_write_b128 v21, a[156:159] offset:39936
  s_waitcnt lgkmcnt(0)
  s_barrier
  ds_read_b64_tr_b16 a[16:17], v29 offset:32768
  ds_read_b64_tr_b16 a[18:19], v29 offset:34816
  ds_read_b64_tr_b16 a[20:21], v29 offset:40960
  ds_read_b64_tr_b16 a[22:23], v29 offset:43008
  ds_read_b64_tr_b16 a[24:25], v29 offset:49152
  ds_read_b64_tr_b16 a[26:27], v29 offset:51200
  ds_read_b64_tr_b16 a[28:29], v29 offset:57344
  ds_read_b64_tr_b16 a[30:31], v29 offset:59392
  ds_read_b64_tr_b16 a[144:145], v30 offset:32768
  ds_read_b64_tr_b16 a[146:147], v30 offset:34816
  ds_read_b64_tr_b16 a[148:149], v30 offset:40960
  ds_read_b64_tr_b16 a[150:151], v30 offset:43008
  ds_read_b64_tr_b16 a[152:153], v30 offset:49152
  ds_read_b64_tr_b16 a[154:155], v30 offset:51200
  ds_read_b64_tr_b16 a[156:157], v30 offset:57344
  ds_read_b64_tr_b16 a[158:159], v30 offset:59392
  s_waitcnt lgkmcnt(0)
  s_waitcnt vmcnt(40)
  ds_write_b128 v21, a[32:35] offset:0
  ds_write_b128 v21, a[36:39] offset:1024
  ds_write_b128 v21, a[40:43] offset:2048
  ds_write_b128 v21, a[44:47] offset:3072
  ds_write_b128 v21, a[160:163] offset:4096
  ds_write_b128 v21, a[164:167] offset:5120
  ds_write_b128 v21, a[168:171] offset:6144
  ds_write_b128 v21, a[172:175] offset:7168
  s_waitcnt lgkmcnt(0)
  s_barrier
  ds_read_b64_tr_b16 a[32:33], v29 offset:0
  ds_read_b64_tr_b16 a[34:35], v29 offset:2048
  ds_read_b64_tr_b16 a[36:37], v29 offset:8192
  ds_read_b64_tr_b16 a[38:39], v29 offset:10240
  ds_read_b64_tr_b16 a[40:41], v29 offset:16384
  ds_read_b64_tr_b16 a[42:43], v29 offset:18432
  ds_read_b64_tr_b16 a[44:45], v29 offset:24576
  ds_read_b64_tr_b16 a[46:47], v29 offset:26624
  ds_read_b64_tr_b16 a[160:161], v30 offset:0
  ds_read_b64_tr_b16 a[162:163], v30 offset:2048
  ds_read_b64_tr_b16 a[164:165], v30 offset:8192
  ds_read_b64_tr_b16 a[166:167], v30 offset:10240
  ds_read_b64_tr_b16 a[168:169], v30 offset:16384
  ds_read_b64_tr_b16 a[170:171], v30 offset:18432
  ds_read_b64_tr_b16 a[172:173], v30 offset:24576
  ds_read_b64_tr_b16 a[174:175], v30 offset:26624
  s_waitcnt lgkmcnt(0)
  s_waitcnt vmcnt(32)
  ds_write_b128 v21, a[48:51] offset:32768
  ds_write_b128 v21, a[52:55] offset:33792
  ds_write_b128 v21, a[56:59] offset:34816
  ds_write_b128 v21, a[60:63] offset:35840
  ds_write_b128 v21, a[176:179] offset:36864
  ds_write_b128 v21, a[180:183] offset:37888
  ds_write_b128 v21, a[184:187] offset:38912
  ds_write_b128 v21, a[188:191] offset:39936
  s_waitcnt lgkmcnt(0)
  s_barrier
  ds_read_b64_tr_b16 a[48:49], v29 offset:32768
  ds_read_b64_tr_b16 a[50:51], v29 offset:34816
  ds_read_b64_tr_b16 a[52:53], v29 offset:40960
  ds_read_b64_tr_b16 a[54:55], v29 offset:43008
  ds_read_b64_tr_b16 a[56:57], v29 offset:49152
  ds_read_b64_tr_b16 a[58:59], v29 offset:51200
  ds_read_b64_tr_b16 a[60:61], v29 offset:57344
  ds_read_b64_tr_b16 a[62:63], v29 offset:59392
  ds_read_b64_tr_b16 a[176:177], v30 offset:32768
  ds_read_b64_tr_b16 a[178:179], v30 offset:34816
  ds_read_b64_tr_b16 a[180:181], v30 offset:40960
  ds_read_b64_tr_b16 a[182:183], v30 offset:43008
  ds_read_b64_tr_b16 a[184:185], v30 offset:49152
  ds_read_b64_tr_b16 a[186:187], v30 offset:51200
  ds_read_b64_tr_b16 a[188:189], v30 offset:57344
  ds_read_b64_tr_b16 a[190:191], v30 offset:59392
  s_waitcnt lgkmcnt(0)
  s_waitcnt vmcnt(24)
  ds_write_b128 v21, a[64:67] offset:0
  ds_write_b128 v21, a[68:71] offset:1024
  ds_write_b128 v21, a[72:75] offset:2048
  ds_write_b128 v21, a[76:79] offset:3072
  ds_write_b128 v21, a[192:195] offset:4096
  ds_write_b128 v21, a[196:199] offset:5120
  ds_write_b128 v21, a[200:203] offset:6144
  ds_write_b128 v21, a[204:207] offset:7168
  s_waitcnt lgkmcnt(0)
  s_barrier
  ds_read_b64_tr_b16 a[64:65], v29 offset:0
  ds_read_b64_tr_b16 a[66:67], v29 offset:2048
  ds_read_b64_tr_b16 a[68:69], v29 offset:8192
  ds_read_b64_tr_b16 a[70:71], v29 offset:10240
  ds_read_b64_tr_b16 a[72:73], v29 offset:16384
  ds_read_b64_tr_b16 a[74:75], v29 offset:18432
  ds_read_b64_tr_b16 a[76:77], v29 offset:24576
  ds_read_b64_tr_b16 a[78:79], v29 offset:26624
  ds_read_b64_tr_b16 a[192:193], v30 offset:0
  ds_read_b64_tr_b16 a[194:195], v30 offset:2048
  ds_read_b64_tr_b16 a[196:197], v30 offset:8192
  ds_read_b64_tr_b16 a[198:199], v30 offset:10240
  ds_read_b64_tr_b16 a[200:201], v30 offset:16384
  ds_read_b64_tr_b16 a[202:203], v30 offset:18432
  ds_read_b64_tr_b16 a[204:205], v30 offset:24576
  ds_read_b64_tr_b16 a[206:207], v30 offset:26624
  s_waitcnt lgkmcnt(0)
  s_waitcnt vmcnt(16)
  ds_write_b128 v21, a[80:83] offset:32768
  ds_write_b128 v21, a[84:87] offset:33792
  ds_write_b128 v21, a[88:91] offset:34816
  ds_write_b128 v21, a[92:95] offset:35840
  ds_write_b128 v21, a[208:211] offset:36864
  ds_write_b128 v21, a[212:215] offset:37888
  ds_write_b128 v21, a[216:219] offset:38912
  ds_write_b128 v21, a[220:223] offset:39936
  s_waitcnt lgkmcnt(0)
  s_barrier
  ds_read_b64_tr_b16 a[80:81], v29 offset:32768
  ds_read_b64_tr_b16 a[82:83], v29 offset:34816
  ds_read_b64_tr_b16 a[84:85], v29 offset:40960
  ds_read_b64_tr_b16 a[86:87], v29 offset:43008
  ds_read_b64_tr_b16 a[88:89], v29 offset:49152
  ds_read_b64_tr_b16 a[90:91], v29 offset:51200
  ds_read_b64_tr_b16 a[92:93], v29 offset:57344
  ds_read_b64_tr_b16 a[94:95], v29 offset:59392
  ds_read_b64_tr_b16 a[208:209], v30 offset:32768
  ds_read_b64_tr_b16 a[210:211], v30 offset:34816
  ds_read_b64_tr_b16 a[212:213], v30 offset:40960
  ds_read_b64_tr_b16 a[214:215], v30 offset:43008
  ds_read_b64_tr_b16 a[216:217], v30 offset:49152
  ds_read_b64_tr_b16 a[218:219], v30 offset:51200
  ds_read_b64_tr_b16 a[220:221], v30 offset:57344
  ds_read_b64_tr_b16 a[222:223], v30 offset:59392
  s_waitcnt lgkmcnt(0)
  s_waitcnt vmcnt(8)
  ds_write_b128 v21, a[96:99] offset:0
  ds_write_b128 v21, a[100:103] offset:1024
  ds_write_b128 v21, a[104:107] offset:2048
  ds_write_b128 v21, a[108:111] offset:3072
  ds_write_b128 v21, a[224:227] offset:4096
  ds_write_b128 v21, a[228:231] offset:5120
  ds_write_b128 v21, a[232:235] offset:6144
  ds_write_b128 v21, a[236:239] offset:7168
  s_waitcnt lgkmcnt(0)
  s_barrier
  ds_read_b64_tr_b16 a[96:97], v29 offset:0
  ds_read_b64_tr_b16 a[98:99], v29 offset:2048
  ds_read_b64_tr_b16 a[100:101], v29 offset:8192
  ds_read_b64_tr_b16 a[102:103], v29 offset:10240
  ds_read_b64_tr_b16 a[104:105], v29 offset:16384
  ds_read_b64_tr_b16 a[106:107], v29 offset:18432
  ds_read_b64_tr_b16 a[108:109], v29 offset:24576
  ds_read_b64_tr_b16 a[110:111], v29 offset:26624
  ds_read_b64_tr_b16 a[224:225], v30 offset:0
  ds_read_b64_tr_b16 a[226:227], v30 offset:2048
  ds_read_b64_tr_b16 a[228:229], v30 offset:8192
  ds_read_b64_tr_b16 a[230:231], v30 offset:10240
  ds_read_b64_tr_b16 a[232:233], v30 offset:16384
  ds_read_b64_tr_b16 a[234:235], v30 offset:18432
  ds_read_b64_tr_b16 a[236:237], v30 offset:24576
  ds_read_b64_tr_b16 a[238:239], v30 offset:26624
  s_waitcnt lgkmcnt(0)
  s_waitcnt vmcnt(0)
  ds_write_b128 v21, a[112:115] offset:32768
  ds_write_b128 v21, a[116:119] offset:33792
  ds_write_b128 v21, a[120:123] offset:34816
  ds_write_b128 v21, a[124:127] offset:35840
  ds_write_b128 v21, a[240:243] offset:36864
  ds_write_b128 v21, a[244:247] offset:37888
  ds_write_b128 v21, a[248:251] offset:38912
  ds_write_b128 v21, a[252:255] offset:39936
  s_waitcnt lgkmcnt(0)
  s_barrier
  ds_read_b64_tr_b16 a[112:113], v29 offset:32768
  ds_read_b64_tr_b16 a[114:115], v29 offset:34816
  ds_read_b64_tr_b16 a[116:117], v29 offset:40960
  ds_read_b64_tr_b16 a[118:119], v29 offset:43008
  ds_read_b64_tr_b16 a[120:121], v29 offset:49152
  ds_read_b64_tr_b16 a[122:123], v29 offset:51200
  ds_read_b64_tr_b16 a[124:125], v29 offset:57344
  ds_read_b64_tr_b16 a[126:127], v29 offset:59392
  ds_read_b64_tr_b16 a[240:241], v30 offset:32768
  ds_read_b64_tr_b16 a[242:243], v30 offset:34816
  ds_read_b64_tr_b16 a[244:245], v30 offset:40960
  ds_read_b64_tr_b16 a[246:247], v30 offset:43008
  ds_read_b64_tr_b16 a[248:249], v30 offset:49152
  ds_read_b64_tr_b16 a[250:251], v30 offset:51200
  ds_read_b64_tr_b16 a[252:253], v30 offset:57344
  ds_read_b64_tr_b16 a[254:255], v30 offset:59392
  s_waitcnt lgkmcnt(0)
  s_barrier
  s_cmp_lg_u32 s8, 0
  s_cbranch_scc1 L_wfiok_68
  v_mov_b32 v254, 16
  s_mov_b32 s49, 0
L_wfi_67:
  global_load_dword v255, v254, s[6:7] sc1
  s_add_u32 s49, s49, 1
  s_cmp_gt_u32 s49, 0x20000
  s_cbranch_scc1 L_wfiok_68
  s_waitcnt vmcnt(0)
  v_cmp_gt_u32 vcc, 256, v255
  s_nop 0
  s_cbranch_vccz L_wfiok_68
  s_sleep 8
  s_branch L_wfi_67
L_wfiok_68:
  s_barrier
  v_and_b32 v12, 31, v0
  v_lshrrev_b32 v13, 5, v0
  v_and_b32 v14, 15, v0
  v_add_u32 v15, 0, v13
  v_xor_b32 v15, v15, v14
  v_lshlrev_b32 v15, 4, v15
  v_lshl_add_u32 v2, v12, 10, v15
  v_add_u32 v15, 2, v13
  v_xor_b32 v15, v15, v14
  v_lshlrev_b32 v15, 4, v15
  v_lshl_add_u32 v3, v12, 10, v15
  v_add_u32 v15, 4, v13
  v_xor_b32 v15, v15, v14
  v_lshlrev_b32 v15, 4, v15
  v_lshl_add_u32 v4, v12, 10, v15
  v_add_u32 v15, 6, v13
  v_xor_b32 v15, v15, v14
  v_lshlrev_b32 v15, 4, v15
  v_lshl_add_u32 v5, v12, 10, v15
  v_add_u32 v15, 8, v13
  v_xor_b32 v15, v15, v14
  v_lshlrev_b32 v15, 4, v15
  v_lshl_add_u32 v6, v12, 10, v15
  v_add_u32 v15, 10, v13
  v_xor_b32 v15, v15, v14
  v_lshlrev_b32 v15, 4, v15
  v_lshl_add_u32 v7, v12, 10, v15
  v_add_u32 v15, 12, v13
  v_xor_b32 v15, v15, v14
  v_lshlrev_b32 v15, 4, v15
  v_lshl_add_u32 v8, v12, 10, v15
  v_add_u32 v15, 14, v13
  v_xor_b32 v15, v15, v14
  v_lshlrev_b32 v15, 4, v15
  v_lshl_add_u32 v9, v12, 10, v15
  s_and_b32 s12, s8, 1
  s_lshl_b32 s12, s12, 7
  v_xor_b32 v10, s12, v1
  v_bfe_u32 v12, v0, 4, 1
  v_lshrrev_b32 v13, 5, v0
  v_and_b32 v14, 15, v0
  v_lshl_add_u32 v13, v13, 4, v14
  v_lshlrev_b32 v13, 4, v13
  v_lshl_add_u32 v116, v12, 12, v13
  s_mov_b32 s34, 0
  s_lshl_b32 s12, s30, 15
  s_add_u32 s26, s60, s12
  s_addc_u32 s27, s61, 0
  s_lshl_b32 s12, s8, 13
  s_add_u32 s16, s26, s12
  s_addc_u32 s17, s27, 0
  s_add_u32 s12, s12, s34
  v_xor_b32 v11, 0, v10
  s_add_u32 m0, s12, 0
  s_nop 0
  global_load_lds_dwordx4 v11, s[16:17]
  s_add_u32 s16, s16, 1024
  s_addc_u32 s17, s17, 0
  v_xor_b32 v11, 16, v10
  s_add_u32 m0, s12, 1024
  s_nop 0
  global_load_lds_dwordx4 v11, s[16:17]
  s_add_u32 s16, s16, 1024
  s_addc_u32 s17, s17, 0
  v_xor_b32 v11, 32, v10
  s_add_u32 m0, s12, 2048
  s_nop 0
  global_load_lds_dwordx4 v11, s[16:17]
  s_add_u32 s16, s16, 1024
  s_addc_u32 s17, s17, 0
  v_xor_b32 v11, 48, v10
  s_add_u32 m0, s12, 3072
  s_nop 0
  global_load_lds_dwordx4 v11, s[16:17]
  s_add_u32 s16, s16, 1024
  s_addc_u32 s17, s17, 0
  v_xor_b32 v11, 64, v10
  s_add_u32 m0, s12, 4096
  s_nop 0
  global_load_lds_dwordx4 v11, s[16:17]
  s_add_u32 s16, s16, 1024
  s_addc_u32 s17, s17, 0
  v_xor_b32 v11, 80, v10
  s_add_u32 m0, s12, 5120
  s_nop 0
  global_load_lds_dwordx4 v11, s[16:17]
  s_add_u32 s16, s16, 1024
  s_addc_u32 s17, s17, 0
  v_xor_b32 v11, 96, v10
  s_add_u32 m0, s12, 6144
  s_nop 0
  global_load_lds_dwordx4 v11, s[16:17]
  s_add_u32 s16, s16, 1024
  s_addc_u32 s17, s17, 0
  v_xor_b32 v11, 112, v10
  s_add_u32 m0, s12, 7168
  s_nop 0
  global_load_lds_dwordx4 v11, s[16:17]
  s_mov_b32 s52, -1
  s_mov_b32 s53, -1
  s_waitcnt vmcnt(0)
L_seg_69:
  s_waitcnt vmcnt(4)
  s_barrier
  s_cmp_eq_u32 s52, -1
  s_cbranch_scc1 L_nf_70
  s_cmp_lg_u32 s8, 0
  s_cbranch_scc1 L_fs_71
  s_lshl_b32 s48, s52, 14
  s_lshl_b32 s49, s36, 7
  s_add_u32 s48, s48, s49
  s_add_u32 s48, s48, 0
  v_mov_b32 v254, s48
  v_mov_b32 v255, 1
  s_mov_b64 exec, 1
  global_store_dword v254, v255, s[46:47] sc1
  s_mov_b64 exec, -1
L_fs_71:
L_nf_70:
  s_mov_b32 s52, s53
  s_mov_b32 s53, s30
  s_lshl_b32 s12, s30, 18
  s_add_u32 s12, s12, s37
  s_add_u32 s12, s12, 0
  s_add_u32 s28, s4, s12
  s_addc_u32 s29, s5, 0
  s_add_u32 s30, s30, s33
  s_sub_u32 s35, s35, 1
  s_xor_b32 s34, s34, 32768
  s_cmp_eq_u32 s35, 0
  s_cbranch_scc1 L_nonext_72
  s_lshl_b32 s12, s30, 15
  s_add_u32 s26, s60, s12
  s_addc_u32 s27, s61, 0
  s_lshl_b32 s12, s8, 13
  s_add_u32 s16, s26, s12
  s_addc_u32 s17, s27, 0
  s_add_u32 s12, s12, s34
  v_xor_b32 v11, 0, v10
  s_add_u32 m0, s12, 0
  s_nop 0
  global_load_lds_dwordx4 v11, s[16:17]
  s_add_u32 s16, s16, 1024
  s_addc_u32 s17, s17, 0
  v_xor_b32 v11, 16, v10
  s_add_u32 m0, s12, 1024
  s_nop 0
  global_load_lds_dwordx4 v11, s[16:17]
  s_add_u32 s16, s16, 1024
  s_addc_u32 s17, s17, 0
  v_xor_b32 v11, 32, v10
  s_add_u32 m0, s12, 2048
  s_nop 0
  global_load_lds_dwordx4 v11, s[16:17]
  s_add_u32 s16, s16, 1024
  s_addc_u32 s17, s17, 0
  v_xor_b32 v11, 48, v10
  s_add_u32 m0, s12, 3072
  s_nop 0
  global_load_lds_dwordx4 v11, s[16:17]
  s_add_u32 s16, s16, 1024
  s_addc_u32 s17, s17, 0
  v_xor_b32 v11, 64, v10
  s_add_u32 m0, s12, 4096
  s_nop 0
  global_load_lds_dwordx4 v11, s[16:17]
  s_add_u32 s16, s16, 1024
  s_addc_u32 s17, s17, 0
  v_xor_b32 v11, 80, v10
  s_add_u32 m0, s12, 5120
  s_nop 0
  global_load_lds_dwordx4 v11, s[16:17]
  s_add_u32 s16, s16, 1024
  s_addc_u32 s17, s17, 0
  v_xor_b32 v11, 96, v10
  s_add_u32 m0, s12, 6144
  s_nop 0
  global_load_lds_dwordx4 v11, s[16:17]
  s_add_u32 s16, s16, 1024
  s_addc_u32 s17, s17, 0
  v_xor_b32 v11, 112, v10
  s_add_u32 m0, s12, 7168
  s_nop 0
  global_load_lds_dwordx4 v11, s[16:17]
L_nonext_72:
  ds_read_b128 v[32:35], v2 offset:0
  ds_read_b128 v[36:39], v3 offset:0
  ds_read_b128 v[40:43], v4 offset:0
  ds_read_b128 v[44:47], v5 offset:0
  ds_read_b128 v[48:51], v6 offset:0
  ds_read_b128 v[52:55], v7 offset:0
  s_waitcnt lgkmcnt(5)
  v_mfma_f32_32x32x16_bf16 v[64:79], a[0:3], v[32:35], 0
  ds_read_b128 v[56:59], v8 offset:0
  v_mfma_f32_32x32x16_bf16 v[80:95], a[128:131], v[32:35], 0
  s_waitcnt lgkmcnt(5)
  v_mfma_f32_32x32x16_bf16 v[64:79], a[4:7], v[36:39], v[64:79]
  ds_read_b128 v[60:63], v9 offset:0
  v_mfma_f32_32x32x16_bf16 v[80:95], a[132:135], v[36:39], v[80:95]
  s_waitcnt lgkmcnt(5)
  v_mfma_f32_32x32x16_bf16 v[64:79], a[8:11], v[40:43], v[64:79]
  ds_read_b128 v[32:35], v2 offset:256
  v_mfma_f32_32x32x16_bf16 v[80:95], a[136:139], v[40:43], v[80:95]
  s_waitcnt lgkmcnt(5)
  v_mfma_f32_32x32x16_bf16 v[64:79], a[12:15], v[44:47], v[64:79]
  ds_read_b128 v[36:39], v3 offset:256
  v_mfma_f32_32x32x16_bf16 v[80:95], a[140:143], v[44:47], v[80:95]
  s_waitcnt lgkmcnt(5)
  v_mfma_f32_32x32x16_bf16 v[64:79], a[16:19], v[48:51], v[64:79]
  ds_read_b128 v[40:43], v4 offset:256
  v_mfma_f32_32x32x16_bf16 v[80:95], a[144:147], v[48:51], v[80:95]
  s_waitcnt lgkmcnt(5)
  v_mfma_f32_32x32x16_bf16 v[64:79], a[20:23], v[52:55], v[64:79]
  ds_read_b128 v[44:47], v5 offset:256
  v_mfma_f32_32x32x16_bf16 v[80:95], a[148:151], v[52:55], v[80:95]
  s_waitcnt lgkmcnt(5)
  v_mfma_f32_32x32x16_bf16 v[64:79], a[24:27], v[56:59], v[64:79]
  ds_read_b128 v[48:51], v6 offset:256
  v_mfma_f32_32x32x16_bf16 v[80:95], a[152:155], v[56:59], v[80:95]
  s_waitcnt lgkmcnt(5)
  v_mfma_f32_32x32x16_bf16 v[64:79], a[28:31], v[60:63], v[64:79]
  ds_read_b128 v[52:55], v7 offset:256
  v_mfma_f32_32x32x16_bf16 v[80:95], a[156:159], v[60:63], v[80:95]
  s_waitcnt lgkmcnt(5)
  v_mfma_f32_32x32x16_bf16 v[64:79], a[32:35], v[32:35], v[64:79]
  ds_read_b128 v[56:59], v8 offset:256
  v_mfma_f32_32x32x16_bf16 v[80:95], a[160:163], v[32:35], v[80:95]
  s_waitcnt lgkmcnt(5)
  v_mfma_f32_32x32x16_bf16 v[64:79], a[36:39], v[36:39], v[64:79]
  ds_read_b128 v[60:63], v9 offset:256
  v_mfma_f32_32x32x16_bf16 v[80:95], a[164:167], v[36:39], v[80:95]
  s_waitcnt lgkmcnt(5)
  v_mfma_f32_32x32x16_bf16 v[64:79], a[40:43], v[40:43], v[64:79]
  ds_read_b128 v[32:35], v2 offset:512
  v_mfma_f32_32x32x16_bf16 v[80:95], a[168:171], v[40:43], v[80:95]
  s_waitcnt lgkmcnt(5)
  v_mfma_f32_32x32x16_bf16 v[64:79], a[44:47], v[44:47], v[64:79]
  ds_read_b128 v[36:39], v3 offset:512
  v_mfma_f32_32x32x16_bf16 v[80:95], a[172:175], v[44:47], v[80:95]
  s_waitcnt lgkmcnt(5)
  v_mfma_f32_32x32x16_bf16 v[64:79], a[48:51], v[48:51], v[64:79]
  ds_read_b128 v[40:43], v4 offset:512
  v_mfma_f32_32x32x16_bf16 v[80:95], a[176:179], v[48:51], v[80:95]
  s_waitcnt lgkmcnt(5)
  v_mfma_f32_32x32x16_bf16 v[64:79], a[52:55], v[52:55], v[64:79]
  ds_read_b128 v[44:47], v5 offset:512
  v_mfma_f32_32x32x16_bf16 v[80:95], a[180:183], v[52:55], v[80:95]
  s_waitcnt lgkmcnt(5)
  v_mfma_f32_32x32x16_bf16 v[64:79], a[56:59], v[56:59], v[64:79]
  ds_read_b128 v[48:51], v6 offset:512
  v_mfma_f32_32x32x16_bf16 v[80:95], a[184:187], v[56:59], v[80:95]
  s_waitcnt lgkmcnt(5)
  v_mfma_f32_32x32x16_bf16 v[64:79], a[60:63], v[60:63], v[64:79]
  ds_read_b128 v[52:55], v7 offset:512
  v_mfma_f32_32x32x16_bf16 v[80:95], a[188:191], v[60:63], v[80:95]
  s_waitcnt lgkmcnt(5)
  v_mfma_f32_32x32x16_bf16 v[64:79], a[64:67], v[32:35], v[64:79]
  ds_read_b128 v[56:59], v8 offset:512
  v_mfma_f32_32x32x16_bf16 v[80:95], a[192:195], v[32:35], v[80:95]
  s_waitcnt lgkmcnt(5)
  v_mfma_f32_32x32x16_bf16 v[64:79], a[68:71], v[36:39], v[64:79]
  ds_read_b128 v[60:63], v9 offset:512
  v_mfma_f32_32x32x16_bf16 v[80:95], a[196:199], v[36:39], v[80:95]
  s_waitcnt lgkmcnt(5)
  v_mfma_f32_32x32x16_bf16 v[64:79], a[72:75], v[40:43], v[64:79]
  ds_read_b128 v[32:35], v2 offset:768
  v_mfma_f32_32x32x16_bf16 v[80:95], a[200:203], v[40:43], v[80:95]
  s_waitcnt lgkmcnt(5)
  v_mfma_f32_32x32x16_bf16 v[64:79], a[76:79], v[44:47], v[64:79]
  ds_read_b128 v[36:39], v3 offset:768
  v_mfma_f32_32x32x16_bf16 v[80:95], a[204:207], v[44:47], v[80:95]
  s_waitcnt lgkmcnt(5)
  v_mfma_f32_32x32x16_bf16 v[64:79], a[80:83], v[48:51], v[64:79]
  ds_read_b128 v[40:43], v4 offset:768
  v_mfma_f32_32x32x16_bf16 v[80:95], a[208:211], v[48:51], v[80:95]
  s_waitcnt lgkmcnt(5)
  v_mfma_f32_32x32x16_bf16 v[64:79], a[84:87], v[52:55], v[64:79]
  ds_read_b128 v[44:47], v5 offset:768
  v_mfma_f32_32x32x16_bf16 v[80:95], a[212:215], v[52:55], v[80:95]
  s_waitcnt lgkmcnt(5)
  v_mfma_f32_32x32x16_bf16 v[64:79], a[88:91], v[56:59], v[64:79]
  ds_read_b128 v[48:51], v6 offset:768
  v_mfma_f32_32x32x16_bf16 v[80:95], a[216:219], v[56:59], v[80:95]
  s_waitcnt lgkmcnt(5)
  v_mfma_f32_32x32x16_bf16 v[64:79], a[92:95], v[60:63], v[64:79]
  ds_read_b128 v[52:55], v7 offset:768
  v_mfma_f32_32x32x16_bf16 v[80:95], a[220:223], v[60:63], v[80:95]
  s_waitcnt lgkmcnt(5)
  v_mfma_f32_32x32x16_bf16 v[64:79], a[96:99], v[32:35], v[64:79]
  ds_read_b128 v[56:59], v8 offset:768
  v_mfma_f32_32x32x16_bf16 v[80:95], a[224:227], v[32:35], v[80:95]
  s_waitcnt lgkmcnt(5)
  v_mfma_f32_32x32x16_bf16 v[64:79], a[100:103], v[36:39], v[64:79]
  ds_read_b128 v[60:63], v9 offset:768
  v_mfma_f32_32x32x16_bf16 v[80:95], a[228:231], v[36:39], v[80:95]
  s_waitcnt lgkmcnt(5)
  v_mfma_f32_32x32x16_bf16 v[64:79], a[104:107], v[40:43], v[64:79]
  v_mfma_f32_32x32x16_bf16 v[80:95], a[232:235], v[40:43], v[80:95]
  s_waitcnt lgkmcnt(4)
  v_mfma_f32_32x32x16_bf16 v[64:79], a[108:111], v[44:47], v[64:79]
  v_mfma_f32_32x32x16_bf16 v[80:95], a[236:239], v[44:47], v[80:95]
  s_waitcnt lgkmcnt(3)
  v_mfma_f32_32x32x16_bf16 v[64:79], a[112:115], v[48:51], v[64:79]
  v_mfma_f32_32x32x16_bf16 v[80:95], a[240:243], v[48:51], v[80:95]
  s_waitcnt lgkmcnt(2)
  v_mfma_f32_32x32x16_bf16 v[64:79], a[116:119], v[52:55], v[64:79]
  v_mfma_f32_32x32x16_bf16 v[80:95], a[244:247], v[52:55], v[80:95]
  s_waitcnt lgkmcnt(1)
  v_mfma_f32_32x32x16_bf16 v[64:79], a[120:123], v[56:59], v[64:79]
  v_mfma_f32_32x32x16_bf16 v[80:95], a[248:251], v[56:59], v[80:95]
  s_waitcnt lgkmcnt(0)
  v_mfma_f32_32x32x16_bf16 v[64:79], a[124:127], v[60:63], v[64:79]
  v_mfma_f32_32x32x16_bf16 v[80:95], a[252:255], v[60:63], v[80:95]
  v_xor_b32 v2, 32768, v2
  v_xor_b32 v3, 32768, v3
  v_xor_b32 v4, 32768, v4
  v_xor_b32 v5, 32768, v5
  v_xor_b32 v6, 32768, v6
  v_xor_b32 v7, 32768, v7
  v_xor_b32 v8, 32768, v8
  v_xor_b32 v9, 32768, v9
  v_cvt_pk_bf16_f32 v96, v64, v65
  v_cvt_pk_bf16_f32 v97, v66, v67
  v_cvt_pk_bf16_f32 v98, v68, v69
  v_cvt_pk_bf16_f32 v99, v70, v71
  global_store_dwordx4 v116, v[96:99], s[28:29] offset:0 sc1
  v_cvt_pk_bf16_f32 v100, v72, v73
  v_cvt_pk_bf16_f32 v101, v74, v75
  v_cvt_pk_bf16_f32 v102, v76, v77
  v_cvt_pk_bf16_f32 v103, v78, v79
  global_store_dwordx4 v116, v[100:103], s[28:29] offset:512 sc1
  v_cvt_pk_bf16_f32 v104, v80, v81
  v_cvt_pk_bf16_f32 v105, v82, v83
  v_cvt_pk_bf16_f32 v106, v84, v85
  v_cvt_pk_bf16_f32 v107, v86, v87
  global_store_dwordx4 v116, v[104:107], s[28:29] offset:1024 sc1
  v_cvt_pk_bf16_f32 v108, v88, v89
  v_cvt_pk_bf16_f32 v109, v90, v91
  v_cvt_pk_bf16_f32 v110, v92, v93
  v_cvt_pk_bf16_f32 v111, v94, v95
  global_store_dwordx4 v116, v[108:111], s[28:29] offset:1536 sc1
  s_cmp_eq_u32 s52, -1
  s_cbranch_scc0 L_nfirst_73
  s_cmp_lt_u32 s53, 3
  s_cbranch_scc0 L_nfirst_73
  s_waitcnt vmcnt(0)
  s_barrier
  s_cmp_lg_u32 s8, 0
  s_cbranch_scc1 L_fs_74
  s_lshl_b32 s48, s53, 14
  s_lshl_b32 s49, s36, 7
  s_add_u32 s48, s48, s49
  s_add_u32 s48, s48, 0
  v_mov_b32 v254, s48
  v_mov_b32 v255, 1
  s_mov_b64 exec, 1
  global_store_dword v254, v255, s[46:47] sc1
  s_mov_b64 exec, -1
L_fs_74:
L_nfirst_73:
  s_cmp_lg_u32 s35, 0
  s_cbranch_scc1 L_seg_69
  s_waitcnt vmcnt(0)
  s_barrier
  s_cmp_eq_u32 s52, -1
  s_cbranch_scc1 L_nf_75
  s_cmp_lg_u32 s8, 0
  s_cbranch_scc1 L_fs_76
  s_lshl_b32 s48, s52, 14
  s_lshl_b32 s49, s36, 7
  s_add_u32 s48, s48, s49
  s_add_u32 s48, s48, 0
  v_mov_b32 v254, s48
  v_mov_b32 v255, 1
  s_mov_b64 exec, 1
  global_store_dword v254, v255, s[46:47] sc1
  s_mov_b64 exec, -1
L_fs_76:
L_nf_75:
  s_cmp_lg_u32 s8, 0
  s_cbranch_scc1 L_fs_77
  s_lshl_b32 s48, s53, 14
  s_lshl_b32 s49, s36, 7
  s_add_u32 s48, s48, s49
  s_add_u32 s48, s48, 0
  v_mov_b32 v254, s48
  v_mov_b32 v255, 1
  s_mov_b64 exec, 1
  global_store_dword v254, v255, s[46:47] sc1
  s_mov_b64 exec, -1
L_fs_77:
  s_branch L_pdone_62
L_pv_64:
  s_sub_u32 s18, s36, 16
  s_lshl_b32 s12, s18, 9
  s_add_u32 s20, s66, s12
  s_addc_u32 s21, s67, 0
  s_mov_b32 s24, 8192
  s_lshr_b32 s12, s8, 1
  s_lshl_b32 s13, s18, 1
  s_add_u32 s12, s12, s13
  s_lshl_b32 s37, s12, 13
  s_and_b32 s12, s8, 1
  s_lshl_b32 s12, s12, 12
  s_add_u32 s37, s37, s12
  v_lshrrev_b32 v12, 5, v0
  v_and_b32 v13, 31, v0
  v_add_u32 v14, 0, v12
  v_lshlrev_b32 v14, 2, v14
  v_xor_b32 v14, v14, v13
  v_lshlrev_b32 v15, 4, v14
  v_mov_b32 v17, s21
  v_add_co_u32 v16, vcc, s20, v15
  s_nop 1
  v_addc_co_u32 v17, vcc, 0, v17, vcc
  s_lshl_b32 s12, s8, 4
  s_add_u32 s12, s12, 0
  v_add_u32 v15, s12, v12
  v_mul_lo_u32 v15, v15, s24
  v_add_co_u32 v16, vcc, v16, v15
  s_nop 1
  v_addc_co_u32 v17, vcc, 0, v17, vcc
  v_add_u32 v14, 2, v12
  v_lshlrev_b32 v14, 2, v14
  v_xor_b32 v14, v14, v13
  v_lshlrev_b32 v15, 4, v14
  v_mov_b32 v19, s21
  v_add_co_u32 v18, vcc, s20, v15
  s_nop 1
  v_addc_co_u32 v19, vcc, 0, v19, vcc
  s_lshl_b32 s12, s8, 4
  s_add_u32 s12, s12, 2
  v_add_u32 v15, s12, v12
  v_mul_lo_u32 v15, v15, s24
  v_add_co_u32 v18, vcc, v18, v15
  s_nop 1
  v_addc_co_u32 v19, vcc, 0, v19, vcc
  s_lshl_b32 s14, s24, 2
  s_mul_i32 s15, s24, 48
  s_lshl_b32 s13, s8, 13
  v_bfe_u32 v22, v0, 2, 2
  v_and_b32 v23, 3, v0
  v_bfe_u32 v24, v0, 4, 1
  v_lshrrev_b32 v25, 5, v0
  v_lshrrev_b32 v26, 1, v23
  v_lshl_add_u32 v26, v24, 1, v26
  v_lshl_add_u32 v25, v25, 3, v22
  s_lshl_b32 s12, s8, 3
  s_add_u32 s12, s12, 0
  v_add_u32 v27, s12, v26
  v_lshlrev_b32 v28, 2, v22
  v_xor_b32 v27, v27, v28
  v_lshlrev_b32 v27, 4, v27
  v_lshl_add_u32 v27, v25, 9, v27
  v_and_b32 v28, 1, v23
  v_lshl_add_u32 v29, v28, 3, v27
  s_lshl_b32 s12, s8, 3
  s_add_u32 s12, s12, 4
  v_add_u32 v27, s12, v26
  v_lshlrev_b32 v28, 2, v22
  v_xor_b32 v27, v27, v28
  v_lshlrev_b32 v27, 4, v27
  v_lshl_add_u32 v27, v25, 9, v27
  v_and_b32 v28, 1, v23
  v_lshl_add_u32 v30, v28, 3, v27
  v_add_u32 v21, s13, v1
  global_load_dwordx4 a[0:3], v[16:17], off
  v_add_co_u32 v16, vcc, s14, v16
  s_nop 1
  v_addc_co_u32 v17, vcc, 0, v17, vcc
  global_load_dwordx4 a[4:7], v[18:19], off
  v_add_co_u32 v18, vcc, s14, v18
  s_nop 1
  v_addc_co_u32 v19, vcc, 0, v19, vcc
  global_load_dwordx4 a[8:11], v[16:17], off
  v_add_co_u32 v16, vcc, s14, v16
  s_nop 1
  v_addc_co_u32 v17, vcc, 0, v17, vcc
  global_load_dwordx4 a[12:15], v[18:19], off
  v_add_co_u32 v18, vcc, s14, v18
  s_nop 1
  v_addc_co_u32 v19, vcc, 0, v19, vcc
  global_load_dwordx4 a[128:131], v[16:17], off
  v_add_co_u32 v16, vcc, s14, v16
  s_nop 1
  v_addc_co_u32 v17, vcc, 0, v17, vcc
  global_load_dwordx4 a[132:135], v[18:19], off
  v_add_co_u32 v18, vcc, s14, v18
  s_nop 1
  v_addc_co_u32 v19, vcc, 0, v19, vcc
  global_load_dwordx4 a[136:139], v[16:17], off
  v_add_co_u32 v16, vcc, s14, v16
  s_nop 1
  v_addc_co_u32 v17, vcc, 0, v17, vcc
  global_load_dwordx4 a[140:143], v[18:19], off
  v_add_co_u32 v18, vcc, s14, v18
  s_nop 1
  v_addc_co_u32 v19, vcc, 0, v19, vcc
  v_add_co_u32 v16, vcc, s15, v16
  s_nop 1
  v_addc_co_u32 v17, vcc, 0, v17, vcc
  v_add_co_u32 v18, vcc, s15, v18
  s_nop 1
  v_addc_co_u32 v19, vcc, 0, v19, vcc
  global_load_dwordx4 a[16:19], v[16:17], off
  v_add_co_u32 v16, vcc, s14, v16
  s_nop 1
  v_addc_co_u32 v17, vcc, 0, v17, vcc
  global_load_dwordx4 a[20:23], v[18:19], off
  v_add_co_u32 v18, vcc, s14, v18
  s_nop 1
  v_addc_co_u32 v19, vcc, 0, v19, vcc
  global_load_dwordx4 a[24:27], v[16:17], off
  v_add_co_u32 v16, vcc, s14, v16
  s_nop 1
  v_addc_co_u32 v17, vcc, 0, v17, vcc
  global_load_dwordx4 a[28:31], v[18:19], off
  v_add_co_u32 v18, vcc, s14, v18
  s_nop 1
  v_addc_co_u32 v19, vcc, 0, v19, vcc
  global_load_dwordx4 a[144:147], v[16:17], off
  v_add_co_u32 v16, vcc, s14, v16
  s_nop 1
  v_addc_co_u32 v17, vcc, 0, v17, vcc
  global_load_dwordx4 a[148:151], v[18:19], off
  v_add_co_u32 v18, vcc, s14, v18
  s_nop 1
  v_addc_co_u32 v19, vcc, 0, v19, vcc
  global_load_dwordx4 a[152:155], v[16:17], off
  v_add_co_u32 v16, vcc, s14, v16
  s_nop 1
  v_addc_co_u32 v17, vcc, 0, v17, vcc
  global_load_dwordx4 a[156:159], v[18:19], off
  v_add_co_u32 v18, vcc, s14, v18
  s_nop 1
  v_addc_co_u32 v19, vcc, 0, v19, vcc
  v_add_co_u32 v16, vcc, s15, v16
  s_nop 1
  v_addc_co_u32 v17, vcc, 0, v17, vcc
  v_add_co_u32 v18, vcc, s15, v18
  s_nop 1
  v_addc_co_u32 v19, vcc, 0, v19, vcc
  global_load_dwordx4 a[32:35], v[16:17], off
  v_add_co_u32 v16, vcc, s14, v16
  s_nop 1
  v_addc_co_u32 v17, vcc, 0, v17, vcc
  global_load_dwordx4 a[36:39], v[18:19], off
  v_add_co_u32 v18, vcc, s14, v18
  s_nop 1
  v_addc_co_u32 v19, vcc, 0, v19, vcc
  global_load_dwordx4 a[40:43], v[16:17], off
  v_add_co_u32 v16, vcc, s14, v16
  s_nop 1
  v_addc_co_u32 v17, vcc, 0, v17, vcc
  global_load_dwordx4 a[44:47], v[18:19], off
  v_add_co_u32 v18, vcc, s14, v18
  s_nop 1
  v_addc_co_u32 v19, vcc, 0, v19, vcc
  global_load_dwordx4 a[160:163], v[16:17], off
  v_add_co_u32 v16, vcc, s14, v16
  s_nop 1
  v_addc_co_u32 v17, vcc, 0, v17, vcc
  global_load_dwordx4 a[164:167], v[18:19], off
  v_add_co_u32 v18, vcc, s14, v18
  s_nop 1
  v_addc_co_u32 v19, vcc, 0, v19, vcc
  global_load_dwordx4 a[168:171], v[16:17], off
  v_add_co_u32 v16, vcc, s14, v16
  s_nop 1
  v_addc_co_u32 v17, vcc, 0, v17, vcc
  global_load_dwordx4 a[172:175], v[18:19], off
  v_add_co_u32 v18, vcc, s14, v18
  s_nop 1
  v_addc_co_u32 v19, vcc, 0, v19, vcc
  v_add_co_u32 v16, vcc, s15, v16
  s_nop 1
  v_addc_co_u32 v17, vcc, 0, v17, vcc
  v_add_co_u32 v18, vcc, s15, v18
  s_nop 1
  v_addc_co_u32 v19, vcc, 0, v19, vcc
  global_load_dwordx4 a[48:51], v[16:17], off
  v_add_co_u32 v16, vcc, s14, v16
  s_nop 1
  v_addc_co_u32 v17, vcc, 0, v17, vcc
  global_load_dwordx4 a[52:55], v[18:19], off
  v_add_co_u32 v18, vcc, s14, v18
  s_nop 1
  v_addc_co_u32 v19, vcc, 0, v19, vcc
  global_load_dwordx4 a[56:59], v[16:17], off
  v_add_co_u32 v16, vcc, s14, v16
  s_nop 1
  v_addc_co_u32 v17, vcc, 0, v17, vcc
  global_load_dwordx4 a[60:63], v[18:19], off
  v_add_co_u32 v18, vcc, s14, v18
  s_nop 1
  v_addc_co_u32 v19, vcc, 0, v19, vcc
  global_load_dwordx4 a[176:179], v[16:17], off
  v_add_co_u32 v16, vcc, s14, v16
  s_nop 1
  v_addc_co_u32 v17, vcc, 0, v17, vcc
  global_load_dwordx4 a[180:183], v[18:19], off
  v_add_co_u32 v18, vcc, s14, v18
  s_nop 1
  v_addc_co_u32 v19, vcc, 0, v19, vcc
  global_load_dwordx4 a[184:187], v[16:17], off
  v_add_co_u32 v16, vcc, s14, v16
  s_nop 1
  v_addc_co_u32 v17, vcc, 0, v17, vcc
  global_load_dwordx4 a[188:191], v[18:19], off
  v_add_co_u32 v18, vcc, s14, v18
  s_nop 1
  v_addc_co_u32 v19, vcc, 0, v19, vcc
  v_add_co_u32 v16, vcc, s15, v16
  s_nop 1
  v_addc_co_u32 v17, vcc, 0, v17, vcc
  v_add_co_u32 v18, vcc, s15, v18
  s_nop 1
  v_addc_co_u32 v19, vcc, 0, v19, vcc
  global_load_dwordx4 a[64:67], v[16:17], off
  v_add_co_u32 v16, vcc, s14, v16
  s_nop 1
  v_addc_co_u32 v17, vcc, 0, v17, vcc
  global_load_dwordx4 a[68:71], v[18:19], off
  v_add_co_u32 v18, vcc, s14, v18
  s_nop 1
  v_addc_co_u32 v19, vcc, 0, v19, vcc
  global_load_dwordx4 a[72:75], v[16:17], off
  v_add_co_u32 v16, vcc, s14, v16
  s_nop 1
  v_addc_co_u32 v17, vcc, 0, v17, vcc
  global_load_dwordx4 a[76:79], v[18:19], off
  v_add_co_u32 v18, vcc, s14, v18
  s_nop 1
  v_addc_co_u32 v19, vcc, 0, v19, vcc
  global_load_dwordx4 a[192:195], v[16:17], off
  v_add_co_u32 v16, vcc, s14, v16
  s_nop 1
  v_addc_co_u32 v17, vcc, 0, v17, vcc
  global_load_dwordx4 a[196:199], v[18:19], off
  v_add_co_u32 v18, vcc, s14, v18
  s_nop 1
  v_addc_co_u32 v19, vcc, 0, v19, vcc
  global_load_dwordx4 a[200:203], v[16:17], off
  v_add_co_u32 v16, vcc, s14, v16
  s_nop 1
  v_addc_co_u32 v17, vcc, 0, v17, vcc
  global_load_dwordx4 a[204:207], v[18:19], off
  v_add_co_u32 v18, vcc, s14, v18
  s_nop 1
  v_addc_co_u32 v19, vcc, 0, v19, vcc
  v_add_co_u32 v16, vcc, s15, v16
  s_nop 1
  v_addc_co_u32 v17, vcc, 0, v17, vcc
  v_add_co_u32 v18, vcc, s15, v18
  s_nop 1
  v_addc_co_u32 v19, vcc, 0, v19, vcc
  global_load_dwordx4 a[80:83], v[16:17], off
  v_add_co_u32 v16, vcc, s14, v16
  s_nop 1
  v_addc_co_u32 v17, vcc, 0, v17, vcc
  global_load_dwordx4 a[84:87], v[18:19], off
  v_add_co_u32 v18, vcc, s14, v18
  s_nop 1
  v_addc_co_u32 v19, vcc, 0, v19, vcc
  global_load_dwordx4 a[88:91], v[16:17], off
  v_add_co_u32 v16, vcc, s14, v16
  s_nop 1
  v_addc_co_u32 v17, vcc, 0, v17, vcc
  global_load_dwordx4 a[92:95], v[18:19], off
  v_add_co_u32 v18, vcc, s14, v18
  s_nop 1
  v_addc_co_u32 v19, vcc, 0, v19, vcc
  global_load_dwordx4 a[208:211], v[16:17], off
  v_add_co_u32 v16, vcc, s14, v16
  s_nop 1
  v_addc_co_u32 v17, vcc, 0, v17, vcc
  global_load_dwordx4 a[212:215], v[18:19], off
  v_add_co_u32 v18, vcc, s14, v18
  s_nop 1
  v_addc_co_u32 v19, vcc, 0, v19, vcc
  global_load_dwordx4 a[216:219], v[16:17], off
  v_add_co_u32 v16, vcc, s14, v16
  s_nop 1
  v_addc_co_u32 v17, vcc, 0, v17, vcc
  global_load_dwordx4 a[220:223], v[18:19], off
  v_add_co_u32 v18, vcc, s14, v18
  s_nop 1
  v_addc_co_u32 v19, vcc, 0, v19, vcc
  v_add_co_u32 v16, vcc, s15, v16
  s_nop 1
  v_addc_co_u32 v17, vcc, 0, v17, vcc
  v_add_co_u32 v18, vcc, s15, v18
  s_nop 1
  v_addc_co_u32 v19, vcc, 0, v19, vcc
  global_load_dwordx4 a[96:99], v[16:17], off
  v_add_co_u32 v16, vcc, s14, v16
  s_nop 1
  v_addc_co_u32 v17, vcc, 0, v17, vcc
  global_load_dwordx4 a[100:103], v[18:19], off
  v_add_co_u32 v18, vcc, s14, v18
  s_nop 1
  v_addc_co_u32 v19, vcc, 0, v19, vcc
  global_load_dwordx4 a[104:107], v[16:17], off
  v_add_co_u32 v16, vcc, s14, v16
  s_nop 1
  v_addc_co_u32 v17, vcc, 0, v17, vcc
  global_load_dwordx4 a[108:111], v[18:19], off
  v_add_co_u32 v18, vcc, s14, v18
  s_nop 1
  v_addc_co_u32 v19, vcc, 0, v19, vcc
  global_load_dwordx4 a[224:227], v[16:17], off
  v_add_co_u32 v16, vcc, s14, v16
  s_nop 1
  v_addc_co_u32 v17, vcc, 0, v17, vcc
  global_load_dwordx4 a[228:231], v[18:19], off
  v_add_co_u32 v18, vcc, s14, v18
  s_nop 1
  v_addc_co_u32 v19, vcc, 0, v19, vcc
  global_load_dwordx4 a[232:235], v[16:17], off
  v_add_co_u32 v16, vcc, s14, v16
  s_nop 1
  v_addc_co_u32 v17, vcc, 0, v17, vcc
  global_load_dwordx4 a[236:239], v[18:19], off
  v_add_co_u32 v18, vcc, s14, v18
  s_nop 1
  v_addc_co_u32 v19, vcc, 0, v19, vcc
  v_add_co_u32 v16, vcc, s15, v16
  s_nop 1
  v_addc_co_u32 v17, vcc, 0, v17, vcc
  v_add_co_u32 v18, vcc, s15, v18
  s_nop 1
  v_addc_co_u32 v19, vcc, 0, v19, vcc
  s_waitcnt vmcnt(48)
  ds_write_b128 v21, a[0:3] offset:0
  ds_write_b128 v21, a[4:7] offset:1024
  ds_write_b128 v21, a[8:11] offset:2048
  ds_write_b128 v21, a[12:15] offset:3072
  ds_write_b128 v21, a[128:131] offset:4096
  ds_write_b128 v21, a[132:135] offset:5120
  ds_write_b128 v21, a[136:139] offset:6144
  ds_write_b128 v21, a[140:143] offset:7168
  s_waitcnt lgkmcnt(0)
  s_barrier
  ds_read_b64_tr_b16 a[0:1], v29 offset:0
  ds_read_b64_tr_b16 a[2:3], v29 offset:2048
  ds_read_b64_tr_b16 a[4:5], v29 offset:8192
  ds_read_b64_tr_b16 a[6:7], v29 offset:10240
  ds_read_b64_tr_b16 a[8:9], v29 offset:16384
  ds_read_b64_tr_b16 a[10:11], v29 offset:18432
  ds_read_b64_tr_b16 a[12:13], v29 offset:24576
  ds_read_b64_tr_b16 a[14:15], v29 offset:26624
  ds_read_b64_tr_b16 a[128:129], v30 offset:0
  ds_read_b64_tr_b16 a[130:131], v30 offset:2048
  ds_read_b64_tr_b16 a[132:133], v30 offset:8192
  ds_read_b64_tr_b16 a[134:135], v30 offset:10240
  ds_read_b64_tr_b16 a[136:137], v30 offset:16384
  ds_read_b64_tr_b16 a[138:139], v30 offset:18432
  ds_read_b64_tr_b16 a[140:141], v30 offset:24576
  ds_read_b64_tr_b16 a[142:143], v30 offset:26624
  global_load_dwordx4 a[112:115], v[16:17], off
  v_add_co_u32 v16, vcc, s14, v16
  s_nop 1
  v_addc_co_u32 v17, vcc, 0, v17, vcc
  global_load_dwordx4 a[116:119], v[18:19], off
  v_add_co_u32 v18, vcc, s14, v18
  s_nop 1
  v_addc_co_u32 v19, vcc, 0, v19, vcc
  global_load_dwordx4 a[120:123], v[16:17], off
  v_add_co_u32 v16, vcc, s14, v16
  s_nop 1
  v_addc_co_u32 v17, vcc, 0, v17, vcc
  global_load_dwordx4 a[124:127], v[18:19], off
  v_add_co_u32 v18, vcc, s14, v18
  s_nop 1
  v_addc_co_u32 v19, vcc, 0, v19, vcc
  global_load_dwordx4 a[240:243], v[16:17], off
  v_add_co_u32 v16, vcc, s14, v16
  s_nop 1
  v_addc_co_u32 v17, vcc, 0, v17, vcc
  global_load_dwordx4 a[244:247], v[18:19], off
  v_add_co_u32 v18, vcc, s14, v18
  s_nop 1
  v_addc_co_u32 v19, vcc, 0, v19, vcc
  global_load_dwordx4 a[248:251], v[16:17], off
  v_add_co_u32 v16, vcc, s14, v16
  s_nop 1
  v_addc_co_u32 v17, vcc, 0, v17, vcc
  global_load_dwordx4 a[252:255], v[18:19], off
  v_add_co_u32 v18, vcc, s14, v18
  s_nop 1
  v_addc_co_u32 v19, vcc, 0, v19, vcc
  v_add_co_u32 v16, vcc, s15, v16
  s_nop 1
  v_addc_co_u32 v17, vcc, 0, v17, vcc
  v_add_co_u32 v18, vcc, s15, v18
  s_nop 1
  v_addc_co_u32 v19, vcc, 0, v19, vcc
  s_waitcnt lgkmcnt(0)
  s_waitcnt vmcnt(48)
  ds_write_b128 v21, a[16:19] offset:32768
  ds_write_b128 v21, a[20:23] offset:33792
  ds_write_b128 v21, a[24:27] offset:34816
  ds_write_b128 v21, a[28:31] offset:35840
  ds_write_b128 v21, a[144:147] offset:36864
  ds_write_b128 v21, a[148:151] offset:37888
  ds_write_b128 v21, a[152:155] offset:38912
  ds_write_b128 v21, a[156:159] offset:39936
  s_waitcnt lgkmcnt(0)
  s_barrier
  ds_read_b64_tr_b16 a[16:17], v29 offset:32768
  ds_read_b64_tr_b16 a[18:19], v29 offset:34816
  ds_read_b64_tr_b16 a[20:21], v29 offset:40960
  ds_read_b64_tr_b16 a[22:23], v29 offset:43008
  ds_read_b64_tr_b16 a[24:25], v29 offset:49152
  ds_read_b64_tr_b16 a[26:27], v29 offset:51200
  ds_read_b64_tr_b16 a[28:29], v29 offset:57344
  ds_read_b64_tr_b16 a[30:31], v29 offset:59392
  ds_read_b64_tr_b16 a[144:145], v30 offset:32768
  ds_read_b64_tr_b16 a[146:147], v30 offset:34816
  ds_read_b64_tr_b16 a[148:149], v30 offset:40960
  ds_read_b64_tr_b16 a[150:151], v30 offset:43008
  ds_read_b64_tr_b16 a[152:153], v30 offset:49152
  ds_read_b64_tr_b16 a[154:155], v30 offset:51200
  ds_read_b64_tr_b16 a[156:157], v30 offset:57344
  ds_read_b64_tr_b16 a[158:159], v30 offset:59392
  s_waitcnt lgkmcnt(0)
  s_waitcnt vmcnt(40)
  ds_write_b128 v21, a[32:35] offset:0
  ds_write_b128 v21, a[36:39] offset:1024
  ds_write_b128 v21, a[40:43] offset:2048
  ds_write_b128 v21, a[44:47] offset:3072
  ds_write_b128 v21, a[160:163] offset:4096
  ds_write_b128 v21, a[164:167] offset:5120
  ds_write_b128 v21, a[168:171] offset:6144
  ds_write_b128 v21, a[172:175] offset:7168
  s_waitcnt lgkmcnt(0)
  s_barrier
  ds_read_b64_tr_b16 a[32:33], v29 offset:0
  ds_read_b64_tr_b16 a[34:35], v29 offset:2048
  ds_read_b64_tr_b16 a[36:37], v29 offset:8192
  ds_read_b64_tr_b16 a[38:39], v29 offset:10240
  ds_read_b64_tr_b16 a[40:41], v29 offset:16384
  ds_read_b64_tr_b16 a[42:43], v29 offset:18432
  ds_read_b64_tr_b16 a[44:45], v29 offset:24576
  ds_read_b64_tr_b16 a[46:47], v29 offset:26624
  ds_read_b64_tr_b16 a[160:161], v30 offset:0
  ds_read_b64_tr_b16 a[162:163], v30 offset:2048
  ds_read_b64_tr_b16 a[164:165], v30 offset:8192
  ds_read_b64_tr_b16 a[166:167], v30 offset:10240
  ds_read_b64_tr_b16 a[168:169], v30 offset:16384
  ds_read_b64_tr_b16 a[170:171], v30 offset:18432
  ds_read_b64_tr_b16 a[172:173], v30 offset:24576
  ds_read_b64_tr_b16 a[174:175], v30 offset:26624
  s_waitcnt lgkmcnt(0)
  s_waitcnt vmcnt(32)
  ds_write_b128 v21, a[48:51] offset:32768
  ds_write_b128 v21, a[52:55] offset:33792
  ds_write_b128 v21, a[56:59] offset:34816
  ds_write_b128 v21, a[60:63] offset:35840
  ds_write_b128 v21, a[176:179] offset:36864
  ds_write_b128 v21, a[180:183] offset:37888
  ds_write_b128 v21, a[184:187] offset:38912
  ds_write_b128 v21, a[188:191] offset:39936
  s_waitcnt lgkmcnt(0)
  s_barrier
  ds_read_b64_tr_b16 a[48:49], v29 offset:32768
  ds_read_b64_tr_b16 a[50:51], v29 offset:34816
  ds_read_b64_tr_b16 a[52:53], v29 offset:40960
  ds_read_b64_tr_b16 a[54:55], v29 offset:43008
  ds_read_b64_tr_b16 a[56:57], v29 offset:49152
  ds_read_b64_tr_b16 a[58:59], v29 offset:51200
  ds_read_b64_tr_b16 a[60:61], v29 offset:57344
  ds_read_b64_tr_b16 a[62:63], v29 offset:59392
  ds_read_b64_tr_b16 a[176:177], v30 offset:32768
  ds_read_b64_tr_b16 a[178:179], v30 offset:34816
  ds_read_b64_tr_b16 a[180:181], v30 offset:40960
  ds_read_b64_tr_b16 a[182:183], v30 offset:43008
  ds_read_b64_tr_b16 a[184:185], v30 offset:49152
  ds_read_b64_tr_b16 a[186:187], v30 offset:51200
  ds_read_b64_tr_b16 a[188:189], v30 offset:57344
  ds_read_b64_tr_b16 a[190:191], v30 offset:59392
  s_waitcnt lgkmcnt(0)
  s_waitcnt vmcnt(24)
  ds_write_b128 v21, a[64:67] offset:0
  ds_write_b128 v21, a[68:71] offset:1024
  ds_write_b128 v21, a[72:75] offset:2048
  ds_write_b128 v21, a[76:79] offset:3072
  ds_write_b128 v21, a[192:195] offset:4096
  ds_write_b128 v21, a[196:199] offset:5120
  ds_write_b128 v21, a[200:203] offset:6144
  ds_write_b128 v21, a[204:207] offset:7168
  s_waitcnt lgkmcnt(0)
  s_barrier
  ds_read_b64_tr_b16 a[64:65], v29 offset:0
  ds_read_b64_tr_b16 a[66:67], v29 offset:2048
  ds_read_b64_tr_b16 a[68:69], v29 offset:8192
  ds_read_b64_tr_b16 a[70:71], v29 offset:10240
  ds_read_b64_tr_b16 a[72:73], v29 offset:16384
  ds_read_b64_tr_b16 a[74:75], v29 offset:18432
  ds_read_b64_tr_b16 a[76:77], v29 offset:24576
  ds_read_b64_tr_b16 a[78:79], v29 offset:26624
  ds_read_b64_tr_b16 a[192:193], v30 offset:0
  ds_read_b64_tr_b16 a[194:195], v30 offset:2048
  ds_read_b64_tr_b16 a[196:197], v30 offset:8192
  ds_read_b64_tr_b16 a[198:199], v30 offset:10240
  ds_read_b64_tr_b16 a[200:201], v30 offset:16384
  ds_read_b64_tr_b16 a[202:203], v30 offset:18432
  ds_read_b64_tr_b16 a[204:205], v30 offset:24576
  ds_read_b64_tr_b16 a[206:207], v30 offset:26624
  s_waitcnt lgkmcnt(0)
  s_waitcnt vmcnt(16)
  ds_write_b128 v21, a[80:83] offset:32768
  ds_write_b128 v21, a[84:87] offset:33792
  ds_write_b128 v21, a[88:91] offset:34816
  ds_write_b128 v21, a[92:95] offset:35840
  ds_write_b128 v21, a[208:211] offset:36864
  ds_write_b128 v21, a[212:215] offset:37888
  ds_write_b128 v21, a[216:219] offset:38912
  ds_write_b128 v21, a[220:223] offset:39936
  s_waitcnt lgkmcnt(0)
  s_barrier
  ds_read_b64_tr_b16 a[80:81], v29 offset:32768
  ds_read_b64_tr_b16 a[82:83], v29 offset:34816
  ds_read_b64_tr_b16 a[84:85], v29 offset:40960
  ds_read_b64_tr_b16 a[86:87], v29 offset:43008
  ds_read_b64_tr_b16 a[88:89], v29 offset:49152
  ds_read_b64_tr_b16 a[90:91], v29 offset:51200
  ds_read_b64_tr_b16 a[92:93], v29 offset:57344
  ds_read_b64_tr_b16 a[94:95], v29 offset:59392
  ds_read_b64_tr_b16 a[208:209], v30 offset:32768
  ds_read_b64_tr_b16 a[210:211], v30 offset:34816
  ds_read_b64_tr_b16 a[212:213], v30 offset:40960
  ds_read_b64_tr_b16 a[214:215], v30 offset:43008
  ds_read_b64_tr_b16 a[216:217], v30 offset:49152
  ds_read_b64_tr_b16 a[218:219], v30 offset:51200
  ds_read_b64_tr_b16 a[220:221], v30 offset:57344
  ds_read_b64_tr_b16 a[222:223], v30 offset:59392
  s_waitcnt lgkmcnt(0)
  s_waitcnt vmcnt(8)
  ds_write_b128 v21, a[96:99] offset:0
  ds_write_b128 v21, a[100:103] offset:1024
  ds_write_b128 v21, a[104:107] offset:2048
  ds_write_b128 v21, a[108:111] offset:3072
  ds_write_b128 v21, a[224:227] offset:4096
  ds_write_b128 v21, a[228:231] offset:5120
  ds_write_b128 v21, a[232:235] offset:6144
  ds_write_b128 v21, a[236:239] offset:7168
  s_waitcnt lgkmcnt(0)
  s_barrier
  ds_read_b64_tr_b16 a[96:97], v29 offset:0
  ds_read_b64_tr_b16 a[98:99], v29 offset:2048
  ds_read_b64_tr_b16 a[100:101], v29 offset:8192
  ds_read_b64_tr_b16 a[102:103], v29 offset:10240
  ds_read_b64_tr_b16 a[104:105], v29 offset:16384
  ds_read_b64_tr_b16 a[106:107], v29 offset:18432
  ds_read_b64_tr_b16 a[108:109], v29 offset:24576
  ds_read_b64_tr_b16 a[110:111], v29 offset:26624
  ds_read_b64_tr_b16 a[224:225], v30 offset:0
  ds_read_b64_tr_b16 a[226:227], v30 offset:2048
  ds_read_b64_tr_b16 a[228:229], v30 offset:8192
  ds_read_b64_tr_b16 a[230:231], v30 offset:10240
  ds_read_b64_tr_b16 a[232:233], v30 offset:16384
  ds_read_b64_tr_b16 a[234:235], v30 offset:18432
  ds_read_b64_tr_b16 a[236:237], v30 offset:24576
  ds_read_b64_tr_b16 a[238:239], v30 offset:26624
  s_waitcnt lgkmcnt(0)
  s_waitcnt vmcnt(0)
  ds_write_b128 v21, a[112:115] offset:32768
  ds_write_b128 v21, a[116:119] offset:33792
  ds_write_b128 v21, a[120:123] offset:34816
  ds_write_b128 v21, a[124:127] offset:35840
  ds_write_b128 v21, a[240:243] offset:36864
  ds_write_b128 v21, a[244:247] offset:37888
  ds_write_b128 v21, a[248:251] offset:38912
  ds_write_b128 v21, a[252:255] offset:39936
  s_waitcnt lgkmcnt(0)
  s_barrier
  ds_read_b64_tr_b16 a[112:113], v29 offset:32768
  ds_read_b64_tr_b16 a[114:115], v29 offset:34816
  ds_read_b64_tr_b16 a[116:117], v29 offset:40960
  ds_read_b64_tr_b16 a[118:119], v29 offset:43008
  ds_read_b64_tr_b16 a[120:121], v29 offset:49152
  ds_read_b64_tr_b16 a[122:123], v29 offset:51200
  ds_read_b64_tr_b16 a[124:125], v29 offset:57344
  ds_read_b64_tr_b16 a[126:127], v29 offset:59392
  ds_read_b64_tr_b16 a[240:241], v30 offset:32768
  ds_read_b64_tr_b16 a[242:243], v30 offset:34816
  ds_read_b64_tr_b16 a[244:245], v30 offset:40960
  ds_read_b64_tr_b16 a[246:247], v30 offset:43008
  ds_read_b64_tr_b16 a[248:249], v30 offset:49152
  ds_read_b64_tr_b16 a[250:251], v30 offset:51200
  ds_read_b64_tr_b16 a[252:253], v30 offset:57344
  ds_read_b64_tr_b16 a[254:255], v30 offset:59392
  s_waitcnt lgkmcnt(0)
  s_barrier
  s_cmp_lg_u32 s8, 0
  s_cbranch_scc1 L_wfiok_79
  v_mov_b32 v254, 16
  s_mov_b32 s49, 0
L_wfi_78:
  global_load_dword v255, v254, s[6:7] sc1
  s_add_u32 s49, s49, 1
  s_cmp_gt_u32 s49, 0x20000
  s_cbranch_scc1 L_wfiok_79
  s_waitcnt vmcnt(0)
  v_cmp_gt_u32 vcc, 256, v255
  s_nop 0
  s_cbranch_vccz L_wfiok_79
  s_sleep 8
  s_branch L_wfi_78
L_wfiok_79:
  s_barrier
  v_and_b32 v12, 31, v0
  v_lshrrev_b32 v13, 5, v0
  v_and_b32 v14, 15, v0
  v_add_u32 v15, 0, v13
  v_xor_b32 v15, v15, v14
  v_lshlrev_b32 v15, 4, v15
  v_lshl_add_u32 v2, v12, 10, v15
  v_add_u32 v15, 2, v13
  v_xor_b32 v15, v15, v14
  v_lshlrev_b32 v15, 4, v15
  v_lshl_add_u32 v3, v12, 10, v15
  v_add_u32 v15, 4, v13
  v_xor_b32 v15, v15, v14
  v_lshlrev_b32 v15, 4, v15
  v_lshl_add_u32 v4, v12, 10, v15
  v_add_u32 v15, 6, v13
  v_xor_b32 v15, v15, v14
  v_lshlrev_b32 v15, 4, v15
  v_lshl_add_u32 v5, v12, 10, v15
  v_add_u32 v15, 8, v13
  v_xor_b32 v15, v15, v14
  v_lshlrev_b32 v15, 4, v15
  v_lshl_add_u32 v6, v12, 10, v15
  v_add_u32 v15, 10, v13
  v_xor_b32 v15, v15, v14
  v_lshlrev_b32 v15, 4, v15
  v_lshl_add_u32 v7, v12, 10, v15
  v_add_u32 v15, 12, v13
  v_xor_b32 v15, v15, v14
  v_lshlrev_b32 v15, 4, v15
  v_lshl_add_u32 v8, v12, 10, v15
  v_add_u32 v15, 14, v13
  v_xor_b32 v15, v15, v14
  v_lshlrev_b32 v15, 4, v15
  v_lshl_add_u32 v9, v12, 10, v15
  s_and_b32 s12, s8, 1
  s_lshl_b32 s12, s12, 7
  v_xor_b32 v10, s12, v1
  v_bfe_u32 v12, v0, 4, 1
  v_lshrrev_b32 v13, 5, v0
  v_and_b32 v14, 15, v0
  v_lshl_add_u32 v13, v13, 4, v14
  v_lshlrev_b32 v13, 4, v13
  v_lshl_add_u32 v116, v12, 10, v13
  s_mov_b32 s34, 0
  s_lshl_b32 s12, s30, 15
  s_add_u32 s26, s60, s12
  s_addc_u32 s27, s61, 0
  s_lshl_b32 s12, s8, 13
  s_add_u32 s16, s26, s12
  s_addc_u32 s17, s27, 0
  s_add_u32 s12, s12, s34
  v_xor_b32 v11, 0, v10
  s_add_u32 m0, s12, 0
  s_nop 0
  global_load_lds_dwordx4 v11, s[16:17]
  s_add_u32 s16, s16, 1024
  s_addc_u32 s17, s17, 0
  v_xor_b32 v11, 16, v10
  s_add_u32 m0, s12, 1024
  s_nop 0
  global_load_lds_dwordx4 v11, s[16:17]
  s_add_u32 s16, s16, 1024
  s_addc_u32 s17, s17, 0
  v_xor_b32 v11, 32, v10
  s_add_u32 m0, s12, 2048
  s_nop 0
  global_load_lds_dwordx4 v11, s[16:17]
  s_add_u32 s16, s16, 1024
  s_addc_u32 s17, s17, 0
  v_xor_b32 v11, 48, v10
  s_add_u32 m0, s12, 3072
  s_nop 0
  global_load_lds_dwordx4 v11, s[16:17]
  s_add_u32 s16, s16, 1024
  s_addc_u32 s17, s17, 0
  v_xor_b32 v11, 64, v10
  s_add_u32 m0, s12, 4096
  s_nop 0
  global_load_lds_dwordx4 v11, s[16:17]
  s_add_u32 s16, s16, 1024
  s_addc_u32 s17, s17, 0
  v_xor_b32 v11, 80, v10
  s_add_u32 m0, s12, 5120
  s_nop 0
  global_load_lds_dwordx4 v11, s[16:17]
  s_add_u32 s16, s16, 1024
  s_addc_u32 s17, s17, 0
  v_xor_b32 v11, 96, v10
  s_add_u32 m0, s12, 6144
  s_nop 0
  global_load_lds_dwordx4 v11, s[16:17]
  s_add_u32 s16, s16, 1024
  s_addc_u32 s17, s17, 0
  v_xor_b32 v11, 112, v10
  s_add_u32 m0, s12, 7168
  s_nop 0
  global_load_lds_dwordx4 v11, s[16:17]
  s_mov_b32 s52, -1
  s_mov_b32 s53, -1
  s_waitcnt vmcnt(0)
L_seg_80:
  s_waitcnt vmcnt(4)
  s_barrier
  s_cmp_eq_u32 s52, -1
  s_cbranch_scc1 L_nf_81
  s_cmp_lg_u32 s8, 0
  s_cbranch_scc1 L_fs_82
  s_lshl_b32 s48, s52, 14
  s_lshl_b32 s49, s36, 7
  s_add_u32 s48, s48, s49
  s_add_u32 s48, s48, 0
  v_mov_b32 v254, s48
  v_mov_b32 v255, 1
  s_mov_b64 exec, 1
  global_store_dword v254, v255, s[46:47] sc1
  s_mov_b64 exec, -1
L_fs_82:
L_nf_81:
  s_mov_b32 s52, s53
  s_mov_b32 s53, s30
  s_lshl_b32 s12, s30, 18
  s_add_u32 s12, s12, s37
  s_add_u32 s12, s12, 16777216
  s_add_u32 s28, s4, s12
  s_addc_u32 s29, s5, 0
  s_add_u32 s30, s30, s33
  s_sub_u32 s35, s35, 1
  s_xor_b32 s34, s34, 32768
  s_cmp_eq_u32 s35, 0
  s_cbranch_scc1 L_nonext_83
  s_lshl_b32 s12, s30, 15
  s_add_u32 s26, s60, s12
  s_addc_u32 s27, s61, 0
  s_lshl_b32 s12, s8, 13
  s_add_u32 s16, s26, s12
  s_addc_u32 s17, s27, 0
  s_add_u32 s12, s12, s34
  v_xor_b32 v11, 0, v10
  s_add_u32 m0, s12, 0
  s_nop 0
  global_load_lds_dwordx4 v11, s[16:17]
  s_add_u32 s16, s16, 1024
  s_addc_u32 s17, s17, 0
  v_xor_b32 v11, 16, v10
  s_add_u32 m0, s12, 1024
  s_nop 0
  global_load_lds_dwordx4 v11, s[16:17]
  s_add_u32 s16, s16, 1024
  s_addc_u32 s17, s17, 0
  v_xor_b32 v11, 32, v10
  s_add_u32 m0, s12, 2048
  s_nop 0
  global_load_lds_dwordx4 v11, s[16:17]
  s_add_u32 s16, s16, 1024
  s_addc_u32 s17, s17, 0
  v_xor_b32 v11, 48, v10
  s_add_u32 m0, s12, 3072
  s_nop 0
  global_load_lds_dwordx4 v11, s[16:17]
  s_add_u32 s16, s16, 1024
  s_addc_u32 s17, s17, 0
  v_xor_b32 v11, 64, v10
  s_add_u32 m0, s12, 4096
  s_nop 0
  global_load_lds_dwordx4 v11, s[16:17]
  s_add_u32 s16, s16, 1024
  s_addc_u32 s17, s17, 0
  v_xor_b32 v11, 80, v10
  s_add_u32 m0, s12, 5120
  s_nop 0
  global_load_lds_dwordx4 v11, s[16:17]
  s_add_u32 s16, s16, 1024
  s_addc_u32 s17, s17, 0
  v_xor_b32 v11, 96, v10
  s_add_u32 m0, s12, 6144
  s_nop 0
  global_load_lds_dwordx4 v11, s[16:17]
  s_add_u32 s16, s16, 1024
  s_addc_u32 s17, s17, 0
  v_xor_b32 v11, 112, v10
  s_add_u32 m0, s12, 7168
  s_nop 0
  global_load_lds_dwordx4 v11, s[16:17]
L_nonext_83:
  ds_read_b128 v[32:35], v2 offset:0
  ds_read_b128 v[36:39], v3 offset:0
  ds_read_b128 v[40:43], v4 offset:0
  ds_read_b128 v[44:47], v5 offset:0
  ds_read_b128 v[48:51], v6 offset:0
  ds_read_b128 v[52:55], v7 offset:0
  s_waitcnt lgkmcnt(5)
  v_mfma_f32_32x32x16_bf16 v[64:79], v[32:35], a[0:3], 0
  ds_read_b128 v[56:59], v8 offset:0
  v_mfma_f32_32x32x16_bf16 v[80:95], v[32:35], a[128:131], 0
  s_waitcnt lgkmcnt(5)
  v_mfma_f32_32x32x16_bf16 v[64:79], v[36:39], a[4:7], v[64:79]
  ds_read_b128 v[60:63], v9 offset:0
  v_mfma_f32_32x32x16_bf16 v[80:95], v[36:39], a[132:135], v[80:95]
  s_waitcnt lgkmcnt(5)
  v_mfma_f32_32x32x16_bf16 v[64:79], v[40:43], a[8:11], v[64:79]
  ds_read_b128 v[32:35], v2 offset:256
  v_mfma_f32_32x32x16_bf16 v[80:95], v[40:43], a[136:139], v[80:95]
  s_waitcnt lgkmcnt(5)
  v_mfma_f32_32x32x16_bf16 v[64:79], v[44:47], a[12:15], v[64:79]
  ds_read_b128 v[36:39], v3 offset:256
  v_mfma_f32_32x32x16_bf16 v[80:95], v[44:47], a[140:143], v[80:95]
  s_waitcnt lgkmcnt(5)
  v_mfma_f32_32x32x16_bf16 v[64:79], v[48:51], a[16:19], v[64:79]
  ds_read_b128 v[40:43], v4 offset:256
  v_mfma_f32_32x32x16_bf16 v[80:95], v[48:51], a[144:147], v[80:95]
  s_waitcnt lgkmcnt(5)
  v_mfma_f32_32x32x16_bf16 v[64:79], v[52:55], a[20:23], v[64:79]
  ds_read_b128 v[44:47], v5 offset:256
  v_mfma_f32_32x32x16_bf16 v[80:95], v[52:55], a[148:151], v[80:95]
  s_waitcnt lgkmcnt(5)
  v_mfma_f32_32x32x16_bf16 v[64:79], v[56:59], a[24:27], v[64:79]
  ds_read_b128 v[48:51], v6 offset:256
  v_mfma_f32_32x32x16_bf16 v[80:95], v[56:59], a[152:155], v[80:95]
  s_waitcnt lgkmcnt(5)
  v_mfma_f32_32x32x16_bf16 v[64:79], v[60:63], a[28:31], v[64:79]
  ds_read_b128 v[52:55], v7 offset:256
  v_mfma_f32_32x32x16_bf16 v[80:95], v[60:63], a[156:159], v[80:95]
  s_waitcnt lgkmcnt(5)
  v_mfma_f32_32x32x16_bf16 v[64:79], v[32:35], a[32:35], v[64:79]
  ds_read_b128 v[56:59], v8 offset:256
  v_mfma_f32_32x32x16_bf16 v[80:95], v[32:35], a[160:163], v[80:95]
  s_waitcnt lgkmcnt(5)
  v_mfma_f32_32x32x16_bf16 v[64:79], v[36:39], a[36:39], v[64:79]
  ds_read_b128 v[60:63], v9 offset:256
  v_mfma_f32_32x32x16_bf16 v[80:95], v[36:39], a[164:167], v[80:95]
  s_waitcnt lgkmcnt(5)
  v_mfma_f32_32x32x16_bf16 v[64:79], v[40:43], a[40:43], v[64:79]
  ds_read_b128 v[32:35], v2 offset:512
  v_mfma_f32_32x32x16_bf16 v[80:95], v[40:43], a[168:171], v[80:95]
  s_waitcnt lgkmcnt(5)
  v_mfma_f32_32x32x16_bf16 v[64:79], v[44:47], a[44:47], v[64:79]
  ds_read_b128 v[36:39], v3 offset:512
  v_mfma_f32_32x32x16_bf16 v[80:95], v[44:47], a[172:175], v[80:95]
  s_waitcnt lgkmcnt(5)
  v_mfma_f32_32x32x16_bf16 v[64:79], v[48:51], a[48:51], v[64:79]
  ds_read_b128 v[40:43], v4 offset:512
  v_mfma_f32_32x32x16_bf16 v[80:95], v[48:51], a[176:179], v[80:95]
  s_waitcnt lgkmcnt(5)
  v_mfma_f32_32x32x16_bf16 v[64:79], v[52:55], a[52:55], v[64:79]
  ds_read_b128 v[44:47], v5 offset:512
  v_mfma_f32_32x32x16_bf16 v[80:95], v[52:55], a[180:183], v[80:95]
  s_waitcnt lgkmcnt(5)
  v_mfma_f32_32x32x16_bf16 v[64:79], v[56:59], a[56:59], v[64:79]
  ds_read_b128 v[48:51], v6 offset:512
  v_mfma_f32_32x32x16_bf16 v[80:95], v[56:59], a[184:187], v[80:95]
  s_waitcnt lgkmcnt(5)
  v_mfma_f32_32x32x16_bf16 v[64:79], v[60:63], a[60:63], v[64:79]
  ds_read_b128 v[52:55], v7 offset:512
  v_mfma_f32_32x32x16_bf16 v[80:95], v[60:63], a[188:191], v[80:95]
  s_waitcnt lgkmcnt(5)
  v_mfma_f32_32x32x16_bf16 v[64:79], v[32:35], a[64:67], v[64:79]
  ds_read_b128 v[56:59], v8 offset:512
  v_mfma_f32_32x32x16_bf16 v[80:95], v[32:35], a[192:195], v[80:95]
  s_waitcnt lgkmcnt(5)
  v_mfma_f32_32x32x16_bf16 v[64:79], v[36:39], a[68:71], v[64:79]
  ds_read_b128 v[60:63], v9 offset:512
  v_mfma_f32_32x32x16_bf16 v[80:95], v[36:39], a[196:199], v[80:95]
  s_waitcnt lgkmcnt(5)
  v_mfma_f32_32x32x16_bf16 v[64:79], v[40:43], a[72:75], v[64:79]
  ds_read_b128 v[32:35], v2 offset:768
  v_mfma_f32_32x32x16_bf16 v[80:95], v[40:43], a[200:203], v[80:95]
  s_waitcnt lgkmcnt(5)
  v_mfma_f32_32x32x16_bf16 v[64:79], v[44:47], a[76:79], v[64:79]
  ds_read_b128 v[36:39], v3 offset:768
  v_mfma_f32_32x32x16_bf16 v[80:95], v[44:47], a[204:207], v[80:95]
  s_waitcnt lgkmcnt(5)
  v_mfma_f32_32x32x16_bf16 v[64:79], v[48:51], a[80:83], v[64:79]
  ds_read_b128 v[40:43], v4 offset:768
  v_mfma_f32_32x32x16_bf16 v[80:95], v[48:51], a[208:211], v[80:95]
  s_waitcnt lgkmcnt(5)
  v_mfma_f32_32x32x16_bf16 v[64:79], v[52:55], a[84:87], v[64:79]
  ds_read_b128 v[44:47], v5 offset:768
  v_mfma_f32_32x32x16_bf16 v[80:95], v[52:55], a[212:215], v[80:95]
  s_waitcnt lgkmcnt(5)
  v_mfma_f32_32x32x16_bf16 v[64:79], v[56:59], a[88:91], v[64:79]
  ds_read_b128 v[48:51], v6 offset:768
  v_mfma_f32_32x32x16_bf16 v[80:95], v[56:59], a[216:219], v[80:95]
  s_waitcnt lgkmcnt(5)
  v_mfma_f32_32x32x16_bf16 v[64:79], v[60:63], a[92:95], v[64:79]
  ds_read_b128 v[52:55], v7 offset:768
  v_mfma_f32_32x32x16_bf16 v[80:95], v[60:63], a[220:223], v[80:95]
  s_waitcnt lgkmcnt(5)
  v_mfma_f32_32x32x16_bf16 v[64:79], v[32:35], a[96:99], v[64:79]
  ds_read_b128 v[56:59], v8 offset:768
  v_mfma_f32_32x32x16_bf16 v[80:95], v[32:35], a[224:227], v[80:95]
  s_waitcnt lgkmcnt(5)
  v_mfma_f32_32x32x16_bf16 v[64:79], v[36:39], a[100:103], v[64:79]
  ds_read_b128 v[60:63], v9 offset:768
  v_mfma_f32_32x32x16_bf16 v[80:95], v[36:39], a[228:231], v[80:95]
  s_waitcnt lgkmcnt(5)
  v_mfma_f32_32x32x16_bf16 v[64:79], v[40:43], a[104:107], v[64:79]
  v_mfma_f32_32x32x16_bf16 v[80:95], v[40:43], a[232:235], v[80:95]
  s_waitcnt lgkmcnt(4)
  v_mfma_f32_32x32x16_bf16 v[64:79], v[44:47], a[108:111], v[64:79]
  v_mfma_f32_32x32x16_bf16 v[80:95], v[44:47], a[236:239], v[80:95]
  s_waitcnt lgkmcnt(3)
  v_mfma_f32_32x32x16_bf16 v[64:79], v[48:51], a[112:115], v[64:79]
  v_mfma_f32_32x32x16_bf16 v[80:95], v[48:51], a[240:243], v[80:95]
  s_waitcnt lgkmcnt(2)
  v_mfma_f32_32x32x16_bf16 v[64:79], v[52:55], a[116:119], v[64:79]
  v_mfma_f32_32x32x16_bf16 v[80:95], v[52:55], a[244:247], v[80:95]
  s_waitcnt lgkmcnt(1)
  v_mfma_f32_32x32x16_bf16 v[64:79], v[56:59], a[120:123], v[64:79]
  v_mfma_f32_32x32x16_bf16 v[80:95], v[56:59], a[248:251], v[80:95]
  s_waitcnt lgkmcnt(0)
  v_mfma_f32_32x32x16_bf16 v[64:79], v[60:63], a[124:127], v[64:79]
  v_mfma_f32_32x32x16_bf16 v[80:95], v[60:63], a[252:255], v[80:95]
  v_xor_b32 v2, 32768, v2
  v_xor_b32 v3, 32768, v3
  v_xor_b32 v4, 32768, v4
  v_xor_b32 v5, 32768, v5
  v_xor_b32 v6, 32768, v6
  v_xor_b32 v7, 32768, v7
  v_xor_b32 v8, 32768, v8
  v_xor_b32 v9, 32768, v9
  v_cvt_pk_bf16_f32 v96, v64, v65
  v_cvt_pk_bf16_f32 v97, v66, v67
  v_cvt_pk_bf16_f32 v98, v72, v73
  v_cvt_pk_bf16_f32 v99, v74, v75
  global_store_dwordx4 v116, v[96:99], s[28:29] offset:0 sc1
  v_cvt_pk_bf16_f32 v100, v68, v69
  v_cvt_pk_bf16_f32 v101, v70, v71
  v_cvt_pk_bf16_f32 v102, v76, v77
  v_cvt_pk_bf16_f32 v103, v78, v79
  global_store_dwordx4 v116, v[100:103], s[28:29] offset:512 sc1
  v_cvt_pk_bf16_f32 v104, v80, v81
  v_cvt_pk_bf16_f32 v105, v82, v83
  v_cvt_pk_bf16_f32 v106, v88, v89
  v_cvt_pk_bf16_f32 v107, v90, v91
  global_store_dwordx4 v116, v[104:107], s[28:29] offset:2048 sc1
  v_cvt_pk_bf16_f32 v108, v84, v85
  v_cvt_pk_bf16_f32 v109, v86, v87
  v_cvt_pk_bf16_f32 v110, v92, v93
  v_cvt_pk_bf16_f32 v111, v94, v95
  global_store_dwordx4 v116, v[108:111], s[28:29] offset:2560 sc1
  s_cmp_eq_u32 s52, -1
  s_cbranch_scc0 L_nfirst_84
  s_cmp_lt_u32 s53, 3
  s_cbranch_scc0 L_nfirst_84
  s_waitcnt vmcnt(0)
  s_barrier
  s_cmp_lg_u32 s8, 0
  s_cbranch_scc1 L_fs_85
  s_lshl_b32 s48, s53, 14
  s_lshl_b32 s49, s36, 7
  s_add_u32 s48, s48, s49
  s_add_u32 s48, s48, 0
  v_mov_b32 v254, s48
  v_mov_b32 v255, 1
  s_mov_b64 exec, 1
  global_store_dword v254, v255, s[46:47] sc1
  s_mov_b64 exec, -1
L_fs_85:
L_nfirst_84:
  s_cmp_lg_u32 s35, 0
  s_cbranch_scc1 L_seg_80
  s_waitcnt vmcnt(0)
  s_barrier
  s_cmp_eq_u32 s52, -1
  s_cbranch_scc1 L_nf_86
  s_cmp_lg_u32 s8, 0
  s_cbranch_scc1 L_fs_87
  s_lshl_b32 s48, s52, 14
  s_lshl_b32 s49, s36, 7
  s_add_u32 s48, s48, s49
  s_add_u32 s48, s48, 0
  v_mov_b32 v254, s48
  v_mov_b32 v255, 1
  s_mov_b64 exec, 1
  global_store_dword v254, v255, s[46:47] sc1
  s_mov_b64 exec, -1
L_fs_87:
L_nf_86:
  s_cmp_lg_u32 s8, 0
  s_cbranch_scc1 L_fs_88
  s_lshl_b32 s48, s53, 14
  s_lshl_b32 s49, s36, 7
  s_add_u32 s48, s48, s49
  s_add_u32 s48, s48, 0
  v_mov_b32 v254, s48
  v_mov_b32 v255, 1
  s_mov_b64 exec, 1
  global_store_dword v254, v255, s[46:47] sc1
  s_mov_b64 exec, -1
L_fs_88:
  s_branch L_pdone_62
L_pq_65:
  s_sub_u32 s18, s36, 32
  s_lshl_b32 s12, s18, 9
  s_add_u32 s20, s62, s12
  s_addc_u32 s21, s63, 0
  s_mov_b32 s24, 8192
  s_lshr_b32 s12, s8, 1
  s_lshl_b32 s13, s18, 1
  s_add_u32 s12, s12, s13
  s_lshl_b32 s37, s12, 13
  s_and_b32 s12, s8, 1
  s_lshl_b32 s12, s12, 11
  s_add_u32 s37, s37, s12
  v_lshrrev_b32 v12, 5, v0
  v_and_b32 v13, 31, v0
  v_add_u32 v14, 0, v12
  v_lshlrev_b32 v14, 2, v14
  v_xor_b32 v14, v14, v13
  v_lshlrev_b32 v15, 4, v14
  v_mov_b32 v17, s21
  v_add_co_u32 v16, vcc, s20, v15
  s_nop 1
  v_addc_co_u32 v17, vcc, 0, v17, vcc
  s_lshl_b32 s12, s8, 4
  s_add_u32 s12, s12, 0
  v_add_u32 v15, s12, v12
  v_mul_lo_u32 v15, v15, s24
  v_add_co_u32 v16, vcc, v16, v15
  s_nop 1
  v_addc_co_u32 v17, vcc, 0, v17, vcc
  v_add_u32 v14, 2, v12
  v_lshlrev_b32 v14, 2, v14
  v_xor_b32 v14, v14, v13
  v_lshlrev_b32 v15, 4, v14
  v_mov_b32 v19, s21
  v_add_co_u32 v18, vcc, s20, v15
  s_nop 1
  v_addc_co_u32 v19, vcc, 0, v19, vcc
  s_lshl_b32 s12, s8, 4
  s_add_u32 s12, s12, 2
  v_add_u32 v15, s12, v12
  v_mul_lo_u32 v15, v15, s24
  v_add_co_u32 v18, vcc, v18, v15
  s_nop 1
  v_addc_co_u32 v19, vcc, 0, v19, vcc
  s_lshl_b32 s14, s24, 2
  s_mul_i32 s15, s24, 48
  s_lshl_b32 s13, s8, 13
  v_bfe_u32 v22, v0, 2, 2
  v_and_b32 v23, 3, v0
  v_and_b32 v24, 1, v23
  v_lshlrev_b32 v24, 1, v24
  v_lshrrev_b32 v23, 1, v23
  v_or_b32 v23, v23, v24
  v_bfe_u32 v24, v0, 4, 1
  v_lshrrev_b32 v25, 5, v0
  v_lshrrev_b32 v26, 1, v23
  v_lshl_add_u32 v26, v24, 1, v26
  v_lshl_add_u32 v25, v25, 3, v22
  s_lshl_b32 s12, s8, 3
  s_add_u32 s12, s12, 0
  v_add_u32 v27, s12, v26
  v_lshlrev_b32 v28, 2, v22
  v_xor_b32 v27, v27, v28
  v_lshlrev_b32 v27, 4, v27
  v_lshl_add_u32 v27, v25, 9, v27
  v_and_b32 v28, 1, v23
  v_lshl_add_u32 v29, v28, 3, v27
  s_lshl_b32 s12, s8, 3
  s_add_u32 s12, s12, 4
  v_add_u32 v27, s12, v26
  v_lshlrev_b32 v28, 2, v22
  v_xor_b32 v27, v27, v28
  v_lshlrev_b32 v27, 4, v27
  v_lshl_add_u32 v27, v25, 9, v27
  v_and_b32 v28, 1, v23
  v_lshl_add_u32 v30, v28, 3, v27
  v_add_u32 v21, s13, v1
  global_load_dwordx4 a[0:3], v[16:17], off
  v_add_co_u32 v16, vcc, s14, v16
  s_nop 1
  v_addc_co_u32 v17, vcc, 0, v17, vcc
  global_load_dwordx4 a[4:7], v[18:19], off
  v_add_co_u32 v18, vcc, s14, v18
  s_nop 1
  v_addc_co_u32 v19, vcc, 0, v19, vcc
  global_load_dwordx4 a[8:11], v[16:17], off
  v_add_co_u32 v16, vcc, s14, v16
  s_nop 1
  v_addc_co_u32 v17, vcc, 0, v17, vcc
  global_load_dwordx4 a[12:15], v[18:19], off
  v_add_co_u32 v18, vcc, s14, v18
  s_nop 1
  v_addc_co_u32 v19, vcc, 0, v19, vcc
  global_load_dwordx4 a[128:131], v[16:17], off
  v_add_co_u32 v16, vcc, s14, v16
  s_nop 1
  v_addc_co_u32 v17, vcc, 0, v17, vcc
  global_load_dwordx4 a[132:135], v[18:19], off
  v_add_co_u32 v18, vcc, s14, v18
  s_nop 1
  v_addc_co_u32 v19, vcc, 0, v19, vcc
  global_load_dwordx4 a[136:139], v[16:17], off
  v_add_co_u32 v16, vcc, s14, v16
  s_nop 1
  v_addc_co_u32 v17, vcc, 0, v17, vcc
  global_load_dwordx4 a[140:143], v[18:19], off
  v_add_co_u32 v18, vcc, s14, v18
  s_nop 1
  v_addc_co_u32 v19, vcc, 0, v19, vcc
  v_add_co_u32 v16, vcc, s15, v16
  s_nop 1
  v_addc_co_u32 v17, vcc, 0, v17, vcc
  v_add_co_u32 v18, vcc, s15, v18
  s_nop 1
  v_addc_co_u32 v19, vcc, 0, v19, vcc
  global_load_dwordx4 a[16:19], v[16:17], off
  v_add_co_u32 v16, vcc, s14, v16
  s_nop 1
  v_addc_co_u32 v17, vcc, 0, v17, vcc
  global_load_dwordx4 a[20:23], v[18:19], off
  v_add_co_u32 v18, vcc, s14, v18
  s_nop 1
  v_addc_co_u32 v19, vcc, 0, v19, vcc
  global_load_dwordx4 a[24:27], v[16:17], off
  v_add_co_u32 v16, vcc, s14, v16
  s_nop 1
  v_addc_co_u32 v17, vcc, 0, v17, vcc
  global_load_dwordx4 a[28:31], v[18:19], off
  v_add_co_u32 v18, vcc, s14, v18
  s_nop 1
  v_addc_co_u32 v19, vcc, 0, v19, vcc
  global_load_dwordx4 a[144:147], v[16:17], off
  v_add_co_u32 v16, vcc, s14, v16
  s_nop 1
  v_addc_co_u32 v17, vcc, 0, v17, vcc
  global_load_dwordx4 a[148:151], v[18:19], off
  v_add_co_u32 v18, vcc, s14, v18
  s_nop 1
  v_addc_co_u32 v19, vcc, 0, v19, vcc
  global_load_dwordx4 a[152:155], v[16:17], off
  v_add_co_u32 v16, vcc, s14, v16
  s_nop 1
  v_addc_co_u32 v17, vcc, 0, v17, vcc
  global_load_dwordx4 a[156:159], v[18:19], off
  v_add_co_u32 v18, vcc, s14, v18
  s_nop 1
  v_addc_co_u32 v19, vcc, 0, v19, vcc
  v_add_co_u32 v16, vcc, s15, v16
  s_nop 1
  v_addc_co_u32 v17, vcc, 0, v17, vcc
  v_add_co_u32 v18, vcc, s15, v18
  s_nop 1
  v_addc_co_u32 v19, vcc, 0, v19, vcc
  global_load_dwordx4 a[32:35], v[16:17], off
  v_add_co_u32 v16, vcc, s14, v16
  s_nop 1
  v_addc_co_u32 v17, vcc, 0, v17, vcc
  global_load_dwordx4 a[36:39], v[18:19], off
  v_add_co_u32 v18, vcc, s14, v18
  s_nop 1
  v_addc_co_u32 v19, vcc, 0, v19, vcc
  global_load_dwordx4 a[40:43], v[16:17], off
  v_add_co_u32 v16, vcc, s14, v16
  s_nop 1
  v_addc_co_u32 v17, vcc, 0, v17, vcc
  global_load_dwordx4 a[44:47], v[18:19], off
  v_add_co_u32 v18, vcc, s14, v18
  s_nop 1
  v_addc_co_u32 v19, vcc, 0, v19, vcc
  global_load_dwordx4 a[160:163], v[16:17], off
  v_add_co_u32 v16, vcc, s14, v16
  s_nop 1
  v_addc_co_u32 v17, vcc, 0, v17, vcc
  global_load_dwordx4 a[164:167], v[18:19], off
  v_add_co_u32 v18, vcc, s14, v18
  s_nop 1
  v_addc_co_u32 v19, vcc, 0, v19, vcc
  global_load_dwordx4 a[168:171], v[16:17], off
  v_add_co_u32 v16, vcc, s14, v16
  s_nop 1
  v_addc_co_u32 v17, vcc, 0, v17, vcc
  global_load_dwordx4 a[172:175], v[18:19], off
  v_add_co_u32 v18, vcc, s14, v18
  s_nop 1
  v_addc_co_u32 v19, vcc, 0, v19, vcc
  v_add_co_u32 v16, vcc, s15, v16
  s_nop 1
  v_addc_co_u32 v17, vcc, 0, v17, vcc
  v_add_co_u32 v18, vcc, s15, v18
  s_nop 1
  v_addc_co_u32 v19, vcc, 0, v19, vcc
  global_load_dwordx4 a[48:51], v[16:17], off
  v_add_co_u32 v16, vcc, s14, v16
  s_nop 1
  v_addc_co_u32 v17, vcc, 0, v17, vcc
  global_load_dwordx4 a[52:55], v[18:19], off
  v_add_co_u32 v18, vcc, s14, v18
  s_nop 1
  v_addc_co_u32 v19, vcc, 0, v19, vcc
  global_load_dwordx4 a[56:59], v[16:17], off
  v_add_co_u32 v16, vcc, s14, v16
  s_nop 1
  v_addc_co_u32 v17, vcc, 0, v17, vcc
  global_load_dwordx4 a[60:63], v[18:19], off
  v_add_co_u32 v18, vcc, s14, v18
  s_nop 1
  v_addc_co_u32 v19, vcc, 0, v19, vcc
  global_load_dwordx4 a[176:179], v[16:17], off
  v_add_co_u32 v16, vcc, s14, v16
  s_nop 1
  v_addc_co_u32 v17, vcc, 0, v17, vcc
  global_load_dwordx4 a[180:183], v[18:19], off
  v_add_co_u32 v18, vcc, s14, v18
  s_nop 1
  v_addc_co_u32 v19, vcc, 0, v19, vcc
  global_load_dwordx4 a[184:187], v[16:17], off
  v_add_co_u32 v16, vcc, s14, v16
  s_nop 1
  v_addc_co_u32 v17, vcc, 0, v17, vcc
  global_load_dwordx4 a[188:191], v[18:19], off
  v_add_co_u32 v18, vcc, s14, v18
  s_nop 1
  v_addc_co_u32 v19, vcc, 0, v19, vcc
  v_add_co_u32 v16, vcc, s15, v16
  s_nop 1
  v_addc_co_u32 v17, vcc, 0, v17, vcc
  v_add_co_u32 v18, vcc, s15, v18
  s_nop 1
  v_addc_co_u32 v19, vcc, 0, v19, vcc
  global_load_dwordx4 a[64:67], v[16:17], off
  v_add_co_u32 v16, vcc, s14, v16
  s_nop 1
  v_addc_co_u32 v17, vcc, 0, v17, vcc
  global_load_dwordx4 a[68:71], v[18:19], off
  v_add_co_u32 v18, vcc, s14, v18
  s_nop 1
  v_addc_co_u32 v19, vcc, 0, v19, vcc
  global_load_dwordx4 a[72:75], v[16:17], off
  v_add_co_u32 v16, vcc, s14, v16
  s_nop 1
  v_addc_co_u32 v17, vcc, 0, v17, vcc
  global_load_dwordx4 a[76:79], v[18:19], off
  v_add_co_u32 v18, vcc, s14, v18
  s_nop 1
  v_addc_co_u32 v19, vcc, 0, v19, vcc
  global_load_dwordx4 a[192:195], v[16:17], off
  v_add_co_u32 v16, vcc, s14, v16
  s_nop 1
  v_addc_co_u32 v17, vcc, 0, v17, vcc
  global_load_dwordx4 a[196:199], v[18:19], off
  v_add_co_u32 v18, vcc, s14, v18
  s_nop 1
  v_addc_co_u32 v19, vcc, 0, v19, vcc
  global_load_dwordx4 a[200:203], v[16:17], off
  v_add_co_u32 v16, vcc, s14, v16
  s_nop 1
  v_addc_co_u32 v17, vcc, 0, v17, vcc
  global_load_dwordx4 a[204:207], v[18:19], off
  v_add_co_u32 v18, vcc, s14, v18
  s_nop 1
  v_addc_co_u32 v19, vcc, 0, v19, vcc
  v_add_co_u32 v16, vcc, s15, v16
  s_nop 1
  v_addc_co_u32 v17, vcc, 0, v17, vcc
  v_add_co_u32 v18, vcc, s15, v18
  s_nop 1
  v_addc_co_u32 v19, vcc, 0, v19, vcc
  global_load_dwordx4 a[80:83], v[16:17], off
  v_add_co_u32 v16, vcc, s14, v16
  s_nop 1
  v_addc_co_u32 v17, vcc, 0, v17, vcc
  global_load_dwordx4 a[84:87], v[18:19], off
  v_add_co_u32 v18, vcc, s14, v18
  s_nop 1
  v_addc_co_u32 v19, vcc, 0, v19, vcc
  global_load_dwordx4 a[88:91], v[16:17], off
  v_add_co_u32 v16, vcc, s14, v16
  s_nop 1
  v_addc_co_u32 v17, vcc, 0, v17, vcc
  global_load_dwordx4 a[92:95], v[18:19], off
  v_add_co_u32 v18, vcc, s14, v18
  s_nop 1
  v_addc_co_u32 v19, vcc, 0, v19, vcc
  global_load_dwordx4 a[208:211], v[16:17], off
  v_add_co_u32 v16, vcc, s14, v16
  s_nop 1
  v_addc_co_u32 v17, vcc, 0, v17, vcc
  global_load_dwordx4 a[212:215], v[18:19], off
  v_add_co_u32 v18, vcc, s14, v18
  s_nop 1
  v_addc_co_u32 v19, vcc, 0, v19, vcc
  global_load_dwordx4 a[216:219], v[16:17], off
  v_add_co_u32 v16, vcc, s14, v16
  s_nop 1
  v_addc_co_u32 v17, vcc, 0, v17, vcc
  global_load_dwordx4 a[220:223], v[18:19], off
  v_add_co_u32 v18, vcc, s14, v18
  s_nop 1
  v_addc_co_u32 v19, vcc, 0, v19, vcc
  v_add_co_u32 v16, vcc, s15, v16
  s_nop 1
  v_addc_co_u32 v17, vcc, 0, v17, vcc
  v_add_co_u32 v18, vcc, s15, v18
  s_nop 1
  v_addc_co_u32 v19, vcc, 0, v19, vcc
  global_load_dwordx4 a[96:99], v[16:17], off
  v_add_co_u32 v16, vcc, s14, v16
  s_nop 1
  v_addc_co_u32 v17, vcc, 0, v17, vcc
  global_load_dwordx4 a[100:103], v[18:19], off
  v_add_co_u32 v18, vcc, s14, v18
  s_nop 1
  v_addc_co_u32 v19, vcc, 0, v19, vcc
  global_load_dwordx4 a[104:107], v[16:17], off
  v_add_co_u32 v16, vcc, s14, v16
  s_nop 1
  v_addc_co_u32 v17, vcc, 0, v17, vcc
  global_load_dwordx4 a[108:111], v[18:19], off
  v_add_co_u32 v18, vcc, s14, v18
  s_nop 1
  v_addc_co_u32 v19, vcc, 0, v19, vcc
  global_load_dwordx4 a[224:227], v[16:17], off
  v_add_co_u32 v16, vcc, s14, v16
  s_nop 1
  v_addc_co_u32 v17, vcc, 0, v17, vcc
  global_load_dwordx4 a[228:231], v[18:19], off
  v_add_co_u32 v18, vcc, s14, v18
  s_nop 1
  v_addc_co_u32 v19, vcc, 0, v19, vcc
  global_load_dwordx4 a[232:235], v[16:17], off
  v_add_co_u32 v16, vcc, s14, v16
  s_nop 1
  v_addc_co_u32 v17, vcc, 0, v17, vcc
  global_load_dwordx4 a[236:239], v[18:19], off
  v_add_co_u32 v18, vcc, s14, v18
  s_nop 1
  v_addc_co_u32 v19, vcc, 0, v19, vcc
  v_add_co_u32 v16, vcc, s15, v16
  s_nop 1
  v_addc_co_u32 v17, vcc, 0, v17, vcc
  v_add_co_u32 v18, vcc, s15, v18
  s_nop 1
  v_addc_co_u32 v19, vcc, 0, v19, vcc
  s_waitcnt vmcnt(48)
  ds_write_b128 v21, a[0:3] offset:0
  ds_write_b128 v21, a[4:7] offset:1024
  ds_write_b128 v21, a[8:11] offset:2048
  ds_write_b128 v21, a[12:15] offset:3072
  ds_write_b128 v21, a[128:131] offset:4096
  ds_write_b128 v21, a[132:135] offset:5120
  ds_write_b128 v21, a[136:139] offset:6144
  ds_write_b128 v21, a[140:143] offset:7168
  s_waitcnt lgkmcnt(0)
  s_barrier
  ds_read_b64_tr_b16 a[0:1], v29 offset:0
  ds_read_b64_tr_b16 a[2:3], v29 offset:2048
  ds_read_b64_tr_b16 a[4:5], v29 offset:8192
  ds_read_b64_tr_b16 a[6:7], v29 offset:10240
  ds_read_b64_tr_b16 a[8:9], v29 offset:16384
  ds_read_b64_tr_b16 a[10:11], v29 offset:18432
  ds_read_b64_tr_b16 a[12:13], v29 offset:24576
  ds_read_b64_tr_b16 a[14:15], v29 offset:26624
  ds_read_b64_tr_b16 a[128:129], v30 offset:0
  ds_read_b64_tr_b16 a[130:131], v30 offset:2048
  ds_read_b64_tr_b16 a[132:133], v30 offset:8192
  ds_read_b64_tr_b16 a[134:135], v30 offset:10240
  ds_read_b64_tr_b16 a[136:137], v30 offset:16384
  ds_read_b64_tr_b16 a[138:139], v30 offset:18432
  ds_read_b64_tr_b16 a[140:141], v30 offset:24576
  ds_read_b64_tr_b16 a[142:143], v30 offset:26624
  global_load_dwordx4 a[112:115], v[16:17], off
  v_add_co_u32 v16, vcc, s14, v16
  s_nop 1
  v_addc_co_u32 v17, vcc, 0, v17, vcc
  global_load_dwordx4 a[116:119], v[18:19], off
  v_add_co_u32 v18, vcc, s14, v18
  s_nop 1
  v_addc_co_u32 v19, vcc, 0, v19, vcc
  global_load_dwordx4 a[120:123], v[16:17], off
  v_add_co_u32 v16, vcc, s14, v16
  s_nop 1
  v_addc_co_u32 v17, vcc, 0, v17, vcc
  global_load_dwordx4 a[124:127], v[18:19], off
  v_add_co_u32 v18, vcc, s14, v18
  s_nop 1
  v_addc_co_u32 v19, vcc, 0, v19, vcc
  global_load_dwordx4 a[240:243], v[16:17], off
  v_add_co_u32 v16, vcc, s14, v16
  s_nop 1
  v_addc_co_u32 v17, vcc, 0, v17, vcc
  global_load_dwordx4 a[244:247], v[18:19], off
  v_add_co_u32 v18, vcc, s14, v18
  s_nop 1
  v_addc_co_u32 v19, vcc, 0, v19, vcc
  global_load_dwordx4 a[248:251], v[16:17], off
  v_add_co_u32 v16, vcc, s14, v16
  s_nop 1
  v_addc_co_u32 v17, vcc, 0, v17, vcc
  global_load_dwordx4 a[252:255], v[18:19], off
  v_add_co_u32 v18, vcc, s14, v18
  s_nop 1
  v_addc_co_u32 v19, vcc, 0, v19, vcc
  v_add_co_u32 v16, vcc, s15, v16
  s_nop 1
  v_addc_co_u32 v17, vcc, 0, v17, vcc
  v_add_co_u32 v18, vcc, s15, v18
  s_nop 1
  v_addc_co_u32 v19, vcc, 0, v19, vcc
  s_waitcnt lgkmcnt(0)
  s_waitcnt vmcnt(48)
  ds_write_b128 v21, a[16:19] offset:32768
  ds_write_b128 v21, a[20:23] offset:33792
  ds_write_b128 v21, a[24:27] offset:34816
  ds_write_b128 v21, a[28:31] offset:35840
  ds_write_b128 v21, a[144:147] offset:36864
  ds_write_b128 v21, a[148:151] offset:37888
  ds_write_b128 v21, a[152:155] offset:38912
  ds_write_b128 v21, a[156:159] offset:39936
  s_waitcnt lgkmcnt(0)
  s_barrier
  ds_read_b64_tr_b16 a[16:17], v29 offset:32768
  ds_read_b64_tr_b16 a[18:19], v29 offset:34816
  ds_read_b64_tr_b16 a[20:21], v29 offset:40960
  ds_read_b64_tr_b16 a[22:23], v29 offset:43008
  ds_read_b64_tr_b16 a[24:25], v29 offset:49152
  ds_read_b64_tr_b16 a[26:27], v29 offset:51200
  ds_read_b64_tr_b16 a[28:29], v29 offset:57344
  ds_read_b64_tr_b16 a[30:31], v29 offset:59392
  ds_read_b64_tr_b16 a[144:145], v30 offset:32768
  ds_read_b64_tr_b16 a[146:147], v30 offset:34816
  ds_read_b64_tr_b16 a[148:149], v30 offset:40960
  ds_read_b64_tr_b16 a[150:151], v30 offset:43008
  ds_read_b64_tr_b16 a[152:153], v30 offset:49152
  ds_read_b64_tr_b16 a[154:155], v30 offset:51200
  ds_read_b64_tr_b16 a[156:157], v30 offset:57344
  ds_read_b64_tr_b16 a[158:159], v30 offset:59392
  s_waitcnt lgkmcnt(0)
  s_waitcnt vmcnt(40)
  ds_write_b128 v21, a[32:35] offset:0
  ds_write_b128 v21, a[36:39] offset:1024
  ds_write_b128 v21, a[40:43] offset:2048
  ds_write_b128 v21, a[44:47] offset:3072
  ds_write_b128 v21, a[160:163] offset:4096
  ds_write_b128 v21, a[164:167] offset:5120
  ds_write_b128 v21, a[168:171] offset:6144
  ds_write_b128 v21, a[172:175] offset:7168
  s_waitcnt lgkmcnt(0)
  s_barrier
  ds_read_b64_tr_b16 a[32:33], v29 offset:0
  ds_read_b64_tr_b16 a[34:35], v29 offset:2048
  ds_read_b64_tr_b16 a[36:37], v29 offset:8192
  ds_read_b64_tr_b16 a[38:39], v29 offset:10240
  ds_read_b64_tr_b16 a[40:41], v29 offset:16384
  ds_read_b64_tr_b16 a[42:43], v29 offset:18432
  ds_read_b64_tr_b16 a[44:45], v29 offset:24576
  ds_read_b64_tr_b16 a[46:47], v29 offset:26624
  ds_read_b64_tr_b16 a[160:161], v30 offset:0
  ds_read_b64_tr_b16 a[162:163], v30 offset:2048
  ds_read_b64_tr_b16 a[164:165], v30 offset:8192
  ds_read_b64_tr_b16 a[166:167], v30 offset:10240
  ds_read_b64_tr_b16 a[168:169], v30 offset:16384
  ds_read_b64_tr_b16 a[170:171], v30 offset:18432
  ds_read_b64_tr_b16 a[172:173], v30 offset:24576
  ds_read_b64_tr_b16 a[174:175], v30 offset:26624
  s_waitcnt lgkmcnt(0)
  s_waitcnt vmcnt(32)
  ds_write_b128 v21, a[48:51] offset:32768
  ds_write_b128 v21, a[52:55] offset:33792
  ds_write_b128 v21, a[56:59] offset:34816
  ds_write_b128 v21, a[60:63] offset:35840
  ds_write_b128 v21, a[176:179] offset:36864
  ds_write_b128 v21, a[180:183] offset:37888
  ds_write_b128 v21, a[184:187] offset:38912
  ds_write_b128 v21, a[188:191] offset:39936
  s_waitcnt lgkmcnt(0)
  s_barrier
  ds_read_b64_tr_b16 a[48:49], v29 offset:32768
  ds_read_b64_tr_b16 a[50:51], v29 offset:34816
  ds_read_b64_tr_b16 a[52:53], v29 offset:40960
  ds_read_b64_tr_b16 a[54:55], v29 offset:43008
  ds_read_b64_tr_b16 a[56:57], v29 offset:49152
  ds_read_b64_tr_b16 a[58:59], v29 offset:51200
  ds_read_b64_tr_b16 a[60:61], v29 offset:57344
  ds_read_b64_tr_b16 a[62:63], v29 offset:59392
  ds_read_b64_tr_b16 a[176:177], v30 offset:32768
  ds_read_b64_tr_b16 a[178:179], v30 offset:34816
  ds_read_b64_tr_b16 a[180:181], v30 offset:40960
  ds_read_b64_tr_b16 a[182:183], v30 offset:43008
  ds_read_b64_tr_b16 a[184:185], v30 offset:49152
  ds_read_b64_tr_b16 a[186:187], v30 offset:51200
  ds_read_b64_tr_b16 a[188:189], v30 offset:57344
  ds_read_b64_tr_b16 a[190:191], v30 offset:59392
  s_waitcnt lgkmcnt(0)
  s_waitcnt vmcnt(24)
  ds_write_b128 v21, a[64:67] offset:0
  ds_write_b128 v21, a[68:71] offset:1024
  ds_write_b128 v21, a[72:75] offset:2048
  ds_write_b128 v21, a[76:79] offset:3072
  ds_write_b128 v21, a[192:195] offset:4096
  ds_write_b128 v21, a[196:199] offset:5120
  ds_write_b128 v21, a[200:203] offset:6144
  ds_write_b128 v21, a[204:207] offset:7168
  s_waitcnt lgkmcnt(0)
  s_barrier
  ds_read_b64_tr_b16 a[64:65], v29 offset:0
  ds_read_b64_tr_b16 a[66:67], v29 offset:2048
  ds_read_b64_tr_b16 a[68:69], v29 offset:8192
  ds_read_b64_tr_b16 a[70:71], v29 offset:10240
  ds_read_b64_tr_b16 a[72:73], v29 offset:16384
  ds_read_b64_tr_b16 a[74:75], v29 offset:18432
  ds_read_b64_tr_b16 a[76:77], v29 offset:24576
  ds_read_b64_tr_b16 a[78:79], v29 offset:26624
  ds_read_b64_tr_b16 a[192:193], v30 offset:0
  ds_read_b64_tr_b16 a[194:195], v30 offset:2048
  ds_read_b64_tr_b16 a[196:197], v30 offset:8192
  ds_read_b64_tr_b16 a[198:199], v30 offset:10240
  ds_read_b64_tr_b16 a[200:201], v30 offset:16384
  ds_read_b64_tr_b16 a[202:203], v30 offset:18432
  ds_read_b64_tr_b16 a[204:205], v30 offset:24576
  ds_read_b64_tr_b16 a[206:207], v30 offset:26624
  s_waitcnt lgkmcnt(0)
  s_waitcnt vmcnt(16)
  ds_write_b128 v21, a[80:83] offset:32768
  ds_write_b128 v21, a[84:87] offset:33792
  ds_write_b128 v21, a[88:91] offset:34816
  ds_write_b128 v21, a[92:95] offset:35840
  ds_write_b128 v21, a[208:211] offset:36864
  ds_write_b128 v21, a[212:215] offset:37888
  ds_write_b128 v21, a[216:219] offset:38912
  ds_write_b128 v21, a[220:223] offset:39936
  s_waitcnt lgkmcnt(0)
  s_barrier
  ds_read_b64_tr_b16 a[80:81], v29 offset:32768
  ds_read_b64_tr_b16 a[82:83], v29 offset:34816
  ds_read_b64_tr_b16 a[84:85], v29 offset:40960
  ds_read_b64_tr_b16 a[86:87], v29 offset:43008
  ds_read_b64_tr_b16 a[88:89], v29 offset:49152
  ds_read_b64_tr_b16 a[90:91], v29 offset:51200
  ds_read_b64_tr_b16 a[92:93], v29 offset:57344
  ds_read_b64_tr_b16 a[94:95], v29 offset:59392
  ds_read_b64_tr_b16 a[208:209], v30 offset:32768
  ds_read_b64_tr_b16 a[210:211], v30 offset:34816
  ds_read_b64_tr_b16 a[212:213], v30 offset:40960
  ds_read_b64_tr_b16 a[214:215], v30 offset:43008
  ds_read_b64_tr_b16 a[216:217], v30 offset:49152
  ds_read_b64_tr_b16 a[218:219], v30 offset:51200
  ds_read_b64_tr_b16 a[220:221], v30 offset:57344
  ds_read_b64_tr_b16 a[222:223], v30 offset:59392
  s_waitcnt lgkmcnt(0)
  s_waitcnt vmcnt(8)
  ds_write_b128 v21, a[96:99] offset:0
  ds_write_b128 v21, a[100:103] offset:1024
  ds_write_b128 v21, a[104:107] offset:2048
  ds_write_b128 v21, a[108:111] offset:3072
  ds_write_b128 v21, a[224:227] offset:4096
  ds_write_b128 v21, a[228:231] offset:5120
  ds_write_b128 v21, a[232:235] offset:6144
  ds_write_b128 v21, a[236:239] offset:7168
  s_waitcnt lgkmcnt(0)
  s_barrier
  ds_read_b64_tr_b16 a[96:97], v29 offset:0
  ds_read_b64_tr_b16 a[98:99], v29 offset:2048
  ds_read_b64_tr_b16 a[100:101], v29 offset:8192
  ds_read_b64_tr_b16 a[102:103], v29 offset:10240
  ds_read_b64_tr_b16 a[104:105], v29 offset:16384
  ds_read_b64_tr_b16 a[106:107], v29 offset:18432
  ds_read_b64_tr_b16 a[108:109], v29 offset:24576
  ds_read_b64_tr_b16 a[110:111], v29 offset:26624
  ds_read_b64_tr_b16 a[224:225], v30 offset:0
  ds_read_b64_tr_b16 a[226:227], v30 offset:2048
  ds_read_b64_tr_b16 a[228:229], v30 offset:8192
  ds_read_b64_tr_b16 a[230:231], v30 offset:10240
  ds_read_b64_tr_b16 a[232:233], v30 offset:16384
  ds_read_b64_tr_b16 a[234:235], v30 offset:18432
  ds_read_b64_tr_b16 a[236:237], v30 offset:24576
  ds_read_b64_tr_b16 a[238:239], v30 offset:26624
  s_waitcnt lgkmcnt(0)
  s_waitcnt vmcnt(0)
  ds_write_b128 v21, a[112:115] offset:32768
  ds_write_b128 v21, a[116:119] offset:33792
  ds_write_b128 v21, a[120:123] offset:34816
  ds_write_b128 v21, a[124:127] offset:35840
  ds_write_b128 v21, a[240:243] offset:36864
  ds_write_b128 v21, a[244:247] offset:37888
  ds_write_b128 v21, a[248:251] offset:38912
  ds_write_b128 v21, a[252:255] offset:39936
  s_waitcnt lgkmcnt(0)
  s_barrier
  ds_read_b64_tr_b16 a[112:113], v29 offset:32768
  ds_read_b64_tr_b16 a[114:115], v29 offset:34816
  ds_read_b64_tr_b16 a[116:117], v29 offset:40960
  ds_read_b64_tr_b16 a[118:119], v29 offset:43008
  ds_read_b64_tr_b16 a[120:121], v29 offset:49152
  ds_read_b64_tr_b16 a[122:123], v29 offset:51200
  ds_read_b64_tr_b16 a[124:125], v29 offset:57344
  ds_read_b64_tr_b16 a[126:127], v29 offset:59392
  ds_read_b64_tr_b16 a[240:241], v30 offset:32768
  ds_read_b64_tr_b16 a[242:243], v30 offset:34816
  ds_read_b64_tr_b16 a[244:245], v30 offset:40960
  ds_read_b64_tr_b16 a[246:247], v30 offset:43008
  ds_read_b64_tr_b16 a[248:249], v30 offset:49152
  ds_read_b64_tr_b16 a[250:251], v30 offset:51200
  ds_read_b64_tr_b16 a[252:253], v30 offset:57344
  ds_read_b64_tr_b16 a[254:255], v30 offset:59392
  s_waitcnt lgkmcnt(0)
  s_barrier
  s_cmp_lg_u32 s8, 0
  s_cbranch_scc1 L_wfiok_90
  v_mov_b32 v254, 16
  s_mov_b32 s49, 0
L_wfi_89:
  global_load_dword v255, v254, s[6:7] sc1
  s_add_u32 s49, s49, 1
  s_cmp_gt_u32 s49, 0x20000
  s_cbranch_scc1 L_wfiok_90
  s_waitcnt vmcnt(0)
  v_cmp_gt_u32 vcc, 256, v255
  s_nop 0
  s_cbranch_vccz L_wfiok_90
  s_sleep 8
  s_branch L_wfi_89
L_wfiok_90:
  s_barrier
  v_and_b32 v12, 31, v0
  v_lshrrev_b32 v13, 5, v0
  v_and_b32 v14, 15, v0
  v_add_u32 v15, 0, v13
  v_xor_b32 v15, v15, v14
  v_lshlrev_b32 v15, 4, v15
  v_lshl_add_u32 v2, v12, 10, v15
  v_add_u32 v15, 2, v13
  v_xor_b32 v15, v15, v14
  v_lshlrev_b32 v15, 4, v15
  v_lshl_add_u32 v3, v12, 10, v15
  v_add_u32 v15, 4, v13
  v_xor_b32 v15, v15, v14
  v_lshlrev_b32 v15, 4, v15
  v_lshl_add_u32 v4, v12, 10, v15
  v_add_u32 v15, 6, v13
  v_xor_b32 v15, v15, v14
  v_lshlrev_b32 v15, 4, v15
  v_lshl_add_u32 v5, v12, 10, v15
  v_add_u32 v15, 8, v13
  v_xor_b32 v15, v15, v14
  v_lshlrev_b32 v15, 4, v15
  v_lshl_add_u32 v6, v12, 10, v15
  v_add_u32 v15, 10, v13
  v_xor_b32 v15, v15, v14
  v_lshlrev_b32 v15, 4, v15
  v_lshl_add_u32 v7, v12, 10, v15
  v_add_u32 v15, 12, v13
  v_xor_b32 v15, v15, v14
  v_lshlrev_b32 v15, 4, v15
  v_lshl_add_u32 v8, v12, 10, v15
  v_add_u32 v15, 14, v13
  v_xor_b32 v15, v15, v14
  v_lshlrev_b32 v15, 4, v15
  v_lshl_add_u32 v9, v12, 10, v15
  s_and_b32 s12, s8, 1
  s_lshl_b32 s12, s12, 7
  v_xor_b32 v10, s12, v1
  v_bfe_u32 v12, v0, 4, 1
  v_lshrrev_b32 v13, 5, v0
  v_and_b32 v14, 15, v0
  v_lshl_add_u32 v13, v13, 4, v14
  v_lshlrev_b32 v13, 4, v13
  v_lshl_add_u32 v116, v12, 12, v13
  s_mov_b32 s34, 0
  s_lshl_b32 s12, s30, 15
  s_add_u32 s26, s60, s12
  s_addc_u32 s27, s61, 0
  s_lshl_b32 s12, s8, 13
  s_add_u32 s16, s26, s12
  s_addc_u32 s17, s27, 0
  s_add_u32 s12, s12, s34
  v_xor_b32 v11, 0, v10
  s_add_u32 m0, s12, 0
  s_nop 0
  global_load_lds_dwordx4 v11, s[16:17]
  s_add_u32 s16, s16, 1024
  s_addc_u32 s17, s17, 0
  v_xor_b32 v11, 16, v10
  s_add_u32 m0, s12, 1024
  s_nop 0
  global_load_lds_dwordx4 v11, s[16:17]
  s_add_u32 s16, s16, 1024
  s_addc_u32 s17, s17, 0
  v_xor_b32 v11, 32, v10
  s_add_u32 m0, s12, 2048
  s_nop 0
  global_load_lds_dwordx4 v11, s[16:17]
  s_add_u32 s16, s16, 1024
  s_addc_u32 s17, s17, 0
  v_xor_b32 v11, 48, v10
  s_add_u32 m0, s12, 3072
  s_nop 0
  global_load_lds_dwordx4 v11, s[16:17]
  s_add_u32 s16, s16, 1024
  s_addc_u32 s17, s17, 0
  v_xor_b32 v11, 64, v10
  s_add_u32 m0, s12, 4096
  s_nop 0
  global_load_lds_dwordx4 v11, s[16:17]
  s_add_u32 s16, s16, 1024
  s_addc_u32 s17, s17, 0
  v_xor_b32 v11, 80, v10
  s_add_u32 m0, s12, 5120
  s_nop 0
  global_load_lds_dwordx4 v11, s[16:17]
  s_add_u32 s16, s16, 1024
  s_addc_u32 s17, s17, 0
  v_xor_b32 v11, 96, v10
  s_add_u32 m0, s12, 6144
  s_nop 0
  global_load_lds_dwordx4 v11, s[16:17]
  s_add_u32 s16, s16, 1024
  s_addc_u32 s17, s17, 0
  v_xor_b32 v11, 112, v10
  s_add_u32 m0, s12, 7168
  s_nop 0
  global_load_lds_dwordx4 v11, s[16:17]
  s_mov_b32 s52, -1
  s_mov_b32 s53, -1
  s_waitcnt vmcnt(0)
L_seg_91:
  s_waitcnt vmcnt(4)
  s_barrier
  s_cmp_eq_u32 s52, -1
  s_cbranch_scc1 L_nf_92
  s_cmp_lg_u32 s8, 0
  s_cbranch_scc1 L_fs_93
  s_lshl_b32 s48, s52, 14
  s_lshl_b32 s49, s36, 7
  s_add_u32 s48, s48, s49
  s_add_u32 s48, s48, 0
  v_mov_b32 v254, s48
  v_mov_b32 v255, 1
  s_mov_b64 exec, 1
  global_store_dword v254, v255, s[46:47] sc1
  s_mov_b64 exec, -1
L_fs_93:
L_nf_92:
  s_mov_b32 s52, s53
  s_mov_b32 s53, s30
  s_lshl_b32 s12, s30, 18
  s_add_u32 s12, s12, s37
  s_add_u32 s12, s12, 33554432
  s_add_u32 s28, s4, s12
  s_addc_u32 s29, s5, 0
  s_add_u32 s30, s30, s33
  s_sub_u32 s35, s35, 1
  s_xor_b32 s34, s34, 32768
  s_cmp_eq_u32 s35, 0
  s_cbranch_scc1 L_nonext_94
  s_lshl_b32 s12, s30, 15
  s_add_u32 s26, s60, s12
  s_addc_u32 s27, s61, 0
  s_lshl_b32 s12, s8, 13
  s_add_u32 s16, s26, s12
  s_addc_u32 s17, s27, 0
  s_add_u32 s12, s12, s34
  v_xor_b32 v11, 0, v10
  s_add_u32 m0, s12, 0
  s_nop 0
  global_load_lds_dwordx4 v11, s[16:17]
  s_add_u32 s16, s16, 1024
  s_addc_u32 s17, s17, 0
  v_xor_b32 v11, 16, v10
  s_add_u32 m0, s12, 1024
  s_nop 0
  global_load_lds_dwordx4 v11, s[16:17]
  s_add_u32 s16, s16, 1024
  s_addc_u32 s17, s17, 0
  v_xor_b32 v11, 32, v10
  s_add_u32 m0, s12, 2048
  s_nop 0
  global_load_lds_dwordx4 v11, s[16:17]
  s_add_u32 s16, s16, 1024
  s_addc_u32 s17, s17, 0
  v_xor_b32 v11, 48, v10
  s_add_u32 m0, s12, 3072
  s_nop 0
  global_load_lds_dwordx4 v11, s[16:17]
  s_add_u32 s16, s16, 1024
  s_addc_u32 s17, s17, 0
  v_xor_b32 v11, 64, v10
  s_add_u32 m0, s12, 4096
  s_nop 0
  global_load_lds_dwordx4 v11, s[16:17]
  s_add_u32 s16, s16, 1024
  s_addc_u32 s17, s17, 0
  v_xor_b32 v11, 80, v10
  s_add_u32 m0, s12, 5120
  s_nop 0
  global_load_lds_dwordx4 v11, s[16:17]
  s_add_u32 s16, s16, 1024
  s_addc_u32 s17, s17, 0
  v_xor_b32 v11, 96, v10
  s_add_u32 m0, s12, 6144
  s_nop 0
  global_load_lds_dwordx4 v11, s[16:17]
  s_add_u32 s16, s16, 1024
  s_addc_u32 s17, s17, 0
  v_xor_b32 v11, 112, v10
  s_add_u32 m0, s12, 7168
  s_nop 0
  global_load_lds_dwordx4 v11, s[16:17]
L_nonext_94:
  ds_read_b128 v[32:35], v2 offset:0
  ds_read_b128 v[36:39], v3 offset:0
  ds_read_b128 v[40:43], v4 offset:0
  ds_read_b128 v[44:47], v5 offset:0
  ds_read_b128 v[48:51], v6 offset:0
  ds_read_b128 v[52:55], v7 offset:0
  s_waitcnt lgkmcnt(5)
  v_mfma_f32_32x32x16_bf16 v[64:79], a[0:3], v[32:35], 0
  ds_read_b128 v[56:59], v8 offset:0
  v_mfma_f32_32x32x16_bf16 v[80:95], a[128:131], v[32:35], 0
  s_waitcnt lgkmcnt(5)
  v_mfma_f32_32x32x16_bf16 v[64:79], a[4:7], v[36:39], v[64:79]
  ds_read_b128 v[60:63], v9 offset:0
  v_mfma_f32_32x32x16_bf16 v[80:95], a[132:135], v[36:39], v[80:95]
  s_waitcnt lgkmcnt(5)
  v_mfma_f32_32x32x16_bf16 v[64:79], a[8:11], v[40:43], v[64:79]
  ds_read_b128 v[32:35], v2 offset:256
  v_mfma_f32_32x32x16_bf16 v[80:95], a[136:139], v[40:43], v[80:95]
  s_waitcnt lgkmcnt(5)
  v_mfma_f32_32x32x16_bf16 v[64:79], a[12:15], v[44:47], v[64:79]
  ds_read_b128 v[36:39], v3 offset:256
  v_mfma_f32_32x32x16_bf16 v[80:95], a[140:143], v[44:47], v[80:95]
  s_waitcnt lgkmcnt(5)
  v_mfma_f32_32x32x16_bf16 v[64:79], a[16:19], v[48:51], v[64:79]
  ds_read_b128 v[40:43], v4 offset:256
  v_mfma_f32_32x32x16_bf16 v[80:95], a[144:147], v[48:51], v[80:95]
  s_waitcnt lgkmcnt(5)
  v_mfma_f32_32x32x16_bf16 v[64:79], a[20:23], v[52:55], v[64:79]
  ds_read_b128 v[44:47], v5 offset:256
  v_mfma_f32_32x32x16_bf16 v[80:95], a[148:151], v[52:55], v[80:95]
  s_waitcnt lgkmcnt(5)
  v_mfma_f32_32x32x16_bf16 v[64:79], a[24:27], v[56:59], v[64:79]
  ds_read_b128 v[48:51], v6 offset:256
  v_mfma_f32_32x32x16_bf16 v[80:95], a[152:155], v[56:59], v[80:95]
  s_waitcnt lgkmcnt(5)
  v_mfma_f32_32x32x16_bf16 v[64:79], a[28:31], v[60:63], v[64:79]
  ds_read_b128 v[52:55], v7 offset:256
  v_mfma_f32_32x32x16_bf16 v[80:95], a[156:159], v[60:63], v[80:95]
  s_waitcnt lgkmcnt(5)
  v_mfma_f32_32x32x16_bf16 v[64:79], a[32:35], v[32:35], v[64:79]
  ds_read_b128 v[56:59], v8 offset:256
  v_mfma_f32_32x32x16_bf16 v[80:95], a[160:163], v[32:35], v[80:95]
  s_waitcnt lgkmcnt(5)
  v_mfma_f32_32x32x16_bf16 v[64:79], a[36:39], v[36:39], v[64:79]
  ds_read_b128 v[60:63], v9 offset:256
  v_mfma_f32_32x32x16_bf16 v[80:95], a[164:167], v[36:39], v[80:95]
  s_waitcnt lgkmcnt(5)
  v_mfma_f32_32x32x16_bf16 v[64:79], a[40:43], v[40:43], v[64:79]
  ds_read_b128 v[32:35], v2 offset:512
  v_mfma_f32_32x32x16_bf16 v[80:95], a[168:171], v[40:43], v[80:95]
  s_waitcnt lgkmcnt(5)
  v_mfma_f32_32x32x16_bf16 v[64:79], a[44:47], v[44:47], v[64:79]
  ds_read_b128 v[36:39], v3 offset:512
  v_mfma_f32_32x32x16_bf16 v[80:95], a[172:175], v[44:47], v[80:95]
  s_waitcnt lgkmcnt(5)
  v_mfma_f32_32x32x16_bf16 v[64:79], a[48:51], v[48:51], v[64:79]
  ds_read_b128 v[40:43], v4 offset:512
  v_mfma_f32_32x32x16_bf16 v[80:95], a[176:179], v[48:51], v[80:95]
  s_waitcnt lgkmcnt(5)
  v_mfma_f32_32x32x16_bf16 v[64:79], a[52:55], v[52:55], v[64:79]
  ds_read_b128 v[44:47], v5 offset:512
  v_mfma_f32_32x32x16_bf16 v[80:95], a[180:183], v[52:55], v[80:95]
  s_waitcnt lgkmcnt(5)
  v_mfma_f32_32x32x16_bf16 v[64:79], a[56:59], v[56:59], v[64:79]
  ds_read_b128 v[48:51], v6 offset:512
  v_mfma_f32_32x32x16_bf16 v[80:95], a[184:187], v[56:59], v[80:95]
  s_waitcnt lgkmcnt(5)
  v_mfma_f32_32x32x16_bf16 v[64:79], a[60:63], v[60:63], v[64:79]
  ds_read_b128 v[52:55], v7 offset:512
  v_mfma_f32_32x32x16_bf16 v[80:95], a[188:191], v[60:63], v[80:95]
  s_waitcnt lgkmcnt(5)
  v_mfma_f32_32x32x16_bf16 v[64:79], a[64:67], v[32:35], v[64:79]
  ds_read_b128 v[56:59], v8 offset:512
  v_mfma_f32_32x32x16_bf16 v[80:95], a[192:195], v[32:35], v[80:95]
  s_waitcnt lgkmcnt(5)
  v_mfma_f32_32x32x16_bf16 v[64:79], a[68:71], v[36:39], v[64:79]
  ds_read_b128 v[60:63], v9 offset:512
  v_mfma_f32_32x32x16_bf16 v[80:95], a[196:199], v[36:39], v[80:95]
  s_waitcnt lgkmcnt(5)
  v_mfma_f32_32x32x16_bf16 v[64:79], a[72:75], v[40:43], v[64:79]
  ds_read_b128 v[32:35], v2 offset:768
  v_mfma_f32_32x32x16_bf16 v[80:95], a[200:203], v[40:43], v[80:95]
  s_waitcnt lgkmcnt(5)
  v_mfma_f32_32x32x16_bf16 v[64:79], a[76:79], v[44:47], v[64:79]
  ds_read_b128 v[36:39], v3 offset:768
  v_mfma_f32_32x32x16_bf16 v[80:95], a[204:207], v[44:47], v[80:95]
  s_waitcnt lgkmcnt(5)
  v_mfma_f32_32x32x16_bf16 v[64:79], a[80:83], v[48:51], v[64:79]
  ds_read_b128 v[40:43], v4 offset:768
  v_mfma_f32_32x32x16_bf16 v[80:95], a[208:211], v[48:51], v[80:95]
  s_waitcnt lgkmcnt(5)
  v_mfma_f32_32x32x16_bf16 v[64:79], a[84:87], v[52:55], v[64:79]
  ds_read_b128 v[44:47], v5 offset:768
  v_mfma_f32_32x32x16_bf16 v[80:95], a[212:215], v[52:55], v[80:95]
  s_waitcnt lgkmcnt(5)
  v_mfma_f32_32x32x16_bf16 v[64:79], a[88:91], v[56:59], v[64:79]
  ds_read_b128 v[48:51], v6 offset:768
  v_mfma_f32_32x32x16_bf16 v[80:95], a[216:219], v[56:59], v[80:95]
  s_waitcnt lgkmcnt(5)
  v_mfma_f32_32x32x16_bf16 v[64:79], a[92:95], v[60:63], v[64:79]
  ds_read_b128 v[52:55], v7 offset:768
  v_mfma_f32_32x32x16_bf16 v[80:95], a[220:223], v[60:63], v[80:95]
  s_waitcnt lgkmcnt(5)
  v_mfma_f32_32x32x16_bf16 v[64:79], a[96:99], v[32:35], v[64:79]
  ds_read_b128 v[56:59], v8 offset:768
  v_mfma_f32_32x32x16_bf16 v[80:95], a[224:227], v[32:35], v[80:95]
  s_waitcnt lgkmcnt(5)
  v_mfma_f32_32x32x16_bf16 v[64:79], a[100:103], v[36:39], v[64:79]
  ds_read_b128 v[60:63], v9 offset:768
  v_mfma_f32_32x32x16_bf16 v[80:95], a[228:231], v[36:39], v[80:95]
  s_waitcnt lgkmcnt(5)
  v_mfma_f32_32x32x16_bf16 v[64:79], a[104:107], v[40:43], v[64:79]
  v_mfma_f32_32x32x16_bf16 v[80:95], a[232:235], v[40:43], v[80:95]
  s_waitcnt lgkmcnt(4)
  v_mfma_f32_32x32x16_bf16 v[64:79], a[108:111], v[44:47], v[64:79]
  v_mfma_f32_32x32x16_bf16 v[80:95], a[236:239], v[44:47], v[80:95]
  s_waitcnt lgkmcnt(3)
  v_mfma_f32_32x32x16_bf16 v[64:79], a[112:115], v[48:51], v[64:79]
  v_mfma_f32_32x32x16_bf16 v[80:95], a[240:243], v[48:51], v[80:95]
  s_waitcnt lgkmcnt(2)
  v_mfma_f32_32x32x16_bf16 v[64:79], a[116:119], v[52:55], v[64:79]
  v_mfma_f32_32x32x16_bf16 v[80:95], a[244:247], v[52:55], v[80:95]
  s_waitcnt lgkmcnt(1)
  v_mfma_f32_32x32x16_bf16 v[64:79], a[120:123], v[56:59], v[64:79]
  v_mfma_f32_32x32x16_bf16 v[80:95], a[248:251], v[56:59], v[80:95]
  s_waitcnt lgkmcnt(0)
  v_mfma_f32_32x32x16_bf16 v[64:79], a[124:127], v[60:63], v[64:79]
  v_mfma_f32_32x32x16_bf16 v[80:95], a[252:255], v[60:63], v[80:95]
  v_xor_b32 v2, 32768, v2
  v_xor_b32 v3, 32768, v3
  v_xor_b32 v4, 32768, v4
  v_xor_b32 v5, 32768, v5
  v_xor_b32 v6, 32768, v6
  v_xor_b32 v7, 32768, v7
  v_xor_b32 v8, 32768, v8
  v_xor_b32 v9, 32768, v9
  v_cvt_pk_bf16_f32 v96, v64, v65
  v_cvt_pk_bf16_f32 v97, v66, v67
  v_cvt_pk_bf16_f32 v98, v68, v69
  v_cvt_pk_bf16_f32 v99, v70, v71
  global_store_dwordx4 v116, v[96:99], s[28:29] offset:0 sc1
  v_cvt_pk_bf16_f32 v100, v72, v73
  v_cvt_pk_bf16_f32 v101, v74, v75
  v_cvt_pk_bf16_f32 v102, v76, v77
  v_cvt_pk_bf16_f32 v103, v78, v79
  global_store_dwordx4 v116, v[100:103], s[28:29] offset:512 sc1
  v_cvt_pk_bf16_f32 v104, v80, v81
  v_cvt_pk_bf16_f32 v105, v82, v83
  v_cvt_pk_bf16_f32 v106, v84, v85
  v_cvt_pk_bf16_f32 v107, v86, v87
  global_store_dwordx4 v116, v[104:107], s[28:29] offset:1024 sc1
  v_cvt_pk_bf16_f32 v108, v88, v89
  v_cvt_pk_bf16_f32 v109, v90, v91
  v_cvt_pk_bf16_f32 v110, v92, v93
  v_cvt_pk_bf16_f32 v111, v94, v95
  global_store_dwordx4 v116, v[108:111], s[28:29] offset:1536 sc1
  s_cmp_eq_u32 s52, -1
  s_cbranch_scc0 L_nfirst_95
  s_cmp_lt_u32 s53, 3
  s_cbranch_scc0 L_nfirst_95
  s_waitcnt vmcnt(0)
  s_barrier
  s_cmp_lg_u32 s8, 0
  s_cbranch_scc1 L_fs_96
  s_lshl_b32 s48, s53, 14
  s_lshl_b32 s49, s36, 7
  s_add_u32 s48, s48, s49
  s_add_u32 s48, s48, 0
  v_mov_b32 v254, s48
  v_mov_b32 v255, 1
  s_mov_b64 exec, 1
  global_store_dword v254, v255, s[46:47] sc1
  s_mov_b64 exec, -1
L_fs_96:
L_nfirst_95:
  s_cmp_lg_u32 s35, 0
  s_cbranch_scc1 L_seg_91
  s_waitcnt vmcnt(0)
  s_barrier
  s_cmp_eq_u32 s52, -1
  s_cbranch_scc1 L_nf_97
  s_cmp_lg_u32 s8, 0
  s_cbranch_scc1 L_fs_98
  s_lshl_b32 s48, s52, 14
  s_lshl_b32 s49, s36, 7
  s_add_u32 s48, s48, s49
  s_add_u32 s48, s48, 0
  v_mov_b32 v254, s48
  v_mov_b32 v255, 1
  s_mov_b64 exec, 1
  global_store_dword v254, v255, s[46:47] sc1
  s_mov_b64 exec, -1
L_fs_98:
L_nf_97:
  s_cmp_lg_u32 s8, 0
  s_cbranch_scc1 L_fs_99
  s_lshl_b32 s48, s53, 14
  s_lshl_b32 s49, s36, 7
  s_add_u32 s48, s48, s49
  s_add_u32 s48, s48, 0
  v_mov_b32 v254, s48
  v_mov_b32 v255, 1
  s_mov_b64 exec, 1
  global_store_dword v254, v255, s[46:47] sc1
  s_mov_b64 exec, -1
L_fs_99:
  s_branch L_pdone_62
L_pf_66:
  s_sub_u32 s18, s36, 48
  s_lshl_b32 s12, s18, 8
  s_add_u32 s20, s70, s12
  s_addc_u32 s21, s71, 0
  s_add_u32 s22, s72, s12
  s_addc_u32 s23, s73, 0
  s_mov_b32 s24, 3584
  s_lshl_b32 s12, s18, 2
  s_add_u32 s12, s12, s8
  s_lshl_b32 s37, s12, 11
  s_mov_b32 s40, 0xbfb8aa3b
  s_mov_b32 s41, 0xbfb8aa3b
  s_mov_b32 s42, 1.0
  s_mov_b32 s43, 1.0
  v_lshrrev_b32 v12, 5, v0
  v_and_b32 v13, 31, v0
  v_add_u32 v14, 0, v12
  v_lshlrev_b32 v14, 2, v14
  v_xor_b32 v14, v14, v13
  v_and_b32 v15, 15, v14
  v_lshlrev_b32 v15, 4, v15
  v_cmp_lt_u32 vcc, 15, v14
  v_mov_b32 v16, s20
  v_mov_b32 v17, s22
  v_cndmask_b32 v16, v16, v17, vcc
  v_mov_b32 v17, s21
  v_mov_b32 v20, s23
  v_cndmask_b32 v17, v17, v20, vcc
  v_add_co_u32 v16, vcc, v16, v15
  s_nop 1
  v_addc_co_u32 v17, vcc, 0, v17, vcc
  s_lshl_b32 s12, s8, 4
  s_add_u32 s12, s12, 0
  v_add_u32 v15, s12, v12
  v_mul_lo_u32 v15, v15, s24
  v_add_co_u32 v16, vcc, v16, v15
  s_nop 1
  v_addc_co_u32 v17, vcc, 0, v17, vcc
  v_add_u32 v14, 2, v12
  v_lshlrev_b32 v14, 2, v14
  v_xor_b32 v14, v14, v13
  v_and_b32 v15, 15, v14
  v_lshlrev_b32 v15, 4, v15
  v_cmp_lt_u32 vcc, 15, v14
  v_mov_b32 v18, s20
  v_mov_b32 v19, s22
  v_cndmask_b32 v18, v18, v19, vcc
  v_mov_b32 v19, s21
  v_mov_b32 v20, s23
  v_cndmask_b32 v19, v19, v20, vcc
  v_add_co_u32 v18, vcc, v18, v15
  s_nop 1
  v_addc_co_u32 v19, vcc, 0, v19, vcc
  s_lshl_b32 s12, s8, 4
  s_add_u32 s12, s12, 2
  v_add_u32 v15, s12, v12
  v_mul_lo_u32 v15, v15, s24
  v_add_co_u32 v18, vcc, v18, v15
  s_nop 1
  v_addc_co_u32 v19, vcc, 0, v19, vcc
  s_lshl_b32 s14, s24, 2
  s_mul_i32 s15, s24, 48
  s_lshl_b32 s13, s8, 13
  v_bfe_u32 v22, v0, 2, 2
  v_and_b32 v23, 3, v0
  v_and_b32 v24, 1, v23
  v_lshlrev_b32 v24, 1, v24
  v_lshrrev_b32 v23, 1, v23
  v_or_b32 v23, v23, v24
  v_bfe_u32 v24, v0, 4, 1
  v_lshrrev_b32 v25, 5, v0
  v_lshrrev_b32 v26, 1, v23
  v_lshl_add_u32 v26, v24, 1, v26
  v_lshl_add_u32 v25, v25, 3, v22
  s_lshl_b32 s12, s8, 2
  s_add_u32 s12, s12, 0
  v_add_u32 v27, s12, v26
  v_lshlrev_b32 v28, 2, v22
  v_xor_b32 v27, v27, v28
  v_lshlrev_b32 v27, 4, v27
  v_lshl_add_u32 v27, v25, 9, v27
  v_and_b32 v28, 1, v23
  v_lshl_add_u32 v29, v28, 3, v27
  s_lshl_b32 s12, s8, 2
  s_add_u32 s12, s12, 16
  v_add_u32 v27, s12, v26
  v_lshlrev_b32 v28, 2, v22
  v_xor_b32 v27, v27, v28
  v_lshlrev_b32 v27, 4, v27
  v_lshl_add_u32 v27, v25, 9, v27
  v_and_b32 v28, 1, v23
  v_lshl_add_u32 v30, v28, 3, v27
  v_add_u32 v21, s13, v1
  global_load_dwordx4 a[0:3], v[16:17], off
  v_add_co_u32 v16, vcc, s14, v16
  s_nop 1
  v_addc_co_u32 v17, vcc, 0, v17, vcc
  global_load_dwordx4 a[4:7], v[18:19], off
  v_add_co_u32 v18, vcc, s14, v18
  s_nop 1
  v_addc_co_u32 v19, vcc, 0, v19, vcc
  global_load_dwordx4 a[8:11], v[16:17], off
  v_add_co_u32 v16, vcc, s14, v16
  s_nop 1
  v_addc_co_u32 v17, vcc, 0, v17, vcc
  global_load_dwordx4 a[12:15], v[18:19], off
  v_add_co_u32 v18, vcc, s14, v18
  s_nop 1
  v_addc_co_u32 v19, vcc, 0, v19, vcc
  global_load_dwordx4 a[128:131], v[16:17], off
  v_add_co_u32 v16, vcc, s14, v16
  s_nop 1
  v_addc_co_u32 v17, vcc, 0, v17, vcc
  global_load_dwordx4 a[132:135], v[18:19], off
  v_add_co_u32 v18, vcc, s14, v18
  s_nop 1
  v_addc_co_u32 v19, vcc, 0, v19, vcc
  global_load_dwordx4 a[136:139], v[16:17], off
  v_add_co_u32 v16, vcc, s14, v16
  s_nop 1
  v_addc_co_u32 v17, vcc, 0, v17, vcc
  global_load_dwordx4 a[140:143], v[18:19], off
  v_add_co_u32 v18, vcc, s14, v18
  s_nop 1
  v_addc_co_u32 v19, vcc, 0, v19, vcc
  v_add_co_u32 v16, vcc, s15, v16
  s_nop 1
  v_addc_co_u32 v17, vcc, 0, v17, vcc
  v_add_co_u32 v18, vcc, s15, v18
  s_nop 1
  v_addc_co_u32 v19, vcc, 0, v19, vcc
  global_load_dwordx4 a[16:19], v[16:17], off
  v_add_co_u32 v16, vcc, s14, v16
  s_nop 1
  v_addc_co_u32 v17, vcc, 0, v17, vcc
  global_load_dwordx4 a[20:23], v[18:19], off
  v_add_co_u32 v18, vcc, s14, v18
  s_nop 1
  v_addc_co_u32 v19, vcc, 0, v19, vcc
  global_load_dwordx4 a[24:27], v[16:17], off
  v_add_co_u32 v16, vcc, s14, v16
  s_nop 1
  v_addc_co_u32 v17, vcc, 0, v17, vcc
  global_load_dwordx4 a[28:31], v[18:19], off
  v_add_co_u32 v18, vcc, s14, v18
  s_nop 1
  v_addc_co_u32 v19, vcc, 0, v19, vcc
  global_load_dwordx4 a[144:147], v[16:17], off
  v_add_co_u32 v16, vcc, s14, v16
  s_nop 1
  v_addc_co_u32 v17, vcc, 0, v17, vcc
  global_load_dwordx4 a[148:151], v[18:19], off
  v_add_co_u32 v18, vcc, s14, v18
  s_nop 1
  v_addc_co_u32 v19, vcc, 0, v19, vcc
  global_load_dwordx4 a[152:155], v[16:17], off
  v_add_co_u32 v16, vcc, s14, v16
  s_nop 1
  v_addc_co_u32 v17, vcc, 0, v17, vcc
  global_load_dwordx4 a[156:159], v[18:19], off
  v_add_co_u32 v18, vcc, s14, v18
  s_nop 1
  v_addc_co_u32 v19, vcc, 0, v19, vcc
  v_add_co_u32 v16, vcc, s15, v16
  s_nop 1
  v_addc_co_u32 v17, vcc, 0, v17, vcc
  v_add_co_u32 v18, vcc, s15, v18
  s_nop 1
  v_addc_co_u32 v19, vcc, 0, v19, vcc
  global_load_dwordx4 a[32:35], v[16:17], off
  v_add_co_u32 v16, vcc, s14, v16
  s_nop 1
  v_addc_co_u32 v17, vcc, 0, v17, vcc
  global_load_dwordx4 a[36:39], v[18:19], off
  v_add_co_u32 v18, vcc, s14, v18
  s_nop 1
  v_addc_co_u32 v19, vcc, 0, v19, vcc
  global_load_dwordx4 a[40:43], v[16:17], off
  v_add_co_u32 v16, vcc, s14, v16
  s_nop 1
  v_addc_co_u32 v17, vcc, 0, v17, vcc
  global_load_dwordx4 a[44:47], v[18:19], off
  v_add_co_u32 v18, vcc, s14, v18
  s_nop 1
  v_addc_co_u32 v19, vcc, 0, v19, vcc
  global_load_dwordx4 a[160:163], v[16:17], off
  v_add_co_u32 v16, vcc, s14, v16
  s_nop 1
  v_addc_co_u32 v17, vcc, 0, v17, vcc
  global_load_dwordx4 a[164:167], v[18:19], off
  v_add_co_u32 v18, vcc, s14, v18
  s_nop 1
  v_addc_co_u32 v19, vcc, 0, v19, vcc
  global_load_dwordx4 a[168:171], v[16:17], off
  v_add_co_u32 v16, vcc, s14, v16
  s_nop 1
  v_addc_co_u32 v17, vcc, 0, v17, vcc
  global_load_dwordx4 a[172:175], v[18:19], off
  v_add_co_u32 v18, vcc, s14, v18
  s_nop 1
  v_addc_co_u32 v19, vcc, 0, v19, vcc
  v_add_co_u32 v16, vcc, s15, v16
  s_nop 1
  v_addc_co_u32 v17, vcc, 0, v17, vcc
  v_add_co_u32 v18, vcc, s15, v18
  s_nop 1
  v_addc_co_u32 v19, vcc, 0, v19, vcc
  global_load_dwordx4 a[48:51], v[16:17], off
  v_add_co_u32 v16, vcc, s14, v16
  s_nop 1
  v_addc_co_u32 v17, vcc, 0, v17, vcc
  global_load_dwordx4 a[52:55], v[18:19], off
  v_add_co_u32 v18, vcc, s14, v18
  s_nop 1
  v_addc_co_u32 v19, vcc, 0, v19, vcc
  global_load_dwordx4 a[56:59], v[16:17], off
  v_add_co_u32 v16, vcc, s14, v16
  s_nop 1
  v_addc_co_u32 v17, vcc, 0, v17, vcc
  global_load_dwordx4 a[60:63], v[18:19], off
  v_add_co_u32 v18, vcc, s14, v18
  s_nop 1
  v_addc_co_u32 v19, vcc, 0, v19, vcc
  global_load_dwordx4 a[176:179], v[16:17], off
  v_add_co_u32 v16, vcc, s14, v16
  s_nop 1
  v_addc_co_u32 v17, vcc, 0, v17, vcc
  global_load_dwordx4 a[180:183], v[18:19], off
  v_add_co_u32 v18, vcc, s14, v18
  s_nop 1
  v_addc_co_u32 v19, vcc, 0, v19, vcc
  global_load_dwordx4 a[184:187], v[16:17], off
  v_add_co_u32 v16, vcc, s14, v16
  s_nop 1
  v_addc_co_u32 v17, vcc, 0, v17, vcc
  global_load_dwordx4 a[188:191], v[18:19], off
  v_add_co_u32 v18, vcc, s14, v18
  s_nop 1
  v_addc_co_u32 v19, vcc, 0, v19, vcc
  v_add_co_u32 v16, vcc, s15, v16
  s_nop 1
  v_addc_co_u32 v17, vcc, 0, v17, vcc
  v_add_co_u32 v18, vcc, s15, v18
  s_nop 1
  v_addc_co_u32 v19, vcc, 0, v19, vcc
  global_load_dwordx4 a[64:67], v[16:17], off
  v_add_co_u32 v16, vcc, s14, v16
  s_nop 1
  v_addc_co_u32 v17, vcc, 0, v17, vcc
  global_load_dwordx4 a[68:71], v[18:19], off
  v_add_co_u32 v18, vcc, s14, v18
  s_nop 1
  v_addc_co_u32 v19, vcc, 0, v19, vcc
  global_load_dwordx4 a[72:75], v[16:17], off
  v_add_co_u32 v16, vcc, s14, v16
  s_nop 1
  v_addc_co_u32 v17, vcc, 0, v17, vcc
  global_load_dwordx4 a[76:79], v[18:19], off
  v_add_co_u32 v18, vcc, s14, v18
  s_nop 1
  v_addc_co_u32 v19, vcc, 0, v19, vcc
  global_load_dwordx4 a[192:195], v[16:17], off
  v_add_co_u32 v16, vcc, s14, v16
  s_nop 1
  v_addc_co_u32 v17, vcc, 0, v17, vcc
  global_load_dwordx4 a[196:199], v[18:19], off
  v_add_co_u32 v18, vcc, s14, v18
  s_nop 1
  v_addc_co_u32 v19, vcc, 0, v19, vcc
  global_load_dwordx4 a[200:203], v[16:17], off
  v_add_co_u32 v16, vcc, s14, v16
  s_nop 1
  v_addc_co_u32 v17, vcc, 0, v17, vcc
  global_load_dwordx4 a[204:207], v[18:19], off
  v_add_co_u32 v18, vcc, s14, v18
  s_nop 1
  v_addc_co_u32 v19, vcc, 0, v19, vcc
  v_add_co_u32 v16, vcc, s15, v16
  s_nop 1
  v_addc_co_u32 v17, vcc, 0, v17, vcc
  v_add_co_u32 v18, vcc, s15, v18
  s_nop 1
  v_addc_co_u32 v19, vcc, 0, v19, vcc
  global_load_dwordx4 a[80:83], v[16:17], off
  v_add_co_u32 v16, vcc, s14, v16
  s_nop 1
  v_addc_co_u32 v17, vcc, 0, v17, vcc
  global_load_dwordx4 a[84:87], v[18:19], off
  v_add_co_u32 v18, vcc, s14, v18
  s_nop 1
  v_addc_co_u32 v19, vcc, 0, v19, vcc
  global_load_dwordx4 a[88:91], v[16:17], off
  v_add_co_u32 v16, vcc, s14, v16
  s_nop 1
  v_addc_co_u32 v17, vcc, 0, v17, vcc
  global_load_dwordx4 a[92:95], v[18:19], off
  v_add_co_u32 v18, vcc, s14, v18
  s_nop 1
  v_addc_co_u32 v19, vcc, 0, v19, vcc
  global_load_dwordx4 a[208:211], v[16:17], off
  v_add_co_u32 v16, vcc, s14, v16
  s_nop 1
  v_addc_co_u32 v17, vcc, 0, v17, vcc
  global_load_dwordx4 a[212:215], v[18:19], off
  v_add_co_u32 v18, vcc, s14, v18
  s_nop 1
  v_addc_co_u32 v19, vcc, 0, v19, vcc
  global_load_dwordx4 a[216:219], v[16:17], off
  v_add_co_u32 v16, vcc, s14, v16
  s_nop 1
  v_addc_co_u32 v17, vcc, 0, v17, vcc
  global_load_dwordx4 a[220:223], v[18:19], off
  v_add_co_u32 v18, vcc, s14, v18
  s_nop 1
  v_addc_co_u32 v19, vcc, 0, v19, vcc
  v_add_co_u32 v16, vcc, s15, v16
  s_nop 1
  v_addc_co_u32 v17, vcc, 0, v17, vcc
  v_add_co_u32 v18, vcc, s15, v18
  s_nop 1
  v_addc_co_u32 v19, vcc, 0, v19, vcc
  global_load_dwordx4 a[96:99], v[16:17], off
  v_add_co_u32 v16, vcc, s14, v16
  s_nop 1
  v_addc_co_u32 v17, vcc, 0, v17, vcc
  global_load_dwordx4 a[100:103], v[18:19], off
  v_add_co_u32 v18, vcc, s14, v18
  s_nop 1
  v_addc_co_u32 v19, vcc, 0, v19, vcc
  global_load_dwordx4 a[104:107], v[16:17], off
  v_add_co_u32 v16, vcc, s14, v16
  s_nop 1
  v_addc_co_u32 v17, vcc, 0, v17, vcc
  global_load_dwordx4 a[108:111], v[18:19], off
  v_add_co_u32 v18, vcc, s14, v18
  s_nop 1
  v_addc_co_u32 v19, vcc, 0, v19, vcc
  global_load_dwordx4 a[224:227], v[16:17], off
  v_add_co_u32 v16, vcc, s14, v16
  s_nop 1
  v_addc_co_u32 v17, vcc, 0, v17, vcc
  global_load_dwordx4 a[228:231], v[18:19], off
  v_add_co_u32 v18, vcc, s14, v18
  s_nop 1
  v_addc_co_u32 v19, vcc, 0, v19, vcc
  global_load_dwordx4 a[232:235], v[16:17], off
  v_add_co_u32 v16, vcc, s14, v16
  s_nop 1
  v_addc_co_u32 v17, vcc, 0, v17, vcc
  global_load_dwordx4 a[236:239], v[18:19], off
  v_add_co_u32 v18, vcc, s14, v18
  s_nop 1
  v_addc_co_u32 v19, vcc, 0, v19, vcc
  v_add_co_u32 v16, vcc, s15, v16
  s_nop 1
  v_addc_co_u32 v17, vcc, 0, v17, vcc
  v_add_co_u32 v18, vcc, s15, v18
  s_nop 1
  v_addc_co_u32 v19, vcc, 0, v19, vcc
  s_waitcnt vmcnt(48)
  ds_write_b128 v21, a[0:3] offset:0
  ds_write_b128 v21, a[4:7] offset:1024
  ds_write_b128 v21, a[8:11] offset:2048
  ds_write_b128 v21, a[12:15] offset:3072
  ds_write_b128 v21, a[128:131] offset:4096
  ds_write_b128 v21, a[132:135] offset:5120
  ds_write_b128 v21, a[136:139] offset:6144
  ds_write_b128 v21, a[140:143] offset:7168
  s_waitcnt lgkmcnt(0)
  s_barrier
  ds_read_b64_tr_b16 a[0:1], v29 offset:0
  ds_read_b64_tr_b16 a[2:3], v29 offset:2048
  ds_read_b64_tr_b16 a[4:5], v29 offset:8192
  ds_read_b64_tr_b16 a[6:7], v29 offset:10240
  ds_read_b64_tr_b16 a[8:9], v29 offset:16384
  ds_read_b64_tr_b16 a[10:11], v29 offset:18432
  ds_read_b64_tr_b16 a[12:13], v29 offset:24576
  ds_read_b64_tr_b16 a[14:15], v29 offset:26624
  ds_read_b64_tr_b16 a[128:129], v30 offset:0
  ds_read_b64_tr_b16 a[130:131], v30 offset:2048
  ds_read_b64_tr_b16 a[132:133], v30 offset:8192
  ds_read_b64_tr_b16 a[134:135], v30 offset:10240
  ds_read_b64_tr_b16 a[136:137], v30 offset:16384
  ds_read_b64_tr_b16 a[138:139], v30 offset:18432
  ds_read_b64_tr_b16 a[140:141], v30 offset:24576
  ds_read_b64_tr_b16 a[142:143], v30 offset:26624
  global_load_dwordx4 a[112:115], v[16:17], off
  v_add_co_u32 v16, vcc, s14, v16
  s_nop 1
  v_addc_co_u32 v17, vcc, 0, v17, vcc
  global_load_dwordx4 a[116:119], v[18:19], off
  v_add_co_u32 v18, vcc, s14, v18
  s_nop 1
  v_addc_co_u32 v19, vcc, 0, v19, vcc
  global_load_dwordx4 a[120:123], v[16:17], off
  v_add_co_u32 v16, vcc, s14, v16
  s_nop 1
  v_addc_co_u32 v17, vcc, 0, v17, vcc
  global_load_dwordx4 a[124:127], v[18:19], off
  v_add_co_u32 v18, vcc, s14, v18
  s_nop 1
  v_addc_co_u32 v19, vcc, 0, v19, vcc
  global_load_dwordx4 a[240:243], v[16:17], off
  v_add_co_u32 v16, vcc, s14, v16
  s_nop 1
  v_addc_co_u32 v17, vcc, 0, v17, vcc
  global_load_dwordx4 a[244:247], v[18:19], off
  v_add_co_u32 v18, vcc, s14, v18
  s_nop 1
  v_addc_co_u32 v19, vcc, 0, v19, vcc
  global_load_dwordx4 a[248:251], v[16:17], off
  v_add_co_u32 v16, vcc, s14, v16
  s_nop 1
  v_addc_co_u32 v17, vcc, 0, v17, vcc
  global_load_dwordx4 a[252:255], v[18:19], off
  v_add_co_u32 v18, vcc, s14, v18
  s_nop 1
  v_addc_co_u32 v19, vcc, 0, v19, vcc
  v_add_co_u32 v16, vcc, s15, v16
  s_nop 1
  v_addc_co_u32 v17, vcc, 0, v17, vcc
  v_add_co_u32 v18, vcc, s15, v18
  s_nop 1
  v_addc_co_u32 v19, vcc, 0, v19, vcc
  s_waitcnt lgkmcnt(0)
  s_waitcnt vmcnt(48)
  ds_write_b128 v21, a[16:19] offset:32768
  ds_write_b128 v21, a[20:23] offset:33792
  ds_write_b128 v21, a[24:27] offset:34816
  ds_write_b128 v21, a[28:31] offset:35840
  ds_write_b128 v21, a[144:147] offset:36864
  ds_write_b128 v21, a[148:151] offset:37888
  ds_write_b128 v21, a[152:155] offset:38912
  ds_write_b128 v21, a[156:159] offset:39936
  s_waitcnt lgkmcnt(0)
  s_barrier
  ds_read_b64_tr_b16 a[16:17], v29 offset:32768
  ds_read_b64_tr_b16 a[18:19], v29 offset:34816
  ds_read_b64_tr_b16 a[20:21], v29 offset:40960
  ds_read_b64_tr_b16 a[22:23], v29 offset:43008
  ds_read_b64_tr_b16 a[24:25], v29 offset:49152
  ds_read_b64_tr_b16 a[26:27], v29 offset:51200
  ds_read_b64_tr_b16 a[28:29], v29 offset:57344
  ds_read_b64_tr_b16 a[30:31], v29 offset:59392
  ds_read_b64_tr_b16 a[144:145], v30 offset:32768
  ds_read_b64_tr_b16 a[146:147], v30 offset:34816
  ds_read_b64_tr_b16 a[148:149], v30 offset:40960
  ds_read_b64_tr_b16 a[150:151], v30 offset:43008
  ds_read_b64_tr_b16 a[152:153], v30 offset:49152
  ds_read_b64_tr_b16 a[154:155], v30 offset:51200
  ds_read_b64_tr_b16 a[156:157], v30 offset:57344
  ds_read_b64_tr_b16 a[158:159], v30 offset:59392
  s_waitcnt lgkmcnt(0)
  s_waitcnt vmcnt(40)
  ds_write_b128 v21, a[32:35] offset:0
  ds_write_b128 v21, a[36:39] offset:1024
  ds_write_b128 v21, a[40:43] offset:2048
  ds_write_b128 v21, a[44:47] offset:3072
  ds_write_b128 v21, a[160:163] offset:4096
  ds_write_b128 v21, a[164:167] offset:5120
  ds_write_b128 v21, a[168:171] offset:6144
  ds_write_b128 v21, a[172:175] offset:7168
  s_waitcnt lgkmcnt(0)
  s_barrier
  ds_read_b64_tr_b16 a[32:33], v29 offset:0
  ds_read_b64_tr_b16 a[34:35], v29 offset:2048
  ds_read_b64_tr_b16 a[36:37], v29 offset:8192
  ds_read_b64_tr_b16 a[38:39], v29 offset:10240
  ds_read_b64_tr_b16 a[40:41], v29 offset:16384
  ds_read_b64_tr_b16 a[42:43], v29 offset:18432
  ds_read_b64_tr_b16 a[44:45], v29 offset:24576
  ds_read_b64_tr_b16 a[46:47], v29 offset:26624
  ds_read_b64_tr_b16 a[160:161], v30 offset:0
  ds_read_b64_tr_b16 a[162:163], v30 offset:2048
  ds_read_b64_tr_b16 a[164:165], v30 offset:8192
  ds_read_b64_tr_b16 a[166:167], v30 offset:10240
  ds_read_b64_tr_b16 a[168:169], v30 offset:16384
  ds_read_b64_tr_b16 a[170:171], v30 offset:18432
  ds_read_b64_tr_b16 a[172:173], v30 offset:24576
  ds_read_b64_tr_b16 a[174:175], v30 offset:26624
  s_waitcnt lgkmcnt(0)
  s_waitcnt vmcnt(32)
  ds_write_b128 v21, a[48:51] offset:32768
  ds_write_b128 v21, a[52:55] offset:33792
  ds_write_b128 v21, a[56:59] offset:34816
  ds_write_b128 v21, a[60:63] offset:35840
  ds_write_b128 v21, a[176:179] offset:36864
  ds_write_b128 v21, a[180:183] offset:37888
  ds_write_b128 v21, a[184:187] offset:38912
  ds_write_b128 v21, a[188:191] offset:39936
  s_waitcnt lgkmcnt(0)
  s_barrier
  ds_read_b64_tr_b16 a[48:49], v29 offset:32768
  ds_read_b64_tr_b16 a[50:51], v29 offset:34816
  ds_read_b64_tr_b16 a[52:53], v29 offset:40960
  ds_read_b64_tr_b16 a[54:55], v29 offset:43008
  ds_read_b64_tr_b16 a[56:57], v29 offset:49152
  ds_read_b64_tr_b16 a[58:59], v29 offset:51200
  ds_read_b64_tr_b16 a[60:61], v29 offset:57344
  ds_read_b64_tr_b16 a[62:63], v29 offset:59392
  ds_read_b64_tr_b16 a[176:177], v30 offset:32768
  ds_read_b64_tr_b16 a[178:179], v30 offset:34816
  ds_read_b64_tr_b16 a[180:181], v30 offset:40960
  ds_read_b64_tr_b16 a[182:183], v30 offset:43008
  ds_read_b64_tr_b16 a[184:185], v30 offset:49152
  ds_read_b64_tr_b16 a[186:187], v30 offset:51200
  ds_read_b64_tr_b16 a[188:189], v30 offset:57344
  ds_read_b64_tr_b16 a[190:191], v30 offset:59392
  s_waitcnt lgkmcnt(0)
  s_waitcnt vmcnt(24)
  ds_write_b128 v21, a[64:67] offset:0
  ds_write_b128 v21, a[68:71] offset:1024
  ds_write_b128 v21, a[72:75] offset:2048
  ds_write_b128 v21, a[76:79] offset:3072
  ds_write_b128 v21, a[192:195] offset:4096
  ds_write_b128 v21, a[196:199] offset:5120
  ds_write_b128 v21, a[200:203] offset:6144
  ds_write_b128 v21, a[204:207] offset:7168
  s_waitcnt lgkmcnt(0)
  s_barrier
  ds_read_b64_tr_b16 a[64:65], v29 offset:0
  ds_read_b64_tr_b16 a[66:67], v29 offset:2048
  ds_read_b64_tr_b16 a[68:69], v29 offset:8192
  ds_read_b64_tr_b16 a[70:71], v29 offset:10240
  ds_read_b64_tr_b16 a[72:73], v29 offset:16384
  ds_read_b64_tr_b16 a[74:75], v29 offset:18432
  ds_read_b64_tr_b16 a[76:77], v29 offset:24576
  ds_read_b64_tr_b16 a[78:79], v29 offset:26624
  ds_read_b64_tr_b16 a[192:193], v30 offset:0
  ds_read_b64_tr_b16 a[194:195], v30 offset:2048
  ds_read_b64_tr_b16 a[196:197], v30 offset:8192
  ds_read_b64_tr_b16 a[198:199], v30 offset:10240
  ds_read_b64_tr_b16 a[200:201], v30 offset:16384
  ds_read_b64_tr_b16 a[202:203], v30 offset:18432
  ds_read_b64_tr_b16 a[204:205], v30 offset:24576
  ds_read_b64_tr_b16 a[206:207], v30 offset:26624
  s_waitcnt lgkmcnt(0)
  s_waitcnt vmcnt(16)
  ds_write_b128 v21, a[80:83] offset:32768
  ds_write_b128 v21, a[84:87] offset:33792
  ds_write_b128 v21, a[88:91] offset:34816
  ds_write_b128 v21, a[92:95] offset:35840
  ds_write_b128 v21, a[208:211] offset:36864
  ds_write_b128 v21, a[212:215] offset:37888
  ds_write_b128 v21, a[216:219] offset:38912
  ds_write_b128 v21, a[220:223] offset:39936
  s_waitcnt lgkmcnt(0)
  s_barrier
  ds_read_b64_tr_b16 a[80:81], v29 offset:32768
  ds_read_b64_tr_b16 a[82:83], v29 offset:34816
  ds_read_b64_tr_b16 a[84:85], v29 offset:40960
  ds_read_b64_tr_b16 a[86:87], v29 offset:43008
  ds_read_b64_tr_b16 a[88:89], v29 offset:49152
  ds_read_b64_tr_b16 a[90:91], v29 offset:51200
  ds_read_b64_tr_b16 a[92:93], v29 offset:57344
  ds_read_b64_tr_b16 a[94:95], v29 offset:59392
  ds_read_b64_tr_b16 a[208:209], v30 offset:32768
  ds_read_b64_tr_b16 a[210:211], v30 offset:34816
  ds_read_b64_tr_b16 a[212:213], v30 offset:40960
  ds_read_b64_tr_b16 a[214:215], v30 offset:43008
  ds_read_b64_tr_b16 a[216:217], v30 offset:49152
  ds_read_b64_tr_b16 a[218:219], v30 offset:51200
  ds_read_b64_tr_b16 a[220:221], v30 offset:57344
  ds_read_b64_tr_b16 a[222:223], v30 offset:59392
  s_waitcnt lgkmcnt(0)
  s_waitcnt vmcnt(8)
  ds_write_b128 v21, a[96:99] offset:0
  ds_write_b128 v21, a[100:103] offset:1024
  ds_write_b128 v21, a[104:107] offset:2048
  ds_write_b128 v21, a[108:111] offset:3072
  ds_write_b128 v21, a[224:227] offset:4096
  ds_write_b128 v21, a[228:231] offset:5120
  ds_write_b128 v21, a[232:235] offset:6144
  ds_write_b128 v21, a[236:239] offset:7168
  s_waitcnt lgkmcnt(0)
  s_barrier
  ds_read_b64_tr_b16 a[96:97], v29 offset:0
  ds_read_b64_tr_b16 a[98:99], v29 offset:2048
  ds_read_b64_tr_b16 a[100:101], v29 offset:8192
  ds_read_b64_tr_b16 a[102:103], v29 offset:10240
  ds_read_b64_tr_b16 a[104:105], v29 offset:16384
  ds_read_b64_tr_b16 a[106:107], v29 offset:18432
  ds_read_b64_tr_b16 a[108:109], v29 offset:24576
  ds_read_b64_tr_b16 a[110:111], v29 offset:26624
  ds_read_b64_tr_b16 a[224:225], v30 offset:0
  ds_read_b64_tr_b16 a[226:227], v30 offset:2048
  ds_read_b64_tr_b16 a[228:229], v30 offset:8192
  ds_read_b64_tr_b16 a[230:231], v30 offset:10240
  ds_read_b64_tr_b16 a[232:233], v30 offset:16384
  ds_read_b64_tr_b16 a[234:235], v30 offset:18432
  ds_read_b64_tr_b16 a[236:237], v30 offset:24576
  ds_read_b64_tr_b16 a[238:239], v30 offset:26624
  s_waitcnt lgkmcnt(0)
  s_waitcnt vmcnt(0)
  ds_write_b128 v21, a[112:115] offset:32768
  ds_write_b128 v21, a[116:119] offset:33792
  ds_write_b128 v21, a[120:123] offset:34816
  ds_write_b128 v21, a[124:127] offset:35840
  ds_write_b128 v21, a[240:243] offset:36864
  ds_write_b128 v21, a[244:247] offset:37888
  ds_write_b128 v21, a[248:251] offset:38912
  ds_write_b128 v21, a[252:255] offset:39936
  s_waitcnt lgkmcnt(0)
  s_barrier
  ds_read_b64_tr_b16 a[112:113], v29 offset:32768
  ds_read_b64_tr_b16 a[114:115], v29 offset:34816
  ds_read_b64_tr_b16 a[116:117], v29 offset:40960
  ds_read_b64_tr_b16 a[118:119], v29 offset:43008
  ds_read_b64_tr_b16 a[120:121], v29 offset:49152
  ds_read_b64_tr_b16 a[122:123], v29 offset:51200
  ds_read_b64_tr_b16 a[124:125], v29 offset:57344
  ds_read_b64_tr_b16 a[126:127], v29 offset:59392
  ds_read_b64_tr_b16 a[240:241], v30 offset:32768
  ds_read_b64_tr_b16 a[242:243], v30 offset:34816
  ds_read_b64_tr_b16 a[244:245], v30 offset:40960
  ds_read_b64_tr_b16 a[246:247], v30 offset:43008
  ds_read_b64_tr_b16 a[248:249], v30 offset:49152
  ds_read_b64_tr_b16 a[250:251], v30 offset:51200
  ds_read_b64_tr_b16 a[252:253], v30 offset:57344
  ds_read_b64_tr_b16 a[254:255], v30 offset:59392
  s_waitcnt lgkmcnt(0)
  s_barrier
  s_cmp_lg_u32 s8, 0
  s_cbranch_scc1 L_wfiok_101
  v_mov_b32 v254, 16
  s_mov_b32 s49, 0
L_wfi_100:
  global_load_dword v255, v254, s[6:7] sc1
  s_add_u32 s49, s49, 1
  s_cmp_gt_u32 s49, 0x20000
  s_cbranch_scc1 L_wfiok_101
  s_waitcnt vmcnt(0)
  v_cmp_gt_u32 vcc, 256, v255
  s_nop 0
  s_cbranch_vccz L_wfiok_101
  s_sleep 8
  s_branch L_wfi_100
L_wfiok_101:
  s_barrier
  v_and_b32 v12, 31, v0
  v_lshrrev_b32 v13, 5, v0
  v_and_b32 v14, 15, v0
  v_add_u32 v15, 0, v13
  v_xor_b32 v15, v15, v14
  v_lshlrev_b32 v15, 4, v15
  v_lshl_add_u32 v2, v12, 10, v15
  v_add_u32 v15, 2, v13
  v_xor_b32 v15, v15, v14
  v_lshlrev_b32 v15, 4, v15
  v_lshl_add_u32 v3, v12, 10, v15
  v_add_u32 v15, 4, v13
  v_xor_b32 v15, v15, v14
  v_lshlrev_b32 v15, 4, v15
  v_lshl_add_u32 v4, v12, 10, v15
  v_add_u32 v15, 6, v13
  v_xor_b32 v15, v15, v14
  v_lshlrev_b32 v15, 4, v15
  v_lshl_add_u32 v5, v12, 10, v15
  v_add_u32 v15, 8, v13
  v_xor_b32 v15, v15, v14
  v_lshlrev_b32 v15, 4, v15
  v_lshl_add_u32 v6, v12, 10, v15
  v_add_u32 v15, 10, v13
  v_xor_b32 v15, v15, v14
  v_lshlrev_b32 v15, 4, v15
  v_lshl_add_u32 v7, v12, 10, v15
  v_add_u32 v15, 12, v13
  v_xor_b32 v15, v15, v14
  v_lshlrev_b32 v15, 4, v15
  v_lshl_add_u32 v8, v12, 10, v15
  v_add_u32 v15, 14, v13
  v_xor_b32 v15, v15, v14
  v_lshlrev_b32 v15, 4, v15
  v_lshl_add_u32 v9, v12, 10, v15
  s_and_b32 s12, s8, 1
  s_lshl_b32 s12, s12, 7
  v_xor_b32 v10, s12, v1
  s_mov_b32 s34, 0
  s_lshl_b32 s12, s30, 15
  s_add_u32 s26, s60, s12
  s_addc_u32 s27, s61, 0
  s_lshl_b32 s12, s8, 13
  s_add_u32 s16, s26, s12
  s_addc_u32 s17, s27, 0
  s_add_u32 s12, s12, s34
  v_xor_b32 v11, 0, v10
  s_add_u32 m0, s12, 0
  s_nop 0
  global_load_lds_dwordx4 v11, s[16:17]
  s_add_u32 s16, s16, 1024
  s_addc_u32 s17, s17, 0
  v_xor_b32 v11, 16, v10
  s_add_u32 m0, s12, 1024
  s_nop 0
  global_load_lds_dwordx4 v11, s[16:17]
  s_add_u32 s16, s16, 1024
  s_addc_u32 s17, s17, 0
  v_xor_b32 v11, 32, v10
  s_add_u32 m0, s12, 2048
  s_nop 0
  global_load_lds_dwordx4 v11, s[16:17]
  s_add_u32 s16, s16, 1024
  s_addc_u32 s17, s17, 0
  v_xor_b32 v11, 48, v10
  s_add_u32 m0, s12, 3072
  s_nop 0
  global_load_lds_dwordx4 v11, s[16:17]
  s_add_u32 s16, s16, 1024
  s_addc_u32 s17, s17, 0
  v_xor_b32 v11, 64, v10
  s_add_u32 m0, s12, 4096
  s_nop 0
  global_load_lds_dwordx4 v11, s[16:17]
  s_add_u32 s16, s16, 1024
  s_addc_u32 s17, s17, 0
  v_xor_b32 v11, 80, v10
  s_add_u32 m0, s12, 5120
  s_nop 0
  global_load_lds_dwordx4 v11, s[16:17]
  s_add_u32 s16, s16, 1024
  s_addc_u32 s17, s17, 0
  v_xor_b32 v11, 96, v10
  s_add_u32 m0, s12, 6144
  s_nop 0
  global_load_lds_dwordx4 v11, s[16:17]
  s_add_u32 s16, s16, 1024
  s_addc_u32 s17, s17, 0
  v_xor_b32 v11, 112, v10
  s_add_u32 m0, s12, 7168
  s_nop 0
  global_load_lds_dwordx4 v11, s[16:17]
  s_mov_b32 s52, -1
  s_mov_b32 s53, -1
  s_waitcnt vmcnt(0)
L_seg_102:
  s_waitcnt vmcnt(2)
  s_barrier
  s_cmp_eq_u32 s52, -1
  s_cbranch_scc1 L_nf_103
  s_cmp_lg_u32 s8, 0
  s_cbranch_scc1 L_fs_104
  s_lshl_b32 s48, s52, 14
  s_lshl_b32 s49, s36, 7
  s_add_u32 s48, s48, s49
  s_add_u32 s48, s48, 0
  v_mov_b32 v254, s48
  v_mov_b32 v255, 1
  s_mov_b64 exec, 1
  global_store_dword v254, v255, s[46:47] sc1
  s_mov_b64 exec, -1
L_fs_104:
L_nf_103:
  s_mov_b32 s52, s53
  s_mov_b32 s53, s30
  s_mul_i32 s12, s30, 114688
  s_add_u32 s12, s12, s37
  s_add_u32 s12, s12, 83886080
  s_add_u32 s28, s4, s12
  s_addc_u32 s29, s5, 0
  s_add_u32 s30, s30, s33
  s_sub_u32 s35, s35, 1
  s_xor_b32 s34, s34, 32768
  s_cmp_eq_u32 s35, 0
  s_cbranch_scc1 L_nonext_105
  s_lshl_b32 s12, s30, 15
  s_add_u32 s26, s60, s12
  s_addc_u32 s27, s61, 0
  s_lshl_b32 s12, s8, 13
  s_add_u32 s16, s26, s12
  s_addc_u32 s17, s27, 0
  s_add_u32 s12, s12, s34
  v_xor_b32 v11, 0, v10
  s_add_u32 m0, s12, 0
  s_nop 0
  global_load_lds_dwordx4 v11, s[16:17]
  s_add_u32 s16, s16, 1024
  s_addc_u32 s17, s17, 0
  v_xor_b32 v11, 16, v10
  s_add_u32 m0, s12, 1024
  s_nop 0
  global_load_lds_dwordx4 v11, s[16:17]
  s_add_u32 s16, s16, 1024
  s_addc_u32 s17, s17, 0
  v_xor_b32 v11, 32, v10
  s_add_u32 m0, s12, 2048
  s_nop 0
  global_load_lds_dwordx4 v11, s[16:17]
  s_add_u32 s16, s16, 1024
  s_addc_u32 s17, s17, 0
  v_xor_b32 v11, 48, v10
  s_add_u32 m0, s12, 3072
  s_nop 0
  global_load_lds_dwordx4 v11, s[16:17]
  s_add_u32 s16, s16, 1024
  s_addc_u32 s17, s17, 0
  v_xor_b32 v11, 64, v10
  s_add_u32 m0, s12, 4096
  s_nop 0
  global_load_lds_dwordx4 v11, s[16:17]
  s_add_u32 s16, s16, 1024
  s_addc_u32 s17, s17, 0
  v_xor_b32 v11, 80, v10
  s_add_u32 m0, s12, 5120
  s_nop 0
  global_load_lds_dwordx4 v11, s[16:17]
  s_add_u32 s16, s16, 1024
  s_addc_u32 s17, s17, 0
  v_xor_b32 v11, 96, v10
  s_add_u32 m0, s12, 6144
  s_nop 0
  global_load_lds_dwordx4 v11, s[16:17]
  s_add_u32 s16, s16, 1024
  s_addc_u32 s17, s17, 0
  v_xor_b32 v11, 112, v10
  s_add_u32 m0, s12, 7168
  s_nop 0
  global_load_lds_dwordx4 v11, s[16:17]
L_nonext_105:
  ds_read_b128 v[32:35], v2 offset:0
  ds_read_b128 v[36:39], v3 offset:0
  ds_read_b128 v[40:43], v4 offset:0
  ds_read_b128 v[44:47], v5 offset:0
  ds_read_b128 v[48:51], v6 offset:0
  ds_read_b128 v[52:55], v7 offset:0
  s_waitcnt lgkmcnt(5)
  v_mfma_f32_32x32x16_bf16 v[64:79], a[0:3], v[32:35], 0
  ds_read_b128 v[56:59], v8 offset:0
  v_mfma_f32_32x32x16_bf16 v[80:95], a[128:131], v[32:35], 0
  s_waitcnt lgkmcnt(5)
  v_mfma_f32_32x32x16_bf16 v[64:79], a[4:7], v[36:39], v[64:79]
  ds_read_b128 v[60:63], v9 offset:0
  v_mfma_f32_32x32x16_bf16 v[80:95], a[132:135], v[36:39], v[80:95]
  s_waitcnt lgkmcnt(5)
  v_mfma_f32_32x32x16_bf16 v[64:79], a[8:11], v[40:43], v[64:79]
  ds_read_b128 v[32:35], v2 offset:256
  v_mfma_f32_32x32x16_bf16 v[80:95], a[136:139], v[40:43], v[80:95]
  s_waitcnt lgkmcnt(5)
  v_mfma_f32_32x32x16_bf16 v[64:79], a[12:15], v[44:47], v[64:79]
  ds_read_b128 v[36:39], v3 offset:256
  v_mfma_f32_32x32x16_bf16 v[80:95], a[140:143], v[44:47], v[80:95]
  s_waitcnt lgkmcnt(5)
  v_mfma_f32_32x32x16_bf16 v[64:79], a[16:19], v[48:51], v[64:79]
  ds_read_b128 v[40:43], v4 offset:256
  v_mfma_f32_32x32x16_bf16 v[80:95], a[144:147], v[48:51], v[80:95]
  s_waitcnt lgkmcnt(5)
  v_mfma_f32_32x32x16_bf16 v[64:79], a[20:23], v[52:55], v[64:79]
  ds_read_b128 v[44:47], v5 offset:256
  v_mfma_f32_32x32x16_bf16 v[80:95], a[148:151], v[52:55], v[80:95]
  s_waitcnt lgkmcnt(5)
  v_mfma_f32_32x32x16_bf16 v[64:79], a[24:27], v[56:59], v[64:79]
  ds_read_b128 v[48:51], v6 offset:256
  v_mfma_f32_32x32x16_bf16 v[80:95], a[152:155], v[56:59], v[80:95]
  s_waitcnt lgkmcnt(5)
  v_mfma_f32_32x32x16_bf16 v[64:79], a[28:31], v[60:63], v[64:79]
  ds_read_b128 v[52:55], v7 offset:256
  v_mfma_f32_32x32x16_bf16 v[80:95], a[156:159], v[60:63], v[80:95]
  s_waitcnt lgkmcnt(5)
  v_mfma_f32_32x32x16_bf16 v[64:79], a[32:35], v[32:35], v[64:79]
  ds_read_b128 v[56:59], v8 offset:256
  v_mfma_f32_32x32x16_bf16 v[80:95], a[160:163], v[32:35], v[80:95]
  s_waitcnt lgkmcnt(5)
  v_mfma_f32_32x32x16_bf16 v[64:79], a[36:39], v[36:39], v[64:79]
  ds_read_b128 v[60:63], v9 offset:256
  v_mfma_f32_32x32x16_bf16 v[80:95], a[164:167], v[36:39], v[80:95]
  s_waitcnt lgkmcnt(5)
  v_mfma_f32_32x32x16_bf16 v[64:79], a[40:43], v[40:43], v[64:79]
  ds_read_b128 v[32:35], v2 offset:512
  v_mfma_f32_32x32x16_bf16 v[80:95], a[168:171], v[40:43], v[80:95]
  s_waitcnt lgkmcnt(5)
  v_mfma_f32_32x32x16_bf16 v[64:79], a[44:47], v[44:47], v[64:79]
  ds_read_b128 v[36:39], v3 offset:512
  v_mfma_f32_32x32x16_bf16 v[80:95], a[172:175], v[44:47], v[80:95]
  s_waitcnt lgkmcnt(5)
  v_mfma_f32_32x32x16_bf16 v[64:79], a[48:51], v[48:51], v[64:79]
  ds_read_b128 v[40:43], v4 offset:512
  v_mfma_f32_32x32x16_bf16 v[80:95], a[176:179], v[48:51], v[80:95]
  s_waitcnt lgkmcnt(5)
  v_mfma_f32_32x32x16_bf16 v[64:79], a[52:55], v[52:55], v[64:79]
  ds_read_b128 v[44:47], v5 offset:512
  v_mfma_f32_32x32x16_bf16 v[80:95], a[180:183], v[52:55], v[80:95]
  s_waitcnt lgkmcnt(5)
  v_mfma_f32_32x32x16_bf16 v[64:79], a[56:59], v[56:59], v[64:79]
  ds_read_b128 v[48:51], v6 offset:512
  v_mfma_f32_32x32x16_bf16 v[80:95], a[184:187], v[56:59], v[80:95]
  s_waitcnt lgkmcnt(5)
  v_mfma_f32_32x32x16_bf16 v[64:79], a[60:63], v[60:63], v[64:79]
  ds_read_b128 v[52:55], v7 offset:512
  v_mfma_f32_32x32x16_bf16 v[80:95], a[188:191], v[60:63], v[80:95]
  s_waitcnt lgkmcnt(5)
  v_mfma_f32_32x32x16_bf16 v[64:79], a[64:67], v[32:35], v[64:79]
  ds_read_b128 v[56:59], v8 offset:512
  v_mfma_f32_32x32x16_bf16 v[80:95], a[192:195], v[32:35], v[80:95]
  s_waitcnt lgkmcnt(5)
  v_mfma_f32_32x32x16_bf16 v[64:79], a[68:71], v[36:39], v[64:79]
  ds_read_b128 v[60:63], v9 offset:512
  v_mfma_f32_32x32x16_bf16 v[80:95], a[196:199], v[36:39], v[80:95]
  s_waitcnt lgkmcnt(5)
  v_mfma_f32_32x32x16_bf16 v[64:79], a[72:75], v[40:43], v[64:79]
  ds_read_b128 v[32:35], v2 offset:768
  v_mfma_f32_32x32x16_bf16 v[80:95], a[200:203], v[40:43], v[80:95]
  s_waitcnt lgkmcnt(5)
  v_mfma_f32_32x32x16_bf16 v[64:79], a[76:79], v[44:47], v[64:79]
  ds_read_b128 v[36:39], v3 offset:768
  v_mfma_f32_32x32x16_bf16 v[80:95], a[204:207], v[44:47], v[80:95]
  s_waitcnt lgkmcnt(5)
  v_mfma_f32_32x32x16_bf16 v[64:79], a[80:83], v[48:51], v[64:79]
  ds_read_b128 v[40:43], v4 offset:768
  v_mfma_f32_32x32x16_bf16 v[80:95], a[208:211], v[48:51], v[80:95]
  s_waitcnt lgkmcnt(5)
  v_mfma_f32_32x32x16_bf16 v[64:79], a[84:87], v[52:55], v[64:79]
  ds_read_b128 v[44:47], v5 offset:768
  v_mfma_f32_32x32x16_bf16 v[80:95], a[212:215], v[52:55], v[80:95]
  s_waitcnt lgkmcnt(5)
  v_mfma_f32_32x32x16_bf16 v[64:79], a[88:91], v[56:59], v[64:79]
  ds_read_b128 v[48:51], v6 offset:768
  v_mfma_f32_32x32x16_bf16 v[80:95], a[216:219], v[56:59], v[80:95]
  s_waitcnt lgkmcnt(5)
  v_mfma_f32_32x32x16_bf16 v[64:79], a[92:95], v[60:63], v[64:79]
  ds_read_b128 v[52:55], v7 offset:768
  v_mfma_f32_32x32x16_bf16 v[80:95], a[220:223], v[60:63], v[80:95]
  s_waitcnt lgkmcnt(5)
  v_mfma_f32_32x32x16_bf16 v[64:79], a[96:99], v[32:35], v[64:79]
  ds_read_b128 v[56:59], v8 offset:768
  v_mfma_f32_32x32x16_bf16 v[80:95], a[224:227], v[32:35], v[80:95]
  s_waitcnt lgkmcnt(5)
  v_mfma_f32_32x32x16_bf16 v[64:79], a[100:103], v[36:39], v[64:79]
  ds_read_b128 v[60:63], v9 offset:768
  v_mfma_f32_32x32x16_bf16 v[80:95], a[228:231], v[36:39], v[80:95]
  s_waitcnt lgkmcnt(5)
  v_mfma_f32_32x32x16_bf16 v[64:79], a[104:107], v[40:43], v[64:79]
  v_mfma_f32_32x32x16_bf16 v[80:95], a[232:235], v[40:43], v[80:95]
  s_waitcnt lgkmcnt(4)
  v_mfma_f32_32x32x16_bf16 v[64:79], a[108:111], v[44:47], v[64:79]
  v_mfma_f32_32x32x16_bf16 v[80:95], a[236:239], v[44:47], v[80:95]
  s_waitcnt lgkmcnt(3)
  v_mfma_f32_32x32x16_bf16 v[64:79], a[112:115], v[48:51], v[64:79]
  v_mfma_f32_32x32x16_bf16 v[80:95], a[240:243], v[48:51], v[80:95]
  s_waitcnt lgkmcnt(2)
  v_mfma_f32_32x32x16_bf16 v[64:79], a[116:119], v[52:55], v[64:79]
  v_mfma_f32_32x32x16_bf16 v[80:95], a[244:247], v[52:55], v[80:95]
  s_waitcnt lgkmcnt(1)
  v_mfma_f32_32x32x16_bf16 v[64:79], a[120:123], v[56:59], v[64:79]
  v_mfma_f32_32x32x16_bf16 v[80:95], a[248:251], v[56:59], v[80:95]
  s_waitcnt lgkmcnt(0)
  v_mfma_f32_32x32x16_bf16 v[64:79], a[124:127], v[60:63], v[64:79]
  v_mfma_f32_32x32x16_bf16 v[80:95], a[252:255], v[60:63], v[80:95]
  v_xor_b32 v2, 32768, v2
  v_xor_b32 v3, 32768, v3
  v_xor_b32 v4, 32768, v4
  v_xor_b32 v5, 32768, v5
  v_xor_b32 v6, 32768, v6
  v_xor_b32 v7, 32768, v7
  v_xor_b32 v8, 32768, v8
  v_xor_b32 v9, 32768, v9
  v_cvt_pk_bf16_f32 v104, v64, v65
  s_nop 2
  v_cvt_pk_bf16_f32 v105, v80, v81
  v_lshlrev_b32 v106, 16, v104
  v_and_b32 v107, 0xffff0000, v104
  v_lshlrev_b32 v110, 16, v105
  v_and_b32 v111, 0xffff0000, v105
  v_pk_mul_f32 v[108:109], v[106:107], s[40:41]
  v_exp_f32 v108, v108
  v_exp_f32 v109, v109
  s_nop 0
  v_pk_add_f32 v[108:109], v[108:109], s[42:43]
  v_rcp_f32 v108, v108
  v_rcp_f32 v109, v109
  s_nop 0
  v_pk_mul_f32 v[108:109], v[108:109], v[106:107]
  v_cvt_pk_bf16_f32 v104, v108, v109
  v_lshlrev_b32 v108, 16, v104
  v_and_b32 v109, 0xffff0000, v104
  v_pk_mul_f32 v[108:109], v[108:109], v[110:111]
  v_cvt_pk_bf16_f32 v96, v108, v109
  v_cvt_pk_bf16_f32 v104, v66, v67
  v_cvt_pk_bf16_f32 v105, v82, v83
  v_lshlrev_b32 v106, 16, v104
  v_and_b32 v107, 0xffff0000, v104
  v_lshlrev_b32 v110, 16, v105
  v_and_b32 v111, 0xffff0000, v105
  v_pk_mul_f32 v[108:109], v[106:107], s[40:41]
  v_exp_f32 v108, v108
  v_exp_f32 v109, v109
  s_nop 0
  v_pk_add_f32 v[108:109], v[108:109], s[42:43]
  v_rcp_f32 v108, v108
  v_rcp_f32 v109, v109
  s_nop 0
  v_pk_mul_f32 v[108:109], v[108:109], v[106:107]
  v_cvt_pk_bf16_f32 v104, v108, v109
  v_lshlrev_b32 v108, 16, v104
  v_and_b32 v109, 0xffff0000, v104
  v_pk_mul_f32 v[108:109], v[108:109], v[110:111]
  v_cvt_pk_bf16_f32 v97, v108, v109
  v_cvt_pk_bf16_f32 v104, v68, v69
  v_cvt_pk_bf16_f32 v105, v84, v85
  v_lshlrev_b32 v106, 16, v104
  v_and_b32 v107, 0xffff0000, v104
  v_lshlrev_b32 v110, 16, v105
  v_and_b32 v111, 0xffff0000, v105
  v_pk_mul_f32 v[108:109], v[106:107], s[40:41]
  v_exp_f32 v108, v108
  v_exp_f32 v109, v109
  s_nop 0
  v_pk_add_f32 v[108:109], v[108:109], s[42:43]
  v_rcp_f32 v108, v108
  v_rcp_f32 v109, v109
  s_nop 0
  v_pk_mul_f32 v[108:109], v[108:109], v[106:107]
  v_cvt_pk_bf16_f32 v104, v108, v109
  v_lshlrev_b32 v108, 16, v104
  v_and_b32 v109, 0xffff0000, v104
  v_pk_mul_f32 v[108:109], v[108:109], v[110:111]
  v_cvt_pk_bf16_f32 v98, v108, v109
  v_cvt_pk_bf16_f32 v104, v70, v71
  v_cvt_pk_bf16_f32 v105, v86, v87
  v_lshlrev_b32 v106, 16, v104
  v_and_b32 v107, 0xffff0000, v104
  v_lshlrev_b32 v110, 16, v105
  v_and_b32 v111, 0xffff0000, v105
  v_pk_mul_f32 v[108:109], v[106:107], s[40:41]
  v_exp_f32 v108, v108
  v_exp_f32 v109, v109
  s_nop 0
  v_pk_add_f32 v[108:109], v[108:109], s[42:43]
  v_rcp_f32 v108, v108
  v_rcp_f32 v109, v109
  s_nop 0
  v_pk_mul_f32 v[108:109], v[108:109], v[106:107]
  v_cvt_pk_bf16_f32 v104, v108, v109
  v_lshlrev_b32 v108, 16, v104
  v_and_b32 v109, 0xffff0000, v104
  v_pk_mul_f32 v[108:109], v[108:109], v[110:111]
  v_cvt_pk_bf16_f32 v99, v108, v109
  global_store_dwordx4 v1, v[96:99], s[28:29] offset:0 sc1
  v_cvt_pk_bf16_f32 v104, v72, v73
  v_cvt_pk_bf16_f32 v105, v88, v89
  v_lshlrev_b32 v106, 16, v104
  v_and_b32 v107, 0xffff0000, v104
  v_lshlrev_b32 v110, 16, v105
  v_and_b32 v111, 0xffff0000, v105
  v_pk_mul_f32 v[108:109], v[106:107], s[40:41]
  v_exp_f32 v108, v108
  v_exp_f32 v109, v109
  s_nop 0
  v_pk_add_f32 v[108:109], v[108:109], s[42:43]
  v_rcp_f32 v108, v108
  v_rcp_f32 v109, v109
  s_nop 0
  v_pk_mul_f32 v[108:109], v[108:109], v[106:107]
  v_cvt_pk_bf16_f32 v104, v108, v109
  v_lshlrev_b32 v108, 16, v104
  v_and_b32 v109, 0xffff0000, v104
  v_pk_mul_f32 v[108:109], v[108:109], v[110:111]
  v_cvt_pk_bf16_f32 v100, v108, v109
  v_cvt_pk_bf16_f32 v104, v74, v75
  v_cvt_pk_bf16_f32 v105, v90, v91
  v_lshlrev_b32 v106, 16, v104
  v_and_b32 v107, 0xffff0000, v104
  v_lshlrev_b32 v110, 16, v105
  v_and_b32 v111, 0xffff0000, v105
  v_pk_mul_f32 v[108:109], v[106:107], s[40:41]
  v_exp_f32 v108, v108
  v_exp_f32 v109, v109
  s_nop 0
  v_pk_add_f32 v[108:109], v[108:109], s[42:43]
  v_rcp_f32 v108, v108
  v_rcp_f32 v109, v109
  s_nop 0
  v_pk_mul_f32 v[108:109], v[108:109], v[106:107]
  v_cvt_pk_bf16_f32 v104, v108, v109
  v_lshlrev_b32 v108, 16, v104
  v_and_b32 v109, 0xffff0000, v104
  v_pk_mul_f32 v[108:109], v[108:109], v[110:111]
  v_cvt_pk_bf16_f32 v101, v108, v109
  v_cvt_pk_bf16_f32 v104, v76, v77
  v_cvt_pk_bf16_f32 v105, v92, v93
  v_lshlrev_b32 v106, 16, v104
  v_and_b32 v107, 0xffff0000, v104
  v_lshlrev_b32 v110, 16, v105
  v_and_b32 v111, 0xffff0000, v105
  v_pk_mul_f32 v[108:109], v[106:107], s[40:41]
  v_exp_f32 v108, v108
  v_exp_f32 v109, v109
  s_nop 0
  v_pk_add_f32 v[108:109], v[108:109], s[42:43]
  v_rcp_f32 v108, v108
  v_rcp_f32 v109, v109
  s_nop 0
  v_pk_mul_f32 v[108:109], v[108:109], v[106:107]
  v_cvt_pk_bf16_f32 v104, v108, v109
  v_lshlrev_b32 v108, 16, v104
  v_and_b32 v109, 0xffff0000, v104
  v_pk_mul_f32 v[108:109], v[108:109], v[110:111]
  v_cvt_pk_bf16_f32 v102, v108, v109
  v_cvt_pk_bf16_f32 v104, v78, v79
  v_cvt_pk_bf16_f32 v105, v94, v95
  v_lshlrev_b32 v106, 16, v104
  v_and_b32 v107, 0xffff0000, v104
  v_lshlrev_b32 v110, 16, v105
  v_and_b32 v111, 0xffff0000, v105
  v_pk_mul_f32 v[108:109], v[106:107], s[40:41]
  v_exp_f32 v108, v108
  v_exp_f32 v109, v109
  s_nop 0
  v_pk_add_f32 v[108:109], v[108:109], s[42:43]
  v_rcp_f32 v108, v108
  v_rcp_f32 v109, v109
  s_nop 0
  v_pk_mul_f32 v[108:109], v[108:109], v[106:107]
  v_cvt_pk_bf16_f32 v104, v108, v109
  v_lshlrev_b32 v108, 16, v104
  v_and_b32 v109, 0xffff0000, v104
  v_pk_mul_f32 v[108:109], v[108:109], v[110:111]
  v_cvt_pk_bf16_f32 v103, v108, v109
  global_store_dwordx4 v1, v[100:103], s[28:29] offset:1024 sc1
  s_cmp_eq_u32 s52, -1
  s_cbranch_scc0 L_nfirst_106
  s_cmp_lt_u32 s53, 3
  s_cbranch_scc0 L_nfirst_106
  s_waitcnt vmcnt(0)
  s_barrier
  s_cmp_lg_u32 s8, 0
  s_cbranch_scc1 L_fs_107
  s_lshl_b32 s48, s53, 14
  s_lshl_b32 s49, s36, 7
  s_add_u32 s48, s48, s49
  s_add_u32 s48, s48, 0
  v_mov_b32 v254, s48
  v_mov_b32 v255, 1
  s_mov_b64 exec, 1
  global_store_dword v254, v255, s[46:47] sc1
  s_mov_b64 exec, -1
L_fs_107:
L_nfirst_106:
  s_cmp_lg_u32 s35, 0
  s_cbranch_scc1 L_seg_102
  s_waitcnt vmcnt(0)
  s_barrier
  s_cmp_eq_u32 s52, -1
  s_cbranch_scc1 L_nf_108
  s_cmp_lg_u32 s8, 0
  s_cbranch_scc1 L_fs_109
  s_lshl_b32 s48, s52, 14
  s_lshl_b32 s49, s36, 7
  s_add_u32 s48, s48, s49
  s_add_u32 s48, s48, 0
  v_mov_b32 v254, s48
  v_mov_b32 v255, 1
  s_mov_b64 exec, 1
  global_store_dword v254, v255, s[46:47] sc1
  s_mov_b64 exec, -1
L_fs_109:
L_nf_108:
  s_cmp_lg_u32 s8, 0
  s_cbranch_scc1 L_fs_110
  s_lshl_b32 s48, s53, 14
  s_lshl_b32 s49, s36, 7
  s_add_u32 s48, s48, s49
  s_add_u32 s48, s48, 0
  v_mov_b32 v254, s48
  v_mov_b32 v255, 1
  s_mov_b64 exec, 1
  global_store_dword v254, v255, s[46:47] sc1
  s_mov_b64 exec, -1
L_fs_110:
L_pdone_62:
L_w2:
  s_cmp_lg_u32 s8, 0
  s_cbranch_scc1 L_wfiok_112
  v_mov_b32 v254, 16
  s_mov_b32 s49, 0
L_wfi_111:
  global_load_dword v255, v254, s[6:7] sc1
  s_add_u32 s49, s49, 1
  s_cmp_gt_u32 s49, 0x20000
  s_cbranch_scc1 L_wfiok_112
  s_waitcnt vmcnt(0)
  v_cmp_gt_u32 vcc, 256, v255
  s_nop 0
  s_cbranch_vccz L_wfiok_112
  s_sleep 8
  s_branch L_wfi_111
L_wfiok_112:
  s_barrier
  s_barrier
  s_cmp_lt_u32 s58, 128
  s_cbranch_scc1 L_w3
  s_cmp_lt_u32 s58, 160
  s_cbranch_scc0 L_w4
  s_sub_u32 s12, s58, 128
  s_lshr_b32 s36, s12, 2
  s_and_b32 s30, s12, 3
  s_mov_b32 s35, 16
  s_lshr_b32 s18, s36, 1
  s_and_b32 s19, s36, 1
  s_lshl_b32 s12, s18, 19
  s_lshl_b32 s13, s19, 9
  s_add_u32 s12, s12, s13
  s_add_u32 s20, s74, s12
  s_addc_u32 s21, s75, 0
  s_mov_b32 s24, 1024
  s_lshl_b32 s37, s18, 15
  s_add_u32 s37, s37, 83886080
  s_lshl_b32 s38, s18, 22
  s_lshl_b32 s12, s19, 15
  s_add_u32 s38, s38, s12
  s_lshl_b32 s12, s8, 13
  s_add_u32 s38, s38, s12
  s_add_u32 s38, s38, 100663296
  v_add_u32 v10, 4096, v1
  s_mov_b32 s54, 0
  s_lshl_b32 s12, s18, 2
  s_add_u32 s12, s12, 16
  s_lshl_b32 s55, 15, s12
  s_and_b32 s55, s55, 0x3fffffff
  s_cmp_eq_u32 s18, 3
  s_cbranch_scc1 L_d3_114
  v_lshrrev_b32 v12, 5, v0
  v_and_b32 v13, 31, v0
  v_add_u32 v14, 0, v12
  v_lshlrev_b32 v14, 2, v14
  v_xor_b32 v14, v14, v13
  v_lshlrev_b32 v15, 4, v14
  v_mov_b32 v17, s21
  v_add_co_u32 v16, vcc, s20, v15
  s_nop 1
  v_addc_co_u32 v17, vcc, 0, v17, vcc
  s_lshl_b32 s12, s8, 4
  s_add_u32 s12, s12, 0
  v_add_u32 v15, s12, v12
  v_mul_lo_u32 v15, v15, s24
  v_add_co_u32 v16, vcc, v16, v15
  s_nop 1
  v_addc_co_u32 v17, vcc, 0, v17, vcc
  v_add_u32 v14, 2, v12
  v_lshlrev_b32 v14, 2, v14
  v_xor_b32 v14, v14, v13
  v_lshlrev_b32 v15, 4, v14
  v_mov_b32 v19, s21
  v_add_co_u32 v18, vcc, s20, v15
  s_nop 1
  v_addc_co_u32 v19, vcc, 0, v19, vcc
  s_lshl_b32 s12, s8, 4
  s_add_u32 s12, s12, 2
  v_add_u32 v15, s12, v12
  v_mul_lo_u32 v15, v15, s24
  v_add_co_u32 v18, vcc, v18, v15
  s_nop 1
  v_addc_co_u32 v19, vcc, 0, v19, vcc
  s_lshl_b32 s14, s24, 2
  s_mul_i32 s15, s24, 48
  s_lshl_b32 s13, s8, 13
  v_bfe_u32 v22, v0, 2, 2
  v_and_b32 v23, 3, v0
  v_and_b32 v24, 1, v23
  v_lshlrev_b32 v24, 1, v24
  v_lshrrev_b32 v23, 1, v23
  v_or_b32 v23, v23, v24
  v_bfe_u32 v24, v0, 4, 1
  v_lshrrev_b32 v25, 5, v0
  v_lshrrev_b32 v26, 1, v23
  v_lshl_add_u32 v26, v24, 1, v26
  v_lshl_add_u32 v25, v25, 3, v22
  s_lshl_b32 s12, s8, 3
  s_add_u32 s12, s12, 0
  v_add_u32 v27, s12, v26
  v_lshlrev_b32 v28, 2, v22
  v_xor_b32 v27, v27, v28
  v_lshlrev_b32 v27, 4, v27
  v_lshl_add_u32 v27, v25, 9, v27
  v_and_b32 v28, 1, v23
  v_lshl_add_u32 v29, v28, 3, v27
  s_lshl_b32 s12, s8, 3
  s_add_u32 s12, s12, 4
  v_add_u32 v27, s12, v26
  v_lshlrev_b32 v28, 2, v22
  v_xor_b32 v27, v27, v28
  v_lshlrev_b32 v27, 4, v27
  v_lshl_add_u32 v27, v25, 9, v27
  v_and_b32 v28, 1, v23
  v_lshl_add_u32 v30, v28, 3, v27
  v_add_u32 v21, s13, v1
  global_load_dwordx4 a[0:3], v[16:17], off
  v_add_co_u32 v16, vcc, s14, v16
  s_nop 1
  v_addc_co_u32 v17, vcc, 0, v17, vcc
  global_load_dwordx4 a[4:7], v[18:19], off
  v_add_co_u32 v18, vcc, s14, v18
  s_nop 1
  v_addc_co_u32 v19, vcc, 0, v19, vcc
  global_load_dwordx4 a[8:11], v[16:17], off
  v_add_co_u32 v16, vcc, s14, v16
  s_nop 1
  v_addc_co_u32 v17, vcc, 0, v17, vcc
  global_load_dwordx4 a[12:15], v[18:19], off
  v_add_co_u32 v18, vcc, s14, v18
  s_nop 1
  v_addc_co_u32 v19, vcc, 0, v19, vcc
  global_load_dwordx4 a[128:131], v[16:17], off
  v_add_co_u32 v16, vcc, s14, v16
  s_nop 1
  v_addc_co_u32 v17, vcc, 0, v17, vcc
  global_load_dwordx4 a[132:135], v[18:19], off
  v_add_co_u32 v18, vcc, s14, v18
  s_nop 1
  v_addc_co_u32 v19, vcc, 0, v19, vcc
  global_load_dwordx4 a[136:139], v[16:17], off
  v_add_co_u32 v16, vcc, s14, v16
  s_nop 1
  v_addc_co_u32 v17, vcc, 0, v17, vcc
  global_load_dwordx4 a[140:143], v[18:19], off
  v_add_co_u32 v18, vcc, s14, v18
  s_nop 1
  v_addc_co_u32 v19, vcc, 0, v19, vcc
  v_add_co_u32 v16, vcc, s15, v16
  s_nop 1
  v_addc_co_u32 v17, vcc, 0, v17, vcc
  v_add_co_u32 v18, vcc, s15, v18
  s_nop 1
  v_addc_co_u32 v19, vcc, 0, v19, vcc
  global_load_dwordx4 a[16:19], v[16:17], off
  v_add_co_u32 v16, vcc, s14, v16
  s_nop 1
  v_addc_co_u32 v17, vcc, 0, v17, vcc
  global_load_dwordx4 a[20:23], v[18:19], off
  v_add_co_u32 v18, vcc, s14, v18
  s_nop 1
  v_addc_co_u32 v19, vcc, 0, v19, vcc
  global_load_dwordx4 a[24:27], v[16:17], off
  v_add_co_u32 v16, vcc, s14, v16
  s_nop 1
  v_addc_co_u32 v17, vcc, 0, v17, vcc
  global_load_dwordx4 a[28:31], v[18:19], off
  v_add_co_u32 v18, vcc, s14, v18
  s_nop 1
  v_addc_co_u32 v19, vcc, 0, v19, vcc
  global_load_dwordx4 a[144:147], v[16:17], off
  v_add_co_u32 v16, vcc, s14, v16
  s_nop 1
  v_addc_co_u32 v17, vcc, 0, v17, vcc
  global_load_dwordx4 a[148:151], v[18:19], off
  v_add_co_u32 v18, vcc, s14, v18
  s_nop 1
  v_addc_co_u32 v19, vcc, 0, v19, vcc
  global_load_dwordx4 a[152:155], v[16:17], off
  v_add_co_u32 v16, vcc, s14, v16
  s_nop 1
  v_addc_co_u32 v17, vcc, 0, v17, vcc
  global_load_dwordx4 a[156:159], v[18:19], off
  v_add_co_u32 v18, vcc, s14, v18
  s_nop 1
  v_addc_co_u32 v19, vcc, 0, v19, vcc
  v_add_co_u32 v16, vcc, s15, v16
  s_nop 1
  v_addc_co_u32 v17, vcc, 0, v17, vcc
  v_add_co_u32 v18, vcc, s15, v18
  s_nop 1
  v_addc_co_u32 v19, vcc, 0, v19, vcc
  global_load_dwordx4 a[32:35], v[16:17], off
  v_add_co_u32 v16, vcc, s14, v16
  s_nop 1
  v_addc_co_u32 v17, vcc, 0, v17, vcc
  global_load_dwordx4 a[36:39], v[18:19], off
  v_add_co_u32 v18, vcc, s14, v18
  s_nop 1
  v_addc_co_u32 v19, vcc, 0, v19, vcc
  global_load_dwordx4 a[40:43], v[16:17], off
  v_add_co_u32 v16, vcc, s14, v16
  s_nop 1
  v_addc_co_u32 v17, vcc, 0, v17, vcc
  global_load_dwordx4 a[44:47], v[18:19], off
  v_add_co_u32 v18, vcc, s14, v18
  s_nop 1
  v_addc_co_u32 v19, vcc, 0, v19, vcc
  global_load_dwordx4 a[160:163], v[16:17], off
  v_add_co_u32 v16, vcc, s14, v16
  s_nop 1
  v_addc_co_u32 v17, vcc, 0, v17, vcc
  global_load_dwordx4 a[164:167], v[18:19], off
  v_add_co_u32 v18, vcc, s14, v18
  s_nop 1
  v_addc_co_u32 v19, vcc, 0, v19, vcc
  global_load_dwordx4 a[168:171], v[16:17], off
  v_add_co_u32 v16, vcc, s14, v16
  s_nop 1
  v_addc_co_u32 v17, vcc, 0, v17, vcc
  global_load_dwordx4 a[172:175], v[18:19], off
  v_add_co_u32 v18, vcc, s14, v18
  s_nop 1
  v_addc_co_u32 v19, vcc, 0, v19, vcc
  v_add_co_u32 v16, vcc, s15, v16
  s_nop 1
  v_addc_co_u32 v17, vcc, 0, v17, vcc
  v_add_co_u32 v18, vcc, s15, v18
  s_nop 1
  v_addc_co_u32 v19, vcc, 0, v19, vcc
  global_load_dwordx4 a[48:51], v[16:17], off
  v_add_co_u32 v16, vcc, s14, v16
  s_nop 1
  v_addc_co_u32 v17, vcc, 0, v17, vcc
  global_load_dwordx4 a[52:55], v[18:19], off
  v_add_co_u32 v18, vcc, s14, v18
  s_nop 1
  v_addc_co_u32 v19, vcc, 0, v19, vcc
  global_load_dwordx4 a[56:59], v[16:17], off
  v_add_co_u32 v16, vcc, s14, v16
  s_nop 1
  v_addc_co_u32 v17, vcc, 0, v17, vcc
  global_load_dwordx4 a[60:63], v[18:19], off
  v_add_co_u32 v18, vcc, s14, v18
  s_nop 1
  v_addc_co_u32 v19, vcc, 0, v19, vcc
  global_load_dwordx4 a[176:179], v[16:17], off
  v_add_co_u32 v16, vcc, s14, v16
  s_nop 1
  v_addc_co_u32 v17, vcc, 0, v17, vcc
  global_load_dwordx4 a[180:183], v[18:19], off
  v_add_co_u32 v18, vcc, s14, v18
  s_nop 1
  v_addc_co_u32 v19, vcc, 0, v19, vcc
  global_load_dwordx4 a[184:187], v[16:17], off
  v_add_co_u32 v16, vcc, s14, v16
  s_nop 1
  v_addc_co_u32 v17, vcc, 0, v17, vcc
  global_load_dwordx4 a[188:191], v[18:19], off
  v_add_co_u32 v18, vcc, s14, v18
  s_nop 1
  v_addc_co_u32 v19, vcc, 0, v19, vcc
  v_add_co_u32 v16, vcc, s15, v16
  s_nop 1
  v_addc_co_u32 v17, vcc, 0, v17, vcc
  v_add_co_u32 v18, vcc, s15, v18
  s_nop 1
  v_addc_co_u32 v19, vcc, 0, v19, vcc
  global_load_dwordx4 a[64:67], v[16:17], off
  v_add_co_u32 v16, vcc, s14, v16
  s_nop 1
  v_addc_co_u32 v17, vcc, 0, v17, vcc
  global_load_dwordx4 a[68:71], v[18:19], off
  v_add_co_u32 v18, vcc, s14, v18
  s_nop 1
  v_addc_co_u32 v19, vcc, 0, v19, vcc
  global_load_dwordx4 a[72:75], v[16:17], off
  v_add_co_u32 v16, vcc, s14, v16
  s_nop 1
  v_addc_co_u32 v17, vcc, 0, v17, vcc
  global_load_dwordx4 a[76:79], v[18:19], off
  v_add_co_u32 v18, vcc, s14, v18
  s_nop 1
  v_addc_co_u32 v19, vcc, 0, v19, vcc
  global_load_dwordx4 a[192:195], v[16:17], off
  v_add_co_u32 v16, vcc, s14, v16
  s_nop 1
  v_addc_co_u32 v17, vcc, 0, v17, vcc
  global_load_dwordx4 a[196:199], v[18:19], off
  v_add_co_u32 v18, vcc, s14, v18
  s_nop 1
  v_addc_co_u32 v19, vcc, 0, v19, vcc
  global_load_dwordx4 a[200:203], v[16:17], off
  v_add_co_u32 v16, vcc, s14, v16
  s_nop 1
  v_addc_co_u32 v17, vcc, 0, v17, vcc
  global_load_dwordx4 a[204:207], v[18:19], off
  v_add_co_u32 v18, vcc, s14, v18
  s_nop 1
  v_addc_co_u32 v19, vcc, 0, v19, vcc
  v_add_co_u32 v16, vcc, s15, v16
  s_nop 1
  v_addc_co_u32 v17, vcc, 0, v17, vcc
  v_add_co_u32 v18, vcc, s15, v18
  s_nop 1
  v_addc_co_u32 v19, vcc, 0, v19, vcc
  global_load_dwordx4 a[80:83], v[16:17], off
  v_add_co_u32 v16, vcc, s14, v16
  s_nop 1
  v_addc_co_u32 v17, vcc, 0, v17, vcc
  global_load_dwordx4 a[84:87], v[18:19], off
  v_add_co_u32 v18, vcc, s14, v18
  s_nop 1
  v_addc_co_u32 v19, vcc, 0, v19, vcc
  global_load_dwordx4 a[88:91], v[16:17], off
  v_add_co_u32 v16, vcc, s14, v16
  s_nop 1
  v_addc_co_u32 v17, vcc, 0, v17, vcc
  global_load_dwordx4 a[92:95], v[18:19], off
  v_add_co_u32 v18, vcc, s14, v18
  s_nop 1
  v_addc_co_u32 v19, vcc, 0, v19, vcc
  global_load_dwordx4 a[208:211], v[16:17], off
  v_add_co_u32 v16, vcc, s14, v16
  s_nop 1
  v_addc_co_u32 v17, vcc, 0, v17, vcc
  global_load_dwordx4 a[212:215], v[18:19], off
  v_add_co_u32 v18, vcc, s14, v18
  s_nop 1
  v_addc_co_u32 v19, vcc, 0, v19, vcc
  global_load_dwordx4 a[216:219], v[16:17], off
  v_add_co_u32 v16, vcc, s14, v16
  s_nop 1
  v_addc_co_u32 v17, vcc, 0, v17, vcc
  global_load_dwordx4 a[220:223], v[18:19], off
  v_add_co_u32 v18, vcc, s14, v18
  s_nop 1
  v_addc_co_u32 v19, vcc, 0, v19, vcc
  v_add_co_u32 v16, vcc, s15, v16
  s_nop 1
  v_addc_co_u32 v17, vcc, 0, v17, vcc
  v_add_co_u32 v18, vcc, s15, v18
  s_nop 1
  v_addc_co_u32 v19, vcc, 0, v19, vcc
  global_load_dwordx4 a[96:99], v[16:17], off
  v_add_co_u32 v16, vcc, s14, v16
  s_nop 1
  v_addc_co_u32 v17, vcc, 0, v17, vcc
  global_load_dwordx4 a[100:103], v[18:19], off
  v_add_co_u32 v18, vcc, s14, v18
  s_nop 1
  v_addc_co_u32 v19, vcc, 0, v19, vcc
  global_load_dwordx4 a[104:107], v[16:17], off
  v_add_co_u32 v16, vcc, s14, v16
  s_nop 1
  v_addc_co_u32 v17, vcc, 0, v17, vcc
  global_load_dwordx4 a[108:111], v[18:19], off
  v_add_co_u32 v18, vcc, s14, v18
  s_nop 1
  v_addc_co_u32 v19, vcc, 0, v19, vcc
  global_load_dwordx4 a[224:227], v[16:17], off
  v_add_co_u32 v16, vcc, s14, v16
  s_nop 1
  v_addc_co_u32 v17, vcc, 0, v17, vcc
  global_load_dwordx4 a[228:231], v[18:19], off
  v_add_co_u32 v18, vcc, s14, v18
  s_nop 1
  v_addc_co_u32 v19, vcc, 0, v19, vcc
  global_load_dwordx4 a[232:235], v[16:17], off
  v_add_co_u32 v16, vcc, s14, v16
  s_nop 1
  v_addc_co_u32 v17, vcc, 0, v17, vcc
  global_load_dwordx4 a[236:239], v[18:19], off
  v_add_co_u32 v18, vcc, s14, v18
  s_nop 1
  v_addc_co_u32 v19, vcc, 0, v19, vcc
  v_add_co_u32 v16, vcc, s15, v16
  s_nop 1
  v_addc_co_u32 v17, vcc, 0, v17, vcc
  v_add_co_u32 v18, vcc, s15, v18
  s_nop 1
  v_addc_co_u32 v19, vcc, 0, v19, vcc
  s_waitcnt vmcnt(48)
  ds_write_b128 v21, a[0:3] offset:0
  ds_write_b128 v21, a[4:7] offset:1024
  ds_write_b128 v21, a[8:11] offset:2048
  ds_write_b128 v21, a[12:15] offset:3072
  ds_write_b128 v21, a[128:131] offset:4096
  ds_write_b128 v21, a[132:135] offset:5120
  ds_write_b128 v21, a[136:139] offset:6144
  ds_write_b128 v21, a[140:143] offset:7168
  s_waitcnt lgkmcnt(0)
  s_barrier
  ds_read_b64_tr_b16 a[0:1], v29 offset:0
  ds_read_b64_tr_b16 a[2:3], v29 offset:2048
  ds_read_b64_tr_b16 a[4:5], v29 offset:8192
  ds_read_b64_tr_b16 a[6:7], v29 offset:10240
  ds_read_b64_tr_b16 a[8:9], v29 offset:16384
  ds_read_b64_tr_b16 a[10:11], v29 offset:18432
  ds_read_b64_tr_b16 a[12:13], v29 offset:24576
  ds_read_b64_tr_b16 a[14:15], v29 offset:26624
  ds_read_b64_tr_b16 a[128:129], v30 offset:0
  ds_read_b64_tr_b16 a[130:131], v30 offset:2048
  ds_read_b64_tr_b16 a[132:133], v30 offset:8192
  ds_read_b64_tr_b16 a[134:135], v30 offset:10240
  ds_read_b64_tr_b16 a[136:137], v30 offset:16384
  ds_read_b64_tr_b16 a[138:139], v30 offset:18432
  ds_read_b64_tr_b16 a[140:141], v30 offset:24576
  ds_read_b64_tr_b16 a[142:143], v30 offset:26624
  global_load_dwordx4 a[112:115], v[16:17], off
  v_add_co_u32 v16, vcc, s14, v16
  s_nop 1
  v_addc_co_u32 v17, vcc, 0, v17, vcc
  global_load_dwordx4 a[116:119], v[18:19], off
  v_add_co_u32 v18, vcc, s14, v18
  s_nop 1
  v_addc_co_u32 v19, vcc, 0, v19, vcc
  global_load_dwordx4 a[120:123], v[16:17], off
  v_add_co_u32 v16, vcc, s14, v16
  s_nop 1
  v_addc_co_u32 v17, vcc, 0, v17, vcc
  global_load_dwordx4 a[124:127], v[18:19], off
  v_add_co_u32 v18, vcc, s14, v18
  s_nop 1
  v_addc_co_u32 v19, vcc, 0, v19, vcc
  global_load_dwordx4 a[240:243], v[16:17], off
  v_add_co_u32 v16, vcc, s14, v16
  s_nop 1
  v_addc_co_u32 v17, vcc, 0, v17, vcc
  global_load_dwordx4 a[244:247], v[18:19], off
  v_add_co_u32 v18, vcc, s14, v18
  s_nop 1
  v_addc_co_u32 v19, vcc, 0, v19, vcc
  global_load_dwordx4 a[248:251], v[16:17], off
  v_add_co_u32 v16, vcc, s14, v16
  s_nop 1
  v_addc_co_u32 v17, vcc, 0, v17, vcc
  global_load_dwordx4 a[252:255], v[18:19], off
  v_add_co_u32 v18, vcc, s14, v18
  s_nop 1
  v_addc_co_u32 v19, vcc, 0, v19, vcc
  v_add_co_u32 v16, vcc, s15, v16
  s_nop 1
  v_addc_co_u32 v17, vcc, 0, v17, vcc
  v_add_co_u32 v18, vcc, s15, v18
  s_nop 1
  v_addc_co_u32 v19, vcc, 0, v19, vcc
  s_waitcnt lgkmcnt(0)
  s_waitcnt vmcnt(48)
  ds_write_b128 v21, a[16:19] offset:32768
  ds_write_b128 v21, a[20:23] offset:33792
  ds_write_b128 v21, a[24:27] offset:34816
  ds_write_b128 v21, a[28:31] offset:35840
  ds_write_b128 v21, a[144:147] offset:36864
  ds_write_b128 v21, a[148:151] offset:37888
  ds_write_b128 v21, a[152:155] offset:38912
  ds_write_b128 v21, a[156:159] offset:39936
  s_waitcnt lgkmcnt(0)
  s_barrier
  ds_read_b64_tr_b16 a[16:17], v29 offset:32768
  ds_read_b64_tr_b16 a[18:19], v29 offset:34816
  ds_read_b64_tr_b16 a[20:21], v29 offset:40960
  ds_read_b64_tr_b16 a[22:23], v29 offset:43008
  ds_read_b64_tr_b16 a[24:25], v29 offset:49152
  ds_read_b64_tr_b16 a[26:27], v29 offset:51200
  ds_read_b64_tr_b16 a[28:29], v29 offset:57344
  ds_read_b64_tr_b16 a[30:31], v29 offset:59392
  ds_read_b64_tr_b16 a[144:145], v30 offset:32768
  ds_read_b64_tr_b16 a[146:147], v30 offset:34816
  ds_read_b64_tr_b16 a[148:149], v30 offset:40960
  ds_read_b64_tr_b16 a[150:151], v30 offset:43008
  ds_read_b64_tr_b16 a[152:153], v30 offset:49152
  ds_read_b64_tr_b16 a[154:155], v30 offset:51200
  ds_read_b64_tr_b16 a[156:157], v30 offset:57344
  ds_read_b64_tr_b16 a[158:159], v30 offset:59392
  s_waitcnt lgkmcnt(0)
  s_waitcnt vmcnt(40)
  ds_write_b128 v21, a[32:35] offset:0
  ds_write_b128 v21, a[36:39] offset:1024
  ds_write_b128 v21, a[40:43] offset:2048
  ds_write_b128 v21, a[44:47] offset:3072
  ds_write_b128 v21, a[160:163] offset:4096
  ds_write_b128 v21, a[164:167] offset:5120
  ds_write_b128 v21, a[168:171] offset:6144
  ds_write_b128 v21, a[172:175] offset:7168
  s_waitcnt lgkmcnt(0)
  s_barrier
  ds_read_b64_tr_b16 a[32:33], v29 offset:0
  ds_read_b64_tr_b16 a[34:35], v29 offset:2048
  ds_read_b64_tr_b16 a[36:37], v29 offset:8192
  ds_read_b64_tr_b16 a[38:39], v29 offset:10240
  ds_read_b64_tr_b16 a[40:41], v29 offset:16384
  ds_read_b64_tr_b16 a[42:43], v29 offset:18432
  ds_read_b64_tr_b16 a[44:45], v29 offset:24576
  ds_read_b64_tr_b16 a[46:47], v29 offset:26624
  ds_read_b64_tr_b16 a[160:161], v30 offset:0
  ds_read_b64_tr_b16 a[162:163], v30 offset:2048
  ds_read_b64_tr_b16 a[164:165], v30 offset:8192
  ds_read_b64_tr_b16 a[166:167], v30 offset:10240
  ds_read_b64_tr_b16 a[168:169], v30 offset:16384
  ds_read_b64_tr_b16 a[170:171], v30 offset:18432
  ds_read_b64_tr_b16 a[172:173], v30 offset:24576
  ds_read_b64_tr_b16 a[174:175], v30 offset:26624
  s_waitcnt lgkmcnt(0)
  s_waitcnt vmcnt(32)
  ds_write_b128 v21, a[48:51] offset:32768
  ds_write_b128 v21, a[52:55] offset:33792
  ds_write_b128 v21, a[56:59] offset:34816
  ds_write_b128 v21, a[60:63] offset:35840
  ds_write_b128 v21, a[176:179] offset:36864
  ds_write_b128 v21, a[180:183] offset:37888
  ds_write_b128 v21, a[184:187] offset:38912
  ds_write_b128 v21, a[188:191] offset:39936
  s_waitcnt lgkmcnt(0)
  s_barrier
  ds_read_b64_tr_b16 a[48:49], v29 offset:32768
  ds_read_b64_tr_b16 a[50:51], v29 offset:34816
  ds_read_b64_tr_b16 a[52:53], v29 offset:40960
  ds_read_b64_tr_b16 a[54:55], v29 offset:43008
  ds_read_b64_tr_b16 a[56:57], v29 offset:49152
  ds_read_b64_tr_b16 a[58:59], v29 offset:51200
  ds_read_b64_tr_b16 a[60:61], v29 offset:57344
  ds_read_b64_tr_b16 a[62:63], v29 offset:59392
  ds_read_b64_tr_b16 a[176:177], v30 offset:32768
  ds_read_b64_tr_b16 a[178:179], v30 offset:34816
  ds_read_b64_tr_b16 a[180:181], v30 offset:40960
  ds_read_b64_tr_b16 a[182:183], v30 offset:43008
  ds_read_b64_tr_b16 a[184:185], v30 offset:49152
  ds_read_b64_tr_b16 a[186:187], v30 offset:51200
  ds_read_b64_tr_b16 a[188:189], v30 offset:57344
  ds_read_b64_tr_b16 a[190:191], v30 offset:59392
  s_waitcnt lgkmcnt(0)
  s_waitcnt vmcnt(24)
  ds_write_b128 v21, a[64:67] offset:0
  ds_write_b128 v21, a[68:71] offset:1024
  ds_write_b128 v21, a[72:75] offset:2048
  ds_write_b128 v21, a[76:79] offset:3072
  ds_write_b128 v21, a[192:195] offset:4096
  ds_write_b128 v21, a[196:199] offset:5120
  ds_write_b128 v21, a[200:203] offset:6144
  ds_write_b128 v21, a[204:207] offset:7168
  s_waitcnt lgkmcnt(0)
  s_barrier
  ds_read_b64_tr_b16 a[64:65], v29 offset:0
  ds_read_b64_tr_b16 a[66:67], v29 offset:2048
  ds_read_b64_tr_b16 a[68:69], v29 offset:8192
  ds_read_b64_tr_b16 a[70:71], v29 offset:10240
  ds_read_b64_tr_b16 a[72:73], v29 offset:16384
  ds_read_b64_tr_b16 a[74:75], v29 offset:18432
  ds_read_b64_tr_b16 a[76:77], v29 offset:24576
  ds_read_b64_tr_b16 a[78:79], v29 offset:26624
  ds_read_b64_tr_b16 a[192:193], v30 offset:0
  ds_read_b64_tr_b16 a[194:195], v30 offset:2048
  ds_read_b64_tr_b16 a[196:197], v30 offset:8192
  ds_read_b64_tr_b16 a[198:199], v30 offset:10240
  ds_read_b64_tr_b16 a[200:201], v30 offset:16384
  ds_read_b64_tr_b16 a[202:203], v30 offset:18432
  ds_read_b64_tr_b16 a[204:205], v30 offset:24576
  ds_read_b64_tr_b16 a[206:207], v30 offset:26624
  s_waitcnt lgkmcnt(0)
  s_waitcnt vmcnt(16)
  ds_write_b128 v21, a[80:83] offset:32768
  ds_write_b128 v21, a[84:87] offset:33792
  ds_write_b128 v21, a[88:91] offset:34816
  ds_write_b128 v21, a[92:95] offset:35840
  ds_write_b128 v21, a[208:211] offset:36864
  ds_write_b128 v21, a[212:215] offset:37888
  ds_write_b128 v21, a[216:219] offset:38912
  ds_write_b128 v21, a[220:223] offset:39936
  s_waitcnt lgkmcnt(0)
  s_barrier
  ds_read_b64_tr_b16 a[80:81], v29 offset:32768
  ds_read_b64_tr_b16 a[82:83], v29 offset:34816
  ds_read_b64_tr_b16 a[84:85], v29 offset:40960
  ds_read_b64_tr_b16 a[86:87], v29 offset:43008
  ds_read_b64_tr_b16 a[88:89], v29 offset:49152
  ds_read_b64_tr_b16 a[90:91], v29 offset:51200
  ds_read_b64_tr_b16 a[92:93], v29 offset:57344
  ds_read_b64_tr_b16 a[94:95], v29 offset:59392
  ds_read_b64_tr_b16 a[208:209], v30 offset:32768
  ds_read_b64_tr_b16 a[210:211], v30 offset:34816
  ds_read_b64_tr_b16 a[212:213], v30 offset:40960
  ds_read_b64_tr_b16 a[214:215], v30 offset:43008
  ds_read_b64_tr_b16 a[216:217], v30 offset:49152
  ds_read_b64_tr_b16 a[218:219], v30 offset:51200
  ds_read_b64_tr_b16 a[220:221], v30 offset:57344
  ds_read_b64_tr_b16 a[222:223], v30 offset:59392
  s_waitcnt lgkmcnt(0)
  s_waitcnt vmcnt(8)
  ds_write_b128 v21, a[96:99] offset:0
  ds_write_b128 v21, a[100:103] offset:1024
  ds_write_b128 v21, a[104:107] offset:2048
  ds_write_b128 v21, a[108:111] offset:3072
  ds_write_b128 v21, a[224:227] offset:4096
  ds_write_b128 v21, a[228:231] offset:5120
  ds_write_b128 v21, a[232:235] offset:6144
  ds_write_b128 v21, a[236:239] offset:7168
  s_waitcnt lgkmcnt(0)
  s_barrier
  ds_read_b64_tr_b16 a[96:97], v29 offset:0
  ds_read_b64_tr_b16 a[98:99], v29 offset:2048
  ds_read_b64_tr_b16 a[100:101], v29 offset:8192
  ds_read_b64_tr_b16 a[102:103], v29 offset:10240
  ds_read_b64_tr_b16 a[104:105], v29 offset:16384
  ds_read_b64_tr_b16 a[106:107], v29 offset:18432
  ds_read_b64_tr_b16 a[108:109], v29 offset:24576
  ds_read_b64_tr_b16 a[110:111], v29 offset:26624
  ds_read_b64_tr_b16 a[224:225], v30 offset:0
  ds_read_b64_tr_b16 a[226:227], v30 offset:2048
  ds_read_b64_tr_b16 a[228:229], v30 offset:8192
  ds_read_b64_tr_b16 a[230:231], v30 offset:10240
  ds_read_b64_tr_b16 a[232:233], v30 offset:16384
  ds_read_b64_tr_b16 a[234:235], v30 offset:18432
  ds_read_b64_tr_b16 a[236:237], v30 offset:24576
  ds_read_b64_tr_b16 a[238:239], v30 offset:26624
  s_waitcnt lgkmcnt(0)
  s_waitcnt vmcnt(0)
  ds_write_b128 v21, a[112:115] offset:32768
  ds_write_b128 v21, a[116:119] offset:33792
  ds_write_b128 v21, a[120:123] offset:34816
  ds_write_b128 v21, a[124:127] offset:35840
  ds_write_b128 v21, a[240:243] offset:36864
  ds_write_b128 v21, a[244:247] offset:37888
  ds_write_b128 v21, a[248:251] offset:38912
  ds_write_b128 v21, a[252:255] offset:39936
  s_waitcnt lgkmcnt(0)
  s_barrier
  ds_read_b64_tr_b16 a[112:113], v29 offset:32768
  ds_read_b64_tr_b16 a[114:115], v29 offset:34816
  ds_read_b64_tr_b16 a[116:117], v29 offset:40960
  ds_read_b64_tr_b16 a[118:119], v29 offset:43008
  ds_read_b64_tr_b16 a[120:121], v29 offset:49152
  ds_read_b64_tr_b16 a[122:123], v29 offset:51200
  ds_read_b64_tr_b16 a[124:125], v29 offset:57344
  ds_read_b64_tr_b16 a[126:127], v29 offset:59392
  ds_read_b64_tr_b16 a[240:241], v30 offset:32768
  ds_read_b64_tr_b16 a[242:243], v30 offset:34816
  ds_read_b64_tr_b16 a[244:245], v30 offset:40960
  ds_read_b64_tr_b16 a[246:247], v30 offset:43008
  ds_read_b64_tr_b16 a[248:249], v30 offset:49152
  ds_read_b64_tr_b16 a[250:251], v30 offset:51200
  ds_read_b64_tr_b16 a[252:253], v30 offset:57344
  ds_read_b64_tr_b16 a[254:255], v30 offset:59392
  s_waitcnt lgkmcnt(0)
  s_barrier
  v_mov_b32 v2, v1
  s_mov_b32 s34, 0
  s_mov_b32 s52, s30
  s_mov_b32 s53, s35
L_dw_116:
  s_cmp_lg_u32 s8, 0
  s_cbranch_scc1 L_fwok_118
  s_lshl_b32 s48, s52, 14
  s_add_u32 s48, s48, 0
  v_lshlrev_b32 v254, 7, v0
  v_add_u32 v254, s48, v254
  s_mov_b32 s49, 0
  s_mov_b32 exec_lo, s54
  s_mov_b32 exec_hi, s55
L_fw_117:
  global_load_dword v255, v254, s[46:47] sc1
  s_add_u32 s49, s49, 1
  s_cmp_gt_u32 s49, 0x20000
  s_cbranch_scc1 L_fwok2_119
  s_waitcnt vmcnt(0)
  v_cmp_ne_u32 vcc, 0, v255
  s_nop 0
  s_and_b32 s50, vcc_lo, s54
  s_and_b32 s51, vcc_hi, s55
  s_xor_b32 s50, s50, s54
  s_xor_b32 s51, s51, s55
  s_or_b32 s50, s50, s51
  s_cmp_eq_u32 s50, 0
  s_cbranch_scc1 L_fwok2_119
  s_sleep 2
  s_branch L_fw_117
L_fwok2_119:
  s_mov_b64 exec, -1
L_fwok_118:
  s_barrier
  s_add_u32 s52, s52, 4
  s_sub_u32 s53, s53, 1
  s_cmp_lg_u32 s53, 0
  s_cbranch_scc1 L_dw_116
  s_mul_i32 s12, s30, 114688
  s_add_u32 s12, s12, s37
  s_add_u32 s26, s4, s12
  s_addc_u32 s27, s5, 0
  s_mul_i32 s12, s8, 8192
  s_add_u32 s16, s26, s12
  s_addc_u32 s17, s27, 0
  s_add_u32 s12, s12, s34
  s_add_u32 m0, s12, 0
  s_nop 0
  global_load_lds_dwordx4 v1, s[16:17] offset:0 sc1
  global_load_lds_dwordx4 v1, s[16:17] offset:1024 sc1
  global_load_lds_dwordx4 v1, s[16:17] offset:2048 sc1
  global_load_lds_dwordx4 v1, s[16:17] offset:3072 sc1
  s_add_u32 s16, s16, 4096
  s_addc_u32 s17, s17, 0
  s_add_u32 m0, s12, 4096
  s_nop 0
  global_load_lds_dwordx4 v1, s[16:17] offset:0 sc1
  global_load_lds_dwordx4 v1, s[16:17] offset:1024 sc1
  global_load_lds_dwordx4 v1, s[16:17] offset:2048 sc1
  global_load_lds_dwordx4 v1, s[16:17] offset:3072 sc1
  s_mov_b32 s52, -1
  s_mov_b32 s53, -1
  s_waitcnt vmcnt(0)
L_seg_115:
  s_waitcnt vmcnt(8)
  s_barrier
  s_cmp_eq_u32 s52, -1
  s_cbranch_scc1 L_nf_120
  s_cmp_lg_u32 s8, 0
  s_cbranch_scc1 L_fs_121
  s_lshl_b32 s48, s52, 14
  s_lshl_b32 s49, s36, 7
  s_add_u32 s48, s48, s49
  s_add_u32 s48, s48, 14336
  v_mov_b32 v254, s48
  v_mov_b32 v255, 1
  s_mov_b64 exec, 1
  global_store_dword v254, v255, s[46:47] sc1
  s_mov_b64 exec, -1
L_fs_121:
L_nf_120:
  s_mov_b32 s52, s53
  s_mov_b32 s53, s30
  s_lshl_b32 s12, s30, 16
  s_add_u32 s12, s12, s38
  s_add_u32 s28, s4, s12
  s_addc_u32 s29, s5, 0
  s_add_u32 s30, s30, 4
  s_sub_u32 s35, s35, 1
  s_xor_b32 s34, s34, 32768
  s_cmp_eq_u32 s35, 0
  s_cbranch_scc1 L_nonext_122
  s_mul_i32 s12, s30, 114688
  s_add_u32 s12, s12, s37
  s_add_u32 s26, s4, s12
  s_addc_u32 s27, s5, 0
  s_mul_i32 s12, s8, 8192
  s_add_u32 s16, s26, s12
  s_addc_u32 s17, s27, 0
  s_add_u32 s12, s12, s34
  s_add_u32 m0, s12, 0
  s_nop 0
  global_load_lds_dwordx4 v1, s[16:17] offset:0 sc1
  global_load_lds_dwordx4 v1, s[16:17] offset:1024 sc1
  global_load_lds_dwordx4 v1, s[16:17] offset:2048 sc1
  global_load_lds_dwordx4 v1, s[16:17] offset:3072 sc1
  s_add_u32 s16, s16, 4096
  s_addc_u32 s17, s17, 0
  s_add_u32 m0, s12, 4096
  s_nop 0
  global_load_lds_dwordx4 v1, s[16:17] offset:0 sc1
  global_load_lds_dwordx4 v1, s[16:17] offset:1024 sc1
  global_load_lds_dwordx4 v1, s[16:17] offset:2048 sc1
  global_load_lds_dwordx4 v1, s[16:17] offset:3072 sc1
L_nonext_122:
  ds_read_b128 v[32:35], v2 offset:0
  ds_read_b128 v[36:39], v2 offset:1024
  ds_read_b128 v[40:43], v2 offset:2048
  ds_read_b128 v[44:47], v2 offset:3072
  ds_read_b128 v[48:51], v2 offset:4096
  ds_read_b128 v[52:55], v2 offset:5120
  s_waitcnt lgkmcnt(5)
  v_mfma_f32_32x32x16_bf16 v[64:79], a[0:3], v[32:35], 0
  ds_read_b128 v[56:59], v2 offset:6144
  v_mfma_f32_32x32x16_bf16 v[80:95], a[128:131], v[32:35], 0
  s_waitcnt lgkmcnt(5)
  v_mfma_f32_32x32x16_bf16 v[64:79], a[4:7], v[36:39], v[64:79]
  ds_read_b128 v[60:63], v2 offset:7168
  v_mfma_f32_32x32x16_bf16 v[80:95], a[132:135], v[36:39], v[80:95]
  s_waitcnt lgkmcnt(5)
  v_mfma_f32_32x32x16_bf16 v[64:79], a[8:11], v[40:43], v[64:79]
  ds_read_b128 v[32:35], v2 offset:8192
  v_mfma_f32_32x32x16_bf16 v[80:95], a[136:139], v[40:43], v[80:95]
  s_waitcnt lgkmcnt(5)
  v_mfma_f32_32x32x16_bf16 v[64:79], a[12:15], v[44:47], v[64:79]
  ds_read_b128 v[36:39], v2 offset:9216
  v_mfma_f32_32x32x16_bf16 v[80:95], a[140:143], v[44:47], v[80:95]
  s_waitcnt lgkmcnt(5)
  v_mfma_f32_32x32x16_bf16 v[64:79], a[16:19], v[48:51], v[64:79]
  ds_read_b128 v[40:43], v2 offset:10240
  v_mfma_f32_32x32x16_bf16 v[80:95], a[144:147], v[48:51], v[80:95]
  s_waitcnt lgkmcnt(5)
  v_mfma_f32_32x32x16_bf16 v[64:79], a[20:23], v[52:55], v[64:79]
  ds_read_b128 v[44:47], v2 offset:11264
  v_mfma_f32_32x32x16_bf16 v[80:95], a[148:151], v[52:55], v[80:95]
  s_waitcnt lgkmcnt(5)
  v_mfma_f32_32x32x16_bf16 v[64:79], a[24:27], v[56:59], v[64:79]
  ds_read_b128 v[48:51], v2 offset:12288
  v_mfma_f32_32x32x16_bf16 v[80:95], a[152:155], v[56:59], v[80:95]
  s_waitcnt lgkmcnt(5)
  v_mfma_f32_32x32x16_bf16 v[64:79], a[28:31], v[60:63], v[64:79]
  ds_read_b128 v[52:55], v2 offset:13312
  v_mfma_f32_32x32x16_bf16 v[80:95], a[156:159], v[60:63], v[80:95]
  s_waitcnt lgkmcnt(5)
  v_mfma_f32_32x32x16_bf16 v[64:79], a[32:35], v[32:35], v[64:79]
  ds_read_b128 v[56:59], v2 offset:14336
  v_mfma_f32_32x32x16_bf16 v[80:95], a[160:163], v[32:35], v[80:95]
  s_waitcnt lgkmcnt(5)
  v_mfma_f32_32x32x16_bf16 v[64:79], a[36:39], v[36:39], v[64:79]
  ds_read_b128 v[60:63], v2 offset:15360
  v_mfma_f32_32x32x16_bf16 v[80:95], a[164:167], v[36:39], v[80:95]
  s_waitcnt lgkmcnt(5)
  v_mfma_f32_32x32x16_bf16 v[64:79], a[40:43], v[40:43], v[64:79]
  ds_read_b128 v[32:35], v2 offset:16384
  v_mfma_f32_32x32x16_bf16 v[80:95], a[168:171], v[40:43], v[80:95]
  s_waitcnt lgkmcnt(5)
  v_mfma_f32_32x32x16_bf16 v[64:79], a[44:47], v[44:47], v[64:79]
  ds_read_b128 v[36:39], v2 offset:17408
  v_mfma_f32_32x32x16_bf16 v[80:95], a[172:175], v[44:47], v[80:95]
  s_waitcnt lgkmcnt(5)
  v_mfma_f32_32x32x16_bf16 v[64:79], a[48:51], v[48:51], v[64:79]
  ds_read_b128 v[40:43], v2 offset:18432
  v_mfma_f32_32x32x16_bf16 v[80:95], a[176:179], v[48:51], v[80:95]
  s_waitcnt lgkmcnt(5)
  v_mfma_f32_32x32x16_bf16 v[64:79], a[52:55], v[52:55], v[64:79]
  ds_read_b128 v[44:47], v2 offset:19456
  v_mfma_f32_32x32x16_bf16 v[80:95], a[180:183], v[52:55], v[80:95]
  s_waitcnt lgkmcnt(5)
  v_mfma_f32_32x32x16_bf16 v[64:79], a[56:59], v[56:59], v[64:79]
  ds_read_b128 v[48:51], v2 offset:20480
  v_mfma_f32_32x32x16_bf16 v[80:95], a[184:187], v[56:59], v[80:95]
  s_waitcnt lgkmcnt(5)
  v_mfma_f32_32x32x16_bf16 v[64:79], a[60:63], v[60:63], v[64:79]
  ds_read_b128 v[52:55], v2 offset:21504
  v_mfma_f32_32x32x16_bf16 v[80:95], a[188:191], v[60:63], v[80:95]
  s_waitcnt lgkmcnt(5)
  v_mfma_f32_32x32x16_bf16 v[64:79], a[64:67], v[32:35], v[64:79]
  ds_read_b128 v[56:59], v2 offset:22528
  v_mfma_f32_32x32x16_bf16 v[80:95], a[192:195], v[32:35], v[80:95]
  s_waitcnt lgkmcnt(5)
  v_mfma_f32_32x32x16_bf16 v[64:79], a[68:71], v[36:39], v[64:79]
  ds_read_b128 v[60:63], v2 offset:23552
  v_mfma_f32_32x32x16_bf16 v[80:95], a[196:199], v[36:39], v[80:95]
  s_waitcnt lgkmcnt(5)
  v_mfma_f32_32x32x16_bf16 v[64:79], a[72:75], v[40:43], v[64:79]
  ds_read_b128 v[32:35], v2 offset:24576
  v_mfma_f32_32x32x16_bf16 v[80:95], a[200:203], v[40:43], v[80:95]
  s_waitcnt lgkmcnt(5)
  v_mfma_f32_32x32x16_bf16 v[64:79], a[76:79], v[44:47], v[64:79]
  ds_read_b128 v[36:39], v2 offset:25600
  v_mfma_f32_32x32x16_bf16 v[80:95], a[204:207], v[44:47], v[80:95]
  s_waitcnt lgkmcnt(5)
  v_mfma_f32_32x32x16_bf16 v[64:79], a[80:83], v[48:51], v[64:79]
  ds_read_b128 v[40:43], v2 offset:26624
  v_mfma_f32_32x32x16_bf16 v[80:95], a[208:211], v[48:51], v[80:95]
  s_waitcnt lgkmcnt(5)
  v_mfma_f32_32x32x16_bf16 v[64:79], a[84:87], v[52:55], v[64:79]
  ds_read_b128 v[44:47], v2 offset:27648
  v_mfma_f32_32x32x16_bf16 v[80:95], a[212:215], v[52:55], v[80:95]
  s_waitcnt lgkmcnt(5)
  v_mfma_f32_32x32x16_bf16 v[64:79], a[88:91], v[56:59], v[64:79]
  ds_read_b128 v[48:51], v2 offset:28672
  v_mfma_f32_32x32x16_bf16 v[80:95], a[216:219], v[56:59], v[80:95]
  s_waitcnt lgkmcnt(5)
  v_mfma_f32_32x32x16_bf16 v[64:79], a[92:95], v[60:63], v[64:79]
  ds_read_b128 v[52:55], v2 offset:29696
  v_mfma_f32_32x32x16_bf16 v[80:95], a[220:223], v[60:63], v[80:95]
  s_waitcnt lgkmcnt(5)
  v_mfma_f32_32x32x16_bf16 v[64:79], a[96:99], v[32:35], v[64:79]
  ds_read_b128 v[56:59], v2 offset:30720
  v_mfma_f32_32x32x16_bf16 v[80:95], a[224:227], v[32:35], v[80:95]
  s_waitcnt lgkmcnt(5)
  v_mfma_f32_32x32x16_bf16 v[64:79], a[100:103], v[36:39], v[64:79]
  ds_read_b128 v[60:63], v2 offset:31744
  v_mfma_f32_32x32x16_bf16 v[80:95], a[228:231], v[36:39], v[80:95]
  s_waitcnt lgkmcnt(5)
  v_mfma_f32_32x32x16_bf16 v[64:79], a[104:107], v[40:43], v[64:79]
  v_mfma_f32_32x32x16_bf16 v[80:95], a[232:235], v[40:43], v[80:95]
  s_waitcnt lgkmcnt(4)
  v_mfma_f32_32x32x16_bf16 v[64:79], a[108:111], v[44:47], v[64:79]
  v_mfma_f32_32x32x16_bf16 v[80:95], a[236:239], v[44:47], v[80:95]
  s_waitcnt lgkmcnt(3)
  v_mfma_f32_32x32x16_bf16 v[64:79], a[112:115], v[48:51], v[64:79]
  v_mfma_f32_32x32x16_bf16 v[80:95], a[240:243], v[48:51], v[80:95]
  s_waitcnt lgkmcnt(2)
  v_mfma_f32_32x32x16_bf16 v[64:79], a[116:119], v[52:55], v[64:79]
  v_mfma_f32_32x32x16_bf16 v[80:95], a[244:247], v[52:55], v[80:95]
  s_waitcnt lgkmcnt(1)
  v_mfma_f32_32x32x16_bf16 v[64:79], a[120:123], v[56:59], v[64:79]
  v_mfma_f32_32x32x16_bf16 v[80:95], a[248:251], v[56:59], v[80:95]
  s_waitcnt lgkmcnt(0)
  v_mfma_f32_32x32x16_bf16 v[64:79], a[124:127], v[60:63], v[64:79]
  v_mfma_f32_32x32x16_bf16 v[80:95], a[252:255], v[60:63], v[80:95]
  v_xor_b32 v2, 32768, v2
  s_nop 3
  global_store_dwordx4 v1, v[64:67], s[28:29] offset:0 sc1
  global_store_dwordx4 v1, v[68:71], s[28:29] offset:1024 sc1
  global_store_dwordx4 v1, v[72:75], s[28:29] offset:2048 sc1
  global_store_dwordx4 v1, v[76:79], s[28:29] offset:3072 sc1
  s_nop 2
  global_store_dwordx4 v10, v[80:83], s[28:29] offset:0 sc1
  global_store_dwordx4 v10, v[84:87], s[28:29] offset:1024 sc1
  global_store_dwordx4 v10, v[88:91], s[28:29] offset:2048 sc1
  global_store_dwordx4 v10, v[92:95], s[28:29] offset:3072 sc1
  s_cmp_lg_u32 s35, 0
  s_cbranch_scc1 L_seg_115
  s_waitcnt vmcnt(0)
  s_barrier
  s_cmp_eq_u32 s52, -1
  s_cbranch_scc1 L_nf_123
  s_cmp_lg_u32 s8, 0
  s_cbranch_scc1 L_fs_124
  s_lshl_b32 s48, s52, 14
  s_lshl_b32 s49, s36, 7
  s_add_u32 s48, s48, s49
  s_add_u32 s48, s48, 14336
  v_mov_b32 v254, s48
  v_mov_b32 v255, 1
  s_mov_b64 exec, 1
  global_store_dword v254, v255, s[46:47] sc1
  s_mov_b64 exec, -1
L_fs_124:
L_nf_123:
  s_cmp_lg_u32 s8, 0
  s_cbranch_scc1 L_fs_125
  s_lshl_b32 s48, s53, 14
  s_lshl_b32 s49, s36, 7
  s_add_u32 s48, s48, s49
  s_add_u32 s48, s48, 14336
  v_mov_b32 v254, s48
  v_mov_b32 v255, 1
  s_mov_b64 exec, 1
  global_store_dword v254, v255, s[46:47] sc1
  s_mov_b64 exec, -1
L_fs_125:
  s_branch L_ddone_113
L_d3_114:
  v_lshrrev_b32 v12, 5, v0
  v_and_b32 v13, 31, v0
  v_add_u32 v14, 0, v12
  v_lshlrev_b32 v14, 2, v14
  v_xor_b32 v14, v14, v13
  v_lshlrev_b32 v15, 4, v14
  v_mov_b32 v17, s21
  v_add_co_u32 v16, vcc, s20, v15
  s_nop 1
  v_addc_co_u32 v17, vcc, 0, v17, vcc
  s_lshl_b32 s12, s8, 4
  s_add_u32 s12, s12, 0
  v_add_u32 v15, s12, v12
  v_mul_lo_u32 v15, v15, s24
  v_add_co_u32 v16, vcc, v16, v15
  s_nop 1
  v_addc_co_u32 v17, vcc, 0, v17, vcc
  v_add_u32 v14, 2, v12
  v_lshlrev_b32 v14, 2, v14
  v_xor_b32 v14, v14, v13
  v_lshlrev_b32 v15, 4, v14
  v_mov_b32 v19, s21
  v_add_co_u32 v18, vcc, s20, v15
  s_nop 1
  v_addc_co_u32 v19, vcc, 0, v19, vcc
  s_lshl_b32 s12, s8, 4
  s_add_u32 s12, s12, 2
  v_add_u32 v15, s12, v12
  v_mul_lo_u32 v15, v15, s24
  v_add_co_u32 v18, vcc, v18, v15
  s_nop 1
  v_addc_co_u32 v19, vcc, 0, v19, vcc
  s_lshl_b32 s14, s24, 2
  s_mul_i32 s15, s24, 48
  s_lshl_b32 s13, s8, 13
  v_bfe_u32 v22, v0, 2, 2
  v_and_b32 v23, 3, v0
  v_and_b32 v24, 1, v23
  v_lshlrev_b32 v24, 1, v24
  v_lshrrev_b32 v23, 1, v23
  v_or_b32 v23, v23, v24
  v_bfe_u32 v24, v0, 4, 1
  v_lshrrev_b32 v25, 5, v0
  v_lshrrev_b32 v26, 1, v23
  v_lshl_add_u32 v26, v24, 1, v26
  v_lshl_add_u32 v25, v25, 3, v22
  s_lshl_b32 s12, s8, 3
  s_add_u32 s12, s12, 0
  v_add_u32 v27, s12, v26
  v_lshlrev_b32 v28, 2, v22
  v_xor_b32 v27, v27, v28
  v_lshlrev_b32 v27, 4, v27
  v_lshl_add_u32 v27, v25, 9, v27
  v_and_b32 v28, 1, v23
  v_lshl_add_u32 v29, v28, 3, v27
  s_lshl_b32 s12, s8, 3
  s_add_u32 s12, s12, 4
  v_add_u32 v27, s12, v26
  v_lshlrev_b32 v28, 2, v22
  v_xor_b32 v27, v27, v28
  v_lshlrev_b32 v27, 4, v27
  v_lshl_add_u32 v27, v25, 9, v27
  v_and_b32 v28, 1, v23
  v_lshl_add_u32 v30, v28, 3, v27
  v_add_u32 v21, s13, v1
  global_load_dwordx4 a[0:3], v[16:17], off
  v_add_co_u32 v16, vcc, s14, v16
  s_nop 1
  v_addc_co_u32 v17, vcc, 0, v17, vcc
  global_load_dwordx4 a[4:7], v[18:19], off
  v_add_co_u32 v18, vcc, s14, v18
  s_nop 1
  v_addc_co_u32 v19, vcc, 0, v19, vcc
  global_load_dwordx4 a[8:11], v[16:17], off
  v_add_co_u32 v16, vcc, s14, v16
  s_nop 1
  v_addc_co_u32 v17, vcc, 0, v17, vcc
  global_load_dwordx4 a[12:15], v[18:19], off
  v_add_co_u32 v18, vcc, s14, v18
  s_nop 1
  v_addc_co_u32 v19, vcc, 0, v19, vcc
  global_load_dwordx4 a[128:131], v[16:17], off
  v_add_co_u32 v16, vcc, s14, v16
  s_nop 1
  v_addc_co_u32 v17, vcc, 0, v17, vcc
  global_load_dwordx4 a[132:135], v[18:19], off
  v_add_co_u32 v18, vcc, s14, v18
  s_nop 1
  v_addc_co_u32 v19, vcc, 0, v19, vcc
  global_load_dwordx4 a[136:139], v[16:17], off
  v_add_co_u32 v16, vcc, s14, v16
  s_nop 1
  v_addc_co_u32 v17, vcc, 0, v17, vcc
  global_load_dwordx4 a[140:143], v[18:19], off
  v_add_co_u32 v18, vcc, s14, v18
  s_nop 1
  v_addc_co_u32 v19, vcc, 0, v19, vcc
  v_add_co_u32 v16, vcc, s15, v16
  s_nop 1
  v_addc_co_u32 v17, vcc, 0, v17, vcc
  v_add_co_u32 v18, vcc, s15, v18
  s_nop 1
  v_addc_co_u32 v19, vcc, 0, v19, vcc
  global_load_dwordx4 a[16:19], v[16:17], off
  v_add_co_u32 v16, vcc, s14, v16
  s_nop 1
  v_addc_co_u32 v17, vcc, 0, v17, vcc
  global_load_dwordx4 a[20:23], v[18:19], off
  v_add_co_u32 v18, vcc, s14, v18
  s_nop 1
  v_addc_co_u32 v19, vcc, 0, v19, vcc
  global_load_dwordx4 a[24:27], v[16:17], off
  v_add_co_u32 v16, vcc, s14, v16
  s_nop 1
  v_addc_co_u32 v17, vcc, 0, v17, vcc
  global_load_dwordx4 a[28:31], v[18:19], off
  v_add_co_u32 v18, vcc, s14, v18
  s_nop 1
  v_addc_co_u32 v19, vcc, 0, v19, vcc
  global_load_dwordx4 a[144:147], v[16:17], off
  v_add_co_u32 v16, vcc, s14, v16
  s_nop 1
  v_addc_co_u32 v17, vcc, 0, v17, vcc
  global_load_dwordx4 a[148:151], v[18:19], off
  v_add_co_u32 v18, vcc, s14, v18
  s_nop 1
  v_addc_co_u32 v19, vcc, 0, v19, vcc
  global_load_dwordx4 a[152:155], v[16:17], off
  v_add_co_u32 v16, vcc, s14, v16
  s_nop 1
  v_addc_co_u32 v17, vcc, 0, v17, vcc
  global_load_dwordx4 a[156:159], v[18:19], off
  v_add_co_u32 v18, vcc, s14, v18
  s_nop 1
  v_addc_co_u32 v19, vcc, 0, v19, vcc
  v_add_co_u32 v16, vcc, s15, v16
  s_nop 1
  v_addc_co_u32 v17, vcc, 0, v17, vcc
  v_add_co_u32 v18, vcc, s15, v18
  s_nop 1
  v_addc_co_u32 v19, vcc, 0, v19, vcc
  global_load_dwordx4 a[32:35], v[16:17], off
  v_add_co_u32 v16, vcc, s14, v16
  s_nop 1
  v_addc_co_u32 v17, vcc, 0, v17, vcc
  global_load_dwordx4 a[36:39], v[18:19], off
  v_add_co_u32 v18, vcc, s14, v18
  s_nop 1
  v_addc_co_u32 v19, vcc, 0, v19, vcc
  global_load_dwordx4 a[40:43], v[16:17], off
  v_add_co_u32 v16, vcc, s14, v16
  s_nop 1
  v_addc_co_u32 v17, vcc, 0, v17, vcc
  global_load_dwordx4 a[44:47], v[18:19], off
  v_add_co_u32 v18, vcc, s14, v18
  s_nop 1
  v_addc_co_u32 v19, vcc, 0, v19, vcc
  global_load_dwordx4 a[160:163], v[16:17], off
  v_add_co_u32 v16, vcc, s14, v16
  s_nop 1
  v_addc_co_u32 v17, vcc, 0, v17, vcc
  global_load_dwordx4 a[164:167], v[18:19], off
  v_add_co_u32 v18, vcc, s14, v18
  s_nop 1
  v_addc_co_u32 v19, vcc, 0, v19, vcc
  global_load_dwordx4 a[168:171], v[16:17], off
  v_add_co_u32 v16, vcc, s14, v16
  s_nop 1
  v_addc_co_u32 v17, vcc, 0, v17, vcc
  global_load_dwordx4 a[172:175], v[18:19], off
  v_add_co_u32 v18, vcc, s14, v18
  s_nop 1
  v_addc_co_u32 v19, vcc, 0, v19, vcc
  v_add_co_u32 v16, vcc, s15, v16
  s_nop 1
  v_addc_co_u32 v17, vcc, 0, v17, vcc
  v_add_co_u32 v18, vcc, s15, v18
  s_nop 1
  v_addc_co_u32 v19, vcc, 0, v19, vcc
  global_load_dwordx4 a[48:51], v[16:17], off
  v_add_co_u32 v16, vcc, s14, v16
  s_nop 1
  v_addc_co_u32 v17, vcc, 0, v17, vcc
  global_load_dwordx4 a[52:55], v[18:19], off
  v_add_co_u32 v18, vcc, s14, v18
  s_nop 1
  v_addc_co_u32 v19, vcc, 0, v19, vcc
  global_load_dwordx4 a[56:59], v[16:17], off
  v_add_co_u32 v16, vcc, s14, v16
  s_nop 1
  v_addc_co_u32 v17, vcc, 0, v17, vcc
  global_load_dwordx4 a[60:63], v[18:19], off
  v_add_co_u32 v18, vcc, s14, v18
  s_nop 1
  v_addc_co_u32 v19, vcc, 0, v19, vcc
  global_load_dwordx4 a[176:179], v[16:17], off
  v_add_co_u32 v16, vcc, s14, v16
  s_nop 1
  v_addc_co_u32 v17, vcc, 0, v17, vcc
  global_load_dwordx4 a[180:183], v[18:19], off
  v_add_co_u32 v18, vcc, s14, v18
  s_nop 1
  v_addc_co_u32 v19, vcc, 0, v19, vcc
  global_load_dwordx4 a[184:187], v[16:17], off
  v_add_co_u32 v16, vcc, s14, v16
  s_nop 1
  v_addc_co_u32 v17, vcc, 0, v17, vcc
  global_load_dwordx4 a[188:191], v[18:19], off
  v_add_co_u32 v18, vcc, s14, v18
  s_nop 1
  v_addc_co_u32 v19, vcc, 0, v19, vcc
  v_add_co_u32 v16, vcc, s15, v16
  s_nop 1
  v_addc_co_u32 v17, vcc, 0, v17, vcc
  v_add_co_u32 v18, vcc, s15, v18
  s_nop 1
  v_addc_co_u32 v19, vcc, 0, v19, vcc
  s_waitcnt vmcnt(24)
  ds_write_b128 v21, a[0:3] offset:0
  ds_write_b128 v21, a[4:7] offset:1024
  ds_write_b128 v21, a[8:11] offset:2048
  ds_write_b128 v21, a[12:15] offset:3072
  ds_write_b128 v21, a[128:131] offset:4096
  ds_write_b128 v21, a[132:135] offset:5120
  ds_write_b128 v21, a[136:139] offset:6144
  ds_write_b128 v21, a[140:143] offset:7168
  s_waitcnt lgkmcnt(0)
  s_barrier
  ds_read_b64_tr_b16 a[0:1], v29 offset:0
  ds_read_b64_tr_b16 a[2:3], v29 offset:2048
  ds_read_b64_tr_b16 a[4:5], v29 offset:8192
  ds_read_b64_tr_b16 a[6:7], v29 offset:10240
  ds_read_b64_tr_b16 a[8:9], v29 offset:16384
  ds_read_b64_tr_b16 a[10:11], v29 offset:18432
  ds_read_b64_tr_b16 a[12:13], v29 offset:24576
  ds_read_b64_tr_b16 a[14:15], v29 offset:26624
  ds_read_b64_tr_b16 a[128:129], v30 offset:0
  ds_read_b64_tr_b16 a[130:131], v30 offset:2048
  ds_read_b64_tr_b16 a[132:133], v30 offset:8192
  ds_read_b64_tr_b16 a[134:135], v30 offset:10240
  ds_read_b64_tr_b16 a[136:137], v30 offset:16384
  ds_read_b64_tr_b16 a[138:139], v30 offset:18432
  ds_read_b64_tr_b16 a[140:141], v30 offset:24576
  ds_read_b64_tr_b16 a[142:143], v30 offset:26624
  s_waitcnt lgkmcnt(0)
  s_waitcnt vmcnt(16)
  ds_write_b128 v21, a[16:19] offset:32768
  ds_write_b128 v21, a[20:23] offset:33792
  ds_write_b128 v21, a[24:27] offset:34816
  ds_write_b128 v21, a[28:31] offset:35840
  ds_write_b128 v21, a[144:147] offset:36864
  ds_write_b128 v21, a[148:151] offset:37888
  ds_write_b128 v21, a[152:155] offset:38912
  ds_write_b128 v21, a[156:159] offset:39936
  s_waitcnt lgkmcnt(0)
  s_barrier
  ds_read_b64_tr_b16 a[16:17], v29 offset:32768
  ds_read_b64_tr_b16 a[18:19], v29 offset:34816
  ds_read_b64_tr_b16 a[20:21], v29 offset:40960
  ds_read_b64_tr_b16 a[22:23], v29 offset:43008
  ds_read_b64_tr_b16 a[24:25], v29 offset:49152
  ds_read_b64_tr_b16 a[26:27], v29 offset:51200
  ds_read_b64_tr_b16 a[28:29], v29 offset:57344
  ds_read_b64_tr_b16 a[30:31], v29 offset:59392
  ds_read_b64_tr_b16 a[144:145], v30 offset:32768
  ds_read_b64_tr_b16 a[146:147], v30 offset:34816
  ds_read_b64_tr_b16 a[148:149], v30 offset:40960
  ds_read_b64_tr_b16 a[150:151], v30 offset:43008
  ds_read_b64_tr_b16 a[152:153], v30 offset:49152
  ds_read_b64_tr_b16 a[154:155], v30 offset:51200
  ds_read_b64_tr_b16 a[156:157], v30 offset:57344
  ds_read_b64_tr_b16 a[158:159], v30 offset:59392
  s_waitcnt lgkmcnt(0)
  s_waitcnt vmcnt(8)
  ds_write_b128 v21, a[32:35] offset:0
  ds_write_b128 v21, a[36:39] offset:1024
  ds_write_b128 v21, a[40:43] offset:2048
  ds_write_b128 v21, a[44:47] offset:3072
  ds_write_b128 v21, a[160:163] offset:4096
  ds_write_b128 v21, a[164:167] offset:5120
  ds_write_b128 v21, a[168:171] offset:6144
  ds_write_b128 v21, a[172:175] offset:7168
  s_waitcnt lgkmcnt(0)
  s_barrier
  ds_read_b64_tr_b16 a[32:33], v29 offset:0
  ds_read_b64_tr_b16 a[34:35], v29 offset:2048
  ds_read_b64_tr_b16 a[36:37], v29 offset:8192
  ds_read_b64_tr_b16 a[38:39], v29 offset:10240
  ds_read_b64_tr_b16 a[40:41], v29 offset:16384
  ds_read_b64_tr_b16 a[42:43], v29 offset:18432
  ds_read_b64_tr_b16 a[44:45], v29 offset:24576
  ds_read_b64_tr_b16 a[46:47], v29 offset:26624
  ds_read_b64_tr_b16 a[160:161], v30 offset:0
  ds_read_b64_tr_b16 a[162:163], v30 offset:2048
  ds_read_b64_tr_b16 a[164:165], v30 offset:8192
  ds_read_b64_tr_b16 a[166:167], v30 offset:10240
  ds_read_b64_tr_b16 a[168:169], v30 offset:16384
  ds_read_b64_tr_b16 a[170:171], v30 offset:18432
  ds_read_b64_tr_b16 a[172:173], v30 offset:24576
  ds_read_b64_tr_b16 a[174:175], v30 offset:26624
  s_waitcnt lgkmcnt(0)
  s_waitcnt vmcnt(0)
  ds_write_b128 v21, a[48:51] offset:32768
  ds_write_b128 v21, a[52:55] offset:33792
  ds_write_b128 v21, a[56:59] offset:34816
  ds_write_b128 v21, a[60:63] offset:35840
  ds_write_b128 v21, a[176:179] offset:36864
  ds_write_b128 v21, a[180:183] offset:37888
  ds_write_b128 v21, a[184:187] offset:38912
  ds_write_b128 v21, a[188:191] offset:39936
  s_waitcnt lgkmcnt(0)
  s_barrier
  ds_read_b64_tr_b16 a[48:49], v29 offset:32768
  ds_read_b64_tr_b16 a[50:51], v29 offset:34816
  ds_read_b64_tr_b16 a[52:53], v29 offset:40960
  ds_read_b64_tr_b16 a[54:55], v29 offset:43008
  ds_read_b64_tr_b16 a[56:57], v29 offset:49152
  ds_read_b64_tr_b16 a[58:59], v29 offset:51200
  ds_read_b64_tr_b16 a[60:61], v29 offset:57344
  ds_read_b64_tr_b16 a[62:63], v29 offset:59392
  ds_read_b64_tr_b16 a[176:177], v30 offset:32768
  ds_read_b64_tr_b16 a[178:179], v30 offset:34816
  ds_read_b64_tr_b16 a[180:181], v30 offset:40960
  ds_read_b64_tr_b16 a[182:183], v30 offset:43008
  ds_read_b64_tr_b16 a[184:185], v30 offset:49152
  ds_read_b64_tr_b16 a[186:187], v30 offset:51200
  ds_read_b64_tr_b16 a[188:189], v30 offset:57344
  ds_read_b64_tr_b16 a[190:191], v30 offset:59392
  s_waitcnt lgkmcnt(0)
  s_barrier
  v_mov_b32 v2, v1
  s_mov_b32 s34, 0
  s_mov_b32 s52, s30
  s_mov_b32 s53, s35
L_dw_127:
  s_cmp_lg_u32 s8, 0
  s_cbranch_scc1 L_fwok_129
  s_lshl_b32 s48, s52, 14
  s_add_u32 s48, s48, 0
  v_lshlrev_b32 v254, 7, v0
  v_add_u32 v254, s48, v254
  s_mov_b32 s49, 0
  s_mov_b32 exec_lo, s54
  s_mov_b32 exec_hi, s55
L_fw_128:
  global_load_dword v255, v254, s[46:47] sc1
  s_add_u32 s49, s49, 1
  s_cmp_gt_u32 s49, 0x20000
  s_cbranch_scc1 L_fwok2_130
  s_waitcnt vmcnt(0)
  v_cmp_ne_u32 vcc, 0, v255
  s_nop 0
  s_and_b32 s50, vcc_lo, s54
  s_and_b32 s51, vcc_hi, s55
  s_xor_b32 s50, s50, s54
  s_xor_b32 s51, s51, s55
  s_or_b32 s50, s50, s51
  s_cmp_eq_u32 s50, 0
  s_cbranch_scc1 L_fwok2_130
  s_sleep 2
  s_branch L_fw_128
L_fwok2_130:
  s_mov_b64 exec, -1
L_fwok_129:
  s_barrier
  s_add_u32 s52, s52, 4
  s_sub_u32 s53, s53, 1
  s_cmp_lg_u32 s53, 0
  s_cbranch_scc1 L_dw_127
  s_mul_i32 s12, s30, 114688
  s_add_u32 s12, s12, s37
  s_add_u32 s26, s4, s12
  s_addc_u32 s27, s5, 0
  s_mul_i32 s12, s8, 4096
  s_add_u32 s16, s26, s12
  s_addc_u32 s17, s27, 0
  s_add_u32 s12, s12, s34
  s_add_u32 m0, s12, 0
  s_nop 0
  global_load_lds_dwordx4 v1, s[16:17] offset:0 sc1
  global_load_lds_dwordx4 v1, s[16:17] offset:1024 sc1
  global_load_lds_dwordx4 v1, s[16:17] offset:2048 sc1
  global_load_lds_dwordx4 v1, s[16:17] offset:3072 sc1
  s_mov_b32 s52, -1
  s_mov_b32 s53, -1
  s_waitcnt vmcnt(0)
L_seg_126:
  s_waitcnt vmcnt(8)
  s_barrier
  s_cmp_eq_u32 s52, -1
  s_cbranch_scc1 L_nf_131
  s_cmp_lg_u32 s8, 0
  s_cbranch_scc1 L_fs_132
  s_lshl_b32 s48, s52, 14
  s_lshl_b32 s49, s36, 7
  s_add_u32 s48, s48, s49
  s_add_u32 s48, s48, 14336
  v_mov_b32 v254, s48
  v_mov_b32 v255, 1
  s_mov_b64 exec, 1
  global_store_dword v254, v255, s[46:47] sc1
  s_mov_b64 exec, -1
L_fs_132:
L_nf_131:
  s_mov_b32 s52, s53
  s_mov_b32 s53, s30
  s_lshl_b32 s12, s30, 16
  s_add_u32 s12, s12, s38
  s_add_u32 s28, s4, s12
  s_addc_u32 s29, s5, 0
  s_add_u32 s30, s30, 4
  s_sub_u32 s35, s35, 1
  s_xor_b32 s34, s34, 32768
  s_cmp_eq_u32 s35, 0
  s_cbranch_scc1 L_nonext_133
  s_mul_i32 s12, s30, 114688
  s_add_u32 s12, s12, s37
  s_add_u32 s26, s4, s12
  s_addc_u32 s27, s5, 0
  s_mul_i32 s12, s8, 4096
  s_add_u32 s16, s26, s12
  s_addc_u32 s17, s27, 0
  s_add_u32 s12, s12, s34
  s_add_u32 m0, s12, 0
  s_nop 0
  global_load_lds_dwordx4 v1, s[16:17] offset:0 sc1
  global_load_lds_dwordx4 v1, s[16:17] offset:1024 sc1
  global_load_lds_dwordx4 v1, s[16:17] offset:2048 sc1
  global_load_lds_dwordx4 v1, s[16:17] offset:3072 sc1
L_nonext_133:
  ds_read_b128 v[32:35], v2 offset:0
  ds_read_b128 v[36:39], v2 offset:1024
  ds_read_b128 v[40:43], v2 offset:2048
  ds_read_b128 v[44:47], v2 offset:3072
  ds_read_b128 v[48:51], v2 offset:4096
  ds_read_b128 v[52:55], v2 offset:5120
  s_waitcnt lgkmcnt(5)
  v_mfma_f32_32x32x16_bf16 v[64:79], a[0:3], v[32:35], 0
  ds_read_b128 v[56:59], v2 offset:6144
  v_mfma_f32_32x32x16_bf16 v[80:95], a[128:131], v[32:35], 0
  s_waitcnt lgkmcnt(5)
  v_mfma_f32_32x32x16_bf16 v[64:79], a[4:7], v[36:39], v[64:79]
  ds_read_b128 v[60:63], v2 offset:7168
  v_mfma_f32_32x32x16_bf16 v[80:95], a[132:135], v[36:39], v[80:95]
  s_waitcnt lgkmcnt(5)
  v_mfma_f32_32x32x16_bf16 v[64:79], a[8:11], v[40:43], v[64:79]
  ds_read_b128 v[32:35], v2 offset:8192
  v_mfma_f32_32x32x16_bf16 v[80:95], a[136:139], v[40:43], v[80:95]
  s_waitcnt lgkmcnt(5)
  v_mfma_f32_32x32x16_bf16 v[64:79], a[12:15], v[44:47], v[64:79]
  ds_read_b128 v[36:39], v2 offset:9216
  v_mfma_f32_32x32x16_bf16 v[80:95], a[140:143], v[44:47], v[80:95]
  s_waitcnt lgkmcnt(5)
  v_mfma_f32_32x32x16_bf16 v[64:79], a[16:19], v[48:51], v[64:79]
  ds_read_b128 v[40:43], v2 offset:10240
  v_mfma_f32_32x32x16_bf16 v[80:95], a[144:147], v[48:51], v[80:95]
  s_waitcnt lgkmcnt(5)
  v_mfma_f32_32x32x16_bf16 v[64:79], a[20:23], v[52:55], v[64:79]
  ds_read_b128 v[44:47], v2 offset:11264
  v_mfma_f32_32x32x16_bf16 v[80:95], a[148:151], v[52:55], v[80:95]
  s_waitcnt lgkmcnt(5)
  v_mfma_f32_32x32x16_bf16 v[64:79], a[24:27], v[56:59], v[64:79]
  ds_read_b128 v[48:51], v2 offset:12288
  v_mfma_f32_32x32x16_bf16 v[80:95], a[152:155], v[56:59], v[80:95]
  s_waitcnt lgkmcnt(5)
  v_mfma_f32_32x32x16_bf16 v[64:79], a[28:31], v[60:63], v[64:79]
  ds_read_b128 v[52:55], v2 offset:13312
  v_mfma_f32_32x32x16_bf16 v[80:95], a[156:159], v[60:63], v[80:95]
  s_waitcnt lgkmcnt(5)
  v_mfma_f32_32x32x16_bf16 v[64:79], a[32:35], v[32:35], v[64:79]
  ds_read_b128 v[56:59], v2 offset:14336
  v_mfma_f32_32x32x16_bf16 v[80:95], a[160:163], v[32:35], v[80:95]
  s_waitcnt lgkmcnt(5)
  v_mfma_f32_32x32x16_bf16 v[64:79], a[36:39], v[36:39], v[64:79]
  ds_read_b128 v[60:63], v2 offset:15360
  v_mfma_f32_32x32x16_bf16 v[80:95], a[164:167], v[36:39], v[80:95]
  s_waitcnt lgkmcnt(5)
  v_mfma_f32_32x32x16_bf16 v[64:79], a[40:43], v[40:43], v[64:79]
  v_mfma_f32_32x32x16_bf16 v[80:95], a[168:171], v[40:43], v[80:95]
  s_waitcnt lgkmcnt(4)
  v_mfma_f32_32x32x16_bf16 v[64:79], a[44:47], v[44:47], v[64:79]
  v_mfma_f32_32x32x16_bf16 v[80:95], a[172:175], v[44:47], v[80:95]
  s_waitcnt lgkmcnt(3)
  v_mfma_f32_32x32x16_bf16 v[64:79], a[48:51], v[48:51], v[64:79]
  v_mfma_f32_32x32x16_bf16 v[80:95], a[176:179], v[48:51], v[80:95]
  s_waitcnt lgkmcnt(2)
  v_mfma_f32_32x32x16_bf16 v[64:79], a[52:55], v[52:55], v[64:79]
  v_mfma_f32_32x32x16_bf16 v[80:95], a[180:183], v[52:55], v[80:95]
  s_waitcnt lgkmcnt(1)
  v_mfma_f32_32x32x16_bf16 v[64:79], a[56:59], v[56:59], v[64:79]
  v_mfma_f32_32x32x16_bf16 v[80:95], a[184:187], v[56:59], v[80:95]
  s_waitcnt lgkmcnt(0)
  v_mfma_f32_32x32x16_bf16 v[64:79], a[60:63], v[60:63], v[64:79]
  v_mfma_f32_32x32x16_bf16 v[80:95], a[188:191], v[60:63], v[80:95]
  v_xor_b32 v2, 32768, v2
  s_nop 3
  global_store_dwordx4 v1, v[64:67], s[28:29] offset:0 sc1
  global_store_dwordx4 v1, v[68:71], s[28:29] offset:1024 sc1
  global_store_dwordx4 v1, v[72:75], s[28:29] offset:2048 sc1
  global_store_dwordx4 v1, v[76:79], s[28:29] offset:3072 sc1
  s_nop 2
  global_store_dwordx4 v10, v[80:83], s[28:29] offset:0 sc1
  global_store_dwordx4 v10, v[84:87], s[28:29] offset:1024 sc1
  global_store_dwordx4 v10, v[88:91], s[28:29] offset:2048 sc1
  global_store_dwordx4 v10, v[92:95], s[28:29] offset:3072 sc1
  s_cmp_lg_u32 s35, 0
  s_cbranch_scc1 L_seg_126
  s_waitcnt vmcnt(0)
  s_barrier
  s_cmp_eq_u32 s52, -1
  s_cbranch_scc1 L_nf_134
  s_cmp_lg_u32 s8, 0
  s_cbranch_scc1 L_fs_135
  s_lshl_b32 s48, s52, 14
  s_lshl_b32 s49, s36, 7
  s_add_u32 s48, s48, s49
  s_add_u32 s48, s48, 14336
  v_mov_b32 v254, s48
  v_mov_b32 v255, 1
  s_mov_b64 exec, 1
  global_store_dword v254, v255, s[46:47] sc1
  s_mov_b64 exec, -1
L_fs_135:
L_nf_134:
  s_cmp_lg_u32 s8, 0
  s_cbranch_scc1 L_fs_136
  s_lshl_b32 s48, s53, 14
  s_lshl_b32 s49, s36, 7
  s_add_u32 s48, s48, s49
  s_add_u32 s48, s48, 14336
  v_mov_b32 v254, s48
  v_mov_b32 v255, 1
  s_mov_b64 exec, 1
  global_store_dword v254, v255, s[46:47] sc1
  s_mov_b64 exec, -1
L_fs_136:
  s_branch L_ddone_113
L_ddone_113:
  s_branch L_wend
L_w3:
  s_lshr_b32 s12, s58, 2
  s_mul_i32 s12, s12, 3
  s_and_b32 s13, s58, 3
  s_add_u32 s12, s12, s13
  s_sub_u32 s12, s12, 1
  s_and_b32 s36, s12, 15
  s_lshr_b32 s30, s12, 4
  s_cmp_lt_u32 s30, 4
  s_cselect_b32 s35, 11, 10
  s_lshr_b32 s18, s36, 1
  s_and_b32 s19, s36, 1
  s_lshl_b32 s12, s18, 19
  s_lshl_b32 s13, s19, 9
  s_add_u32 s12, s12, s13
  s_add_u32 s20, s68, s12
  s_addc_u32 s21, s69, 0
  s_mov_b32 s24, 1024
  s_lshl_b32 s39, s18, 2
  s_add_u32 s39, s39, s8
  s_lshl_b32 s38, s18, 22
  s_lshl_b32 s12, s19, 15
  s_add_u32 s38, s38, s12
  s_lshl_b32 s12, s8, 13
  s_add_u32 s38, s38, s12
  s_add_u32 s38, s38, 117440512
  v_lshrrev_b32 v12, 5, v0
  v_and_b32 v13, 31, v0
  v_add_u32 v14, 0, v12
  v_lshlrev_b32 v14, 2, v14
  v_xor_b32 v14, v14, v13
  v_lshlrev_b32 v15, 4, v14
  v_mov_b32 v17, s21
  v_add_co_u32 v16, vcc, s20, v15
  s_nop 1
  v_addc_co_u32 v17, vcc, 0, v17, vcc
  s_lshl_b32 s12, s8, 4
  s_add_u32 s12, s12, 0
  v_add_u32 v15, s12, v12
  v_mul_lo_u32 v15, v15, s24
  v_add_co_u32 v16, vcc, v16, v15
  s_nop 1
  v_addc_co_u32 v17, vcc, 0, v17, vcc
  v_add_u32 v14, 2, v12
  v_lshlrev_b32 v14, 2, v14
  v_xor_b32 v14, v14, v13
  v_lshlrev_b32 v15, 4, v14
  v_mov_b32 v19, s21
  v_add_co_u32 v18, vcc, s20, v15
  s_nop 1
  v_addc_co_u32 v19, vcc, 0, v19, vcc
  s_lshl_b32 s12, s8, 4
  s_add_u32 s12, s12, 2
  v_add_u32 v15, s12, v12
  v_mul_lo_u32 v15, v15, s24
  v_add_co_u32 v18, vcc, v18, v15
  s_nop 1
  v_addc_co_u32 v19, vcc, 0, v19, vcc
  s_lshl_b32 s14, s24, 2
  s_mul_i32 s15, s24, 48
  s_lshl_b32 s13, s8, 13
  v_bfe_u32 v22, v0, 2, 2
  v_and_b32 v23, 3, v0
  v_and_b32 v24, 1, v23
  v_lshlrev_b32 v24, 1, v24
  v_lshrrev_b32 v23, 1, v23
  v_or_b32 v23, v23, v24
  v_bfe_u32 v24, v0, 4, 1
  v_lshrrev_b32 v25, 5, v0
  v_lshrrev_b32 v26, 1, v23
  v_lshl_add_u32 v26, v24, 1, v26
  v_lshl_add_u32 v25, v25, 3, v22
  s_lshl_b32 s12, s8, 3
  s_add_u32 s12, s12, 0
  v_add_u32 v27, s12, v26
  v_lshlrev_b32 v28, 2, v22
  v_xor_b32 v27, v27, v28
  v_lshlrev_b32 v27, 4, v27
  v_lshl_add_u32 v27, v25, 9, v27
  v_and_b32 v28, 1, v23
  v_lshl_add_u32 v29, v28, 3, v27
  s_lshl_b32 s12, s8, 3
  s_add_u32 s12, s12, 4
  v_add_u32 v27, s12, v26
  v_lshlrev_b32 v28, 2, v22
  v_xor_b32 v27, v27, v28
  v_lshlrev_b32 v27, 4, v27
  v_lshl_add_u32 v27, v25, 9, v27
  v_and_b32 v28, 1, v23
  v_lshl_add_u32 v30, v28, 3, v27
  v_add_u32 v21, s13, v1
  global_load_dwordx4 a[0:3], v[16:17], off
  v_add_co_u32 v16, vcc, s14, v16
  s_nop 1
  v_addc_co_u32 v17, vcc, 0, v17, vcc
  global_load_dwordx4 a[4:7], v[18:19], off
  v_add_co_u32 v18, vcc, s14, v18
  s_nop 1
  v_addc_co_u32 v19, vcc, 0, v19, vcc
  global_load_dwordx4 a[8:11], v[16:17], off
  v_add_co_u32 v16, vcc, s14, v16
  s_nop 1
  v_addc_co_u32 v17, vcc, 0, v17, vcc
  global_load_dwordx4 a[12:15], v[18:19], off
  v_add_co_u32 v18, vcc, s14, v18
  s_nop 1
  v_addc_co_u32 v19, vcc, 0, v19, vcc
  global_load_dwordx4 a[128:131], v[16:17], off
  v_add_co_u32 v16, vcc, s14, v16
  s_nop 1
  v_addc_co_u32 v17, vcc, 0, v17, vcc
  global_load_dwordx4 a[132:135], v[18:19], off
  v_add_co_u32 v18, vcc, s14, v18
  s_nop 1
  v_addc_co_u32 v19, vcc, 0, v19, vcc
  global_load_dwordx4 a[136:139], v[16:17], off
  v_add_co_u32 v16, vcc, s14, v16
  s_nop 1
  v_addc_co_u32 v17, vcc, 0, v17, vcc
  global_load_dwordx4 a[140:143], v[18:19], off
  v_add_co_u32 v18, vcc, s14, v18
  s_nop 1
  v_addc_co_u32 v19, vcc, 0, v19, vcc
  v_add_co_u32 v16, vcc, s15, v16
  s_nop 1
  v_addc_co_u32 v17, vcc, 0, v17, vcc
  v_add_co_u32 v18, vcc, s15, v18
  s_nop 1
  v_addc_co_u32 v19, vcc, 0, v19, vcc
  global_load_dwordx4 a[16:19], v[16:17], off
  v_add_co_u32 v16, vcc, s14, v16
  s_nop 1
  v_addc_co_u32 v17, vcc, 0, v17, vcc
  global_load_dwordx4 a[20:23], v[18:19], off
  v_add_co_u32 v18, vcc, s14, v18
  s_nop 1
  v_addc_co_u32 v19, vcc, 0, v19, vcc
  global_load_dwordx4 a[24:27], v[16:17], off
  v_add_co_u32 v16, vcc, s14, v16
  s_nop 1
  v_addc_co_u32 v17, vcc, 0, v17, vcc
  global_load_dwordx4 a[28:31], v[18:19], off
  v_add_co_u32 v18, vcc, s14, v18
  s_nop 1
  v_addc_co_u32 v19, vcc, 0, v19, vcc
  global_load_dwordx4 a[144:147], v[16:17], off
  v_add_co_u32 v16, vcc, s14, v16
  s_nop 1
  v_addc_co_u32 v17, vcc, 0, v17, vcc
  global_load_dwordx4 a[148:151], v[18:19], off
  v_add_co_u32 v18, vcc, s14, v18
  s_nop 1
  v_addc_co_u32 v19, vcc, 0, v19, vcc
  global_load_dwordx4 a[152:155], v[16:17], off
  v_add_co_u32 v16, vcc, s14, v16
  s_nop 1
  v_addc_co_u32 v17, vcc, 0, v17, vcc
  global_load_dwordx4 a[156:159], v[18:19], off
  v_add_co_u32 v18, vcc, s14, v18
  s_nop 1
  v_addc_co_u32 v19, vcc, 0, v19, vcc
  v_add_co_u32 v16, vcc, s15, v16
  s_nop 1
  v_addc_co_u32 v17, vcc, 0, v17, vcc
  v_add_co_u32 v18, vcc, s15, v18
  s_nop 1
  v_addc_co_u32 v19, vcc, 0, v19, vcc
  global_load_dwordx4 a[32:35], v[16:17], off
  v_add_co_u32 v16, vcc, s14, v16
  s_nop 1
  v_addc_co_u32 v17, vcc, 0, v17, vcc
  global_load_dwordx4 a[36:39], v[18:19], off
  v_add_co_u32 v18, vcc, s14, v18
  s_nop 1
  v_addc_co_u32 v19, vcc, 0, v19, vcc
  global_load_dwordx4 a[40:43], v[16:17], off
  v_add_co_u32 v16, vcc, s14, v16
  s_nop 1
  v_addc_co_u32 v17, vcc, 0, v17, vcc
  global_load_dwordx4 a[44:47], v[18:19], off
  v_add_co_u32 v18, vcc, s14, v18
  s_nop 1
  v_addc_co_u32 v19, vcc, 0, v19, vcc
  global_load_dwordx4 a[160:163], v[16:17], off
  v_add_co_u32 v16, vcc, s14, v16
  s_nop 1
  v_addc_co_u32 v17, vcc, 0, v17, vcc
  global_load_dwordx4 a[164:167], v[18:19], off
  v_add_co_u32 v18, vcc, s14, v18
  s_nop 1
  v_addc_co_u32 v19, vcc, 0, v19, vcc
  global_load_dwordx4 a[168:171], v[16:17], off
  v_add_co_u32 v16, vcc, s14, v16
  s_nop 1
  v_addc_co_u32 v17, vcc, 0, v17, vcc
  global_load_dwordx4 a[172:175], v[18:19], off
  v_add_co_u32 v18, vcc, s14, v18
  s_nop 1
  v_addc_co_u32 v19, vcc, 0, v19, vcc
  v_add_co_u32 v16, vcc, s15, v16
  s_nop 1
  v_addc_co_u32 v17, vcc, 0, v17, vcc
  v_add_co_u32 v18, vcc, s15, v18
  s_nop 1
  v_addc_co_u32 v19, vcc, 0, v19, vcc
  global_load_dwordx4 a[48:51], v[16:17], off
  v_add_co_u32 v16, vcc, s14, v16
  s_nop 1
  v_addc_co_u32 v17, vcc, 0, v17, vcc
  global_load_dwordx4 a[52:55], v[18:19], off
  v_add_co_u32 v18, vcc, s14, v18
  s_nop 1
  v_addc_co_u32 v19, vcc, 0, v19, vcc
  global_load_dwordx4 a[56:59], v[16:17], off
  v_add_co_u32 v16, vcc, s14, v16
  s_nop 1
  v_addc_co_u32 v17, vcc, 0, v17, vcc
  global_load_dwordx4 a[60:63], v[18:19], off
  v_add_co_u32 v18, vcc, s14, v18
  s_nop 1
  v_addc_co_u32 v19, vcc, 0, v19, vcc
  global_load_dwordx4 a[176:179], v[16:17], off
  v_add_co_u32 v16, vcc, s14, v16
  s_nop 1
  v_addc_co_u32 v17, vcc, 0, v17, vcc
  global_load_dwordx4 a[180:183], v[18:19], off
  v_add_co_u32 v18, vcc, s14, v18
  s_nop 1
  v_addc_co_u32 v19, vcc, 0, v19, vcc
  global_load_dwordx4 a[184:187], v[16:17], off
  v_add_co_u32 v16, vcc, s14, v16
  s_nop 1
  v_addc_co_u32 v17, vcc, 0, v17, vcc
  global_load_dwordx4 a[188:191], v[18:19], off
  v_add_co_u32 v18, vcc, s14, v18
  s_nop 1
  v_addc_co_u32 v19, vcc, 0, v19, vcc
  v_add_co_u32 v16, vcc, s15, v16
  s_nop 1
  v_addc_co_u32 v17, vcc, 0, v17, vcc
  v_add_co_u32 v18, vcc, s15, v18
  s_nop 1
  v_addc_co_u32 v19, vcc, 0, v19, vcc
  global_load_dwordx4 a[64:67], v[16:17], off
  v_add_co_u32 v16, vcc, s14, v16
  s_nop 1
  v_addc_co_u32 v17, vcc, 0, v17, vcc
  global_load_dwordx4 a[68:71], v[18:19], off
  v_add_co_u32 v18, vcc, s14, v18
  s_nop 1
  v_addc_co_u32 v19, vcc, 0, v19, vcc
  global_load_dwordx4 a[72:75], v[16:17], off
  v_add_co_u32 v16, vcc, s14, v16
  s_nop 1
  v_addc_co_u32 v17, vcc, 0, v17, vcc
  global_load_dwordx4 a[76:79], v[18:19], off
  v_add_co_u32 v18, vcc, s14, v18
  s_nop 1
  v_addc_co_u32 v19, vcc, 0, v19, vcc
  global_load_dwordx4 a[192:195], v[16:17], off
  v_add_co_u32 v16, vcc, s14, v16
  s_nop 1
  v_addc_co_u32 v17, vcc, 0, v17, vcc
  global_load_dwordx4 a[196:199], v[18:19], off
  v_add_co_u32 v18, vcc, s14, v18
  s_nop 1
  v_addc_co_u32 v19, vcc, 0, v19, vcc
  global_load_dwordx4 a[200:203], v[16:17], off
  v_add_co_u32 v16, vcc, s14, v16
  s_nop 1
  v_addc_co_u32 v17, vcc, 0, v17, vcc
  global_load_dwordx4 a[204:207], v[18:19], off
  v_add_co_u32 v18, vcc, s14, v18
  s_nop 1
  v_addc_co_u32 v19, vcc, 0, v19, vcc
  v_add_co_u32 v16, vcc, s15, v16
  s_nop 1
  v_addc_co_u32 v17, vcc, 0, v17, vcc
  v_add_co_u32 v18, vcc, s15, v18
  s_nop 1
  v_addc_co_u32 v19, vcc, 0, v19, vcc
  global_load_dwordx4 a[80:83], v[16:17], off
  v_add_co_u32 v16, vcc, s14, v16
  s_nop 1
  v_addc_co_u32 v17, vcc, 0, v17, vcc
  global_load_dwordx4 a[84:87], v[18:19], off
  v_add_co_u32 v18, vcc, s14, v18
  s_nop 1
  v_addc_co_u32 v19, vcc, 0, v19, vcc
  global_load_dwordx4 a[88:91], v[16:17], off
  v_add_co_u32 v16, vcc, s14, v16
  s_nop 1
  v_addc_co_u32 v17, vcc, 0, v17, vcc
  global_load_dwordx4 a[92:95], v[18:19], off
  v_add_co_u32 v18, vcc, s14, v18
  s_nop 1
  v_addc_co_u32 v19, vcc, 0, v19, vcc
  global_load_dwordx4 a[208:211], v[16:17], off
  v_add_co_u32 v16, vcc, s14, v16
  s_nop 1
  v_addc_co_u32 v17, vcc, 0, v17, vcc
  global_load_dwordx4 a[212:215], v[18:19], off
  v_add_co_u32 v18, vcc, s14, v18
  s_nop 1
  v_addc_co_u32 v19, vcc, 0, v19, vcc
  global_load_dwordx4 a[216:219], v[16:17], off
  v_add_co_u32 v16, vcc, s14, v16
  s_nop 1
  v_addc_co_u32 v17, vcc, 0, v17, vcc
  global_load_dwordx4 a[220:223], v[18:19], off
  v_add_co_u32 v18, vcc, s14, v18
  s_nop 1
  v_addc_co_u32 v19, vcc, 0, v19, vcc
  v_add_co_u32 v16, vcc, s15, v16
  s_nop 1
  v_addc_co_u32 v17, vcc, 0, v17, vcc
  v_add_co_u32 v18, vcc, s15, v18
  s_nop 1
  v_addc_co_u32 v19, vcc, 0, v19, vcc
  global_load_dwordx4 a[96:99], v[16:17], off
  v_add_co_u32 v16, vcc, s14, v16
  s_nop 1
  v_addc_co_u32 v17, vcc, 0, v17, vcc
  global_load_dwordx4 a[100:103], v[18:19], off
  v_add_co_u32 v18, vcc, s14, v18
  s_nop 1
  v_addc_co_u32 v19, vcc, 0, v19, vcc
  global_load_dwordx4 a[104:107], v[16:17], off
  v_add_co_u32 v16, vcc, s14, v16
  s_nop 1
  v_addc_co_u32 v17, vcc, 0, v17, vcc
  global_load_dwordx4 a[108:111], v[18:19], off
  v_add_co_u32 v18, vcc, s14, v18
  s_nop 1
  v_addc_co_u32 v19, vcc, 0, v19, vcc
  global_load_dwordx4 a[224:227], v[16:17], off
  v_add_co_u32 v16, vcc, s14, v16
  s_nop 1
  v_addc_co_u32 v17, vcc, 0, v17, vcc
  global_load_dwordx4 a[228:231], v[18:19], off
  v_add_co_u32 v18, vcc, s14, v18
  s_nop 1
  v_addc_co_u32 v19, vcc, 0, v19, vcc
  global_load_dwordx4 a[232:235], v[16:17], off
  v_add_co_u32 v16, vcc, s14, v16
  s_nop 1
  v_addc_co_u32 v17, vcc, 0, v17, vcc
  global_load_dwordx4 a[236:239], v[18:19], off
  v_add_co_u32 v18, vcc, s14, v18
  s_nop 1
  v_addc_co_u32 v19, vcc, 0, v19, vcc
  v_add_co_u32 v16, vcc, s15, v16
  s_nop 1
  v_addc_co_u32 v17, vcc, 0, v17, vcc
  v_add_co_u32 v18, vcc, s15, v18
  s_nop 1
  v_addc_co_u32 v19, vcc, 0, v19, vcc
  s_waitcnt vmcnt(48)
  ds_write_b128 v21, a[0:3] offset:0
  ds_write_b128 v21, a[4:7] offset:1024
  ds_write_b128 v21, a[8:11] offset:2048
  ds_write_b128 v21, a[12:15] offset:3072
  ds_write_b128 v21, a[128:131] offset:4096
  ds_write_b128 v21, a[132:135] offset:5120
  ds_write_b128 v21, a[136:139] offset:6144
  ds_write_b128 v21, a[140:143] offset:7168
  s_waitcnt lgkmcnt(0)
  s_barrier
  ds_read_b64_tr_b16 a[0:1], v29 offset:0
  ds_read_b64_tr_b16 a[2:3], v29 offset:2048
  ds_read_b64_tr_b16 a[4:5], v29 offset:8192
  ds_read_b64_tr_b16 a[6:7], v29 offset:10240
  ds_read_b64_tr_b16 a[8:9], v29 offset:16384
  ds_read_b64_tr_b16 a[10:11], v29 offset:18432
  ds_read_b64_tr_b16 a[12:13], v29 offset:24576
  ds_read_b64_tr_b16 a[14:15], v29 offset:26624
  ds_read_b64_tr_b16 a[128:129], v30 offset:0
  ds_read_b64_tr_b16 a[130:131], v30 offset:2048
  ds_read_b64_tr_b16 a[132:133], v30 offset:8192
  ds_read_b64_tr_b16 a[134:135], v30 offset:10240
  ds_read_b64_tr_b16 a[136:137], v30 offset:16384
  ds_read_b64_tr_b16 a[138:139], v30 offset:18432
  ds_read_b64_tr_b16 a[140:141], v30 offset:24576
  ds_read_b64_tr_b16 a[142:143], v30 offset:26624
  global_load_dwordx4 a[112:115], v[16:17], off
  v_add_co_u32 v16, vcc, s14, v16
  s_nop 1
  v_addc_co_u32 v17, vcc, 0, v17, vcc
  global_load_dwordx4 a[116:119], v[18:19], off
  v_add_co_u32 v18, vcc, s14, v18
  s_nop 1
  v_addc_co_u32 v19, vcc, 0, v19, vcc
  global_load_dwordx4 a[120:123], v[16:17], off
  v_add_co_u32 v16, vcc, s14, v16
  s_nop 1
  v_addc_co_u32 v17, vcc, 0, v17, vcc
  global_load_dwordx4 a[124:127], v[18:19], off
  v_add_co_u32 v18, vcc, s14, v18
  s_nop 1
  v_addc_co_u32 v19, vcc, 0, v19, vcc
  global_load_dwordx4 a[240:243], v[16:17], off
  v_add_co_u32 v16, vcc, s14, v16
  s_nop 1
  v_addc_co_u32 v17, vcc, 0, v17, vcc
  global_load_dwordx4 a[244:247], v[18:19], off
  v_add_co_u32 v18, vcc, s14, v18
  s_nop 1
  v_addc_co_u32 v19, vcc, 0, v19, vcc
  global_load_dwordx4 a[248:251], v[16:17], off
  v_add_co_u32 v16, vcc, s14, v16
  s_nop 1
  v_addc_co_u32 v17, vcc, 0, v17, vcc
  global_load_dwordx4 a[252:255], v[18:19], off
  v_add_co_u32 v18, vcc, s14, v18
  s_nop 1
  v_addc_co_u32 v19, vcc, 0, v19, vcc
  v_add_co_u32 v16, vcc, s15, v16
  s_nop 1
  v_addc_co_u32 v17, vcc, 0, v17, vcc
  v_add_co_u32 v18, vcc, s15, v18
  s_nop 1
  v_addc_co_u32 v19, vcc, 0, v19, vcc
  s_waitcnt lgkmcnt(0)
  s_waitcnt vmcnt(48)
  ds_write_b128 v21, a[16:19] offset:32768
  ds_write_b128 v21, a[20:23] offset:33792
  ds_write_b128 v21, a[24:27] offset:34816
  ds_write_b128 v21, a[28:31] offset:35840
  ds_write_b128 v21, a[144:147] offset:36864
  ds_write_b128 v21, a[148:151] offset:37888
  ds_write_b128 v21, a[152:155] offset:38912
  ds_write_b128 v21, a[156:159] offset:39936
  s_waitcnt lgkmcnt(0)
  s_barrier
  ds_read_b64_tr_b16 a[16:17], v29 offset:32768
  ds_read_b64_tr_b16 a[18:19], v29 offset:34816
  ds_read_b64_tr_b16 a[20:21], v29 offset:40960
  ds_read_b64_tr_b16 a[22:23], v29 offset:43008
  ds_read_b64_tr_b16 a[24:25], v29 offset:49152
  ds_read_b64_tr_b16 a[26:27], v29 offset:51200
  ds_read_b64_tr_b16 a[28:29], v29 offset:57344
  ds_read_b64_tr_b16 a[30:31], v29 offset:59392
  ds_read_b64_tr_b16 a[144:145], v30 offset:32768
  ds_read_b64_tr_b16 a[146:147], v30 offset:34816
  ds_read_b64_tr_b16 a[148:149], v30 offset:40960
  ds_read_b64_tr_b16 a[150:151], v30 offset:43008
  ds_read_b64_tr_b16 a[152:153], v30 offset:49152
  ds_read_b64_tr_b16 a[154:155], v30 offset:51200
  ds_read_b64_tr_b16 a[156:157], v30 offset:57344
  ds_read_b64_tr_b16 a[158:159], v30 offset:59392
  s_waitcnt lgkmcnt(0)
  s_waitcnt vmcnt(40)
  ds_write_b128 v21, a[32:35] offset:0
  ds_write_b128 v21, a[36:39] offset:1024
  ds_write_b128 v21, a[40:43] offset:2048
  ds_write_b128 v21, a[44:47] offset:3072
  ds_write_b128 v21, a[160:163] offset:4096
  ds_write_b128 v21, a[164:167] offset:5120
  ds_write_b128 v21, a[168:171] offset:6144
  ds_write_b128 v21, a[172:175] offset:7168
  s_waitcnt lgkmcnt(0)
  s_barrier
  ds_read_b64_tr_b16 a[32:33], v29 offset:0
  ds_read_b64_tr_b16 a[34:35], v29 offset:2048
  ds_read_b64_tr_b16 a[36:37], v29 offset:8192
  ds_read_b64_tr_b16 a[38:39], v29 offset:10240
  ds_read_b64_tr_b16 a[40:41], v29 offset:16384
  ds_read_b64_tr_b16 a[42:43], v29 offset:18432
  ds_read_b64_tr_b16 a[44:45], v29 offset:24576
  ds_read_b64_tr_b16 a[46:47], v29 offset:26624
  ds_read_b64_tr_b16 a[160:161], v30 offset:0
  ds_read_b64_tr_b16 a[162:163], v30 offset:2048
  ds_read_b64_tr_b16 a[164:165], v30 offset:8192
  ds_read_b64_tr_b16 a[166:167], v30 offset:10240
  ds_read_b64_tr_b16 a[168:169], v30 offset:16384
  ds_read_b64_tr_b16 a[170:171], v30 offset:18432
  ds_read_b64_tr_b16 a[172:173], v30 offset:24576
  ds_read_b64_tr_b16 a[174:175], v30 offset:26624
  s_waitcnt lgkmcnt(0)
  s_waitcnt vmcnt(32)
  ds_write_b128 v21, a[48:51] offset:32768
  ds_write_b128 v21, a[52:55] offset:33792
  ds_write_b128 v21, a[56:59] offset:34816
  ds_write_b128 v21, a[60:63] offset:35840
  ds_write_b128 v21, a[176:179] offset:36864
  ds_write_b128 v21, a[180:183] offset:37888
  ds_write_b128 v21, a[184:187] offset:38912
  ds_write_b128 v21, a[188:191] offset:39936
  s_waitcnt lgkmcnt(0)
  s_barrier
  ds_read_b64_tr_b16 a[48:49], v29 offset:32768
  ds_read_b64_tr_b16 a[50:51], v29 offset:34816
  ds_read_b64_tr_b16 a[52:53], v29 offset:40960
  ds_read_b64_tr_b16 a[54:55], v29 offset:43008
  ds_read_b64_tr_b16 a[56:57], v29 offset:49152
  ds_read_b64_tr_b16 a[58:59], v29 offset:51200
  ds_read_b64_tr_b16 a[60:61], v29 offset:57344
  ds_read_b64_tr_b16 a[62:63], v29 offset:59392
  ds_read_b64_tr_b16 a[176:177], v30 offset:32768
  ds_read_b64_tr_b16 a[178:179], v30 offset:34816
  ds_read_b64_tr_b16 a[180:181], v30 offset:40960
  ds_read_b64_tr_b16 a[182:183], v30 offset:43008
  ds_read_b64_tr_b16 a[184:185], v30 offset:49152
  ds_read_b64_tr_b16 a[186:187], v30 offset:51200
  ds_read_b64_tr_b16 a[188:189], v30 offset:57344
  ds_read_b64_tr_b16 a[190:191], v30 offset:59392
  s_waitcnt lgkmcnt(0)
  s_waitcnt vmcnt(24)
  ds_write_b128 v21, a[64:67] offset:0
  ds_write_b128 v21, a[68:71] offset:1024
  ds_write_b128 v21, a[72:75] offset:2048
  ds_write_b128 v21, a[76:79] offset:3072
  ds_write_b128 v21, a[192:195] offset:4096
  ds_write_b128 v21, a[196:199] offset:5120
  ds_write_b128 v21, a[200:203] offset:6144
  ds_write_b128 v21, a[204:207] offset:7168
  s_waitcnt lgkmcnt(0)
  s_barrier
  ds_read_b64_tr_b16 a[64:65], v29 offset:0
  ds_read_b64_tr_b16 a[66:67], v29 offset:2048
  ds_read_b64_tr_b16 a[68:69], v29 offset:8192
  ds_read_b64_tr_b16 a[70:71], v29 offset:10240
  ds_read_b64_tr_b16 a[72:73], v29 offset:16384
  ds_read_b64_tr_b16 a[74:75], v29 offset:18432
  ds_read_b64_tr_b16 a[76:77], v29 offset:24576
  ds_read_b64_tr_b16 a[78:79], v29 offset:26624
  ds_read_b64_tr_b16 a[192:193], v30 offset:0
  ds_read_b64_tr_b16 a[194:195], v30 offset:2048
  ds_read_b64_tr_b16 a[196:197], v30 offset:8192
  ds_read_b64_tr_b16 a[198:199], v30 offset:10240
  ds_read_b64_tr_b16 a[200:201], v30 offset:16384
  ds_read_b64_tr_b16 a[202:203], v30 offset:18432
  ds_read_b64_tr_b16 a[204:205], v30 offset:24576
  ds_read_b64_tr_b16 a[206:207], v30 offset:26624
  s_waitcnt lgkmcnt(0)
  s_waitcnt vmcnt(16)
  ds_write_b128 v21, a[80:83] offset:32768
  ds_write_b128 v21, a[84:87] offset:33792
  ds_write_b128 v21, a[88:91] offset:34816
  ds_write_b128 v21, a[92:95] offset:35840
  ds_write_b128 v21, a[208:211] offset:36864
  ds_write_b128 v21, a[212:215] offset:37888
  ds_write_b128 v21, a[216:219] offset:38912
  ds_write_b128 v21, a[220:223] offset:39936
  s_waitcnt lgkmcnt(0)
  s_barrier
  ds_read_b64_tr_b16 a[80:81], v29 offset:32768
  ds_read_b64_tr_b16 a[82:83], v29 offset:34816
  ds_read_b64_tr_b16 a[84:85], v29 offset:40960
  ds_read_b64_tr_b16 a[86:87], v29 offset:43008
  ds_read_b64_tr_b16 a[88:89], v29 offset:49152
  ds_read_b64_tr_b16 a[90:91], v29 offset:51200
  ds_read_b64_tr_b16 a[92:93], v29 offset:57344
  ds_read_b64_tr_b16 a[94:95], v29 offset:59392
  ds_read_b64_tr_b16 a[208:209], v30 offset:32768
  ds_read_b64_tr_b16 a[210:211], v30 offset:34816
  ds_read_b64_tr_b16 a[212:213], v30 offset:40960
  ds_read_b64_tr_b16 a[214:215], v30 offset:43008
  ds_read_b64_tr_b16 a[216:217], v30 offset:49152
  ds_read_b64_tr_b16 a[218:219], v30 offset:51200
  ds_read_b64_tr_b16 a[220:221], v30 offset:57344
  ds_read_b64_tr_b16 a[222:223], v30 offset:59392
  s_waitcnt lgkmcnt(0)
  s_waitcnt vmcnt(8)
  ds_write_b128 v21, a[96:99] offset:0
  ds_write_b128 v21, a[100:103] offset:1024
  ds_write_b128 v21, a[104:107] offset:2048
  ds_write_b128 v21, a[108:111] offset:3072
  ds_write_b128 v21, a[224:227] offset:4096
  ds_write_b128 v21, a[228:231] offset:5120
  ds_write_b128 v21, a[232:235] offset:6144
  ds_write_b128 v21, a[236:239] offset:7168
  s_waitcnt lgkmcnt(0)
  s_barrier
  ds_read_b64_tr_b16 a[96:97], v29 offset:0
  ds_read_b64_tr_b16 a[98:99], v29 offset:2048
  ds_read_b64_tr_b16 a[100:101], v29 offset:8192
  ds_read_b64_tr_b16 a[102:103], v29 offset:10240
  ds_read_b64_tr_b16 a[104:105], v29 offset:16384
  ds_read_b64_tr_b16 a[106:107], v29 offset:18432
  ds_read_b64_tr_b16 a[108:109], v29 offset:24576
  ds_read_b64_tr_b16 a[110:111], v29 offset:26624
  ds_read_b64_tr_b16 a[224:225], v30 offset:0
  ds_read_b64_tr_b16 a[226:227], v30 offset:2048
  ds_read_b64_tr_b16 a[228:229], v30 offset:8192
  ds_read_b64_tr_b16 a[230:231], v30 offset:10240
  ds_read_b64_tr_b16 a[232:233], v30 offset:16384
  ds_read_b64_tr_b16 a[234:235], v30 offset:18432
  ds_read_b64_tr_b16 a[236:237], v30 offset:24576
  ds_read_b64_tr_b16 a[238:239], v30 offset:26624
  s_waitcnt lgkmcnt(0)
  s_waitcnt vmcnt(0)
  ds_write_b128 v21, a[112:115] offset:32768
  ds_write_b128 v21, a[116:119] offset:33792
  ds_write_b128 v21, a[120:123] offset:34816
  ds_write_b128 v21, a[124:127] offset:35840
  ds_write_b128 v21, a[240:243] offset:36864
  ds_write_b128 v21, a[244:247] offset:37888
  ds_write_b128 v21, a[248:251] offset:38912
  ds_write_b128 v21, a[252:255] offset:39936
  s_waitcnt lgkmcnt(0)
  s_barrier
  ds_read_b64_tr_b16 a[112:113], v29 offset:32768
  ds_read_b64_tr_b16 a[114:115], v29 offset:34816
  ds_read_b64_tr_b16 a[116:117], v29 offset:40960
  ds_read_b64_tr_b16 a[118:119], v29 offset:43008
  ds_read_b64_tr_b16 a[120:121], v29 offset:49152
  ds_read_b64_tr_b16 a[122:123], v29 offset:51200
  ds_read_b64_tr_b16 a[124:125], v29 offset:57344
  ds_read_b64_tr_b16 a[126:127], v29 offset:59392
  ds_read_b64_tr_b16 a[240:241], v30 offset:32768
  ds_read_b64_tr_b16 a[242:243], v30 offset:34816
  ds_read_b64_tr_b16 a[244:245], v30 offset:40960
  ds_read_b64_tr_b16 a[246:247], v30 offset:43008
  ds_read_b64_tr_b16 a[248:249], v30 offset:49152
  ds_read_b64_tr_b16 a[250:251], v30 offset:51200
  ds_read_b64_tr_b16 a[252:253], v30 offset:57344
  ds_read_b64_tr_b16 a[254:255], v30 offset:59392
  s_waitcnt lgkmcnt(0)
  s_barrier
  v_mov_b32 v2, v1
  v_add_u32 v10, 4096, v1
  v_and_b32 v12, 15, v0
  v_lshrrev_b32 v13, 4, v0
  v_lshlrev_b32 v14, 2, v13
  v_mov_b32 v16, 0xff000000
  v_add_u32 v15, 0, v14
  v_cmp_gt_u32 vcc, v15, v12
  s_nop 1
  v_cndmask_b32 v236, 0, v16, vcc
  v_add_u32 v15, 1, v14
  v_cmp_gt_u32 vcc, v15, v12
  s_nop 1
  v_cndmask_b32 v237, 0, v16, vcc
  v_add_u32 v15, 2, v14
  v_cmp_gt_u32 vcc, v15, v12
  s_nop 1
  v_cndmask_b32 v238, 0, v16, vcc
  v_add_u32 v15, 3, v14
  v_cmp_gt_u32 vcc, v15, v12
  s_nop 1
  v_cndmask_b32 v239, 0, v16, vcc
  v_mov_b32 v242, 0
  v_mov_b32 v243, 0
  v_mov_b32 v249, 0
  v_mov_b32 v251, 0
  v_lshrrev_b32 v14, 1, v13
  v_lshl_add_u32 v14, v14, 5, v12
  v_lshlrev_b32 v14, 4, v14
  v_and_b32 v15, 1, v13
  v_lshl_add_u32 v14, v15, 3, v14
  s_lshl_b32 s12, s8, 13
  v_add_u32 v11, s12, v14
  s_mov_b32 s40, 0x3e0293ee
  s_mov_b32 s41, 0xbe0293ee
  s_lshr_b32 s12, s36, 1
  s_lshl_b32 s12, s12, 1
  s_lshl_b32 s54, 0x30003, s12
  s_lshl_b32 s55, 3, s12
  s_lshl_b32 s12, s12, 1
  s_lshl_b32 s59, 15, s12
  s_mov_b32 s57, 0
  s_mov_b32 s52, -1
L_aseg_137:
  s_cmp_lg_u32 s8, 0
  s_cbranch_scc1 L_fwok_139
  s_lshl_b32 s48, s30, 14
  s_add_u32 s48, s48, 0
  v_lshlrev_b32 v254, 7, v0
  v_add_u32 v254, s48, v254
  s_mov_b32 s49, 0
  s_mov_b32 exec_lo, s54
  s_mov_b32 exec_hi, s55
L_fw_138:
  global_load_dword v255, v254, s[46:47] sc1
  s_add_u32 s49, s49, 1
  s_cmp_gt_u32 s49, 0x20000
  s_cbranch_scc1 L_fwok2_140
  s_waitcnt vmcnt(0)
  v_cmp_ne_u32 vcc, 0, v255
  s_nop 0
  s_and_b32 s50, vcc_lo, s54
  s_and_b32 s51, vcc_hi, s55
  s_xor_b32 s50, s50, s54
  s_xor_b32 s51, s51, s55
  s_or_b32 s50, s50, s51
  s_cmp_eq_u32 s50, 0
  s_cbranch_scc1 L_fwok2_140
  s_sleep 2
  s_branch L_fw_138
L_fwok2_140:
  s_mov_b64 exec, -1
L_fwok_139:
  s_barrier
  s_lshl_b32 s12, s30, 5
  s_add_u32 s12, s12, s39
  s_lshl_b32 s13, s12, 13
  s_add_u32 s14, s13, 33554432
  s_add_u32 s44, s4, s14
  s_addc_u32 s45, s5, 0
  global_load_dwordx4 v[96:99], v1, s[44:45] offset:0 sc1
  global_load_dwordx4 v[100:103], v1, s[44:45] offset:1024 sc1
  global_load_dwordx4 v[104:107], v1, s[44:45] offset:2048 sc1
  global_load_dwordx4 v[108:111], v1, s[44:45] offset:3072 sc1
  s_add_u32 s44, s44, 4096
  s_addc_u32 s45, s45, 0
  global_load_dwordx4 v[112:115], v1, s[44:45] offset:0 sc1
  global_load_dwordx4 v[116:119], v1, s[44:45] offset:1024 sc1
  global_load_dwordx4 v[120:123], v1, s[44:45] offset:2048 sc1
  global_load_dwordx4 v[124:127], v1, s[44:45] offset:3072 sc1
  s_add_u32 s14, s13, 0
  s_add_u32 s44, s4, s14
  s_addc_u32 s45, s5, 0
  global_load_dwordx4 v[128:131], v1, s[44:45] offset:0 sc1
  global_load_dwordx4 v[132:135], v1, s[44:45] offset:1024 sc1
  global_load_dwordx4 v[136:139], v1, s[44:45] offset:2048 sc1
  global_load_dwordx4 v[140:143], v1, s[44:45] offset:3072 sc1
  s_add_u32 s44, s44, 4096
  s_addc_u32 s45, s45, 0
  global_load_dwordx4 v[144:147], v1, s[44:45] offset:0 sc1
  global_load_dwordx4 v[148:151], v1, s[44:45] offset:1024 sc1
  global_load_dwordx4 v[152:155], v1, s[44:45] offset:2048 sc1
  global_load_dwordx4 v[156:159], v1, s[44:45] offset:3072 sc1
  s_add_u32 s14, s13, 16777216
  s_add_u32 s44, s4, s14
  s_addc_u32 s45, s5, 0
  global_load_dwordx4 v[176:179], v1, s[44:45] offset:0 sc1
  global_load_dwordx4 v[180:183], v1, s[44:45] offset:1024 sc1
  global_load_dwordx4 v[184:187], v1, s[44:45] offset:2048 sc1
  global_load_dwordx4 v[188:191], v1, s[44:45] offset:3072 sc1
  s_add_u32 s44, s44, 4096
  s_addc_u32 s45, s45, 0
  global_load_dwordx4 v[192:195], v1, s[44:45] offset:0 sc1
  global_load_dwordx4 v[196:199], v1, s[44:45] offset:1024 sc1
  global_load_dwordx4 v[200:203], v1, s[44:45] offset:2048 sc1
  global_load_dwordx4 v[204:207], v1, s[44:45] offset:3072 sc1
  s_cmp_eq_u32 s30, 63
  s_cselect_b32 s56, s59, s54
  s_cmp_lg_u32 s8, 0
  s_cbranch_scc1 L_fwok_142
  s_lshl_b32 s48, s30, 14
  s_add_u32 s48, s48, 8192
  v_lshlrev_b32 v254, 7, v0
  v_add_u32 v254, s48, v254
  s_mov_b32 s49, 0
  s_mov_b32 exec_lo, s56
  s_mov_b32 exec_hi, s57
L_fw_141:
  global_load_dword v255, v254, s[46:47] sc1
  s_add_u32 s49, s49, 1
  s_cmp_gt_u32 s49, 0x20000
  s_cbranch_scc1 L_fwok2_143
  s_waitcnt vmcnt(0)
  v_cmp_ne_u32 vcc, 0, v255
  s_nop 0
  s_and_b32 s50, vcc_lo, s56
  s_and_b32 s51, vcc_hi, s57
  s_xor_b32 s50, s50, s56
  s_xor_b32 s51, s51, s57
  s_or_b32 s50, s50, s51
  s_cmp_eq_u32 s50, 0
  s_cbranch_scc1 L_fwok2_143
  s_sleep 2
  s_branch L_fw_141
L_fwok2_143:
  s_mov_b64 exec, -1
L_fwok_142:
  s_barrier
  s_lshl_b32 s12, s30, 5
  s_add_u32 s12, s12, s39
  s_lshl_b32 s13, s12, 13
  s_lshl_b32 s13, s12, 12
  s_add_u32 s14, s13, 50462720
  s_add_u32 s44, s4, s14
  s_addc_u32 s45, s5, 0
  global_load_dwordx4 v[160:163], v1, s[44:45] offset:0 sc1
  global_load_dwordx4 v[164:167], v1, s[44:45] offset:1024 sc1
  global_load_dwordx4 v[168:171], v1, s[44:45] offset:2048 sc1
  global_load_dwordx4 v[172:175], v1, s[44:45] offset:3072 sc1
  s_add_u32 s14, s13, 59899904
  s_add_u32 s44, s4, s14
  s_addc_u32 s45, s5, 0
  v_lshrrev_b32 v30, 1, v1
  global_load_dwordx2 v[208:209], v30, s[44:45] offset:0 sc1
  global_load_dwordx2 v[210:211], v30, s[44:45] offset:512 sc1
  global_load_dwordx2 v[212:213], v30, s[44:45] offset:1024 sc1
  global_load_dwordx2 v[214:215], v30, s[44:45] offset:1536 sc1
  s_lshl_b32 s12, s30, 16
  s_add_u32 s12, s12, s38
  s_add_u32 s28, s4, s12
  s_addc_u32 s29, s5, 0
  s_waitcnt vmcnt(0)
  v_mov_b32 v20, v209
  v_mov_b32 v21, v208
  v_mov_b32 v22, v211
  v_mov_b32 v23, v210
  v_mov_b32 v24, v213
  v_mov_b32 v25, v212
  v_mov_b32 v26, v215
  v_mov_b32 v27, v214
  v_mfma_f32_16x16x32_bf16 v[216:219], v[128:131], v[96:99], v[236:239]
  v_mfma_f32_16x16x32_bf16 v[220:223], v[128:131], v[112:115], 0
  v_mfma_f32_16x16x32_bf16 v[224:227], v[144:147], v[112:115], v[236:239]
  v_mfma_f32_16x16x32_bf16 v[228:231], v[160:163], v[96:99], 0
  v_mfma_f32_16x16x32_bf16 v[232:235], v[160:163], v[112:115], 0
  v_mfma_f32_16x16x32_bf16 v[216:219], v[132:135], v[100:103], v[216:219]
  v_mfma_f32_16x16x32_bf16 v[220:223], v[132:135], v[116:119], v[220:223]
  v_mfma_f32_16x16x32_bf16 v[224:227], v[148:151], v[116:119], v[224:227]
  v_mfma_f32_16x16x32_bf16 v[228:231], v[164:167], v[100:103], v[228:231]
  v_mfma_f32_16x16x32_bf16 v[232:235], v[164:167], v[116:119], v[232:235]
  v_mfma_f32_16x16x32_bf16 v[216:219], v[136:139], v[104:107], v[216:219]
  v_mfma_f32_16x16x32_bf16 v[220:223], v[136:139], v[120:123], v[220:223]
  v_mfma_f32_16x16x32_bf16 v[224:227], v[152:155], v[120:123], v[224:227]
  v_mfma_f32_16x16x32_bf16 v[228:231], v[168:171], v[104:107], v[228:231]
  v_mfma_f32_16x16x32_bf16 v[232:235], v[168:171], v[120:123], v[232:235]
  v_mfma_f32_16x16x32_bf16 v[216:219], v[140:143], v[108:111], v[216:219]
  v_mfma_f32_16x16x32_bf16 v[220:223], v[140:143], v[124:127], v[220:223]
  v_mfma_f32_16x16x32_bf16 v[224:227], v[156:159], v[124:127], v[224:227]
  v_mfma_f32_16x16x32_bf16 v[228:231], v[172:175], v[108:111], v[228:231]
  v_mfma_f32_16x16x32_bf16 v[232:235], v[172:175], v[124:127], v[232:235]
  v_max3_f32 v12, v216, v217, v218
  s_nop 3
  v_max3_f32 v12, v12, v219, v228
  v_max_f32 v12, v12, v229
  v_max3_f32 v13, v220, v221, v222
  v_max3_f32 v13, v13, v223, v224
  v_max3_f32 v13, v13, v225, v226
  v_max3_f32 v13, v13, v227, v232
  v_max_f32 v13, v13, v233
  v_mov_b32 v14, v12
  s_nop 1
  v_permlane16_swap_b32 v12, v14
  v_max_f32 v12, v12, v14
  v_mov_b32 v14, v12
  s_nop 1
  v_permlane32_swap_b32 v12, v14
  v_max_f32 v12, v12, v14
  v_mov_b32 v15, v13
  s_nop 1
  v_permlane16_swap_b32 v13, v15
  v_max_f32 v13, v13, v15
  v_mov_b32 v15, v13
  s_nop 1
  v_permlane32_swap_b32 v13, v15
  v_max_f32 v13, v13, v15
  v_mul_f32 v12, s41, v12
  v_mul_f32 v13, s41, v13
  v_fma_f32 v216, v216, s40, v12
  v_exp_f32 v216, v216
  v_fma_f32 v217, v217, s40, v12
  v_exp_f32 v217, v217
  v_fma_f32 v218, v218, s40, v12
  v_exp_f32 v218, v218
  v_fma_f32 v219, v219, s40, v12
  v_exp_f32 v219, v219
  v_fma_f32 v228, v228, s40, v12
  v_exp_f32 v228, v228
  v_fma_f32 v229, v229, s40, v12
  v_exp_f32 v229, v229
  v_fma_f32 v220, v220, s40, v13
  v_exp_f32 v220, v220
  v_fma_f32 v221, v221, s40, v13
  v_exp_f32 v221, v221
  v_fma_f32 v222, v222, s40, v13
  v_exp_f32 v222, v222
  v_fma_f32 v223, v223, s40, v13
  v_exp_f32 v223, v223
  v_fma_f32 v224, v224, s40, v13
  v_exp_f32 v224, v224
  v_fma_f32 v225, v225, s40, v13
  v_exp_f32 v225, v225
  v_fma_f32 v226, v226, s40, v13
  v_exp_f32 v226, v226
  v_fma_f32 v227, v227, s40, v13
  v_exp_f32 v227, v227
  v_fma_f32 v232, v232, s40, v13
  v_exp_f32 v232, v232
  v_fma_f32 v233, v233, s40, v13
  v_exp_f32 v233, v233
  v_cvt_pk_bf16_f32 v240, v216, v217
  v_cvt_pk_bf16_f32 v241, v218, v219
  v_cvt_pk_bf16_f32 v244, v220, v221
  v_cvt_pk_bf16_f32 v245, v222, v223
  v_cvt_pk_bf16_f32 v246, v224, v225
  v_cvt_pk_bf16_f32 v247, v226, v227
  v_cvt_pk_bf16_f32 v248, v228, v229
  v_cvt_pk_bf16_f32 v250, v232, v233
  v_add_f32 v16, v216, v217
  v_add_f32 v16, v16, v218
  v_add_f32 v16, v16, v219
  v_add_f32 v16, v16, v228
  v_add_f32 v16, v16, v229
  v_add_f32 v17, v220, v221
  v_add_f32 v17, v17, v222
  v_add_f32 v17, v17, v223
  v_add_f32 v17, v17, v224
  v_add_f32 v17, v17, v225
  v_add_f32 v17, v17, v226
  v_add_f32 v17, v17, v227
  v_add_f32 v17, v17, v232
  v_add_f32 v17, v17, v233
  v_mov_b32 v14, v16
  s_nop 1
  v_permlane16_swap_b32 v16, v14
  v_add_f32 v16, v16, v14
  v_mov_b32 v14, v16
  s_nop 1
  v_permlane32_swap_b32 v16, v14
  v_add_f32 v16, v16, v14
  v_mov_b32 v15, v17
  s_nop 1
  v_permlane16_swap_b32 v17, v15
  v_add_f32 v17, v17, v15
  v_mov_b32 v15, v17
  s_nop 1
  v_permlane32_swap_b32 v17, v15
  v_add_f32 v17, v17, v15
  v_rcp_f32 v16, v16
  v_rcp_f32 v17, v17
  v_mfma_f32_16x16x32_bf16 v[64:67], v[176:179], v[240:243], 0
  v_mfma_f32_16x16x32_bf16 v[68:71], v[180:183], v[240:243], 0
  v_mfma_f32_16x16x32_bf16 v[72:75], v[184:187], v[240:243], 0
  v_mfma_f32_16x16x32_bf16 v[76:79], v[188:191], v[240:243], 0
  v_mfma_f32_16x16x32_bf16 v[80:83], v[192:195], v[240:243], 0
  v_mfma_f32_16x16x32_bf16 v[84:87], v[196:199], v[240:243], 0
  v_mfma_f32_16x16x32_bf16 v[88:91], v[200:203], v[240:243], 0
  v_mfma_f32_16x16x32_bf16 v[92:95], v[204:207], v[240:243], 0
  v_mfma_f32_16x16x16_bf16 v[64:67], v[208:209], v[248:249], v[64:67]
  v_mfma_f32_16x16x16_bf16 v[68:71], v[20:21], v[248:249], v[68:71]
  v_mfma_f32_16x16x16_bf16 v[72:75], v[210:211], v[248:249], v[72:75]
  v_mfma_f32_16x16x16_bf16 v[76:79], v[22:23], v[248:249], v[76:79]
  v_mfma_f32_16x16x16_bf16 v[80:83], v[212:213], v[248:249], v[80:83]
  v_mfma_f32_16x16x16_bf16 v[84:87], v[24:25], v[248:249], v[84:87]
  v_mfma_f32_16x16x16_bf16 v[88:91], v[214:215], v[248:249], v[88:91]
  v_mfma_f32_16x16x16_bf16 v[92:95], v[26:27], v[248:249], v[92:95]
  v_mul_f32 v64, v64, v16
  v_mul_f32 v65, v65, v16
  v_mul_f32 v66, v66, v16
  v_mul_f32 v67, v67, v16
  v_cvt_pk_bf16_f32 v28, v64, v65
  v_cvt_pk_bf16_f32 v29, v66, v67
  ds_write_b64 v11, v[28:29] offset:0
  v_mul_f32 v68, v68, v16
  v_mul_f32 v69, v69, v16
  v_mul_f32 v70, v70, v16
  v_mul_f32 v71, v71, v16
  v_cvt_pk_bf16_f32 v28, v68, v69
  v_cvt_pk_bf16_f32 v29, v70, v71
  ds_write_b64 v11, v[28:29] offset:1024
  v_mul_f32 v72, v72, v16
  v_mul_f32 v73, v73, v16
  v_mul_f32 v74, v74, v16
  v_mul_f32 v75, v75, v16
  v_cvt_pk_bf16_f32 v28, v72, v73
  v_cvt_pk_bf16_f32 v29, v74, v75
  ds_write_b64 v11, v[28:29] offset:2048
  v_mul_f32 v76, v76, v16
  v_mul_f32 v77, v77, v16
  v_mul_f32 v78, v78, v16
  v_mul_f32 v79, v79, v16
  v_cvt_pk_bf16_f32 v28, v76, v77
  v_cvt_pk_bf16_f32 v29, v78, v79
  ds_write_b64 v11, v[28:29] offset:3072
  v_mul_f32 v80, v80, v16
  v_mul_f32 v81, v81, v16
  v_mul_f32 v82, v82, v16
  v_mul_f32 v83, v83, v16
  v_cvt_pk_bf16_f32 v28, v80, v81
  v_cvt_pk_bf16_f32 v29, v82, v83
  ds_write_b64 v11, v[28:29] offset:4096
  v_mul_f32 v84, v84, v16
  v_mul_f32 v85, v85, v16
  v_mul_f32 v86, v86, v16
  v_mul_f32 v87, v87, v16
  v_cvt_pk_bf16_f32 v28, v84, v85
  v_cvt_pk_bf16_f32 v29, v86, v87
  ds_write_b64 v11, v[28:29] offset:5120
  v_mul_f32 v88, v88, v16
  v_mul_f32 v89, v89, v16
  v_mul_f32 v90, v90, v16
  v_mul_f32 v91, v91, v16
  v_cvt_pk_bf16_f32 v28, v88, v89
  v_cvt_pk_bf16_f32 v29, v90, v91
  ds_write_b64 v11, v[28:29] offset:6144
  v_mul_f32 v92, v92, v16
  v_mul_f32 v93, v93, v16
  v_mul_f32 v94, v94, v16
  v_mul_f32 v95, v95, v16
  v_cvt_pk_bf16_f32 v28, v92, v93
  v_cvt_pk_bf16_f32 v29, v94, v95
  ds_write_b64 v11, v[28:29] offset:7168
  v_mfma_f32_16x16x32_bf16 v[64:67], v[176:179], v[244:247], 0
  v_mfma_f32_16x16x32_bf16 v[68:71], v[180:183], v[244:247], 0
  v_mfma_f32_16x16x32_bf16 v[72:75], v[184:187], v[244:247], 0
  v_mfma_f32_16x16x32_bf16 v[76:79], v[188:191], v[244:247], 0
  v_mfma_f32_16x16x32_bf16 v[80:83], v[192:195], v[244:247], 0
  v_mfma_f32_16x16x32_bf16 v[84:87], v[196:199], v[244:247], 0
  v_mfma_f32_16x16x32_bf16 v[88:91], v[200:203], v[244:247], 0
  v_mfma_f32_16x16x32_bf16 v[92:95], v[204:207], v[244:247], 0
  v_mfma_f32_16x16x16_bf16 v[64:67], v[208:209], v[250:251], v[64:67]
  v_mfma_f32_16x16x16_bf16 v[68:71], v[20:21], v[250:251], v[68:71]
  v_mfma_f32_16x16x16_bf16 v[72:75], v[210:211], v[250:251], v[72:75]
  v_mfma_f32_16x16x16_bf16 v[76:79], v[22:23], v[250:251], v[76:79]
  v_mfma_f32_16x16x16_bf16 v[80:83], v[212:213], v[250:251], v[80:83]
  v_mfma_f32_16x16x16_bf16 v[84:87], v[24:25], v[250:251], v[84:87]
  v_mfma_f32_16x16x16_bf16 v[88:91], v[214:215], v[250:251], v[88:91]
  v_mfma_f32_16x16x16_bf16 v[92:95], v[26:27], v[250:251], v[92:95]
  v_mul_f32 v64, v64, v17
  v_mul_f32 v65, v65, v17
  v_mul_f32 v66, v66, v17
  v_mul_f32 v67, v67, v17
  v_cvt_pk_bf16_f32 v28, v64, v65
  v_cvt_pk_bf16_f32 v29, v66, v67
  ds_write_b64 v11, v[28:29] offset:256
  v_mul_f32 v68, v68, v17
  v_mul_f32 v69, v69, v17
  v_mul_f32 v70, v70, v17
  v_mul_f32 v71, v71, v17
  v_cvt_pk_bf16_f32 v28, v68, v69
  v_cvt_pk_bf16_f32 v29, v70, v71
  ds_write_b64 v11, v[28:29] offset:1280
  v_mul_f32 v72, v72, v17
  v_mul_f32 v73, v73, v17
  v_mul_f32 v74, v74, v17
  v_mul_f32 v75, v75, v17
  v_cvt_pk_bf16_f32 v28, v72, v73
  v_cvt_pk_bf16_f32 v29, v74, v75
  ds_write_b64 v11, v[28:29] offset:2304
  v_mul_f32 v76, v76, v17
  v_mul_f32 v77, v77, v17
  v_mul_f32 v78, v78, v17
  v_mul_f32 v79, v79, v17
  v_cvt_pk_bf16_f32 v28, v76, v77
  v_cvt_pk_bf16_f32 v29, v78, v79
  ds_write_b64 v11, v[28:29] offset:3328
  v_mul_f32 v80, v80, v17
  v_mul_f32 v81, v81, v17
  v_mul_f32 v82, v82, v17
  v_mul_f32 v83, v83, v17
  v_cvt_pk_bf16_f32 v28, v80, v81
  v_cvt_pk_bf16_f32 v29, v82, v83
  ds_write_b64 v11, v[28:29] offset:4352
  v_mul_f32 v84, v84, v17
  v_mul_f32 v85, v85, v17
  v_mul_f32 v86, v86, v17
  v_mul_f32 v87, v87, v17
  v_cvt_pk_bf16_f32 v28, v84, v85
  v_cvt_pk_bf16_f32 v29, v86, v87
  ds_write_b64 v11, v[28:29] offset:5376
  v_mul_f32 v88, v88, v17
  v_mul_f32 v89, v89, v17
  v_mul_f32 v90, v90, v17
  v_mul_f32 v91, v91, v17
  v_cvt_pk_bf16_f32 v28, v88, v89
  v_cvt_pk_bf16_f32 v29, v90, v91
  ds_write_b64 v11, v[28:29] offset:6400
  v_mul_f32 v92, v92, v17
  v_mul_f32 v93, v93, v17
  v_mul_f32 v94, v94, v17
  v_mul_f32 v95, v95, v17
  v_cvt_pk_bf16_f32 v28, v92, v93
  v_cvt_pk_bf16_f32 v29, v94, v95
  ds_write_b64 v11, v[28:29] offset:7424
  s_waitcnt lgkmcnt(0)
  s_barrier
  s_cmp_eq_u32 s52, -1
  s_cbranch_scc1 L_nf_144
  s_cmp_lg_u32 s8, 0
  s_cbranch_scc1 L_fs_145
  s_lshl_b32 s48, s52, 14
  s_lshl_b32 s49, s36, 7
  s_add_u32 s48, s48, s49
  s_add_u32 s48, s48, 12288
  v_mov_b32 v254, s48
  v_mov_b32 v255, 1
  s_mov_b64 exec, 1
  global_store_dword v254, v255, s[46:47] sc1
  s_mov_b64 exec, -1
L_fs_145:
L_nf_144:
  s_mov_b32 s52, s30
  ds_read_b128 v[32:35], v2 offset:0
  ds_read_b128 v[36:39], v2 offset:1024
  ds_read_b128 v[40:43], v2 offset:2048
  ds_read_b128 v[44:47], v2 offset:3072
  ds_read_b128 v[48:51], v2 offset:4096
  ds_read_b128 v[52:55], v2 offset:5120
  s_waitcnt lgkmcnt(5)
  v_mfma_f32_32x32x16_bf16 v[64:79], a[0:3], v[32:35], 0
  ds_read_b128 v[56:59], v2 offset:6144
  v_mfma_f32_32x32x16_bf16 v[80:95], a[128:131], v[32:35], 0
  s_waitcnt lgkmcnt(5)
  v_mfma_f32_32x32x16_bf16 v[64:79], a[4:7], v[36:39], v[64:79]
  ds_read_b128 v[60:63], v2 offset:7168
  v_mfma_f32_32x32x16_bf16 v[80:95], a[132:135], v[36:39], v[80:95]
  s_waitcnt lgkmcnt(5)
  v_mfma_f32_32x32x16_bf16 v[64:79], a[8:11], v[40:43], v[64:79]
  ds_read_b128 v[32:35], v2 offset:8192
  v_mfma_f32_32x32x16_bf16 v[80:95], a[136:139], v[40:43], v[80:95]
  s_waitcnt lgkmcnt(5)
  v_mfma_f32_32x32x16_bf16 v[64:79], a[12:15], v[44:47], v[64:79]
  ds_read_b128 v[36:39], v2 offset:9216
  v_mfma_f32_32x32x16_bf16 v[80:95], a[140:143], v[44:47], v[80:95]
  s_waitcnt lgkmcnt(5)
  v_mfma_f32_32x32x16_bf16 v[64:79], a[16:19], v[48:51], v[64:79]
  ds_read_b128 v[40:43], v2 offset:10240
  v_mfma_f32_32x32x16_bf16 v[80:95], a[144:147], v[48:51], v[80:95]
  s_waitcnt lgkmcnt(5)
  v_mfma_f32_32x32x16_bf16 v[64:79], a[20:23], v[52:55], v[64:79]
  ds_read_b128 v[44:47], v2 offset:11264
  v_mfma_f32_32x32x16_bf16 v[80:95], a[148:151], v[52:55], v[80:95]
  s_waitcnt lgkmcnt(5)
  v_mfma_f32_32x32x16_bf16 v[64:79], a[24:27], v[56:59], v[64:79]
  ds_read_b128 v[48:51], v2 offset:12288
  v_mfma_f32_32x32x16_bf16 v[80:95], a[152:155], v[56:59], v[80:95]
  s_waitcnt lgkmcnt(5)
  v_mfma_f32_32x32x16_bf16 v[64:79], a[28:31], v[60:63], v[64:79]
  ds_read_b128 v[52:55], v2 offset:13312
  v_mfma_f32_32x32x16_bf16 v[80:95], a[156:159], v[60:63], v[80:95]
  s_waitcnt lgkmcnt(5)
  v_mfma_f32_32x32x16_bf16 v[64:79], a[32:35], v[32:35], v[64:79]
  ds_read_b128 v[56:59], v2 offset:14336
  v_mfma_f32_32x32x16_bf16 v[80:95], a[160:163], v[32:35], v[80:95]
  s_waitcnt lgkmcnt(5)
  v_mfma_f32_32x32x16_bf16 v[64:79], a[36:39], v[36:39], v[64:79]
  ds_read_b128 v[60:63], v2 offset:15360
  v_mfma_f32_32x32x16_bf16 v[80:95], a[164:167], v[36:39], v[80:95]
  s_waitcnt lgkmcnt(5)
  v_mfma_f32_32x32x16_bf16 v[64:79], a[40:43], v[40:43], v[64:79]
  ds_read_b128 v[32:35], v2 offset:16384
  v_mfma_f32_32x32x16_bf16 v[80:95], a[168:171], v[40:43], v[80:95]
  s_waitcnt lgkmcnt(5)
  v_mfma_f32_32x32x16_bf16 v[64:79], a[44:47], v[44:47], v[64:79]
  ds_read_b128 v[36:39], v2 offset:17408
  v_mfma_f32_32x32x16_bf16 v[80:95], a[172:175], v[44:47], v[80:95]
  s_waitcnt lgkmcnt(5)
  v_mfma_f32_32x32x16_bf16 v[64:79], a[48:51], v[48:51], v[64:79]
  ds_read_b128 v[40:43], v2 offset:18432
  v_mfma_f32_32x32x16_bf16 v[80:95], a[176:179], v[48:51], v[80:95]
  s_waitcnt lgkmcnt(5)
  v_mfma_f32_32x32x16_bf16 v[64:79], a[52:55], v[52:55], v[64:79]
  ds_read_b128 v[44:47], v2 offset:19456
  v_mfma_f32_32x32x16_bf16 v[80:95], a[180:183], v[52:55], v[80:95]
  s_waitcnt lgkmcnt(5)
  v_mfma_f32_32x32x16_bf16 v[64:79], a[56:59], v[56:59], v[64:79]
  ds_read_b128 v[48:51], v2 offset:20480
  v_mfma_f32_32x32x16_bf16 v[80:95], a[184:187], v[56:59], v[80:95]
  s_waitcnt lgkmcnt(5)
  v_mfma_f32_32x32x16_bf16 v[64:79], a[60:63], v[60:63], v[64:79]
  ds_read_b128 v[52:55], v2 offset:21504
  v_mfma_f32_32x32x16_bf16 v[80:95], a[188:191], v[60:63], v[80:95]
  s_waitcnt lgkmcnt(5)
  v_mfma_f32_32x32x16_bf16 v[64:79], a[64:67], v[32:35], v[64:79]
  ds_read_b128 v[56:59], v2 offset:22528
  v_mfma_f32_32x32x16_bf16 v[80:95], a[192:195], v[32:35], v[80:95]
  s_waitcnt lgkmcnt(5)
  v_mfma_f32_32x32x16_bf16 v[64:79], a[68:71], v[36:39], v[64:79]
  ds_read_b128 v[60:63], v2 offset:23552
  v_mfma_f32_32x32x16_bf16 v[80:95], a[196:199], v[36:39], v[80:95]
  s_waitcnt lgkmcnt(5)
  v_mfma_f32_32x32x16_bf16 v[64:79], a[72:75], v[40:43], v[64:79]
  ds_read_b128 v[32:35], v2 offset:24576
  v_mfma_f32_32x32x16_bf16 v[80:95], a[200:203], v[40:43], v[80:95]
  s_waitcnt lgkmcnt(5)
  v_mfma_f32_32x32x16_bf16 v[64:79], a[76:79], v[44:47], v[64:79]
  ds_read_b128 v[36:39], v2 offset:25600
  v_mfma_f32_32x32x16_bf16 v[80:95], a[204:207], v[44:47], v[80:95]
  s_waitcnt lgkmcnt(5)
  v_mfma_f32_32x32x16_bf16 v[64:79], a[80:83], v[48:51], v[64:79]
  ds_read_b128 v[40:43], v2 offset:26624
  v_mfma_f32_32x32x16_bf16 v[80:95], a[208:211], v[48:51], v[80:95]
  s_waitcnt lgkmcnt(5)
  v_mfma_f32_32x32x16_bf16 v[64:79], a[84:87], v[52:55], v[64:79]
  ds_read_b128 v[44:47], v2 offset:27648
  v_mfma_f32_32x32x16_bf16 v[80:95], a[212:215], v[52:55], v[80:95]
  s_waitcnt lgkmcnt(5)
  v_mfma_f32_32x32x16_bf16 v[64:79], a[88:91], v[56:59], v[64:79]
  ds_read_b128 v[48:51], v2 offset:28672
  v_mfma_f32_32x32x16_bf16 v[80:95], a[216:219], v[56:59], v[80:95]
  s_waitcnt lgkmcnt(5)
  v_mfma_f32_32x32x16_bf16 v[64:79], a[92:95], v[60:63], v[64:79]
  ds_read_b128 v[52:55], v2 offset:29696
  v_mfma_f32_32x32x16_bf16 v[80:95], a[220:223], v[60:63], v[80:95]
  s_waitcnt lgkmcnt(5)
  v_mfma_f32_32x32x16_bf16 v[64:79], a[96:99], v[32:35], v[64:79]
  ds_read_b128 v[56:59], v2 offset:30720
  v_mfma_f32_32x32x16_bf16 v[80:95], a[224:227], v[32:35], v[80:95]
  s_waitcnt lgkmcnt(5)
  v_mfma_f32_32x32x16_bf16 v[64:79], a[100:103], v[36:39], v[64:79]
  ds_read_b128 v[60:63], v2 offset:31744
  v_mfma_f32_32x32x16_bf16 v[80:95], a[228:231], v[36:39], v[80:95]
  s_waitcnt lgkmcnt(5)
  v_mfma_f32_32x32x16_bf16 v[64:79], a[104:107], v[40:43], v[64:79]
  v_mfma_f32_32x32x16_bf16 v[80:95], a[232:235], v[40:43], v[80:95]
  s_waitcnt lgkmcnt(4)
  v_mfma_f32_32x32x16_bf16 v[64:79], a[108:111], v[44:47], v[64:79]
  v_mfma_f32_32x32x16_bf16 v[80:95], a[236:239], v[44:47], v[80:95]
  s_waitcnt lgkmcnt(3)
  v_mfma_f32_32x32x16_bf16 v[64:79], a[112:115], v[48:51], v[64:79]
  v_mfma_f32_32x32x16_bf16 v[80:95], a[240:243], v[48:51], v[80:95]
  s_waitcnt lgkmcnt(2)
  v_mfma_f32_32x32x16_bf16 v[64:79], a[116:119], v[52:55], v[64:79]
  v_mfma_f32_32x32x16_bf16 v[80:95], a[244:247], v[52:55], v[80:95]
  s_waitcnt lgkmcnt(1)
  v_mfma_f32_32x32x16_bf16 v[64:79], a[120:123], v[56:59], v[64:79]
  v_mfma_f32_32x32x16_bf16 v[80:95], a[248:251], v[56:59], v[80:95]
  s_waitcnt lgkmcnt(0)
  v_mfma_f32_32x32x16_bf16 v[64:79], a[124:127], v[60:63], v[64:79]
  v_mfma_f32_32x32x16_bf16 v[80:95], a[252:255], v[60:63], v[80:95]
  v_xor_b32 v2, 32768, v2
  v_xor_b32 v11, 32768, v11
  s_nop 2
  global_store_dwordx4 v1, v[64:67], s[28:29] offset:0 sc1
  global_store_dwordx4 v1, v[68:71], s[28:29] offset:1024 sc1
  global_store_dwordx4 v1, v[72:75], s[28:29] offset:2048 sc1
  global_store_dwordx4 v1, v[76:79], s[28:29] offset:3072 sc1
  s_nop 2
  global_store_dwordx4 v10, v[80:83], s[28:29] offset:0 sc1
  global_store_dwordx4 v10, v[84:87], s[28:29] offset:1024 sc1
  global_store_dwordx4 v10, v[88:91], s[28:29] offset:2048 sc1
  global_store_dwordx4 v10, v[92:95], s[28:29] offset:3072 sc1
  s_waitcnt vmcnt(0)
  s_barrier
  s_cmp_lg_u32 s8, 0
  s_cbranch_scc1 L_fs_146
  s_lshl_b32 s48, s52, 14
  s_lshl_b32 s49, s36, 7
  s_add_u32 s48, s48, s49
  s_add_u32 s48, s48, 12288
  v_mov_b32 v254, s48
  v_mov_b32 v255, 1
  s_mov_b64 exec, 1
  global_store_dword v254, v255, s[46:47] sc1
  s_mov_b64 exec, -1
L_fs_146:
  s_mov_b32 s52, -1
  s_add_u32 s30, s30, 6
  s_sub_u32 s35, s35, 1
  s_cmp_lg_u32 s35, 0
  s_cbranch_scc1 L_aseg_137
  s_branch L_wend
L_w4:
  s_sub_u32 s59, s58, 160
L_w4loop:
  s_lshr_b32 s30, s59, 2
  s_and_b32 s36, s59, 3
  s_lshr_b32 s12, s36, 1
  s_lshl_b32 s55, 0x550000, s12
  s_lshl_b32 s57, 0x5555, s12
  s_mov_b32 s54, 0
  s_lshl_b32 s12, s8, 6
  v_add_u32 v12, s12, v0
  v_lshrrev_b32 v13, 3, v12
  v_and_b32 v14, 7, v12
  v_lshlrev_b32 v15, 7, v14
  v_lshl_add_u32 v16, v13, 10, v15
  s_lshl_b32 s12, s30, 15
  s_add_u32 s44, s60, s12
  s_addc_u32 s45, s61, 0
  global_load_dwordx4 v[32:35], v16, s[44:45] offset:0
  global_load_dwordx4 v[64:67], v15, s[76:77] offset:0
  global_load_dwordx4 v[36:39], v16, s[44:45] offset:16
  global_load_dwordx4 v[68:71], v15, s[76:77] offset:16
  global_load_dwordx4 v[40:43], v16, s[44:45] offset:32
  global_load_dwordx4 v[72:75], v15, s[76:77] offset:32
  global_load_dwordx4 v[44:47], v16, s[44:45] offset:48
  global_load_dwordx4 v[76:79], v15, s[76:77] offset:48
  global_load_dwordx4 v[48:51], v16, s[44:45] offset:64
  global_load_dwordx4 v[80:83], v15, s[76:77] offset:64
  global_load_dwordx4 v[52:55], v16, s[44:45] offset:80
  global_load_dwordx4 v[84:87], v15, s[76:77] offset:80
  global_load_dwordx4 v[56:59], v16, s[44:45] offset:96
  global_load_dwordx4 v[88:91], v15, s[76:77] offset:96
  global_load_dwordx4 v[60:63], v16, s[44:45] offset:112
  global_load_dwordx4 v[92:95], v15, s[76:77] offset:112
  s_lshr_b32 s12, s36, 1
  s_lshl_b32 s12, s12, 15
  s_and_b32 s13, s36, 1
  s_lshl_b32 s13, s13, 12
  s_add_u32 s12, s12, s13
  s_lshl_b32 s13, s8, 13
  s_add_u32 s12, s12, s13
  s_lshl_b32 s13, s30, 16
  s_add_u32 s14, s12, s13
  s_waitcnt vmcnt(0)
  v_mov_b32 v17, 0
  v_lshlrev_b32 v18, 16, v32
  v_and_b32 v19, 0xffff0000, v32
  v_lshlrev_b32 v20, 16, v64
  v_and_b32 v21, 0xffff0000, v64
  v_mul_f32 v18, v18, v20
  v_mul_f32 v19, v19, v21
  v_cvt_pk_bf16_f32 v18, v18, v19
  v_lshlrev_b32 v19, 16, v18
  v_and_b32 v18, 0xffff0000, v18
  v_add_f32 v17, v17, v19
  v_add_f32 v17, v17, v18
  v_lshlrev_b32 v18, 16, v33
  v_and_b32 v19, 0xffff0000, v33
  v_lshlrev_b32 v20, 16, v65
  v_and_b32 v21, 0xffff0000, v65
  v_mul_f32 v18, v18, v20
  v_mul_f32 v19, v19, v21
  v_cvt_pk_bf16_f32 v18, v18, v19
  v_lshlrev_b32 v19, 16, v18
  v_and_b32 v18, 0xffff0000, v18
  v_add_f32 v17, v17, v19
  v_add_f32 v17, v17, v18
  v_lshlrev_b32 v18, 16, v34
  v_and_b32 v19, 0xffff0000, v34
  v_lshlrev_b32 v20, 16, v66
  v_and_b32 v21, 0xffff0000, v66
  v_mul_f32 v18, v18, v20
  v_mul_f32 v19, v19, v21
  v_cvt_pk_bf16_f32 v18, v18, v19
  v_lshlrev_b32 v19, 16, v18
  v_and_b32 v18, 0xffff0000, v18
  v_add_f32 v17, v17, v19
  v_add_f32 v17, v17, v18
  v_lshlrev_b32 v18, 16, v35
  v_and_b32 v19, 0xffff0000, v35
  v_lshlrev_b32 v20, 16, v67
  v_and_b32 v21, 0xffff0000, v67
  v_mul_f32 v18, v18, v20
  v_mul_f32 v19, v19, v21
  v_cvt_pk_bf16_f32 v18, v18, v19
  v_lshlrev_b32 v19, 16, v18
  v_and_b32 v18, 0xffff0000, v18
  v_add_f32 v17, v17, v19
  v_add_f32 v17, v17, v18
  v_lshlrev_b32 v18, 16, v36
  v_and_b32 v19, 0xffff0000, v36
  v_lshlrev_b32 v20, 16, v68
  v_and_b32 v21, 0xffff0000, v68
  v_mul_f32 v18, v18, v20
  v_mul_f32 v19, v19, v21
  v_cvt_pk_bf16_f32 v18, v18, v19
  v_lshlrev_b32 v19, 16, v18
  v_and_b32 v18, 0xffff0000, v18
  v_add_f32 v17, v17, v19
  v_add_f32 v17, v17, v18
  v_lshlrev_b32 v18, 16, v37
  v_and_b32 v19, 0xffff0000, v37
  v_lshlrev_b32 v20, 16, v69
  v_and_b32 v21, 0xffff0000, v69
  v_mul_f32 v18, v18, v20
  v_mul_f32 v19, v19, v21
  v_cvt_pk_bf16_f32 v18, v18, v19
  v_lshlrev_b32 v19, 16, v18
  v_and_b32 v18, 0xffff0000, v18
  v_add_f32 v17, v17, v19
  v_add_f32 v17, v17, v18
  v_lshlrev_b32 v18, 16, v38
  v_and_b32 v19, 0xffff0000, v38
  v_lshlrev_b32 v20, 16, v70
  v_and_b32 v21, 0xffff0000, v70
  v_mul_f32 v18, v18, v20
  v_mul_f32 v19, v19, v21
  v_cvt_pk_bf16_f32 v18, v18, v19
  v_lshlrev_b32 v19, 16, v18
  v_and_b32 v18, 0xffff0000, v18
  v_add_f32 v17, v17, v19
  v_add_f32 v17, v17, v18
  v_lshlrev_b32 v18, 16, v39
  v_and_b32 v19, 0xffff0000, v39
  v_lshlrev_b32 v20, 16, v71
  v_and_b32 v21, 0xffff0000, v71
  v_mul_f32 v18, v18, v20
  v_mul_f32 v19, v19, v21
  v_cvt_pk_bf16_f32 v18, v18, v19
  v_lshlrev_b32 v19, 16, v18
  v_and_b32 v18, 0xffff0000, v18
  v_add_f32 v17, v17, v19
  v_add_f32 v17, v17, v18
  v_lshlrev_b32 v18, 16, v40
  v_and_b32 v19, 0xffff0000, v40
  v_lshlrev_b32 v20, 16, v72
  v_and_b32 v21, 0xffff0000, v72
  v_mul_f32 v18, v18, v20
  v_mul_f32 v19, v19, v21
  v_cvt_pk_bf16_f32 v18, v18, v19
  v_lshlrev_b32 v19, 16, v18
  v_and_b32 v18, 0xffff0000, v18
  v_add_f32 v17, v17, v19
  v_add_f32 v17, v17, v18
  v_lshlrev_b32 v18, 16, v41
  v_and_b32 v19, 0xffff0000, v41
  v_lshlrev_b32 v20, 16, v73
  v_and_b32 v21, 0xffff0000, v73
  v_mul_f32 v18, v18, v20
  v_mul_f32 v19, v19, v21
  v_cvt_pk_bf16_f32 v18, v18, v19
  v_lshlrev_b32 v19, 16, v18
  v_and_b32 v18, 0xffff0000, v18
  v_add_f32 v17, v17, v19
  v_add_f32 v17, v17, v18
  v_lshlrev_b32 v18, 16, v42
  v_and_b32 v19, 0xffff0000, v42
  v_lshlrev_b32 v20, 16, v74
  v_and_b32 v21, 0xffff0000, v74
  v_mul_f32 v18, v18, v20
  v_mul_f32 v19, v19, v21
  v_cvt_pk_bf16_f32 v18, v18, v19
  v_lshlrev_b32 v19, 16, v18
  v_and_b32 v18, 0xffff0000, v18
  v_add_f32 v17, v17, v19
  v_add_f32 v17, v17, v18
  v_lshlrev_b32 v18, 16, v43
  v_and_b32 v19, 0xffff0000, v43
  v_lshlrev_b32 v20, 16, v75
  v_and_b32 v21, 0xffff0000, v75
  v_mul_f32 v18, v18, v20
  v_mul_f32 v19, v19, v21
  v_cvt_pk_bf16_f32 v18, v18, v19
  v_lshlrev_b32 v19, 16, v18
  v_and_b32 v18, 0xffff0000, v18
  v_add_f32 v17, v17, v19
  v_add_f32 v17, v17, v18
  v_lshlrev_b32 v18, 16, v44
  v_and_b32 v19, 0xffff0000, v44
  v_lshlrev_b32 v20, 16, v76
  v_and_b32 v21, 0xffff0000, v76
  v_mul_f32 v18, v18, v20
  v_mul_f32 v19, v19, v21
  v_cvt_pk_bf16_f32 v18, v18, v19
  v_lshlrev_b32 v19, 16, v18
  v_and_b32 v18, 0xffff0000, v18
  v_add_f32 v17, v17, v19
  v_add_f32 v17, v17, v18
  v_lshlrev_b32 v18, 16, v45
  v_and_b32 v19, 0xffff0000, v45
  v_lshlrev_b32 v20, 16, v77
  v_and_b32 v21, 0xffff0000, v77
  v_mul_f32 v18, v18, v20
  v_mul_f32 v19, v19, v21
  v_cvt_pk_bf16_f32 v18, v18, v19
  v_lshlrev_b32 v19, 16, v18
  v_and_b32 v18, 0xffff0000, v18
  v_add_f32 v17, v17, v19
  v_add_f32 v17, v17, v18
  v_lshlrev_b32 v18, 16, v46
  v_and_b32 v19, 0xffff0000, v46
  v_lshlrev_b32 v20, 16, v78
  v_and_b32 v21, 0xffff0000, v78
  v_mul_f32 v18, v18, v20
  v_mul_f32 v19, v19, v21
  v_cvt_pk_bf16_f32 v18, v18, v19
  v_lshlrev_b32 v19, 16, v18
  v_and_b32 v18, 0xffff0000, v18
  v_add_f32 v17, v17, v19
  v_add_f32 v17, v17, v18
  v_lshlrev_b32 v18, 16, v47
  v_and_b32 v19, 0xffff0000, v47
  v_lshlrev_b32 v20, 16, v79
  v_and_b32 v21, 0xffff0000, v79
  v_mul_f32 v18, v18, v20
  v_mul_f32 v19, v19, v21
  v_cvt_pk_bf16_f32 v18, v18, v19
  v_lshlrev_b32 v19, 16, v18
  v_and_b32 v18, 0xffff0000, v18
  v_add_f32 v17, v17, v19
  v_add_f32 v17, v17, v18
  v_lshlrev_b32 v18, 16, v48
  v_and_b32 v19, 0xffff0000, v48
  v_lshlrev_b32 v20, 16, v80
  v_and_b32 v21, 0xffff0000, v80
  v_mul_f32 v18, v18, v20
  v_mul_f32 v19, v19, v21
  v_cvt_pk_bf16_f32 v18, v18, v19
  v_lshlrev_b32 v19, 16, v18
  v_and_b32 v18, 0xffff0000, v18
  v_add_f32 v17, v17, v19
  v_add_f32 v17, v17, v18
  v_lshlrev_b32 v18, 16, v49
  v_and_b32 v19, 0xffff0000, v49
  v_lshlrev_b32 v20, 16, v81
  v_and_b32 v21, 0xffff0000, v81
  v_mul_f32 v18, v18, v20
  v_mul_f32 v19, v19, v21
  v_cvt_pk_bf16_f32 v18, v18, v19
  v_lshlrev_b32 v19, 16, v18
  v_and_b32 v18, 0xffff0000, v18
  v_add_f32 v17, v17, v19
  v_add_f32 v17, v17, v18
  v_lshlrev_b32 v18, 16, v50
  v_and_b32 v19, 0xffff0000, v50
  v_lshlrev_b32 v20, 16, v82
  v_and_b32 v21, 0xffff0000, v82
  v_mul_f32 v18, v18, v20
  v_mul_f32 v19, v19, v21
  v_cvt_pk_bf16_f32 v18, v18, v19
  v_lshlrev_b32 v19, 16, v18
  v_and_b32 v18, 0xffff0000, v18
  v_add_f32 v17, v17, v19
  v_add_f32 v17, v17, v18
  v_lshlrev_b32 v18, 16, v51
  v_and_b32 v19, 0xffff0000, v51
  v_lshlrev_b32 v20, 16, v83
  v_and_b32 v21, 0xffff0000, v83
  v_mul_f32 v18, v18, v20
  v_mul_f32 v19, v19, v21
  v_cvt_pk_bf16_f32 v18, v18, v19
  v_lshlrev_b32 v19, 16, v18
  v_and_b32 v18, 0xffff0000, v18
  v_add_f32 v17, v17, v19
  v_add_f32 v17, v17, v18
  v_lshlrev_b32 v18, 16, v52
  v_and_b32 v19, 0xffff0000, v52
  v_lshlrev_b32 v20, 16, v84
  v_and_b32 v21, 0xffff0000, v84
  v_mul_f32 v18, v18, v20
  v_mul_f32 v19, v19, v21
  v_cvt_pk_bf16_f32 v18, v18, v19
  v_lshlrev_b32 v19, 16, v18
  v_and_b32 v18, 0xffff0000, v18
  v_add_f32 v17, v17, v19
  v_add_f32 v17, v17, v18
  v_lshlrev_b32 v18, 16, v53
  v_and_b32 v19, 0xffff0000, v53
  v_lshlrev_b32 v20, 16, v85
  v_and_b32 v21, 0xffff0000, v85
  v_mul_f32 v18, v18, v20
  v_mul_f32 v19, v19, v21
  v_cvt_pk_bf16_f32 v18, v18, v19
  v_lshlrev_b32 v19, 16, v18
  v_and_b32 v18, 0xffff0000, v18
  v_add_f32 v17, v17, v19
  v_add_f32 v17, v17, v18
  v_lshlrev_b32 v18, 16, v54
  v_and_b32 v19, 0xffff0000, v54
  v_lshlrev_b32 v20, 16, v86
  v_and_b32 v21, 0xffff0000, v86
  v_mul_f32 v18, v18, v20
  v_mul_f32 v19, v19, v21
  v_cvt_pk_bf16_f32 v18, v18, v19
  v_lshlrev_b32 v19, 16, v18
  v_and_b32 v18, 0xffff0000, v18
  v_add_f32 v17, v17, v19
  v_add_f32 v17, v17, v18
  v_lshlrev_b32 v18, 16, v55
  v_and_b32 v19, 0xffff0000, v55
  v_lshlrev_b32 v20, 16, v87
  v_and_b32 v21, 0xffff0000, v87
  v_mul_f32 v18, v18, v20
  v_mul_f32 v19, v19, v21
  v_cvt_pk_bf16_f32 v18, v18, v19
  v_lshlrev_b32 v19, 16, v18
  v_and_b32 v18, 0xffff0000, v18
  v_add_f32 v17, v17, v19
  v_add_f32 v17, v17, v18
  v_lshlrev_b32 v18, 16, v56
  v_and_b32 v19, 0xffff0000, v56
  v_lshlrev_b32 v20, 16, v88
  v_and_b32 v21, 0xffff0000, v88
  v_mul_f32 v18, v18, v20
  v_mul_f32 v19, v19, v21
  v_cvt_pk_bf16_f32 v18, v18, v19
  v_lshlrev_b32 v19, 16, v18
  v_and_b32 v18, 0xffff0000, v18
  v_add_f32 v17, v17, v19
  v_add_f32 v17, v17, v18
  v_lshlrev_b32 v18, 16, v57
  v_and_b32 v19, 0xffff0000, v57
  v_lshlrev_b32 v20, 16, v89
  v_and_b32 v21, 0xffff0000, v89
  v_mul_f32 v18, v18, v20
  v_mul_f32 v19, v19, v21
  v_cvt_pk_bf16_f32 v18, v18, v19
  v_lshlrev_b32 v19, 16, v18
  v_and_b32 v18, 0xffff0000, v18
  v_add_f32 v17, v17, v19
  v_add_f32 v17, v17, v18
  v_lshlrev_b32 v18, 16, v58
  v_and_b32 v19, 0xffff0000, v58
  v_lshlrev_b32 v20, 16, v90
  v_and_b32 v21, 0xffff0000, v90
  v_mul_f32 v18, v18, v20
  v_mul_f32 v19, v19, v21
  v_cvt_pk_bf16_f32 v18, v18, v19
  v_lshlrev_b32 v19, 16, v18
  v_and_b32 v18, 0xffff0000, v18
  v_add_f32 v17, v17, v19
  v_add_f32 v17, v17, v18
  v_lshlrev_b32 v18, 16, v59
  v_and_b32 v19, 0xffff0000, v59
  v_lshlrev_b32 v20, 16, v91
  v_and_b32 v21, 0xffff0000, v91
  v_mul_f32 v18, v18, v20
  v_mul_f32 v19, v19, v21
  v_cvt_pk_bf16_f32 v18, v18, v19
  v_lshlrev_b32 v19, 16, v18
  v_and_b32 v18, 0xffff0000, v18
  v_add_f32 v17, v17, v19
  v_add_f32 v17, v17, v18
  v_lshlrev_b32 v18, 16, v60
  v_and_b32 v19, 0xffff0000, v60
  v_lshlrev_b32 v20, 16, v92
  v_and_b32 v21, 0xffff0000, v92
  v_mul_f32 v18, v18, v20
  v_mul_f32 v19, v19, v21
  v_cvt_pk_bf16_f32 v18, v18, v19
  v_lshlrev_b32 v19, 16, v18
  v_and_b32 v18, 0xffff0000, v18
  v_add_f32 v17, v17, v19
  v_add_f32 v17, v17, v18
  v_lshlrev_b32 v18, 16, v61
  v_and_b32 v19, 0xffff0000, v61
  v_lshlrev_b32 v20, 16, v93
  v_and_b32 v21, 0xffff0000, v93
  v_mul_f32 v18, v18, v20
  v_mul_f32 v19, v19, v21
  v_cvt_pk_bf16_f32 v18, v18, v19
  v_lshlrev_b32 v19, 16, v18
  v_and_b32 v18, 0xffff0000, v18
  v_add_f32 v17, v17, v19
  v_add_f32 v17, v17, v18
  v_lshlrev_b32 v18, 16, v62
  v_and_b32 v19, 0xffff0000, v62
  v_lshlrev_b32 v20, 16, v94
  v_and_b32 v21, 0xffff0000, v94
  v_mul_f32 v18, v18, v20
  v_mul_f32 v19, v19, v21
  v_cvt_pk_bf16_f32 v18, v18, v19
  v_lshlrev_b32 v19, 16, v18
  v_and_b32 v18, 0xffff0000, v18
  v_add_f32 v17, v17, v19
  v_add_f32 v17, v17, v18
  v_lshlrev_b32 v18, 16, v63
  v_and_b32 v19, 0xffff0000, v63
  v_lshlrev_b32 v20, 16, v95
  v_and_b32 v21, 0xffff0000, v95
  v_mul_f32 v18, v18, v20
  v_mul_f32 v19, v19, v21
  v_cvt_pk_bf16_f32 v18, v18, v19
  v_lshlrev_b32 v19, 16, v18
  v_and_b32 v18, 0xffff0000, v18
  v_add_f32 v17, v17, v19
  v_add_f32 v17, v17, v18
  s_nop 1
  v_add_f32_dpp v17, v17, v17 quad_perm:[1,0,3,2] row_mask:0xf bank_mask:0xf
  s_nop 1
  v_add_f32_dpp v17, v17, v17 quad_perm:[2,3,0,1] row_mask:0xf bank_mask:0xf
  s_nop 1
  v_add_f32_dpp v17, v17, v17 row_half_mirror row_mask:0xf bank_mask:0xf
  v_cvt_pk_bf16_f32 v17, v17, v17
  v_lshlrev_b32 v17, 16, v17
  v_mul_f32 v18, 0xbfb8aa3b, v17
  v_exp_f32 v18, v18
  s_nop 0
  v_add_f32 v18, 1.0, v18
  v_rcp_f32 v18, v18
  s_nop 0
  v_cvt_pk_bf16_f32 v18, v18, v18
  v_lshlrev_b32 v18, 16, v18
  v_lshlrev_b32 v19, 2, v13
  v_add_u32 v19, 131072, v19
  ds_write_b32 v19, v18
  s_cmp_lg_u32 s8, 0
  s_cbranch_scc1 L_fwok_148
  s_lshl_b32 s48, s30, 14
  s_add_u32 s48, s48, 8192
  v_lshlrev_b32 v254, 7, v0
  v_add_u32 v254, s48, v254
  s_mov_b32 s49, 0
  s_mov_b32 exec_lo, s54
  s_mov_b32 exec_hi, s55
L_fw_147:
  global_load_dword v255, v254, s[46:47] sc1
  s_add_u32 s49, s49, 1
  s_cmp_gt_u32 s49, 0x20000
  s_cbranch_scc1 L_fwok2_149
  s_waitcnt vmcnt(0)
  v_cmp_ne_u32 vcc, 0, v255
  s_nop 0
  s_and_b32 s50, vcc_lo, s54
  s_and_b32 s51, vcc_hi, s55
  s_xor_b32 s50, s50, s54
  s_xor_b32 s51, s51, s55
  s_or_b32 s50, s50, s51
  s_cmp_eq_u32 s50, 0
  s_cbranch_scc1 L_fwok2_149
  s_sleep 2
  s_branch L_fw_147
L_fwok2_149:
  s_mov_b64 exec, -1
L_fwok_148:
  s_barrier
  s_add_u32 s15, s14, 100663296
  s_add_u32 s44, s4, s15
  s_addc_u32 s45, s5, 0
  global_load_dwordx4 v[160:163], v1, s[44:45] offset:0 sc1
  global_load_dwordx4 v[164:167], v1, s[44:45] offset:1024 sc1
  global_load_dwordx4 v[168:171], v1, s[44:45] offset:2048 sc1
  global_load_dwordx4 v[172:175], v1, s[44:45] offset:3072 sc1
  s_add_u32 s15, s14, 104857600
  s_add_u32 s44, s4, s15
  s_addc_u32 s45, s5, 0
  global_load_dwordx4 v[176:179], v1, s[44:45] offset:0 sc1
  global_load_dwordx4 v[180:183], v1, s[44:45] offset:1024 sc1
  global_load_dwordx4 v[184:187], v1, s[44:45] offset:2048 sc1
  global_load_dwordx4 v[188:191], v1, s[44:45] offset:3072 sc1
  s_add_u32 s15, s14, 109051904
  s_add_u32 s44, s4, s15
  s_addc_u32 s45, s5, 0
  global_load_dwordx4 v[192:195], v1, s[44:45] offset:0 sc1
  global_load_dwordx4 v[196:199], v1, s[44:45] offset:1024 sc1
  global_load_dwordx4 v[200:203], v1, s[44:45] offset:2048 sc1
  global_load_dwordx4 v[204:207], v1, s[44:45] offset:3072 sc1
  s_add_u32 s15, s14, 113246208
  s_add_u32 s44, s4, s15
  s_addc_u32 s45, s5, 0
  global_load_dwordx4 v[208:211], v1, s[44:45] offset:0 sc1
  global_load_dwordx4 v[212:215], v1, s[44:45] offset:1024 sc1
  global_load_dwordx4 v[216:219], v1, s[44:45] offset:2048 sc1
  global_load_dwordx4 v[220:223], v1, s[44:45] offset:3072 sc1
  s_waitcnt lgkmcnt(0)
  s_barrier
  v_and_b32 v19, 31, v0
  v_lshlrev_b32 v20, 2, v19
  v_add_u32 v20, 131072, v20
  ds_read_b32 v18, v20
  s_cmp_lg_u32 s8, 0
  s_cbranch_scc1 L_fwok_151
  s_lshl_b32 s48, s30, 14
  s_add_u32 s48, s48, 8192
  v_lshlrev_b32 v254, 7, v0
  v_add_u32 v254, s48, v254
  s_mov_b32 s49, 0
  s_mov_b32 exec_lo, s54
  s_mov_b32 exec_hi, s57
L_fw_150:
  global_load_dword v255, v254, s[46:47] sc1
  s_add_u32 s49, s49, 1
  s_cmp_gt_u32 s49, 0x20000
  s_cbranch_scc1 L_fwok2_152
  s_waitcnt vmcnt(0)
  v_cmp_ne_u32 vcc, 0, v255
  s_nop 0
  s_and_b32 s50, vcc_lo, s54
  s_and_b32 s51, vcc_hi, s57
  s_xor_b32 s50, s50, s54
  s_xor_b32 s51, s51, s57
  s_or_b32 s50, s50, s51
  s_cmp_eq_u32 s50, 0
  s_cbranch_scc1 L_fwok2_152
  s_sleep 2
  s_branch L_fw_150
L_fwok2_152:
  s_mov_b64 exec, -1
L_fwok_151:
  s_barrier
  s_add_u32 s15, s14, 117440512
  s_add_u32 s44, s4, s15
  s_addc_u32 s45, s5, 0
  global_load_dwordx4 v[32:35], v1, s[44:45] offset:0 sc1
  global_load_dwordx4 v[36:39], v1, s[44:45] offset:1024 sc1
  global_load_dwordx4 v[40:43], v1, s[44:45] offset:2048 sc1
  global_load_dwordx4 v[44:47], v1, s[44:45] offset:3072 sc1
  s_add_u32 s15, s14, 121634816
  s_add_u32 s44, s4, s15
  s_addc_u32 s45, s5, 0
  global_load_dwordx4 v[48:51], v1, s[44:45] offset:0 sc1
  global_load_dwordx4 v[52:55], v1, s[44:45] offset:1024 sc1
  global_load_dwordx4 v[56:59], v1, s[44:45] offset:2048 sc1
  global_load_dwordx4 v[60:63], v1, s[44:45] offset:3072 sc1
  s_add_u32 s15, s14, 125829120
  s_add_u32 s44, s4, s15
  s_addc_u32 s45, s5, 0
  global_load_dwordx4 v[64:67], v1, s[44:45] offset:0 sc1
  global_load_dwordx4 v[68:71], v1, s[44:45] offset:1024 sc1
  global_load_dwordx4 v[72:75], v1, s[44:45] offset:2048 sc1
  global_load_dwordx4 v[76:79], v1, s[44:45] offset:3072 sc1
  s_add_u32 s15, s14, 130023424
  s_add_u32 s44, s4, s15
  s_addc_u32 s45, s5, 0
  global_load_dwordx4 v[80:83], v1, s[44:45] offset:0 sc1
  global_load_dwordx4 v[84:87], v1, s[44:45] offset:1024 sc1
  global_load_dwordx4 v[88:91], v1, s[44:45] offset:2048 sc1
  global_load_dwordx4 v[92:95], v1, s[44:45] offset:3072 sc1
  s_add_u32 s15, s14, 134217728
  s_add_u32 s44, s4, s15
  s_addc_u32 s45, s5, 0
  global_load_dwordx4 v[96:99], v1, s[44:45] offset:0 sc1
  global_load_dwordx4 v[100:103], v1, s[44:45] offset:1024 sc1
  global_load_dwordx4 v[104:107], v1, s[44:45] offset:2048 sc1
  global_load_dwordx4 v[108:111], v1, s[44:45] offset:3072 sc1
  s_add_u32 s15, s14, 138412032
  s_add_u32 s44, s4, s15
  s_addc_u32 s45, s5, 0
  global_load_dwordx4 v[112:115], v1, s[44:45] offset:0 sc1
  global_load_dwordx4 v[116:119], v1, s[44:45] offset:1024 sc1
  global_load_dwordx4 v[120:123], v1, s[44:45] offset:2048 sc1
  global_load_dwordx4 v[124:127], v1, s[44:45] offset:3072 sc1
  s_add_u32 s15, s14, 142606336
  s_add_u32 s44, s4, s15
  s_addc_u32 s45, s5, 0
  global_load_dwordx4 v[128:131], v1, s[44:45] offset:0 sc1
  global_load_dwordx4 v[132:135], v1, s[44:45] offset:1024 sc1
  global_load_dwordx4 v[136:139], v1, s[44:45] offset:2048 sc1
  global_load_dwordx4 v[140:143], v1, s[44:45] offset:3072 sc1
  s_add_u32 s15, s14, 146800640
  s_add_u32 s44, s4, s15
  s_addc_u32 s45, s5, 0
  global_load_dwordx4 v[144:147], v1, s[44:45] offset:0 sc1
  global_load_dwordx4 v[148:151], v1, s[44:45] offset:1024 sc1
  global_load_dwordx4 v[152:155], v1, s[44:45] offset:2048 sc1
  global_load_dwordx4 v[156:159], v1, s[44:45] offset:3072 sc1
  s_waitcnt vmcnt(0) lgkmcnt(0)
  v_sub_f32 v21, 1.0, v18
  v_cvt_pk_bf16_f32 v21, v21, v21
  v_lshlrev_b32 v21, 16, v21
  v_pk_add_f32 v[32:33], v[32:33], v[48:49]
  v_pk_add_f32 v[34:35], v[34:35], v[50:51]
  v_pk_add_f32 v[36:37], v[36:37], v[52:53]
  v_pk_add_f32 v[38:39], v[38:39], v[54:55]
  v_pk_add_f32 v[40:41], v[40:41], v[56:57]
  v_pk_add_f32 v[42:43], v[42:43], v[58:59]
  v_pk_add_f32 v[44:45], v[44:45], v[60:61]
  v_pk_add_f32 v[46:47], v[46:47], v[62:63]
  v_pk_add_f32 v[32:33], v[32:33], v[64:65]
  v_pk_add_f32 v[34:35], v[34:35], v[66:67]
  v_pk_add_f32 v[36:37], v[36:37], v[68:69]
  v_pk_add_f32 v[38:39], v[38:39], v[70:71]
  v_pk_add_f32 v[40:41], v[40:41], v[72:73]
  v_pk_add_f32 v[42:43], v[42:43], v[74:75]
  v_pk_add_f32 v[44:45], v[44:45], v[76:77]
  v_pk_add_f32 v[46:47], v[46:47], v[78:79]
  v_pk_add_f32 v[32:33], v[32:33], v[80:81]
  v_pk_add_f32 v[34:35], v[34:35], v[82:83]
  v_pk_add_f32 v[36:37], v[36:37], v[84:85]
  v_pk_add_f32 v[38:39], v[38:39], v[86:87]
  v_pk_add_f32 v[40:41], v[40:41], v[88:89]
  v_pk_add_f32 v[42:43], v[42:43], v[90:91]
  v_pk_add_f32 v[44:45], v[44:45], v[92:93]
  v_pk_add_f32 v[46:47], v[46:47], v[94:95]
  v_pk_add_f32 v[32:33], v[32:33], v[96:97]
  v_pk_add_f32 v[34:35], v[34:35], v[98:99]
  v_pk_add_f32 v[36:37], v[36:37], v[100:101]
  v_pk_add_f32 v[38:39], v[38:39], v[102:103]
  v_pk_add_f32 v[40:41], v[40:41], v[104:105]
  v_pk_add_f32 v[42:43], v[42:43], v[106:107]
  v_pk_add_f32 v[44:45], v[44:45], v[108:109]
  v_pk_add_f32 v[46:47], v[46:47], v[110:111]
  v_pk_add_f32 v[32:33], v[32:33], v[112:113]
  v_pk_add_f32 v[34:35], v[34:35], v[114:115]
  v_pk_add_f32 v[36:37], v[36:37], v[116:117]
  v_pk_add_f32 v[38:39], v[38:39], v[118:119]
  v_pk_add_f32 v[40:41], v[40:41], v[120:121]
  v_pk_add_f32 v[42:43], v[42:43], v[122:123]
  v_pk_add_f32 v[44:45], v[44:45], v[124:125]
  v_pk_add_f32 v[46:47], v[46:47], v[126:127]
  v_pk_add_f32 v[32:33], v[32:33], v[128:129]
  v_pk_add_f32 v[34:35], v[34:35], v[130:131]
  v_pk_add_f32 v[36:37], v[36:37], v[132:133]
  v_pk_add_f32 v[38:39], v[38:39], v[134:135]
  v_pk_add_f32 v[40:41], v[40:41], v[136:137]
  v_pk_add_f32 v[42:43], v[42:43], v[138:139]
  v_pk_add_f32 v[44:45], v[44:45], v[140:141]
  v_pk_add_f32 v[46:47], v[46:47], v[142:143]
  v_pk_add_f32 v[32:33], v[32:33], v[144:145]
  v_pk_add_f32 v[34:35], v[34:35], v[146:147]
  v_pk_add_f32 v[36:37], v[36:37], v[148:149]
  v_pk_add_f32 v[38:39], v[38:39], v[150:151]
  v_pk_add_f32 v[40:41], v[40:41], v[152:153]
  v_pk_add_f32 v[42:43], v[42:43], v[154:155]
  v_pk_add_f32 v[44:45], v[44:45], v[156:157]
  v_pk_add_f32 v[46:47], v[46:47], v[158:159]
  v_pk_add_f32 v[160:161], v[160:161], v[176:177]
  v_pk_add_f32 v[162:163], v[162:163], v[178:179]
  v_pk_add_f32 v[164:165], v[164:165], v[180:181]
  v_pk_add_f32 v[166:167], v[166:167], v[182:183]
  v_pk_add_f32 v[168:169], v[168:169], v[184:185]
  v_pk_add_f32 v[170:171], v[170:171], v[186:187]
  v_pk_add_f32 v[172:173], v[172:173], v[188:189]
  v_pk_add_f32 v[174:175], v[174:175], v[190:191]
  v_pk_add_f32 v[160:161], v[160:161], v[192:193]
  v_pk_add_f32 v[162:163], v[162:163], v[194:195]
  v_pk_add_f32 v[164:165], v[164:165], v[196:197]
  v_pk_add_f32 v[166:167], v[166:167], v[198:199]
  v_pk_add_f32 v[168:169], v[168:169], v[200:201]
  v_pk_add_f32 v[170:171], v[170:171], v[202:203]
  v_pk_add_f32 v[172:173], v[172:173], v[204:205]
  v_pk_add_f32 v[174:175], v[174:175], v[206:207]
  v_pk_add_f32 v[160:161], v[160:161], v[208:209]
  v_pk_add_f32 v[162:163], v[162:163], v[210:211]
  v_pk_add_f32 v[164:165], v[164:165], v[212:213]
  v_pk_add_f32 v[166:167], v[166:167], v[214:215]
  v_pk_add_f32 v[168:169], v[168:169], v[216:217]
  v_pk_add_f32 v[170:171], v[170:171], v[218:219]
  v_pk_add_f32 v[172:173], v[172:173], v[220:221]
  v_pk_add_f32 v[174:175], v[174:175], v[222:223]
  v_cvt_pk_bf16_f32 v22, v32, v33
  v_cvt_pk_bf16_f32 v23, v160, v161
  v_lshlrev_b32 v48, 16, v22
  v_and_b32 v49, 0xffff0000, v22
  v_lshlrev_b32 v50, 16, v23
  v_and_b32 v51, 0xffff0000, v23
  v_mul_f32 v48, v48, v18
  v_mul_f32 v49, v49, v18
  v_mul_f32 v50, v50, v21
  v_mul_f32 v51, v51, v21
  v_cvt_pk_bf16_f32 v22, v48, v49
  v_cvt_pk_bf16_f32 v23, v50, v51
  v_lshlrev_b32 v48, 16, v22
  v_and_b32 v49, 0xffff0000, v22
  v_lshlrev_b32 v50, 16, v23
  v_and_b32 v51, 0xffff0000, v23
  v_pk_add_f32 v[48:49], v[48:49], v[50:51]
  v_cvt_pk_bf16_f32 v56, v48, v49
  v_cvt_pk_bf16_f32 v22, v34, v35
  v_cvt_pk_bf16_f32 v23, v162, v163
  v_lshlrev_b32 v48, 16, v22
  v_and_b32 v49, 0xffff0000, v22
  v_lshlrev_b32 v50, 16, v23
  v_and_b32 v51, 0xffff0000, v23
  v_mul_f32 v48, v48, v18
  v_mul_f32 v49, v49, v18
  v_mul_f32 v50, v50, v21
  v_mul_f32 v51, v51, v21
  v_cvt_pk_bf16_f32 v22, v48, v49
  v_cvt_pk_bf16_f32 v23, v50, v51
  v_lshlrev_b32 v48, 16, v22
  v_and_b32 v49, 0xffff0000, v22
  v_lshlrev_b32 v50, 16, v23
  v_and_b32 v51, 0xffff0000, v23
  v_pk_add_f32 v[48:49], v[48:49], v[50:51]
  v_cvt_pk_bf16_f32 v57, v48, v49
  v_cvt_pk_bf16_f32 v22, v36, v37
  v_cvt_pk_bf16_f32 v23, v164, v165
  v_lshlrev_b32 v48, 16, v22
  v_and_b32 v49, 0xffff0000, v22
  v_lshlrev_b32 v50, 16, v23
  v_and_b32 v51, 0xffff0000, v23
  v_mul_f32 v48, v48, v18
  v_mul_f32 v49, v49, v18
  v_mul_f32 v50, v50, v21
  v_mul_f32 v51, v51, v21
  v_cvt_pk_bf16_f32 v22, v48, v49
  v_cvt_pk_bf16_f32 v23, v50, v51
  v_lshlrev_b32 v48, 16, v22
  v_and_b32 v49, 0xffff0000, v22
  v_lshlrev_b32 v50, 16, v23
  v_and_b32 v51, 0xffff0000, v23
  v_pk_add_f32 v[48:49], v[48:49], v[50:51]
  v_cvt_pk_bf16_f32 v58, v48, v49
  v_cvt_pk_bf16_f32 v22, v38, v39
  v_cvt_pk_bf16_f32 v23, v166, v167
  v_lshlrev_b32 v48, 16, v22
  v_and_b32 v49, 0xffff0000, v22
  v_lshlrev_b32 v50, 16, v23
  v_and_b32 v51, 0xffff0000, v23
  v_mul_f32 v48, v48, v18
  v_mul_f32 v49, v49, v18
  v_mul_f32 v50, v50, v21
  v_mul_f32 v51, v51, v21
  v_cvt_pk_bf16_f32 v22, v48, v49
  v_cvt_pk_bf16_f32 v23, v50, v51
  v_lshlrev_b32 v48, 16, v22
  v_and_b32 v49, 0xffff0000, v22
  v_lshlrev_b32 v50, 16, v23
  v_and_b32 v51, 0xffff0000, v23
  v_pk_add_f32 v[48:49], v[48:49], v[50:51]
  v_cvt_pk_bf16_f32 v59, v48, v49
  v_cvt_pk_bf16_f32 v22, v40, v41
  v_cvt_pk_bf16_f32 v23, v168, v169
  v_lshlrev_b32 v48, 16, v22
  v_and_b32 v49, 0xffff0000, v22
  v_lshlrev_b32 v50, 16, v23
  v_and_b32 v51, 0xffff0000, v23
  v_mul_f32 v48, v48, v18
  v_mul_f32 v49, v49, v18
  v_mul_f32 v50, v50, v21
  v_mul_f32 v51, v51, v21
  v_cvt_pk_bf16_f32 v22, v48, v49
  v_cvt_pk_bf16_f32 v23, v50, v51
  v_lshlrev_b32 v48, 16, v22
  v_and_b32 v49, 0xffff0000, v22
  v_lshlrev_b32 v50, 16, v23
  v_and_b32 v51, 0xffff0000, v23
  v_pk_add_f32 v[48:49], v[48:49], v[50:51]
  v_cvt_pk_bf16_f32 v60, v48, v49
  v_cvt_pk_bf16_f32 v22, v42, v43
  v_cvt_pk_bf16_f32 v23, v170, v171
  v_lshlrev_b32 v48, 16, v22
  v_and_b32 v49, 0xffff0000, v22
  v_lshlrev_b32 v50, 16, v23
  v_and_b32 v51, 0xffff0000, v23
  v_mul_f32 v48, v48, v18
  v_mul_f32 v49, v49, v18
  v_mul_f32 v50, v50, v21
  v_mul_f32 v51, v51, v21
  v_cvt_pk_bf16_f32 v22, v48, v49
  v_cvt_pk_bf16_f32 v23, v50, v51
  v_lshlrev_b32 v48, 16, v22
  v_and_b32 v49, 0xffff0000, v22
  v_lshlrev_b32 v50, 16, v23
  v_and_b32 v51, 0xffff0000, v23
  v_pk_add_f32 v[48:49], v[48:49], v[50:51]
  v_cvt_pk_bf16_f32 v61, v48, v49
  v_cvt_pk_bf16_f32 v22, v44, v45
  v_cvt_pk_bf16_f32 v23, v172, v173
  v_lshlrev_b32 v48, 16, v22
  v_and_b32 v49, 0xffff0000, v22
  v_lshlrev_b32 v50, 16, v23
  v_and_b32 v51, 0xffff0000, v23
  v_mul_f32 v48, v48, v18
  v_mul_f32 v49, v49, v18
  v_mul_f32 v50, v50, v21
  v_mul_f32 v51, v51, v21
  v_cvt_pk_bf16_f32 v22, v48, v49
  v_cvt_pk_bf16_f32 v23, v50, v51
  v_lshlrev_b32 v48, 16, v22
  v_and_b32 v49, 0xffff0000, v22
  v_lshlrev_b32 v50, 16, v23
  v_and_b32 v51, 0xffff0000, v23
  v_pk_add_f32 v[48:49], v[48:49], v[50:51]
  v_cvt_pk_bf16_f32 v62, v48, v49
  v_cvt_pk_bf16_f32 v22, v46, v47
  v_cvt_pk_bf16_f32 v23, v174, v175
  v_lshlrev_b32 v48, 16, v22
  v_and_b32 v49, 0xffff0000, v22
  v_lshlrev_b32 v50, 16, v23
  v_and_b32 v51, 0xffff0000, v23
  v_mul_f32 v48, v48, v18
  v_mul_f32 v49, v49, v18
  v_mul_f32 v50, v50, v21
  v_mul_f32 v51, v51, v21
  v_cvt_pk_bf16_f32 v22, v48, v49
  v_cvt_pk_bf16_f32 v23, v50, v51
  v_lshlrev_b32 v48, 16, v22
  v_and_b32 v49, 0xffff0000, v22
  v_lshlrev_b32 v50, 16, v23
  v_and_b32 v51, 0xffff0000, v23
  v_pk_add_f32 v[48:49], v[48:49], v[50:51]
  v_cvt_pk_bf16_f32 v63, v48, v49
  s_lshr_b32 s12, s36, 1
  s_lshl_b32 s12, s12, 9
  s_and_b32 s13, s36, 1
  s_lshl_b32 s13, s13, 6
  s_add_u32 s12, s12, s13
  s_lshl_b32 s13, s8, 7
  s_add_u32 s12, s12, s13
  s_lshl_b32 s13, s30, 15
  s_add_u32 s12, s12, s13
  s_add_u32 s44, s78, s12
  s_addc_u32 s45, s79, 0
  v_lshrrev_b32 v20, 5, v0
  v_lshlrev_b32 v20, 4, v20
  v_lshl_add_u32 v20, v19, 10, v20
  global_store_dwordx4 v20, v[56:59], s[44:45] sc1
  global_store_dwordx4 v20, v[60:63], s[44:45] offset:32 sc1
  s_barrier
  s_add_u32 s59, s59, 64
  s_cmp_lt_u32 s59, 256
  s_cbranch_scc1 L_w4loop
L_wend:
  s_waitcnt vmcnt(0)
L_exit:
  s_endpgm
L_code_end:
.fill 6144, 4, 0xbf800000
.section .rodata,"a"
.p2align 6
.amdhsa_kernel gated_mix__memory_aug_recurrent_mem_tr__glu_gated_swiglu__prompt_kernel
  .amdhsa_next_free_vgpr 512
  .amdhsa_next_free_sgpr 102
  .amdhsa_accum_offset 256
  .amdhsa_group_segment_fixed_size 0
  .amdhsa_kernarg_size 120
  .amdhsa_user_sgpr_count 2
  .amdhsa_user_sgpr_kernarg_segment_ptr 1
  .amdhsa_system_sgpr_workgroup_id_x 1
.end_amdhsa_kernel
```
